```python
import torch

def _softmax(x, axis=-1):
    return torch.softmax(x, dim=axis)
def _gelu(x):
    return torch.nn.functional.gelu(x, approximate="tanh")
def _silu(x):
    return torch.nn.functional.silu(x)
def _sigmoid(x):
    return torch.sigmoid(x)
def _layernorm(x, axis=-1, eps=1e-5):
    m = x.mean(dim=axis, keepdim=True)
    v = x.var(dim=axis, keepdim=True, unbiased=False)
    return (x - m) / torch.sqrt(v + eps)
def _scatter_add(tgt, idx, src, axis=0):
    return tgt.clone().index_add_(axis, idx, src)
def _segment_sum(src, seg, n):
    out = torch.zeros((n,) + src.shape[1:], dtype=src.dtype)
    return out.index_add_(0, seg, src)
def _pad(x, pw):
    flat = tuple(v for pair in reversed(pw) for v in pair)
    return torch.nn.functional.pad(x, flat)

kernel_name = 'recurrent_scan__mha_block_cached__glu_gated_bilinear__prompt'

def setup_inputs():

    _w = (lambda a: (lambda t: t.to(torch.bfloat16) if t.is_floating_point() else t)(torch.as_tensor(a)))
    def _A_setup():
        B, Sq, D = 1, 2048, 576
        H, Sk, Dh = 32, 2048, 128
        return {
            "x": _w((lambda *s: torch.randn(*s, dtype=torch.bfloat16) * 0.05)(B, Sq, D)),
            "k_cache": _w((lambda *s: torch.randn(*s, dtype=torch.bfloat16) * 1.6)(B, H, Sk, Dh)),
            "v_cache": _w((lambda *s: torch.randn(*s, dtype=torch.bfloat16) * 1.6)(B, H, Sk, Dh)),
            "wq": _w((lambda *s: torch.randn(*s, dtype=torch.bfloat16) * 1.6)(D, H * Dh) * (D ** -0.5)),
            "wo": _w((lambda *s: torch.randn(*s, dtype=torch.bfloat16) * 1.6)(H * Dh, D) * ((H * Dh) ** -0.5)),
        }
    _A_in = _A_setup()

    def _B_setup():
        B, S, D, F = 1, 2048, 576, 4608
        return {
            "x": _w((lambda *s: torch.randn(*s, dtype=torch.bfloat16) * 0.05)(B, S, D)),
            "w_gate": _w((lambda *s: torch.randn(*s, dtype=torch.bfloat16) * 0.2)(D, F) * (D ** -0.5)),
            "w_up": _w((lambda *s: torch.randn(*s, dtype=torch.bfloat16) * 0.2)(D, F) * (D ** -0.5)),
            "w_down": _w((lambda *s: torch.randn(*s, dtype=torch.bfloat16) * 0.2)(F, D) * (F ** -0.5)),
        }
    _B_in = _B_setup()

    return {
        "A_x": _A_in["x"],
        "A_k_cache": _A_in["k_cache"],
        "A_v_cache": _A_in["v_cache"],
        "A_wq": _A_in["wq"],
        "A_wo": _A_in["wo"],
        "B_x": _B_in["x"],
        "B_w_gate": _B_in["w_gate"],
        "B_w_up": _B_in["w_up"],
        "B_w_down": _B_in["w_down"],
    }

def reference(A_x, A_k_cache, A_v_cache, A_wq, A_wo, B_x, B_w_gate, B_w_up, B_w_down):
    def _A_ref(x, k_cache, v_cache, wq, wo):
        B, Sq, D = x.shape
        H, Dh = 32, 128
        q = (lambda x, *d: x.permute(*d))((x @ wq).reshape(B, Sq, H, Dh), 0, 2, 1, 3)
        scores = torch.einsum("bhqd,bhkd->bhqk", q, k_cache) * (Dh ** -0.5)
        p = _softmax(scores, axis=-1)
        o = torch.einsum("bhqk,bhkd->bhqd", p, v_cache)
        return (lambda x, *d: x.permute(*d))(o, 0, 2, 1, 3).reshape(B, Sq, H * Dh) @ wo

    def _B_ref(x, w_gate, w_up, w_down):
        g = torch.einsum("bsd,df->bsf", x, w_gate)
        u = torch.einsum("bsd,df->bsf", x, w_up)
        h = g * u
        return torch.einsum("bsf,fd->bsd", h, w_down)

    x = A_x
    xn = _layernorm(x, axis=-1)
    s = _A_ref(xn, A_k_cache, A_v_cache, A_wq, A_wo)
    g = _silu(_B_ref(xn, B_w_gate, B_w_up, B_w_down))
    return x + s * g
```

```asm
; @launch grid=(256,1,1) block=(256,1,1) lds=163840
.amdgcn_target "amdgcn-amd-amdhsa--gfx950"
.text

.globl recurrent_scan__mha_block_cached__glu_gated_bilinear__prompt_kernel
.p2align 8
.type recurrent_scan__mha_block_cached__glu_gated_bilinear__prompt_kernel,@function
recurrent_scan__mha_block_cached__glu_gated_bilinear__prompt_kernel:
    s_cmp_ge_u32 s2, 256
    s_cbranch_scc1 L_at_end
    s_getpc_b64 s[20:21]
    s_mov_b32 s22, 0x4000
    s_mov_b32 s23, 0x00020000
    v_lshlrev_b32 v1, 4, v0
    buffer_load_dwordx4 v[124:127], v1, s[20:23], 0 offen
    v_add_u32 v1, 4096, v1
    buffer_load_dwordx4 v[128:131], v1, s[20:23], 0 offen
    s_load_dwordx2 s[56:57], s[0:1], 0
    s_load_dwordx4 s[64:67], s[0:1], 8
    s_load_dwordx4 s[68:71], s[0:1], 24
    s_load_dwordx4 s[72:75], s[0:1], 48
    s_load_dwordx2 s[78:79], s[0:1], 64
    s_load_dwordx2 s[58:59], s[0:1], 80
    s_load_dwordx2 s[76:77], s[0:1], 88
    v_lshrrev_b32 v248, 6, v0
    v_and_b32 v0, 63, v0
    v_readfirstlane_b32 s3, v248
    s_and_b32 s4, s2, 7
    s_lshl_b32 s4, s4, 2
    s_bfe_u32 s5, s2, 0x20003
    s_add_u32 s4, s4, s5
    s_lshr_b32 s5, s2, 5
    v_lshlrev_b32 v1, 4, v0
    v_and_b32 v110, 7, v0
    v_bfe_u32 v111, v0, 3, 2
    v_lshrrev_b32 v112, 5, v0
    v_mul_u32_u24 v113, 1152, v110
    v_lshl_add_u32 v113, v111, 3, v113
    v_lshl_add_u32 v113, v112, 6, v113
    s_lshl_b32 s52, s5, 5
    s_add_u32 s52, s52, s4
    s_mul_i32 s52, s52, 9216
    s_lshl_b32 s53, s3, 7
    s_add_u32 s52, s52, s53
    s_cmp_eq_u32 s3, 3
    s_cselect_b32 s53, 0x40000000, 0
    s_or_b32 s52, s52, s53
    s_getpc_b64 s[20:21]
L_at_pc:
    s_sub_u32 s20, s20, L_at_pc-recurrent_scan__mha_block_cached__glu_gated_bilinear__prompt_kernel
    s_subb_u32 s21, s21, 0
    s_mov_b32 s22, L_at_codeend-recurrent_scan__mha_block_cached__glu_gated_bilinear__prompt_kernel
    s_mov_b32 s23, 0x00020000
    s_lshr_b32 s54, s2, 3
    s_lshl_b32 s54, s54, 2
    s_add_u32 s54, s54, s3
    s_mul_i32 s54, s54, 768
    s_waitcnt lgkmcnt(0)
    s_mov_b32 s28, s56
    s_mov_b32 s29, s57
    s_mov_b32 s30, 2359296
    s_mov_b32 s31, 0x00020000
    buffer_load_dwordx2 v[64:65], v113, s[28:31], s52 offen offset:0
    buffer_load_dwordx2 v[66:67], v113, s[28:31], s52 offen offset:32
    buffer_load_dwordx2 v[68:69], v113, s[28:31], s52 offen offset:384
    buffer_load_dwordx2 v[70:71], v113, s[28:31], s52 offen offset:416
    buffer_load_dwordx2 v[72:73], v113, s[28:31], s52 offen offset:768
    buffer_load_dwordx2 v[74:75], v113, s[28:31], s52 offen offset:800
    buffer_load_dwordx4 v[120:123], v1, s[20:23], s54 offen
    s_cmp_lg_u32 s3, 3
    s_cbranch_scc1 L_at_nopf
    s_add_u32 s24, s76, 62914560
    s_addc_u32 s25, s77, 0
    s_mov_b32 s26, 16384
    s_mov_b32 s27, 0x00020000
    s_mov_b32 s32, s58
    s_mov_b32 s33, s59
    s_mov_b32 s34, 256
    s_mov_b32 s35, 0x00020000
    v_lshlrev_b32 v116, 7, v0
    v_mov_b32 v117, 0
    s_cmp_eq_u32 s4, 0
    s_cselect_b32 s50, 0, 0x40000000
    s_lshl_b32 s55, s5, 11
    s_or_b32 s55, s55, s50
    s_mov_b64 exec, 0xffff
    buffer_store_dword v117, v116, s[24:27], s55 offen sc1
    s_mov_b64 exec, -1
    s_mov_b32 s28, s72
    s_mov_b32 s29, s73
    s_mov_b32 s30, 5308416
    s_mov_b32 s31, 0x00020000
    s_mov_b32 s12, s74
    s_mov_b32 s13, s75
    s_mov_b32 s14, 5308416
    s_mov_b32 s15, 0x00020000
    s_lshr_b32 s53, s2, 3
    s_mul_i32 s52, s53, 165888
    s_and_b32 s55, s2, 7
    s_lshl_b32 s54, s55, 7
    s_add_u32 s54, s54, s52
    s_add_u32 s54, s54, 8192
    s_lshl_b32 s55, s55, 10
    s_add_u32 s52, s52, s55
    v_mul_u32_u24 v113, 9216, v112
    v_lshl_add_u32 v113, v111, 8, v113
    v_lshl_add_u32 v113, v110, 4, v113
    v_lshrrev_b32 v111, 3, v0
    v_mul_u32_u24 v111, 9216, v111
    v_lshl_add_u32 v111, v110, 4, v111
    buffer_load_dwordx4 a[0:3], v113, s[28:31], s52 offen nt
    buffer_load_dwordx4 a[4:7], v113, s[12:15], s52 offen nt
    s_add_u32 s52, s52, 18432
    buffer_load_dwordx4 a[8:11], v111, s[28:31], s54 offen nt
    buffer_load_dwordx4 a[12:15], v111, s[12:15], s54 offen nt
    s_add_u32 s54, s54, 73728
    buffer_load_dwordx4 a[16:19], v113, s[28:31], s52 offen nt
    buffer_load_dwordx4 a[20:23], v113, s[12:15], s52 offen nt
    s_add_u32 s52, s52, 18432
    buffer_load_dwordx4 a[24:27], v113, s[28:31], s52 offen nt
    buffer_load_dwordx4 a[28:31], v113, s[12:15], s52 offen nt
    s_add_u32 s52, s52, 18432
    buffer_load_dwordx4 a[32:35], v113, s[28:31], s52 offen nt
    buffer_load_dwordx4 a[36:39], v113, s[12:15], s52 offen nt
    s_add_u32 s52, s52, 18432
    buffer_load_dwordx4 a[40:43], v113, s[28:31], s52 offen nt
    buffer_load_dwordx4 a[44:47], v113, s[12:15], s52 offen nt
    s_add_u32 s52, s52, 18432
    buffer_load_dwordx4 a[48:51], v111, s[28:31], s54 offen nt
    buffer_load_dwordx4 a[52:55], v111, s[12:15], s54 offen nt
    s_add_u32 s54, s54, 73728
    buffer_load_dwordx4 a[56:59], v113, s[28:31], s52 offen nt
    buffer_load_dwordx4 a[60:63], v113, s[12:15], s52 offen nt
    s_add_u32 s52, s52, 18432
    buffer_load_dwordx4 a[64:67], v113, s[28:31], s52 offen nt
    buffer_load_dwordx4 a[68:71], v113, s[12:15], s52 offen nt
    s_add_u32 s52, s52, 18432
    buffer_load_dwordx4 a[72:75], v113, s[28:31], s52 offen nt
    buffer_load_dwordx4 a[76:79], v113, s[12:15], s52 offen nt
    s_add_u32 s52, s52, 18432
    buffer_load_dwordx4 a[80:83], v113, s[28:31], s52 offen nt
    buffer_load_dwordx4 a[84:87], v113, s[12:15], s52 offen nt
    s_add_u32 s52, s52, 18432
    buffer_load_dwordx4 a[88:91], v111, s[28:31], s54 offen nt
    buffer_load_dwordx4 a[92:95], v111, s[12:15], s54 offen nt
    s_add_u32 s54, s54, 73728
    s_lshl_b32 s55, s5, 5
    s_or_b32 s55, s55, s50
    v_mov_b32 v117, 1
    s_waitcnt vmcnt(24)
    s_mov_b64 exec, 1
    buffer_store_dword v117, off, s[32:35], s55 sc1
    s_mov_b64 exec, -1
    s_barrier
    s_branch L_at_setup
L_at_nopf:
    s_mov_b32 s8, s76
    s_mov_b32 s9, s77
    s_mov_b32 s10, 2359296
    s_mov_b32 s11, 0x00020000
    s_mov_b32 s32, s58
    s_mov_b32 s33, s59
    s_mov_b32 s34, 256
    s_mov_b32 s35, 0x00020000
    v_lshlrev_b32 v114, 5, v110
    v_add_u32 v114, 122880, v114
    s_lshl_b32 s52, s3, 3
    v_add_u32 v115, s52, v114
    v_lshlrev_b32 v113, 4, v110
    v_lshl_add_u32 v113, v111, 8, v113
    v_lshl_add_u32 v113, v112, 10, v113
    s_lshl_b32 s52, s5, 4
    s_lshr_b32 s53, s4, 1
    s_add_u32 s52, s52, s53
    s_mul_i32 s52, s52, 18432
    s_and_b32 s53, s4, 1
    s_lshl_b32 s53, s53, 7
    s_add_u32 s52, s52, s53
    s_lshl_b32 s53, s3, 11
    s_add_u32 s52, s52, s53
    s_add_u32 s53, s52, 6144
    s_add_u32 s54, s52, 12288
    s_lshl_b32 s55, s5, 5
    s_waitcnt vmcnt(6)
    v_lshlrev_b32 v80, 16, v64
    v_and_b32 v81, 0xffff0000, v64
    v_lshlrev_b32 v82, 16, v65
    v_and_b32 v83, 0xffff0000, v65
    s_waitcnt vmcnt(5)
    v_lshlrev_b32 v84, 16, v66
    v_and_b32 v85, 0xffff0000, v66
    v_lshlrev_b32 v86, 16, v67
    v_and_b32 v87, 0xffff0000, v67
    s_waitcnt vmcnt(4)
    v_lshlrev_b32 v88, 16, v68
    v_and_b32 v89, 0xffff0000, v68
    v_lshlrev_b32 v90, 16, v69
    v_and_b32 v91, 0xffff0000, v69
    s_waitcnt vmcnt(3)
    v_lshlrev_b32 v92, 16, v70
    v_and_b32 v93, 0xffff0000, v70
    v_lshlrev_b32 v94, 16, v71
    v_and_b32 v95, 0xffff0000, v71
    s_waitcnt vmcnt(2)
    v_lshlrev_b32 v96, 16, v72
    v_and_b32 v97, 0xffff0000, v72
    v_lshlrev_b32 v98, 16, v73
    v_and_b32 v99, 0xffff0000, v73
    s_waitcnt vmcnt(1)
    v_lshlrev_b32 v100, 16, v74
    v_and_b32 v101, 0xffff0000, v74
    v_lshlrev_b32 v102, 16, v75
    v_and_b32 v103, 0xffff0000, v75
    v_add_f32 v104, v80, v81
    v_add_f32 v106, v82, v83
    v_add_f32 v104, v104, v84
    v_add_f32 v106, v106, v85
    v_add_f32 v104, v104, v86
    v_add_f32 v106, v106, v87
    v_add_f32 v104, v104, v88
    v_add_f32 v106, v106, v89
    v_add_f32 v104, v104, v90
    v_add_f32 v106, v106, v91
    v_add_f32 v104, v104, v92
    v_add_f32 v106, v106, v93
    v_add_f32 v104, v104, v94
    v_add_f32 v106, v106, v95
    v_add_f32 v104, v104, v96
    v_add_f32 v106, v106, v97
    v_add_f32 v104, v104, v98
    v_add_f32 v106, v106, v99
    v_add_f32 v104, v104, v100
    v_add_f32 v106, v106, v101
    v_add_f32 v104, v104, v102
    v_add_f32 v106, v106, v103
    v_add_f32 v104, v104, v106
    s_nop 1
    v_add_f32_dpp v104, v104, v104 row_ror:8 row_mask:0xf bank_mask:0xf
    v_mov_b32 v106, v104
    s_nop 1
    v_permlane16_swap_b32 v104, v106
    v_add_f32 v104, v104, v106
    v_mov_b32 v106, v104
    s_nop 1
    v_permlane32_swap_b32 v104, v106
    v_add_f32 v104, v104, v106
    v_mul_f32 v104, 0x3baaaaab, v104
    v_sub_f32 v80, v80, v104
    v_sub_f32 v81, v81, v104
    v_sub_f32 v82, v82, v104
    v_sub_f32 v83, v83, v104
    v_sub_f32 v84, v84, v104
    v_sub_f32 v85, v85, v104
    v_sub_f32 v86, v86, v104
    v_sub_f32 v87, v87, v104
    v_sub_f32 v88, v88, v104
    v_sub_f32 v89, v89, v104
    v_sub_f32 v90, v90, v104
    v_sub_f32 v91, v91, v104
    v_sub_f32 v92, v92, v104
    v_sub_f32 v93, v93, v104
    v_sub_f32 v94, v94, v104
    v_sub_f32 v95, v95, v104
    v_sub_f32 v96, v96, v104
    v_sub_f32 v97, v97, v104
    v_sub_f32 v98, v98, v104
    v_sub_f32 v99, v99, v104
    v_sub_f32 v100, v100, v104
    v_sub_f32 v101, v101, v104
    v_sub_f32 v102, v102, v104
    v_sub_f32 v103, v103, v104
    v_mul_f32 v105, v80, v80
    v_mul_f32 v106, v81, v81
    v_fmac_f32 v105, v82, v82
    v_fmac_f32 v106, v83, v83
    v_fmac_f32 v105, v84, v84
    v_fmac_f32 v106, v85, v85
    v_fmac_f32 v105, v86, v86
    v_fmac_f32 v106, v87, v87
    v_fmac_f32 v105, v88, v88
    v_fmac_f32 v106, v89, v89
    v_fmac_f32 v105, v90, v90
    v_fmac_f32 v106, v91, v91
    v_fmac_f32 v105, v92, v92
    v_fmac_f32 v106, v93, v93
    v_fmac_f32 v105, v94, v94
    v_fmac_f32 v106, v95, v95
    v_fmac_f32 v105, v96, v96
    v_fmac_f32 v106, v97, v97
    v_fmac_f32 v105, v98, v98
    v_fmac_f32 v106, v99, v99
    v_fmac_f32 v105, v100, v100
    v_fmac_f32 v106, v101, v101
    v_fmac_f32 v105, v102, v102
    v_fmac_f32 v106, v103, v103
    v_add_f32 v105, v105, v106
    s_nop 1
    v_add_f32_dpp v105, v105, v105 row_ror:8 row_mask:0xf bank_mask:0xf
    v_mov_b32 v106, v105
    s_nop 1
    v_permlane16_swap_b32 v105, v106
    v_add_f32 v105, v105, v106
    v_mov_b32 v106, v105
    s_nop 1
    v_permlane32_swap_b32 v105, v106
    v_add_f32 v105, v105, v106
    ds_write_b64 v115, v[104:105]
    s_waitcnt lgkmcnt(0)
    s_barrier
    ds_read_b128 v[64:67], v114
    ds_read_b64 v[68:69], v114 offset:16
    s_waitcnt lgkmcnt(1)
    v_add_f32 v106, v64, v66
    s_waitcnt lgkmcnt(0)
    v_add_f32 v106, v106, v68
    v_mul_f32 v106, 0x3eaaaaab, v106
    v_add_f32 v105, v65, v67
    v_add_f32 v105, v105, v69
    v_mul_f32 v105, 0x3ae38e39, v105
    v_sub_f32 v64, v64, v106
    v_sub_f32 v66, v66, v106
    v_sub_f32 v68, v68, v106
    v_mul_f32 v65, v64, v64
    v_fmac_f32 v65, v66, v66
    v_fmac_f32 v65, v68, v68
    v_fmac_f32 v105, 0x3eaaaaab, v65
    v_add_f32 v105, 0x3727c5ac, v105
    v_rsq_f32 v105, v105
    v_sub_f32 v104, v104, v106
    v_mul_f32 v105, 0x3e0293ee, v105
    v_mul_f32 v104, v104, v105
    v_fma_f32 v80, v80, v105, v104
    v_fma_f32 v81, v81, v105, v104
    v_fma_f32 v82, v82, v105, v104
    v_fma_f32 v83, v83, v105, v104
    v_fma_f32 v84, v84, v105, v104
    v_fma_f32 v85, v85, v105, v104
    v_fma_f32 v86, v86, v105, v104
    v_fma_f32 v87, v87, v105, v104
    v_cvt_pk_bf16_f32 v64, v80, v81
    v_cvt_pk_bf16_f32 v65, v82, v83
    v_cvt_pk_bf16_f32 v66, v84, v85
    v_cvt_pk_bf16_f32 v67, v86, v87
    buffer_store_dwordx4 v[64:67], v113, s[8:11], s52 offen sc1
    v_fma_f32 v88, v88, v105, v104
    v_fma_f32 v89, v89, v105, v104
    v_fma_f32 v90, v90, v105, v104
    v_fma_f32 v91, v91, v105, v104
    v_fma_f32 v92, v92, v105, v104
    v_fma_f32 v93, v93, v105, v104
    v_fma_f32 v94, v94, v105, v104
    v_fma_f32 v95, v95, v105, v104
    v_cvt_pk_bf16_f32 v68, v88, v89
    v_cvt_pk_bf16_f32 v69, v90, v91
    v_cvt_pk_bf16_f32 v70, v92, v93
    v_cvt_pk_bf16_f32 v71, v94, v95
    buffer_store_dwordx4 v[68:71], v113, s[8:11], s53 offen sc1
    v_fma_f32 v96, v96, v105, v104
    v_fma_f32 v97, v97, v105, v104
    v_fma_f32 v98, v98, v105, v104
    v_fma_f32 v99, v99, v105, v104
    v_fma_f32 v100, v100, v105, v104
    v_fma_f32 v101, v101, v105, v104
    v_fma_f32 v102, v102, v105, v104
    v_fma_f32 v103, v103, v105, v104
    v_cvt_pk_bf16_f32 v72, v96, v97
    v_cvt_pk_bf16_f32 v73, v98, v99
    v_cvt_pk_bf16_f32 v74, v100, v101
    v_cvt_pk_bf16_f32 v75, v102, v103
    buffer_store_dwordx4 v[72:75], v113, s[8:11], s54 offen sc1
    buffer_load_dword v119, off, s[32:35], s55 sc1
L_at_setup:
    s_mul_i32 s62, s4, 224
    s_sub_u32 s62, 8064, s62
    v_add_u32 v249, 0, v0
    v_mul_u32_u24 v250, 205, v249
    v_lshrrev_b32 v250, 11, v250
    v_mul_u32_u24 v251, 10, v250
    v_sub_u32 v251, v249, v251
    v_mul_u32_u24 v250, 9216, v250
    v_lshl_add_u32 v250, v251, 4, v250
    v_lshrrev_b32 v251, 3, v251
    v_mad_u32_u24 v250, v251, s62, v250
    v_mov_b32 v118, v251
    v_subrev_u32 v20, 0, v250
    v_add_u32 v249, 64, v0
    v_mul_u32_u24 v250, 205, v249
    v_lshrrev_b32 v250, 11, v250
    v_mul_u32_u24 v251, 10, v250
    v_sub_u32 v251, v249, v251
    v_mul_u32_u24 v250, 9216, v250
    v_lshl_add_u32 v250, v251, 4, v250
    v_lshrrev_b32 v251, 3, v251
    v_mad_u32_u24 v250, v251, s62, v250
    v_lshl_or_b32 v118, v251, 1, v118
    v_subrev_u32 v21, 1024, v250
    v_add_u32 v249, 128, v0
    v_mul_u32_u24 v250, 205, v249
    v_lshrrev_b32 v250, 11, v250
    v_mul_u32_u24 v251, 10, v250
    v_sub_u32 v251, v249, v251
    v_mul_u32_u24 v250, 9216, v250
    v_lshl_add_u32 v250, v251, 4, v250
    v_lshrrev_b32 v251, 3, v251
    v_mad_u32_u24 v250, v251, s62, v250
    v_lshl_or_b32 v118, v251, 2, v118
    v_subrev_u32 v22, 2048, v250
    v_add_u32 v249, 192, v0
    v_mul_u32_u24 v250, 205, v249
    v_lshrrev_b32 v250, 11, v250
    v_mul_u32_u24 v251, 10, v250
    v_sub_u32 v251, v249, v251
    v_mul_u32_u24 v250, 9216, v250
    v_lshl_add_u32 v250, v251, 4, v250
    v_lshrrev_b32 v251, 3, v251
    v_mad_u32_u24 v250, v251, s62, v250
    v_lshl_or_b32 v118, v251, 3, v118
    v_subrev_u32 v23, 3072, v250
    v_add_u32 v249, 256, v0
    v_mul_u32_u24 v250, 205, v249
    v_lshrrev_b32 v250, 11, v250
    v_mul_u32_u24 v251, 10, v250
    v_sub_u32 v251, v249, v251
    v_mul_u32_u24 v250, 9216, v250
    v_lshl_add_u32 v250, v251, 4, v250
    v_lshrrev_b32 v251, 3, v251
    v_mad_u32_u24 v250, v251, s62, v250
    v_lshl_or_b32 v118, v251, 4, v118
    v_subrev_u32 v24, 0, v250
    s_lshr_b32 s52, s3, 1
    s_and_b32 s53, s3, 1
    s_mul_i32 s36, s3, 5120
    s_mul_i32 s37, s53, 294912
    s_lshl_b32 s54, s4, 8
    s_add_u32 s37, s37, s54
    s_lshl_b32 s39, s3, 17
    s_lshl_b32 s54, s4, 8
    s_add_u32 s39, s39, s54
    s_lshl_b32 s40, s3, 12
    s_mov_b32 s46, 4096
    s_mov_b32 s47, 8192
    s_mov_b32 s48, 12288
    s_mov_b32 s49, 16384
    s_lshl_b32 s54, s5, 4
    s_lshl_b32 s55, s3, 2
    s_add_u32 s54, s54, s55
    s_mul_i32 s55, s54, 18432
    v_add_u32 v28, s55, v1
    v_add_u32 v29, 18432, v28
    v_add_u32 v30, 36864, v28
    v_add_u32 v31, 55296, v28
    s_mul_i32 s44, s54, 147456
    s_lshl_b32 s45, s54, 17
    s_lshl_b32 s55, s4, 12
    s_add_u32 s45, s45, s55
    s_cmp_eq_u32 s52, 0
    s_cselect_b32 s12, s72, s74
    s_cselect_b32 s13, s73, s75
    s_mov_b32 s14, 5308416
    s_mov_b32 s15, 0x00020000
    s_mov_b32 s8, s76
    s_mov_b32 s9, s77
    s_mov_b32 s10, 2359296
    s_mov_b32 s11, 0x00020000
    s_mov_b32 s16, s68
    s_mov_b32 s17, s69
    s_mov_b32 s18, 4718592
    s_mov_b32 s19, 0x00020000
    s_lshl_b32 s54, s4, 19
    s_add_u32 s20, s64, s54
    s_addc_u32 s21, s65, 0
    s_mov_b32 s22, 0x80000
    s_mov_b32 s23, 0x00020000
    s_add_u32 s24, s66, s54
    s_addc_u32 s25, s67, 0
    s_mov_b32 s26, 0x80000
    s_mov_b32 s27, 0x00020000
    s_mov_b32 s64, s70
    s_mov_b32 s65, s71
    s_mov_b32 s66, 4718592
    s_mov_b32 s67, 0x00020000
    s_mov_b32 s68, s78
    s_mov_b32 s69, s79
    s_mov_b32 s70, 5308416
    s_mov_b32 s71, 0x00020000
    s_add_u32 s72, s76, 62914560
    s_addc_u32 s73, s77, 0
    s_mov_b32 s74, 16384
    s_mov_b32 s75, 0x00020000
    s_bfe_u32 s6, s2, 0x20003
    s_and_b32 s7, s2, 7
    s_lshl_b32 s61, s2, 2
    s_add_u32 s61, s61, s3
    s_lshl_b32 s61, s61, 10
    s_mov_b32 s51, 0x3c853526
    s_mov_b32 s60, 0
    s_lshr_b32 s50, s2, 3
    s_mul_i32 s50, s50, 18
    s_mul_i32 s54, s3, 5
    s_add_u32 s50, s50, s54
    s_lshl_b32 s50, s50, 13
    s_lshl_b32 s54, s7, 10
    s_add_u32 s50, s50, s54
    s_lshl_b32 s58, s4, 12
    s_add_u32 s58, s58, s44
    s_lshr_b32 s57, s4, 1
    s_lshl_b32 s57, s57, 10
    s_and_b32 s56, s4, 1
    s_lshl_b32 s56, s56, 3
    s_add_u32 s57, s57, s56
    s_add_u32 s57, s57, s44
    s_add_u32 s57, s57, 131072
    v_and_b32 v249, 15, v0
    v_lshrrev_b32 v250, 4, v0
    v_lshrrev_b32 v251, 2, v249
    v_and_b32 v252, 3, v0
    v_lshrrev_b32 v253, 2, v0
    v_mul_u32_u24 v254, 160, v253
    v_lshl_add_u32 v25, v252, 3, v254
    v_lshlrev_b32 v254, 8, v249
    v_add_u32 v254, 98304, v254
    v_add_u32 v248, 0, v250
    v_xor_b32 v248, v248, v249
    v_lshl_add_u32 v2, v248, 4, v254
    v_add_u32 v248, 4, v250
    v_xor_b32 v248, v248, v249
    v_lshl_add_u32 v3, v248, 4, v254
    v_add_u32 v248, 8, v250
    v_xor_b32 v248, v248, v249
    v_lshl_add_u32 v4, v248, 4, v254
    v_add_u32 v248, 12, v250
    v_xor_b32 v248, v248, v249
    v_lshl_add_u32 v5, v248, 4, v254
    v_lshlrev_b32 v254, 8, v253
    v_lshl_add_u32 v254, v252, 3, v254
    v_add_u32 v254, 32768, v254
    v_and_b32 v255, 7, v253
    v_xor_b32 v248, 0, v255
    v_lshl_add_u32 v6, v248, 5, v254
    v_xor_b32 v248, 1, v255
    v_lshl_add_u32 v7, v248, 5, v254
    v_xor_b32 v248, 2, v255
    v_lshl_add_u32 v8, v248, 5, v254
    v_xor_b32 v248, 3, v255
    v_lshl_add_u32 v9, v248, 5, v254
    v_xor_b32 v248, 4, v255
    v_lshl_add_u32 v10, v248, 5, v254
    v_xor_b32 v248, 5, v255
    v_lshl_add_u32 v11, v248, 5, v254
    v_xor_b32 v248, 6, v255
    v_lshl_add_u32 v12, v248, 5, v254
    v_xor_b32 v248, 7, v255
    v_lshl_add_u32 v13, v248, 5, v254
    v_lshlrev_b32 v254, 8, v250
    v_add_u32 v248, 0, v250
    v_xor_b32 v248, v248, v249
    v_lshl_add_u32 v14, v248, 4, v254
    v_add_u32 v248, 4, v250
    v_xor_b32 v248, v248, v249
    v_lshl_add_u32 v15, v248, 4, v254
    v_add_u32 v248, 8, v250
    v_xor_b32 v248, v248, v249
    v_lshl_add_u32 v16, v248, 4, v254
    v_add_u32 v248, 12, v250
    v_xor_b32 v248, v248, v249
    v_lshl_add_u32 v17, v248, 4, v254
    v_add_u32 v248, 0, v250
    v_lshlrev_b32 v248, 1, v248
    v_xor_b32 v248, v248, v249
    v_lshl_add_u32 v18, v248, 4, v254
    v_add_u32 v248, 4, v250
    v_lshlrev_b32 v248, 1, v248
    v_xor_b32 v248, v248, v249
    v_lshl_add_u32 v19, v248, 4, v254
    s_cmp_eq_u32 s3, 3
    s_cbranch_scc1 L_at_join
    s_lshl_b32 s55, s5, 5
    s_mov_b32 s53, 0x10000
L_at_rdy:
    s_waitcnt vmcnt(0)
    v_readfirstlane_b32 s52, v119
    s_sub_u32 s53, s53, 1
    s_cbranch_scc1 L_at_join
    s_cmp_lg_u32 s52, 0
    s_cbranch_scc1 L_at_join
    buffer_load_dword v119, off, s[32:35], s55 sc1
    s_branch L_at_rdy
L_at_join:
    s_barrier
    s_lshl_b32 s59, s5, 11
    s_add_u32 s59, s59, 1536
    s_cmp_eq_u32 s3, 0
    s_cselect_b32 s55, 0, 0x40000000
    s_or_b32 s55, s55, s59
    s_lshr_b32 s52, s4, 3
    s_lshl_b32 s52, s52, 7
    s_add_u32 s55, s55, s52
    s_lshl_b32 s52, s3, 7
    s_add_u32 s59, s59, s52
    v_mov_b32 v110, 1
    s_mov_b64 exec, 1
    buffer_atomic_add v110, off, s[72:75], s55 sc1
    s_mov_b64 exec, -1
    s_add_u32 s52, s37, 0
    s_add_u32 m0, s36, 40960
    s_nop 0
    buffer_load_dwordx4 v20, s[12:15], s52 offen offset:0 lds
    buffer_load_dwordx4 v21, s[12:15], s52 offen offset:1024 lds
    buffer_load_dwordx4 v22, s[12:15], s52 offen offset:2048 lds
    buffer_load_dwordx4 v23, s[12:15], s52 offen offset:3072 lds
    s_add_u32 m0, s36, 45056
    s_nop 0
    buffer_load_dwordx4 v24, s[12:15], s52 offen offset:0 lds
    s_add_u32 s52, s37, 589824
    s_add_u32 m0, s36, 61440
    s_nop 0
    buffer_load_dwordx4 v20, s[12:15], s52 offen offset:0 lds
    buffer_load_dwordx4 v21, s[12:15], s52 offen offset:1024 lds
    buffer_load_dwordx4 v22, s[12:15], s52 offen offset:2048 lds
    buffer_load_dwordx4 v23, s[12:15], s52 offen offset:3072 lds
    s_add_u32 m0, s36, 65536
    s_nop 0
    buffer_load_dwordx4 v24, s[12:15], s52 offen offset:0 lds
    s_add_u32 s52, s37, 1179648
    s_add_u32 m0, s36, 0
    s_nop 0
    buffer_load_dwordx4 v20, s[12:15], s52 offen offset:0 lds
    buffer_load_dwordx4 v21, s[12:15], s52 offen offset:1024 lds
    buffer_load_dwordx4 v22, s[12:15], s52 offen offset:2048 lds
    buffer_load_dwordx4 v23, s[12:15], s52 offen offset:3072 lds
    s_add_u32 m0, s36, 4096
    s_nop 0
    buffer_load_dwordx4 v24, s[12:15], s52 offen offset:0 lds
    s_add_u32 s52, s37, 1769472
    s_add_u32 m0, s36, 20480
    s_nop 0
    buffer_load_dwordx4 v20, s[12:15], s52 offen offset:0 lds
    buffer_load_dwordx4 v21, s[12:15], s52 offen offset:1024 lds
    buffer_load_dwordx4 v22, s[12:15], s52 offen offset:2048 lds
    buffer_load_dwordx4 v23, s[12:15], s52 offen offset:3072 lds
    s_add_u32 m0, s36, 24576
    s_nop 0
    buffer_load_dwordx4 v24, s[12:15], s52 offen offset:0 lds
    s_lshr_b32 s55, s2, 3
    s_mul_i32 s55, s55, 18
    s_and_b32 s52, s3, 1
    s_lshl_b32 s52, s52, 3
    s_add_u32 s55, s55, s52
    s_mul_i32 s55, s55, 9216
    s_lshl_b32 s53, s7, 10
    s_add_u32 s55, s55, s53
    s_add_u32 s55, s55, 128
    v_lshrrev_b32 v255, 5, v0
    v_mul_u32_u24 v255, 9216, v255
    v_bfe_u32 v254, v0, 3, 2
    v_lshl_add_u32 v255, v254, 8, v255
    v_and_b32 v254, 7, v0
    v_lshl_add_u32 v255, v254, 4, v255
    v_mov_b32 v248, v118
    s_mov_b32 s53, 0x10000
L_poll_x:
    buffer_load_dword v110, off, s[72:75], s59 sc1
    s_waitcnt vmcnt(0)
    v_readfirstlane_b32 s52, v110
    s_sub_u32 s53, s53, 1
    s_cbranch_scc1 L_skip_x
    s_cmp_ge_u32 s52, 8
    s_cbranch_scc1 L_skip_x
    s_sleep 1
    s_branch L_poll_x
L_skip_x:
    v_add_u32 v26, 40960, v25
    buffer_load_dwordx4 a[0:3], v28, s[8:11], 0 offen offset:0 sc1
    buffer_load_dwordx4 a[16:19], v28, s[8:11], 0 offen offset:1024 sc1
    buffer_load_dwordx4 a[4:7], v29, s[8:11], 0 offen offset:0 sc1
    buffer_load_dwordx4 a[20:23], v29, s[8:11], 0 offen offset:1024 sc1
    buffer_load_dwordx4 a[8:11], v30, s[8:11], 0 offen offset:0 sc1
    buffer_load_dwordx4 a[24:27], v30, s[8:11], 0 offen offset:1024 sc1
    buffer_load_dwordx4 a[12:15], v31, s[8:11], 0 offen offset:0 sc1
    buffer_load_dwordx4 a[28:31], v31, s[8:11], 0 offen offset:1024 sc1
    s_barrier
    buffer_load_dwordx4 a[32:35], v28, s[8:11], 0 offen offset:2048 sc1
    buffer_load_dwordx4 a[48:51], v28, s[8:11], 0 offen offset:3072 sc1
    buffer_load_dwordx4 a[36:39], v29, s[8:11], 0 offen offset:2048 sc1
    buffer_load_dwordx4 a[52:55], v29, s[8:11], 0 offen offset:3072 sc1
    buffer_load_dwordx4 a[40:43], v30, s[8:11], 0 offen offset:2048 sc1
    buffer_load_dwordx4 a[56:59], v30, s[8:11], 0 offen offset:3072 sc1
    buffer_load_dwordx4 a[44:47], v31, s[8:11], 0 offen offset:2048 sc1
    buffer_load_dwordx4 a[60:63], v31, s[8:11], 0 offen offset:3072 sc1
    s_add_u32 s28, s76, 4194304
    s_addc_u32 s29, s77, 0
    s_mov_b32 s30, 16777216
    s_mov_b32 s31, 0x00020000
    s_add_u32 s32, s76, 20971520
    s_addc_u32 s33, s77, 0
    s_mov_b32 s34, 18874368
    s_mov_b32 s35, 0x00020000
    ds_read_b64_tr_b16 v[224:225], v26 offset:128
    ds_read_b64_tr_b16 v[226:227], v26 offset:2688
    ds_read_b64_tr_b16 v[228:229], v26 offset:5248
    ds_read_b64_tr_b16 v[230:231], v26 offset:7808
    ds_read_b64_tr_b16 v[232:233], v26 offset:10368
    ds_read_b64_tr_b16 v[234:235], v26 offset:12928
    ds_read_b64_tr_b16 v[236:237], v26 offset:15488
    ds_read_b64_tr_b16 v[238:239], v26 offset:18048
    s_waitcnt vmcnt(15) lgkmcnt(6)
    v_mfma_f32_16x16x32_bf16 v[192:195], v[224:227], a[0:3], 0
    s_waitcnt vmcnt(14) lgkmcnt(4)
    ds_read_b64_tr_b16 v[240:241], v26 offset:0
    v_mfma_f32_16x16x32_bf16 v[192:195], v[228:231], a[16:19], v[192:195]
    s_waitcnt vmcnt(13)
    buffer_load_dwordx4 a[64:67], v28, s[8:11], s46 offen offset:0 sc1
    v_mfma_f32_16x16x32_bf16 v[196:199], v[224:227], a[4:7], 0
    s_waitcnt vmcnt(13)
    ds_read_b64_tr_b16 v[242:243], v26 offset:2560
    v_mfma_f32_16x16x32_bf16 v[196:199], v[228:231], a[20:23], v[196:199]
    s_waitcnt vmcnt(12)
    v_mfma_f32_16x16x32_bf16 v[200:203], v[224:227], a[8:11], 0
    s_waitcnt vmcnt(11)
    ds_read_b64_tr_b16 v[244:245], v26 offset:5120
    v_mfma_f32_16x16x32_bf16 v[200:203], v[228:231], a[24:27], v[200:203]
    s_waitcnt vmcnt(10)
    v_mfma_f32_16x16x32_bf16 v[204:207], v[224:227], a[12:15], 0
    s_waitcnt vmcnt(9)
    ds_read_b64_tr_b16 v[246:247], v26 offset:7680
    v_mfma_f32_16x16x32_bf16 v[204:207], v[228:231], a[28:31], v[204:207]
    s_waitcnt lgkmcnt(6)
    buffer_load_dwordx4 a[80:83], v28, s[8:11], s46 offen offset:1024 sc1
    v_mfma_f32_16x16x32_bf16 v[208:211], v[232:235], a[0:3], 0
    s_waitcnt lgkmcnt(4)
    ds_read_b64_tr_b16 v[224:225], v26 offset:10240
    v_mfma_f32_16x16x32_bf16 v[208:211], v[236:239], a[16:19], v[208:211]
    v_mfma_f32_16x16x32_bf16 v[212:215], v[232:235], a[4:7], 0
    ds_read_b64_tr_b16 v[226:227], v26 offset:12800
    v_mfma_f32_16x16x32_bf16 v[212:215], v[236:239], a[20:23], v[212:215]
    v_mfma_f32_16x16x32_bf16 v[216:219], v[232:235], a[8:11], 0
    ds_read_b64_tr_b16 v[228:229], v26 offset:15360
    v_mfma_f32_16x16x32_bf16 v[216:219], v[236:239], a[24:27], v[216:219]
    buffer_load_dwordx4 a[68:71], v29, s[8:11], s46 offen offset:0 sc1
    v_mfma_f32_16x16x32_bf16 v[220:223], v[232:235], a[12:15], 0
    ds_read_b64_tr_b16 v[230:231], v26 offset:17920
    v_mfma_f32_16x16x32_bf16 v[220:223], v[236:239], a[28:31], v[220:223]
    s_waitcnt lgkmcnt(6)
    v_mfma_f32_16x16x32_bf16 v[64:67], v[240:243], a[0:3], 0
    s_waitcnt lgkmcnt(4)
    ds_read_b64_tr_b16 v[232:233], v26 offset:32
    v_mfma_f32_16x16x32_bf16 v[64:67], v[244:247], a[16:19], v[64:67]
    v_mfma_f32_16x16x32_bf16 v[68:71], v[240:243], a[4:7], 0
    ds_read_b64_tr_b16 v[234:235], v26 offset:2592
    v_mfma_f32_16x16x32_bf16 v[68:71], v[244:247], a[20:23], v[68:71]
    buffer_load_dwordx4 a[84:87], v29, s[8:11], s46 offen offset:1024 sc1
    v_mfma_f32_16x16x32_bf16 v[72:75], v[240:243], a[8:11], 0
    ds_read_b64_tr_b16 v[236:237], v26 offset:5152
    v_mfma_f32_16x16x32_bf16 v[72:75], v[244:247], a[24:27], v[72:75]
    v_mfma_f32_16x16x32_bf16 v[76:79], v[240:243], a[12:15], 0
    ds_read_b64_tr_b16 v[238:239], v26 offset:7712
    v_mfma_f32_16x16x32_bf16 v[76:79], v[244:247], a[28:31], v[76:79]
    s_waitcnt lgkmcnt(6)
    v_mfma_f32_16x16x32_bf16 v[80:83], v[224:227], a[0:3], 0
    s_waitcnt lgkmcnt(4)
    ds_read_b64_tr_b16 v[240:241], v26 offset:10272
    v_mfma_f32_16x16x32_bf16 v[80:83], v[228:231], a[16:19], v[80:83]
    buffer_load_dwordx4 a[72:75], v30, s[8:11], s46 offen offset:0 sc1
    v_mfma_f32_16x16x32_bf16 v[84:87], v[224:227], a[4:7], 0
    ds_read_b64_tr_b16 v[242:243], v26 offset:12832
    v_mfma_f32_16x16x32_bf16 v[84:87], v[228:231], a[20:23], v[84:87]
    v_mfma_f32_16x16x32_bf16 v[88:91], v[224:227], a[8:11], 0
    ds_read_b64_tr_b16 v[244:245], v26 offset:15392
    v_mfma_f32_16x16x32_bf16 v[88:91], v[228:231], a[24:27], v[88:91]
    v_mfma_f32_16x16x32_bf16 v[92:95], v[224:227], a[12:15], 0
    ds_read_b64_tr_b16 v[246:247], v26 offset:17952
    v_mfma_f32_16x16x32_bf16 v[92:95], v[228:231], a[28:31], v[92:95]
    s_waitcnt lgkmcnt(6)
    buffer_load_dwordx4 a[88:91], v30, s[8:11], s46 offen offset:1024 sc1
    v_mfma_f32_16x16x32_bf16 v[96:99], v[232:235], a[0:3], 0
    s_waitcnt lgkmcnt(4)
    ds_read_b64_tr_b16 v[224:225], v26 offset:64
    v_mfma_f32_16x16x32_bf16 v[96:99], v[236:239], a[16:19], v[96:99]
    v_mfma_f32_16x16x32_bf16 v[100:103], v[232:235], a[4:7], 0
    ds_read_b64_tr_b16 v[226:227], v26 offset:2624
    v_mfma_f32_16x16x32_bf16 v[100:103], v[236:239], a[20:23], v[100:103]
    v_mfma_f32_16x16x32_bf16 v[104:107], v[232:235], a[8:11], 0
    ds_read_b64_tr_b16 v[228:229], v26 offset:5184
    v_mfma_f32_16x16x32_bf16 v[104:107], v[236:239], a[24:27], v[104:107]
    buffer_load_dwordx4 a[76:79], v31, s[8:11], s46 offen offset:0 sc1
    v_mfma_f32_16x16x32_bf16 v[108:111], v[232:235], a[12:15], 0
    ds_read_b64_tr_b16 v[230:231], v26 offset:7744
    v_mfma_f32_16x16x32_bf16 v[108:111], v[236:239], a[28:31], v[108:111]
    s_waitcnt lgkmcnt(6)
    v_mfma_f32_16x16x32_bf16 v[112:115], v[240:243], a[0:3], 0
    s_waitcnt lgkmcnt(4)
    ds_read_b64_tr_b16 v[232:233], v26 offset:10304
    v_mfma_f32_16x16x32_bf16 v[112:115], v[244:247], a[16:19], v[112:115]
    v_mfma_f32_16x16x32_bf16 v[116:119], v[240:243], a[4:7], 0
    ds_read_b64_tr_b16 v[234:235], v26 offset:12864
    v_mfma_f32_16x16x32_bf16 v[116:119], v[244:247], a[20:23], v[116:119]
    buffer_load_dwordx4 a[92:95], v31, s[8:11], s46 offen offset:1024 sc1
    v_mfma_f32_16x16x32_bf16 v[120:123], v[240:243], a[8:11], 0
    ds_read_b64_tr_b16 v[236:237], v26 offset:15424
    v_mfma_f32_16x16x32_bf16 v[120:123], v[244:247], a[24:27], v[120:123]
    v_mfma_f32_16x16x32_bf16 v[124:127], v[240:243], a[12:15], 0
    ds_read_b64_tr_b16 v[238:239], v26 offset:17984
    v_mfma_f32_16x16x32_bf16 v[124:127], v[244:247], a[28:31], v[124:127]
    s_waitcnt lgkmcnt(6)
    v_mfma_f32_16x16x32_bf16 v[128:131], v[224:227], a[0:3], 0
    s_waitcnt lgkmcnt(4)
    ds_read_b64_tr_b16 v[240:241], v26 offset:96
    v_mfma_f32_16x16x32_bf16 v[128:131], v[228:231], a[16:19], v[128:131]
    buffer_load_dwordx4 a[96:99], v28, s[8:11], s46 offen offset:2048 sc1
    v_mfma_f32_16x16x32_bf16 v[132:135], v[224:227], a[4:7], 0
    ds_read_b64_tr_b16 v[242:243], v26 offset:2656
    v_mfma_f32_16x16x32_bf16 v[132:135], v[228:231], a[20:23], v[132:135]
    v_mfma_f32_16x16x32_bf16 v[136:139], v[224:227], a[8:11], 0
    ds_read_b64_tr_b16 v[244:245], v26 offset:5216
    v_mfma_f32_16x16x32_bf16 v[136:139], v[228:231], a[24:27], v[136:139]
    v_mfma_f32_16x16x32_bf16 v[140:143], v[224:227], a[12:15], 0
    ds_read_b64_tr_b16 v[246:247], v26 offset:7776
    v_mfma_f32_16x16x32_bf16 v[140:143], v[228:231], a[28:31], v[140:143]
    s_waitcnt lgkmcnt(6)
    buffer_load_dwordx4 a[112:115], v28, s[8:11], s46 offen offset:3072 sc1
    v_mfma_f32_16x16x32_bf16 v[144:147], v[232:235], a[0:3], 0
    s_waitcnt lgkmcnt(4)
    ds_read_b64_tr_b16 v[224:225], v26 offset:10336
    v_mfma_f32_16x16x32_bf16 v[144:147], v[236:239], a[16:19], v[144:147]
    v_mfma_f32_16x16x32_bf16 v[148:151], v[232:235], a[4:7], 0
    ds_read_b64_tr_b16 v[226:227], v26 offset:12896
    v_mfma_f32_16x16x32_bf16 v[148:151], v[236:239], a[20:23], v[148:151]
    v_mfma_f32_16x16x32_bf16 v[152:155], v[232:235], a[8:11], 0
    ds_read_b64_tr_b16 v[228:229], v26 offset:15456
    v_mfma_f32_16x16x32_bf16 v[152:155], v[236:239], a[24:27], v[152:155]
    buffer_load_dwordx4 a[100:103], v29, s[8:11], s46 offen offset:2048 sc1
    v_mfma_f32_16x16x32_bf16 v[156:159], v[232:235], a[12:15], 0
    ds_read_b64_tr_b16 v[230:231], v26 offset:18016
    v_mfma_f32_16x16x32_bf16 v[156:159], v[236:239], a[28:31], v[156:159]
    s_waitcnt lgkmcnt(6)
    v_mfma_f32_16x16x32_bf16 v[160:163], v[240:243], a[0:3], 0
    s_waitcnt lgkmcnt(4)
    ds_read_b64_tr_b16 v[232:233], v26 offset:20608
    v_mfma_f32_16x16x32_bf16 v[160:163], v[244:247], a[16:19], v[160:163]
    v_mfma_f32_16x16x32_bf16 v[164:167], v[240:243], a[4:7], 0
    ds_read_b64_tr_b16 v[234:235], v26 offset:23168
    v_mfma_f32_16x16x32_bf16 v[164:167], v[244:247], a[20:23], v[164:167]
    buffer_load_dwordx4 a[116:119], v29, s[8:11], s46 offen offset:3072 sc1
    v_mfma_f32_16x16x32_bf16 v[168:171], v[240:243], a[8:11], 0
    ds_read_b64_tr_b16 v[236:237], v26 offset:25728
    v_mfma_f32_16x16x32_bf16 v[168:171], v[244:247], a[24:27], v[168:171]
    v_mfma_f32_16x16x32_bf16 v[172:175], v[240:243], a[12:15], 0
    ds_read_b64_tr_b16 v[238:239], v26 offset:28288
    v_mfma_f32_16x16x32_bf16 v[172:175], v[244:247], a[28:31], v[172:175]
    s_waitcnt lgkmcnt(6)
    v_mfma_f32_16x16x32_bf16 v[176:179], v[224:227], a[0:3], 0
    s_waitcnt lgkmcnt(4)
    ds_read_b64_tr_b16 v[240:241], v26 offset:30848
    v_mfma_f32_16x16x32_bf16 v[176:179], v[228:231], a[16:19], v[176:179]
    buffer_load_dwordx4 a[104:107], v30, s[8:11], s46 offen offset:2048 sc1
    v_mfma_f32_16x16x32_bf16 v[180:183], v[224:227], a[4:7], 0
    ds_read_b64_tr_b16 v[242:243], v26 offset:33408
    v_mfma_f32_16x16x32_bf16 v[180:183], v[228:231], a[20:23], v[180:183]
    v_mfma_f32_16x16x32_bf16 v[184:187], v[224:227], a[8:11], 0
    ds_read_b64_tr_b16 v[244:245], v26 offset:35968
    v_mfma_f32_16x16x32_bf16 v[184:187], v[228:231], a[24:27], v[184:187]
    v_mfma_f32_16x16x32_bf16 v[188:191], v[224:227], a[12:15], 0
    ds_read_b64_tr_b16 v[246:247], v26 offset:38528
    v_mfma_f32_16x16x32_bf16 v[188:191], v[228:231], a[28:31], v[188:191]
    s_waitcnt vmcnt(20) lgkmcnt(6)
    buffer_load_dwordx4 a[120:123], v30, s[8:11], s46 offen offset:3072 sc1
    v_mfma_f32_16x16x32_bf16 v[192:195], v[232:235], a[32:35], v[192:195]
    s_waitcnt vmcnt(20) lgkmcnt(4)
    ds_read_b64_tr_b16 v[224:225], v26 offset:20480
    v_mfma_f32_16x16x32_bf16 v[192:195], v[236:239], a[48:51], v[192:195]
    s_waitcnt vmcnt(19)
    v_mfma_f32_16x16x32_bf16 v[196:199], v[232:235], a[36:39], v[196:199]
    s_waitcnt vmcnt(18)
    ds_read_b64_tr_b16 v[226:227], v26 offset:23040
    v_mfma_f32_16x16x32_bf16 v[196:199], v[236:239], a[52:55], v[196:199]
    s_waitcnt vmcnt(17)
    v_mfma_f32_16x16x32_bf16 v[200:203], v[232:235], a[40:43], v[200:203]
    s_waitcnt vmcnt(16)
    ds_read_b64_tr_b16 v[228:229], v26 offset:25600
    v_mfma_f32_16x16x32_bf16 v[200:203], v[236:239], a[56:59], v[200:203]
    s_waitcnt vmcnt(15)
    buffer_load_dwordx4 a[108:111], v31, s[8:11], s46 offen offset:2048 sc1
    v_mfma_f32_16x16x32_bf16 v[204:207], v[232:235], a[44:47], v[204:207]
    s_waitcnt vmcnt(15)
    ds_read_b64_tr_b16 v[230:231], v26 offset:28160
    v_mfma_f32_16x16x32_bf16 v[204:207], v[236:239], a[60:63], v[204:207]
    s_waitcnt lgkmcnt(6)
    v_mfma_f32_16x16x32_bf16 v[208:211], v[240:243], a[32:35], v[208:211]
    s_waitcnt lgkmcnt(4)
    ds_read_b64_tr_b16 v[232:233], v26 offset:30720
    v_mfma_f32_16x16x32_bf16 v[208:211], v[244:247], a[48:51], v[208:211]
    v_mfma_f32_16x16x32_bf16 v[212:215], v[240:243], a[36:39], v[212:215]
    ds_read_b64_tr_b16 v[234:235], v26 offset:33280
    v_mfma_f32_16x16x32_bf16 v[212:215], v[244:247], a[52:55], v[212:215]
    buffer_load_dwordx4 a[124:127], v31, s[8:11], s46 offen offset:3072 sc1
    v_mfma_f32_16x16x32_bf16 v[216:219], v[240:243], a[40:43], v[216:219]
    ds_read_b64_tr_b16 v[236:237], v26 offset:35840
    v_mfma_f32_16x16x32_bf16 v[216:219], v[244:247], a[56:59], v[216:219]
    v_mfma_f32_16x16x32_bf16 v[220:223], v[240:243], a[44:47], v[220:223]
    ds_read_b64_tr_b16 v[238:239], v26 offset:38400
    v_mfma_f32_16x16x32_bf16 v[220:223], v[244:247], a[60:63], v[220:223]
    s_waitcnt lgkmcnt(6)
    v_mfma_f32_16x16x32_bf16 v[64:67], v[224:227], a[32:35], v[64:67]
    s_waitcnt lgkmcnt(4)
    s_add_u32 s52, s37, 2359296
    s_add_u32 m0, s36, 81920
    ds_read_b64_tr_b16 v[240:241], v26 offset:20512
    v_mfma_f32_16x16x32_bf16 v[64:67], v[228:231], a[48:51], v[64:67]
    buffer_load_dwordx4 v20, s[12:15], s52 offen offset:0 lds
    v_mfma_f32_16x16x32_bf16 v[68:71], v[224:227], a[36:39], v[68:71]
    ds_read_b64_tr_b16 v[242:243], v26 offset:23072
    v_mfma_f32_16x16x32_bf16 v[68:71], v[228:231], a[52:55], v[68:71]
    v_mfma_f32_16x16x32_bf16 v[72:75], v[224:227], a[40:43], v[72:75]
    ds_read_b64_tr_b16 v[244:245], v26 offset:25632
    v_mfma_f32_16x16x32_bf16 v[72:75], v[228:231], a[56:59], v[72:75]
    v_mfma_f32_16x16x32_bf16 v[76:79], v[224:227], a[44:47], v[76:79]
    ds_read_b64_tr_b16 v[246:247], v26 offset:28192
    v_mfma_f32_16x16x32_bf16 v[76:79], v[228:231], a[60:63], v[76:79]
    s_waitcnt lgkmcnt(6)
    buffer_load_dwordx4 v21, s[12:15], s52 offen offset:1024 lds
    v_mfma_f32_16x16x32_bf16 v[80:83], v[232:235], a[32:35], v[80:83]
    s_waitcnt lgkmcnt(4)
    ds_read_b64_tr_b16 v[224:225], v26 offset:30752
    v_mfma_f32_16x16x32_bf16 v[80:83], v[236:239], a[48:51], v[80:83]
    v_mfma_f32_16x16x32_bf16 v[84:87], v[232:235], a[36:39], v[84:87]
    ds_read_b64_tr_b16 v[226:227], v26 offset:33312
    v_mfma_f32_16x16x32_bf16 v[84:87], v[236:239], a[52:55], v[84:87]
    v_mfma_f32_16x16x32_bf16 v[88:91], v[232:235], a[40:43], v[88:91]
    ds_read_b64_tr_b16 v[228:229], v26 offset:35872
    v_mfma_f32_16x16x32_bf16 v[88:91], v[236:239], a[56:59], v[88:91]
    buffer_load_dwordx4 v22, s[12:15], s52 offen offset:2048 lds
    v_mfma_f32_16x16x32_bf16 v[92:95], v[232:235], a[44:47], v[92:95]
    ds_read_b64_tr_b16 v[230:231], v26 offset:38432
    v_mfma_f32_16x16x32_bf16 v[92:95], v[236:239], a[60:63], v[92:95]
    s_waitcnt lgkmcnt(6)
    v_mfma_f32_16x16x32_bf16 v[96:99], v[240:243], a[32:35], v[96:99]
    s_waitcnt lgkmcnt(4)
    ds_read_b64_tr_b16 v[232:233], v26 offset:20544
    v_mfma_f32_16x16x32_bf16 v[96:99], v[244:247], a[48:51], v[96:99]
    v_mfma_f32_16x16x32_bf16 v[100:103], v[240:243], a[36:39], v[100:103]
    ds_read_b64_tr_b16 v[234:235], v26 offset:23104
    v_mfma_f32_16x16x32_bf16 v[100:103], v[244:247], a[52:55], v[100:103]
    buffer_load_dwordx4 v23, s[12:15], s52 offen offset:3072 lds
    v_mfma_f32_16x16x32_bf16 v[104:107], v[240:243], a[40:43], v[104:107]
    ds_read_b64_tr_b16 v[236:237], v26 offset:25664
    v_mfma_f32_16x16x32_bf16 v[104:107], v[244:247], a[56:59], v[104:107]
    v_mfma_f32_16x16x32_bf16 v[108:111], v[240:243], a[44:47], v[108:111]
    ds_read_b64_tr_b16 v[238:239], v26 offset:28224
    v_mfma_f32_16x16x32_bf16 v[108:111], v[244:247], a[60:63], v[108:111]
    s_waitcnt lgkmcnt(6)
    v_mfma_f32_16x16x32_bf16 v[112:115], v[224:227], a[32:35], v[112:115]
    s_waitcnt lgkmcnt(4)
    s_add_u32 m0, s36, 86016
    ds_read_b64_tr_b16 v[240:241], v26 offset:30784
    v_mfma_f32_16x16x32_bf16 v[112:115], v[228:231], a[48:51], v[112:115]
    buffer_load_dwordx4 v24, s[12:15], s52 offen offset:0 lds
    v_mfma_f32_16x16x32_bf16 v[116:119], v[224:227], a[36:39], v[116:119]
    ds_read_b64_tr_b16 v[242:243], v26 offset:33344
    v_mfma_f32_16x16x32_bf16 v[116:119], v[228:231], a[52:55], v[116:119]
    v_mfma_f32_16x16x32_bf16 v[120:123], v[224:227], a[40:43], v[120:123]
    ds_read_b64_tr_b16 v[244:245], v26 offset:35904
    v_mfma_f32_16x16x32_bf16 v[120:123], v[228:231], a[56:59], v[120:123]
    v_mfma_f32_16x16x32_bf16 v[124:127], v[224:227], a[44:47], v[124:127]
    s_add_u32 s52, s37, 2949120
    s_add_u32 m0, s36, 102400
    ds_read_b64_tr_b16 v[246:247], v26 offset:38464
    v_mfma_f32_16x16x32_bf16 v[124:127], v[228:231], a[60:63], v[124:127]
    s_waitcnt lgkmcnt(6)
    buffer_load_dwordx4 v20, s[12:15], s52 offen offset:0 lds
    v_mfma_f32_16x16x32_bf16 v[128:131], v[232:235], a[32:35], v[128:131]
    s_waitcnt lgkmcnt(4)
    ds_read_b64_tr_b16 v[224:225], v26 offset:20576
    v_mfma_f32_16x16x32_bf16 v[128:131], v[236:239], a[48:51], v[128:131]
    v_mfma_f32_16x16x32_bf16 v[132:135], v[232:235], a[36:39], v[132:135]
    ds_read_b64_tr_b16 v[226:227], v26 offset:23136
    v_mfma_f32_16x16x32_bf16 v[132:135], v[236:239], a[52:55], v[132:135]
    v_mfma_f32_16x16x32_bf16 v[136:139], v[232:235], a[40:43], v[136:139]
    ds_read_b64_tr_b16 v[228:229], v26 offset:25696
    v_mfma_f32_16x16x32_bf16 v[136:139], v[236:239], a[56:59], v[136:139]
    buffer_load_dwordx4 v21, s[12:15], s52 offen offset:1024 lds
    v_mfma_f32_16x16x32_bf16 v[140:143], v[232:235], a[44:47], v[140:143]
    ds_read_b64_tr_b16 v[230:231], v26 offset:28256
    v_mfma_f32_16x16x32_bf16 v[140:143], v[236:239], a[60:63], v[140:143]
    s_waitcnt lgkmcnt(6)
    v_mfma_f32_16x16x32_bf16 v[144:147], v[240:243], a[32:35], v[144:147]
    s_waitcnt lgkmcnt(4)
    ds_read_b64_tr_b16 v[232:233], v26 offset:30816
    v_mfma_f32_16x16x32_bf16 v[144:147], v[244:247], a[48:51], v[144:147]
    ds_read_b64_tr_b16 v[234:235], v26 offset:33376
    v_mfma_f32_16x16x32_bf16 v[148:151], v[240:243], a[36:39], v[148:151]
    ds_read_b64_tr_b16 v[236:237], v26 offset:35936
    v_mfma_f32_16x16x32_bf16 v[148:151], v[244:247], a[52:55], v[148:151]
    ds_read_b64_tr_b16 v[238:239], v26 offset:38496
    v_mfma_f32_16x16x32_bf16 v[152:155], v[240:243], a[40:43], v[152:155]
    v_add_u32 v27, 0, v25
    v_mfma_f32_16x16x32_bf16 v[152:155], v[244:247], a[56:59], v[152:155]
    buffer_load_dwordx4 v22, s[12:15], s52 offen offset:2048 lds
    v_mfma_f32_16x16x32_bf16 v[156:159], v[240:243], a[44:47], v[156:159]
    v_mfma_f32_16x16x32_bf16 v[156:159], v[244:247], a[60:63], v[156:159]
    s_waitcnt lgkmcnt(0)
    v_mfma_f32_16x16x32_bf16 v[160:163], v[224:227], a[32:35], v[160:163]
    s_waitcnt vmcnt(41)
    s_barrier
    ds_read_b64_tr_b16 v[240:241], v27 offset:128
    v_mfma_f32_16x16x32_bf16 v[160:163], v[228:231], a[48:51], v[160:163]
    v_mfma_f32_16x16x32_bf16 v[164:167], v[224:227], a[36:39], v[164:167]
    ds_read_b64_tr_b16 v[242:243], v27 offset:2688
    v_mfma_f32_16x16x32_bf16 v[164:167], v[228:231], a[52:55], v[164:167]
    buffer_load_dwordx4 v23, s[12:15], s52 offen offset:3072 lds
    v_mfma_f32_16x16x32_bf16 v[168:171], v[224:227], a[40:43], v[168:171]
    ds_read_b64_tr_b16 v[244:245], v27 offset:5248
    v_mfma_f32_16x16x32_bf16 v[168:171], v[228:231], a[56:59], v[168:171]
    v_mfma_f32_16x16x32_bf16 v[172:175], v[224:227], a[44:47], v[172:175]
    ds_read_b64_tr_b16 v[246:247], v27 offset:7808
    v_mfma_f32_16x16x32_bf16 v[172:175], v[228:231], a[60:63], v[172:175]
    v_mfma_f32_16x16x32_bf16 v[176:179], v[232:235], a[32:35], v[176:179]
    s_add_u32 m0, s36, 106496
    ds_read_b64_tr_b16 v[224:225], v27 offset:10368
    v_mfma_f32_16x16x32_bf16 v[176:179], v[236:239], a[48:51], v[176:179]
    buffer_load_dwordx4 v24, s[12:15], s52 offen offset:0 lds
    v_mfma_f32_16x16x32_bf16 v[180:183], v[232:235], a[36:39], v[180:183]
    ds_read_b64_tr_b16 v[226:227], v27 offset:12928
    v_mfma_f32_16x16x32_bf16 v[180:183], v[236:239], a[52:55], v[180:183]
    v_mfma_f32_16x16x32_bf16 v[184:187], v[232:235], a[40:43], v[184:187]
    ds_read_b64_tr_b16 v[228:229], v27 offset:15488
    v_mfma_f32_16x16x32_bf16 v[184:187], v[236:239], a[56:59], v[184:187]
    v_mfma_f32_16x16x32_bf16 v[188:191], v[232:235], a[44:47], v[188:191]
    ds_read_b64_tr_b16 v[230:231], v27 offset:18048
    v_mfma_f32_16x16x32_bf16 v[188:191], v[236:239], a[60:63], v[188:191]
    s_waitcnt vmcnt(25) lgkmcnt(6)
    buffer_load_dwordx4 a[128:131], v28, s[8:11], s47 offen offset:0 sc1
    v_mfma_f32_16x16x32_bf16 v[192:195], v[240:243], a[64:67], v[192:195]
    s_waitcnt vmcnt(25) lgkmcnt(4)
    ds_read_b64_tr_b16 v[232:233], v27 offset:0
    v_mfma_f32_16x16x32_bf16 v[192:195], v[244:247], a[80:83], v[192:195]
    s_waitcnt vmcnt(24)
    v_mfma_f32_16x16x32_bf16 v[196:199], v[240:243], a[68:71], v[196:199]
    s_waitcnt vmcnt(23)
    ds_read_b64_tr_b16 v[234:235], v27 offset:2560
    v_mfma_f32_16x16x32_bf16 v[196:199], v[244:247], a[84:87], v[196:199]
    s_waitcnt vmcnt(22)
    v_mfma_f32_16x16x32_bf16 v[200:203], v[240:243], a[72:75], v[200:203]
    s_waitcnt vmcnt(21)
    ds_read_b64_tr_b16 v[236:237], v27 offset:5120
    v_mfma_f32_16x16x32_bf16 v[200:203], v[244:247], a[88:91], v[200:203]
    s_waitcnt vmcnt(20)
    buffer_load_dwordx4 a[144:147], v28, s[8:11], s47 offen offset:1024 sc1
    v_mfma_f32_16x16x32_bf16 v[204:207], v[240:243], a[76:79], v[204:207]
    s_waitcnt vmcnt(20)
    ds_read_b64_tr_b16 v[238:239], v27 offset:7680
    v_mfma_f32_16x16x32_bf16 v[204:207], v[244:247], a[92:95], v[204:207]
    s_waitcnt lgkmcnt(6)
    v_mfma_f32_16x16x32_bf16 v[208:211], v[224:227], a[64:67], v[208:211]
    s_waitcnt lgkmcnt(4)
    ds_read_b64_tr_b16 v[240:241], v27 offset:10240
    v_mfma_f32_16x16x32_bf16 v[208:211], v[228:231], a[80:83], v[208:211]
    v_mfma_f32_16x16x32_bf16 v[212:215], v[224:227], a[68:71], v[212:215]
    ds_read_b64_tr_b16 v[242:243], v27 offset:12800
    v_mfma_f32_16x16x32_bf16 v[212:215], v[228:231], a[84:87], v[212:215]
    buffer_load_dwordx4 a[132:135], v29, s[8:11], s47 offen offset:0 sc1
    v_mfma_f32_16x16x32_bf16 v[216:219], v[224:227], a[72:75], v[216:219]
    ds_read_b64_tr_b16 v[244:245], v27 offset:15360
    v_mfma_f32_16x16x32_bf16 v[216:219], v[228:231], a[88:91], v[216:219]
    v_mfma_f32_16x16x32_bf16 v[220:223], v[224:227], a[76:79], v[220:223]
    ds_read_b64_tr_b16 v[246:247], v27 offset:17920
    v_mfma_f32_16x16x32_bf16 v[220:223], v[228:231], a[92:95], v[220:223]
    s_waitcnt lgkmcnt(6)
    v_mfma_f32_16x16x32_bf16 v[64:67], v[232:235], a[64:67], v[64:67]
    s_waitcnt lgkmcnt(4)
    ds_read_b64_tr_b16 v[224:225], v27 offset:32
    v_mfma_f32_16x16x32_bf16 v[64:67], v[236:239], a[80:83], v[64:67]
    buffer_load_dwordx4 a[148:151], v29, s[8:11], s47 offen offset:1024 sc1
    v_mfma_f32_16x16x32_bf16 v[68:71], v[232:235], a[68:71], v[68:71]
    ds_read_b64_tr_b16 v[226:227], v27 offset:2592
    v_mfma_f32_16x16x32_bf16 v[68:71], v[236:239], a[84:87], v[68:71]
    v_mfma_f32_16x16x32_bf16 v[72:75], v[232:235], a[72:75], v[72:75]
    ds_read_b64_tr_b16 v[228:229], v27 offset:5152
    v_mfma_f32_16x16x32_bf16 v[72:75], v[236:239], a[88:91], v[72:75]
    v_mfma_f32_16x16x32_bf16 v[76:79], v[232:235], a[76:79], v[76:79]
    ds_read_b64_tr_b16 v[230:231], v27 offset:7712
    v_mfma_f32_16x16x32_bf16 v[76:79], v[236:239], a[92:95], v[76:79]
    s_waitcnt lgkmcnt(6)
    buffer_load_dwordx4 a[136:139], v30, s[8:11], s47 offen offset:0 sc1
    v_mfma_f32_16x16x32_bf16 v[80:83], v[240:243], a[64:67], v[80:83]
    s_waitcnt lgkmcnt(4)
    ds_read_b64_tr_b16 v[232:233], v27 offset:10272
    v_mfma_f32_16x16x32_bf16 v[80:83], v[244:247], a[80:83], v[80:83]
    v_mfma_f32_16x16x32_bf16 v[84:87], v[240:243], a[68:71], v[84:87]
    ds_read_b64_tr_b16 v[234:235], v27 offset:12832
    v_mfma_f32_16x16x32_bf16 v[84:87], v[244:247], a[84:87], v[84:87]
    v_mfma_f32_16x16x32_bf16 v[88:91], v[240:243], a[72:75], v[88:91]
    ds_read_b64_tr_b16 v[236:237], v27 offset:15392
    v_mfma_f32_16x16x32_bf16 v[88:91], v[244:247], a[88:91], v[88:91]
    buffer_load_dwordx4 a[152:155], v30, s[8:11], s47 offen offset:1024 sc1
    v_mfma_f32_16x16x32_bf16 v[92:95], v[240:243], a[76:79], v[92:95]
    ds_read_b64_tr_b16 v[238:239], v27 offset:17952
    v_mfma_f32_16x16x32_bf16 v[92:95], v[244:247], a[92:95], v[92:95]
    s_waitcnt lgkmcnt(6)
    v_mfma_f32_16x16x32_bf16 v[96:99], v[224:227], a[64:67], v[96:99]
    s_waitcnt lgkmcnt(4)
    ds_read_b64_tr_b16 v[240:241], v27 offset:64
    v_mfma_f32_16x16x32_bf16 v[96:99], v[228:231], a[80:83], v[96:99]
    v_mfma_f32_16x16x32_bf16 v[100:103], v[224:227], a[68:71], v[100:103]
    ds_read_b64_tr_b16 v[242:243], v27 offset:2624
    v_mfma_f32_16x16x32_bf16 v[100:103], v[228:231], a[84:87], v[100:103]
    buffer_load_dwordx4 a[140:143], v31, s[8:11], s47 offen offset:0 sc1
    v_mfma_f32_16x16x32_bf16 v[104:107], v[224:227], a[72:75], v[104:107]
    ds_read_b64_tr_b16 v[244:245], v27 offset:5184
    v_mfma_f32_16x16x32_bf16 v[104:107], v[228:231], a[88:91], v[104:107]
    v_mfma_f32_16x16x32_bf16 v[108:111], v[224:227], a[76:79], v[108:111]
    ds_read_b64_tr_b16 v[246:247], v27 offset:7744
    v_mfma_f32_16x16x32_bf16 v[108:111], v[228:231], a[92:95], v[108:111]
    s_waitcnt lgkmcnt(6)
    v_mfma_f32_16x16x32_bf16 v[112:115], v[232:235], a[64:67], v[112:115]
    s_waitcnt lgkmcnt(4)
    ds_read_b64_tr_b16 v[224:225], v27 offset:10304
    v_mfma_f32_16x16x32_bf16 v[112:115], v[236:239], a[80:83], v[112:115]
    buffer_load_dwordx4 a[156:159], v31, s[8:11], s47 offen offset:1024 sc1
    v_mfma_f32_16x16x32_bf16 v[116:119], v[232:235], a[68:71], v[116:119]
    ds_read_b64_tr_b16 v[226:227], v27 offset:12864
    v_mfma_f32_16x16x32_bf16 v[116:119], v[236:239], a[84:87], v[116:119]
    v_mfma_f32_16x16x32_bf16 v[120:123], v[232:235], a[72:75], v[120:123]
    ds_read_b64_tr_b16 v[228:229], v27 offset:15424
    v_mfma_f32_16x16x32_bf16 v[120:123], v[236:239], a[88:91], v[120:123]
    v_mfma_f32_16x16x32_bf16 v[124:127], v[232:235], a[76:79], v[124:127]
    ds_read_b64_tr_b16 v[230:231], v27 offset:17984
    v_mfma_f32_16x16x32_bf16 v[124:127], v[236:239], a[92:95], v[124:127]
    s_waitcnt lgkmcnt(6)
    buffer_load_dwordx4 a[160:163], v28, s[8:11], s47 offen offset:2048 sc1
    v_mfma_f32_16x16x32_bf16 v[128:131], v[240:243], a[64:67], v[128:131]
    s_waitcnt lgkmcnt(4)
    ds_read_b64_tr_b16 v[232:233], v27 offset:96
    v_mfma_f32_16x16x32_bf16 v[128:131], v[244:247], a[80:83], v[128:131]
    v_mfma_f32_16x16x32_bf16 v[132:135], v[240:243], a[68:71], v[132:135]
    ds_read_b64_tr_b16 v[234:235], v27 offset:2656
    v_mfma_f32_16x16x32_bf16 v[132:135], v[244:247], a[84:87], v[132:135]
    v_mfma_f32_16x16x32_bf16 v[136:139], v[240:243], a[72:75], v[136:139]
    ds_read_b64_tr_b16 v[236:237], v27 offset:5216
    v_mfma_f32_16x16x32_bf16 v[136:139], v[244:247], a[88:91], v[136:139]
    buffer_load_dwordx4 a[176:179], v28, s[8:11], s47 offen offset:3072 sc1
    v_mfma_f32_16x16x32_bf16 v[140:143], v[240:243], a[76:79], v[140:143]
    ds_read_b64_tr_b16 v[238:239], v27 offset:7776
    v_mfma_f32_16x16x32_bf16 v[140:143], v[244:247], a[92:95], v[140:143]
    s_waitcnt lgkmcnt(6)
    v_mfma_f32_16x16x32_bf16 v[144:147], v[224:227], a[64:67], v[144:147]
    s_waitcnt lgkmcnt(4)
    ds_read_b64_tr_b16 v[240:241], v27 offset:10336
    v_mfma_f32_16x16x32_bf16 v[144:147], v[228:231], a[80:83], v[144:147]
    v_mfma_f32_16x16x32_bf16 v[148:151], v[224:227], a[68:71], v[148:151]
    ds_read_b64_tr_b16 v[242:243], v27 offset:12896
    v_mfma_f32_16x16x32_bf16 v[148:151], v[228:231], a[84:87], v[148:151]
    buffer_load_dwordx4 a[164:167], v29, s[8:11], s47 offen offset:2048 sc1
    v_mfma_f32_16x16x32_bf16 v[152:155], v[224:227], a[72:75], v[152:155]
    ds_read_b64_tr_b16 v[244:245], v27 offset:15456
    v_mfma_f32_16x16x32_bf16 v[152:155], v[228:231], a[88:91], v[152:155]
    v_mfma_f32_16x16x32_bf16 v[156:159], v[224:227], a[76:79], v[156:159]
    ds_read_b64_tr_b16 v[246:247], v27 offset:18016
    v_mfma_f32_16x16x32_bf16 v[156:159], v[228:231], a[92:95], v[156:159]
    s_waitcnt lgkmcnt(6)
    v_mfma_f32_16x16x32_bf16 v[160:163], v[232:235], a[64:67], v[160:163]
    s_waitcnt lgkmcnt(4)
    ds_read_b64_tr_b16 v[224:225], v27 offset:20608
    v_mfma_f32_16x16x32_bf16 v[160:163], v[236:239], a[80:83], v[160:163]
    buffer_load_dwordx4 a[180:183], v29, s[8:11], s47 offen offset:3072 sc1
    v_mfma_f32_16x16x32_bf16 v[164:167], v[232:235], a[68:71], v[164:167]
    ds_read_b64_tr_b16 v[226:227], v27 offset:23168
    v_mfma_f32_16x16x32_bf16 v[164:167], v[236:239], a[84:87], v[164:167]
    v_mfma_f32_16x16x32_bf16 v[168:171], v[232:235], a[72:75], v[168:171]
    ds_read_b64_tr_b16 v[228:229], v27 offset:25728
    v_mfma_f32_16x16x32_bf16 v[168:171], v[236:239], a[88:91], v[168:171]
    v_mfma_f32_16x16x32_bf16 v[172:175], v[232:235], a[76:79], v[172:175]
    ds_read_b64_tr_b16 v[230:231], v27 offset:28288
    v_mfma_f32_16x16x32_bf16 v[172:175], v[236:239], a[92:95], v[172:175]
    s_waitcnt lgkmcnt(6)
    buffer_load_dwordx4 a[168:171], v30, s[8:11], s47 offen offset:2048 sc1
    v_mfma_f32_16x16x32_bf16 v[176:179], v[240:243], a[64:67], v[176:179]
    s_waitcnt lgkmcnt(4)
    ds_read_b64_tr_b16 v[232:233], v27 offset:30848
    v_mfma_f32_16x16x32_bf16 v[176:179], v[244:247], a[80:83], v[176:179]
    v_mfma_f32_16x16x32_bf16 v[180:183], v[240:243], a[68:71], v[180:183]
    ds_read_b64_tr_b16 v[234:235], v27 offset:33408
    v_mfma_f32_16x16x32_bf16 v[180:183], v[244:247], a[84:87], v[180:183]
    v_mfma_f32_16x16x32_bf16 v[184:187], v[240:243], a[72:75], v[184:187]
    ds_read_b64_tr_b16 v[236:237], v27 offset:35968
    v_mfma_f32_16x16x32_bf16 v[184:187], v[244:247], a[88:91], v[184:187]
    buffer_load_dwordx4 a[184:187], v30, s[8:11], s47 offen offset:3072 sc1
    v_mfma_f32_16x16x32_bf16 v[188:191], v[240:243], a[76:79], v[188:191]
    ds_read_b64_tr_b16 v[238:239], v27 offset:38528
    v_mfma_f32_16x16x32_bf16 v[188:191], v[244:247], a[92:95], v[188:191]
    s_waitcnt vmcnt(31) lgkmcnt(6)
    v_mfma_f32_16x16x32_bf16 v[192:195], v[224:227], a[96:99], v[192:195]
    s_waitcnt vmcnt(30) lgkmcnt(4)
    ds_read_b64_tr_b16 v[240:241], v27 offset:20480
    v_mfma_f32_16x16x32_bf16 v[192:195], v[228:231], a[112:115], v[192:195]
    s_waitcnt vmcnt(29)
    v_mfma_f32_16x16x32_bf16 v[196:199], v[224:227], a[100:103], v[196:199]
    s_waitcnt vmcnt(28)
    ds_read_b64_tr_b16 v[242:243], v27 offset:23040
    v_mfma_f32_16x16x32_bf16 v[196:199], v[228:231], a[116:119], v[196:199]
    s_waitcnt vmcnt(27)
    buffer_load_dwordx4 a[172:175], v31, s[8:11], s47 offen offset:2048 sc1
    v_mfma_f32_16x16x32_bf16 v[200:203], v[224:227], a[104:107], v[200:203]
    s_waitcnt vmcnt(27)
    ds_read_b64_tr_b16 v[244:245], v27 offset:25600
    v_mfma_f32_16x16x32_bf16 v[200:203], v[228:231], a[120:123], v[200:203]
    s_waitcnt vmcnt(26)
    v_mfma_f32_16x16x32_bf16 v[204:207], v[224:227], a[108:111], v[204:207]
    s_waitcnt vmcnt(25)
    ds_read_b64_tr_b16 v[246:247], v27 offset:28160
    v_mfma_f32_16x16x32_bf16 v[204:207], v[228:231], a[124:127], v[204:207]
    s_waitcnt lgkmcnt(6)
    v_mfma_f32_16x16x32_bf16 v[208:211], v[232:235], a[96:99], v[208:211]
    s_waitcnt lgkmcnt(4)
    ds_read_b64_tr_b16 v[224:225], v27 offset:30720
    v_mfma_f32_16x16x32_bf16 v[208:211], v[236:239], a[112:115], v[208:211]
    buffer_load_dwordx4 a[188:191], v31, s[8:11], s47 offen offset:3072 sc1
    v_mfma_f32_16x16x32_bf16 v[212:215], v[232:235], a[100:103], v[212:215]
    ds_read_b64_tr_b16 v[226:227], v27 offset:33280
    v_mfma_f32_16x16x32_bf16 v[212:215], v[236:239], a[116:119], v[212:215]
    v_mfma_f32_16x16x32_bf16 v[216:219], v[232:235], a[104:107], v[216:219]
    ds_read_b64_tr_b16 v[228:229], v27 offset:35840
    v_mfma_f32_16x16x32_bf16 v[216:219], v[236:239], a[120:123], v[216:219]
    v_mfma_f32_16x16x32_bf16 v[220:223], v[232:235], a[108:111], v[220:223]
    s_add_u32 s52, s37, 3538944
    s_add_u32 m0, s36, 40960
    ds_read_b64_tr_b16 v[230:231], v27 offset:38400
    v_mfma_f32_16x16x32_bf16 v[220:223], v[236:239], a[124:127], v[220:223]
    s_waitcnt lgkmcnt(6)
    buffer_load_dwordx4 v20, s[12:15], s52 offen offset:0 lds
    v_mfma_f32_16x16x32_bf16 v[64:67], v[240:243], a[96:99], v[64:67]
    s_waitcnt lgkmcnt(4)
    ds_read_b64_tr_b16 v[232:233], v27 offset:20512
    v_mfma_f32_16x16x32_bf16 v[64:67], v[244:247], a[112:115], v[64:67]
    v_mfma_f32_16x16x32_bf16 v[68:71], v[240:243], a[100:103], v[68:71]
    ds_read_b64_tr_b16 v[234:235], v27 offset:23072
    v_mfma_f32_16x16x32_bf16 v[68:71], v[244:247], a[116:119], v[68:71]
    v_mfma_f32_16x16x32_bf16 v[72:75], v[240:243], a[104:107], v[72:75]
    ds_read_b64_tr_b16 v[236:237], v27 offset:25632
    v_mfma_f32_16x16x32_bf16 v[72:75], v[244:247], a[120:123], v[72:75]
    buffer_load_dwordx4 v21, s[12:15], s52 offen offset:1024 lds
    v_mfma_f32_16x16x32_bf16 v[76:79], v[240:243], a[108:111], v[76:79]
    ds_read_b64_tr_b16 v[238:239], v27 offset:28192
    v_mfma_f32_16x16x32_bf16 v[76:79], v[244:247], a[124:127], v[76:79]
    s_waitcnt lgkmcnt(6)
    v_mfma_f32_16x16x32_bf16 v[80:83], v[224:227], a[96:99], v[80:83]
    s_waitcnt lgkmcnt(4)
    ds_read_b64_tr_b16 v[240:241], v27 offset:30752
    v_mfma_f32_16x16x32_bf16 v[80:83], v[228:231], a[112:115], v[80:83]
    v_mfma_f32_16x16x32_bf16 v[84:87], v[224:227], a[100:103], v[84:87]
    ds_read_b64_tr_b16 v[242:243], v27 offset:33312
    v_mfma_f32_16x16x32_bf16 v[84:87], v[228:231], a[116:119], v[84:87]
    buffer_load_dwordx4 v22, s[12:15], s52 offen offset:2048 lds
    v_mfma_f32_16x16x32_bf16 v[88:91], v[224:227], a[104:107], v[88:91]
    ds_read_b64_tr_b16 v[244:245], v27 offset:35872
    v_mfma_f32_16x16x32_bf16 v[88:91], v[228:231], a[120:123], v[88:91]
    v_mfma_f32_16x16x32_bf16 v[92:95], v[224:227], a[108:111], v[92:95]
    ds_read_b64_tr_b16 v[246:247], v27 offset:38432
    v_mfma_f32_16x16x32_bf16 v[92:95], v[228:231], a[124:127], v[92:95]
    s_waitcnt lgkmcnt(6)
    v_mfma_f32_16x16x32_bf16 v[96:99], v[232:235], a[96:99], v[96:99]
    s_waitcnt lgkmcnt(4)
    ds_read_b64_tr_b16 v[224:225], v27 offset:20544
    v_mfma_f32_16x16x32_bf16 v[96:99], v[236:239], a[112:115], v[96:99]
    buffer_load_dwordx4 v23, s[12:15], s52 offen offset:3072 lds
    v_mfma_f32_16x16x32_bf16 v[100:103], v[232:235], a[100:103], v[100:103]
    ds_read_b64_tr_b16 v[226:227], v27 offset:23104
    v_mfma_f32_16x16x32_bf16 v[100:103], v[236:239], a[116:119], v[100:103]
    v_mfma_f32_16x16x32_bf16 v[104:107], v[232:235], a[104:107], v[104:107]
    ds_read_b64_tr_b16 v[228:229], v27 offset:25664
    v_mfma_f32_16x16x32_bf16 v[104:107], v[236:239], a[120:123], v[104:107]
    v_mfma_f32_16x16x32_bf16 v[108:111], v[232:235], a[108:111], v[108:111]
    s_add_u32 m0, s36, 45056
    ds_read_b64_tr_b16 v[230:231], v27 offset:28224
    v_mfma_f32_16x16x32_bf16 v[108:111], v[236:239], a[124:127], v[108:111]
    s_waitcnt lgkmcnt(6)
    buffer_load_dwordx4 v24, s[12:15], s52 offen offset:0 lds
    v_mfma_f32_16x16x32_bf16 v[112:115], v[240:243], a[96:99], v[112:115]
    s_waitcnt lgkmcnt(4)
    ds_read_b64_tr_b16 v[232:233], v27 offset:30784
    v_mfma_f32_16x16x32_bf16 v[112:115], v[244:247], a[112:115], v[112:115]
    v_mfma_f32_16x16x32_bf16 v[116:119], v[240:243], a[100:103], v[116:119]
    ds_read_b64_tr_b16 v[234:235], v27 offset:33344
    v_mfma_f32_16x16x32_bf16 v[116:119], v[244:247], a[116:119], v[116:119]
    v_mfma_f32_16x16x32_bf16 v[120:123], v[240:243], a[104:107], v[120:123]
    s_add_u32 s52, s37, 4128768
    s_add_u32 m0, s36, 61440
    ds_read_b64_tr_b16 v[236:237], v27 offset:35904
    v_mfma_f32_16x16x32_bf16 v[120:123], v[244:247], a[120:123], v[120:123]
    buffer_load_dwordx4 v20, s[12:15], s52 offen offset:0 lds
    v_mfma_f32_16x16x32_bf16 v[124:127], v[240:243], a[108:111], v[124:127]
    ds_read_b64_tr_b16 v[238:239], v27 offset:38464
    v_mfma_f32_16x16x32_bf16 v[124:127], v[244:247], a[124:127], v[124:127]
    s_waitcnt lgkmcnt(6)
    v_mfma_f32_16x16x32_bf16 v[128:131], v[224:227], a[96:99], v[128:131]
    s_waitcnt lgkmcnt(4)
    ds_read_b64_tr_b16 v[240:241], v27 offset:20576
    v_mfma_f32_16x16x32_bf16 v[128:131], v[228:231], a[112:115], v[128:131]
    v_mfma_f32_16x16x32_bf16 v[132:135], v[224:227], a[100:103], v[132:135]
    ds_read_b64_tr_b16 v[242:243], v27 offset:23136
    v_mfma_f32_16x16x32_bf16 v[132:135], v[228:231], a[116:119], v[132:135]
    buffer_load_dwordx4 v21, s[12:15], s52 offen offset:1024 lds
    v_mfma_f32_16x16x32_bf16 v[136:139], v[224:227], a[104:107], v[136:139]
    ds_read_b64_tr_b16 v[244:245], v27 offset:25696
    v_mfma_f32_16x16x32_bf16 v[136:139], v[228:231], a[120:123], v[136:139]
    v_mfma_f32_16x16x32_bf16 v[140:143], v[224:227], a[108:111], v[140:143]
    ds_read_b64_tr_b16 v[246:247], v27 offset:28256
    v_mfma_f32_16x16x32_bf16 v[140:143], v[228:231], a[124:127], v[140:143]
    s_waitcnt lgkmcnt(6)
    v_mfma_f32_16x16x32_bf16 v[144:147], v[232:235], a[96:99], v[144:147]
    s_waitcnt lgkmcnt(4)
    ds_read_b64_tr_b16 v[224:225], v27 offset:30816
    v_mfma_f32_16x16x32_bf16 v[144:147], v[236:239], a[112:115], v[144:147]
    ds_read_b64_tr_b16 v[226:227], v27 offset:33376
    v_mfma_f32_16x16x32_bf16 v[148:151], v[232:235], a[100:103], v[148:151]
    ds_read_b64_tr_b16 v[228:229], v27 offset:35936
    v_mfma_f32_16x16x32_bf16 v[148:151], v[236:239], a[116:119], v[148:151]
    ds_read_b64_tr_b16 v[230:231], v27 offset:38496
    v_mfma_f32_16x16x32_bf16 v[152:155], v[232:235], a[104:107], v[152:155]
    v_add_u32 v26, 81920, v25
    v_mfma_f32_16x16x32_bf16 v[152:155], v[236:239], a[120:123], v[152:155]
    buffer_load_dwordx4 v22, s[12:15], s52 offen offset:2048 lds
    v_mfma_f32_16x16x32_bf16 v[156:159], v[232:235], a[108:111], v[156:159]
    v_mfma_f32_16x16x32_bf16 v[156:159], v[236:239], a[124:127], v[156:159]
    s_waitcnt lgkmcnt(0)
    v_mfma_f32_16x16x32_bf16 v[160:163], v[240:243], a[96:99], v[160:163]
    s_waitcnt vmcnt(24)
    s_barrier
    ds_read_b64_tr_b16 v[232:233], v26 offset:128
    v_mfma_f32_16x16x32_bf16 v[160:163], v[244:247], a[112:115], v[160:163]
    v_mfma_f32_16x16x32_bf16 v[164:167], v[240:243], a[100:103], v[164:167]
    ds_read_b64_tr_b16 v[234:235], v26 offset:2688
    v_mfma_f32_16x16x32_bf16 v[164:167], v[244:247], a[116:119], v[164:167]
    buffer_load_dwordx4 v23, s[12:15], s52 offen offset:3072 lds
    v_mfma_f32_16x16x32_bf16 v[168:171], v[240:243], a[104:107], v[168:171]
    ds_read_b64_tr_b16 v[236:237], v26 offset:5248
    v_mfma_f32_16x16x32_bf16 v[168:171], v[244:247], a[120:123], v[168:171]
    v_mfma_f32_16x16x32_bf16 v[172:175], v[240:243], a[108:111], v[172:175]
    ds_read_b64_tr_b16 v[238:239], v26 offset:7808
    v_mfma_f32_16x16x32_bf16 v[172:175], v[244:247], a[124:127], v[172:175]
    v_mfma_f32_16x16x32_bf16 v[176:179], v[224:227], a[96:99], v[176:179]
    s_add_u32 m0, s36, 65536
    ds_read_b64_tr_b16 v[240:241], v26 offset:10368
    v_mfma_f32_16x16x32_bf16 v[176:179], v[228:231], a[112:115], v[176:179]
    buffer_load_dwordx4 v24, s[12:15], s52 offen offset:0 lds
    v_mfma_f32_16x16x32_bf16 v[180:183], v[224:227], a[100:103], v[180:183]
    ds_read_b64_tr_b16 v[242:243], v26 offset:12928
    v_mfma_f32_16x16x32_bf16 v[180:183], v[228:231], a[116:119], v[180:183]
    v_mfma_f32_16x16x32_bf16 v[184:187], v[224:227], a[104:107], v[184:187]
    ds_read_b64_tr_b16 v[244:245], v26 offset:15488
    v_mfma_f32_16x16x32_bf16 v[184:187], v[228:231], a[120:123], v[184:187]
    v_mfma_f32_16x16x32_bf16 v[188:191], v[224:227], a[108:111], v[188:191]
    ds_read_b64_tr_b16 v[246:247], v26 offset:18048
    v_mfma_f32_16x16x32_bf16 v[188:191], v[228:231], a[124:127], v[188:191]
    s_waitcnt vmcnt(25) lgkmcnt(6)
    buffer_load_dwordx4 a[192:195], v28, s[8:11], s48 offen offset:0 sc1
    v_mfma_f32_16x16x32_bf16 v[192:195], v[232:235], a[128:131], v[192:195]
    s_waitcnt vmcnt(25) lgkmcnt(4)
    ds_read_b64_tr_b16 v[224:225], v26 offset:0
    v_mfma_f32_16x16x32_bf16 v[192:195], v[236:239], a[144:147], v[192:195]
    s_waitcnt vmcnt(24)
    v_mfma_f32_16x16x32_bf16 v[196:199], v[232:235], a[132:135], v[196:199]
    s_waitcnt vmcnt(23)
    ds_read_b64_tr_b16 v[226:227], v26 offset:2560
    v_mfma_f32_16x16x32_bf16 v[196:199], v[236:239], a[148:151], v[196:199]
    s_waitcnt vmcnt(22)
    v_mfma_f32_16x16x32_bf16 v[200:203], v[232:235], a[136:139], v[200:203]
    s_waitcnt vmcnt(21)
    ds_read_b64_tr_b16 v[228:229], v26 offset:5120
    v_mfma_f32_16x16x32_bf16 v[200:203], v[236:239], a[152:155], v[200:203]
    s_waitcnt vmcnt(20)
    buffer_load_dwordx4 a[208:211], v28, s[8:11], s48 offen offset:1024 sc1
    v_mfma_f32_16x16x32_bf16 v[204:207], v[232:235], a[140:143], v[204:207]
    s_waitcnt vmcnt(20)
    ds_read_b64_tr_b16 v[230:231], v26 offset:7680
    v_mfma_f32_16x16x32_bf16 v[204:207], v[236:239], a[156:159], v[204:207]
    s_waitcnt lgkmcnt(6)
    v_mfma_f32_16x16x32_bf16 v[208:211], v[240:243], a[128:131], v[208:211]
    s_waitcnt lgkmcnt(4)
    ds_read_b64_tr_b16 v[232:233], v26 offset:10240
    v_mfma_f32_16x16x32_bf16 v[208:211], v[244:247], a[144:147], v[208:211]
    v_mfma_f32_16x16x32_bf16 v[212:215], v[240:243], a[132:135], v[212:215]
    ds_read_b64_tr_b16 v[234:235], v26 offset:12800
    v_mfma_f32_16x16x32_bf16 v[212:215], v[244:247], a[148:151], v[212:215]
    buffer_load_dwordx4 a[196:199], v29, s[8:11], s48 offen offset:0 sc1
    v_mfma_f32_16x16x32_bf16 v[216:219], v[240:243], a[136:139], v[216:219]
    ds_read_b64_tr_b16 v[236:237], v26 offset:15360
    v_mfma_f32_16x16x32_bf16 v[216:219], v[244:247], a[152:155], v[216:219]
    v_mfma_f32_16x16x32_bf16 v[220:223], v[240:243], a[140:143], v[220:223]
    ds_read_b64_tr_b16 v[238:239], v26 offset:17920
    v_mfma_f32_16x16x32_bf16 v[220:223], v[244:247], a[156:159], v[220:223]
    s_waitcnt lgkmcnt(6)
    v_mfma_f32_16x16x32_bf16 v[64:67], v[224:227], a[128:131], v[64:67]
    s_waitcnt lgkmcnt(4)
    ds_read_b64_tr_b16 v[240:241], v26 offset:32
    v_mfma_f32_16x16x32_bf16 v[64:67], v[228:231], a[144:147], v[64:67]
    buffer_load_dwordx4 a[212:215], v29, s[8:11], s48 offen offset:1024 sc1
    v_mfma_f32_16x16x32_bf16 v[68:71], v[224:227], a[132:135], v[68:71]
    ds_read_b64_tr_b16 v[242:243], v26 offset:2592
    v_mfma_f32_16x16x32_bf16 v[68:71], v[228:231], a[148:151], v[68:71]
    v_mfma_f32_16x16x32_bf16 v[72:75], v[224:227], a[136:139], v[72:75]
    ds_read_b64_tr_b16 v[244:245], v26 offset:5152
    v_mfma_f32_16x16x32_bf16 v[72:75], v[228:231], a[152:155], v[72:75]
    v_mfma_f32_16x16x32_bf16 v[76:79], v[224:227], a[140:143], v[76:79]
    ds_read_b64_tr_b16 v[246:247], v26 offset:7712
    v_mfma_f32_16x16x32_bf16 v[76:79], v[228:231], a[156:159], v[76:79]
    s_waitcnt lgkmcnt(6)
    buffer_load_dwordx4 a[200:203], v30, s[8:11], s48 offen offset:0 sc1
    v_mfma_f32_16x16x32_bf16 v[80:83], v[232:235], a[128:131], v[80:83]
    s_waitcnt lgkmcnt(4)
    ds_read_b64_tr_b16 v[224:225], v26 offset:10272
    v_mfma_f32_16x16x32_bf16 v[80:83], v[236:239], a[144:147], v[80:83]
    v_mfma_f32_16x16x32_bf16 v[84:87], v[232:235], a[132:135], v[84:87]
    ds_read_b64_tr_b16 v[226:227], v26 offset:12832
    v_mfma_f32_16x16x32_bf16 v[84:87], v[236:239], a[148:151], v[84:87]
    v_mfma_f32_16x16x32_bf16 v[88:91], v[232:235], a[136:139], v[88:91]
    ds_read_b64_tr_b16 v[228:229], v26 offset:15392
    v_mfma_f32_16x16x32_bf16 v[88:91], v[236:239], a[152:155], v[88:91]
    buffer_load_dwordx4 a[216:219], v30, s[8:11], s48 offen offset:1024 sc1
    v_mfma_f32_16x16x32_bf16 v[92:95], v[232:235], a[140:143], v[92:95]
    ds_read_b64_tr_b16 v[230:231], v26 offset:17952
    v_mfma_f32_16x16x32_bf16 v[92:95], v[236:239], a[156:159], v[92:95]
    s_waitcnt lgkmcnt(6)
    v_mfma_f32_16x16x32_bf16 v[96:99], v[240:243], a[128:131], v[96:99]
    s_waitcnt lgkmcnt(4)
    ds_read_b64_tr_b16 v[232:233], v26 offset:64
    v_mfma_f32_16x16x32_bf16 v[96:99], v[244:247], a[144:147], v[96:99]
    v_mfma_f32_16x16x32_bf16 v[100:103], v[240:243], a[132:135], v[100:103]
    ds_read_b64_tr_b16 v[234:235], v26 offset:2624
    v_mfma_f32_16x16x32_bf16 v[100:103], v[244:247], a[148:151], v[100:103]
    buffer_load_dwordx4 a[204:207], v31, s[8:11], s48 offen offset:0 sc1
    v_mfma_f32_16x16x32_bf16 v[104:107], v[240:243], a[136:139], v[104:107]
    ds_read_b64_tr_b16 v[236:237], v26 offset:5184
    v_mfma_f32_16x16x32_bf16 v[104:107], v[244:247], a[152:155], v[104:107]
    v_mfma_f32_16x16x32_bf16 v[108:111], v[240:243], a[140:143], v[108:111]
    ds_read_b64_tr_b16 v[238:239], v26 offset:7744
    v_mfma_f32_16x16x32_bf16 v[108:111], v[244:247], a[156:159], v[108:111]
    s_waitcnt lgkmcnt(6)
    v_mfma_f32_16x16x32_bf16 v[112:115], v[224:227], a[128:131], v[112:115]
    s_waitcnt lgkmcnt(4)
    ds_read_b64_tr_b16 v[240:241], v26 offset:10304
    v_mfma_f32_16x16x32_bf16 v[112:115], v[228:231], a[144:147], v[112:115]
    buffer_load_dwordx4 a[220:223], v31, s[8:11], s48 offen offset:1024 sc1
    v_mfma_f32_16x16x32_bf16 v[116:119], v[224:227], a[132:135], v[116:119]
    ds_read_b64_tr_b16 v[242:243], v26 offset:12864
    v_mfma_f32_16x16x32_bf16 v[116:119], v[228:231], a[148:151], v[116:119]
    v_mfma_f32_16x16x32_bf16 v[120:123], v[224:227], a[136:139], v[120:123]
    ds_read_b64_tr_b16 v[244:245], v26 offset:15424
    v_mfma_f32_16x16x32_bf16 v[120:123], v[228:231], a[152:155], v[120:123]
    v_mfma_f32_16x16x32_bf16 v[124:127], v[224:227], a[140:143], v[124:127]
    ds_read_b64_tr_b16 v[246:247], v26 offset:17984
    v_mfma_f32_16x16x32_bf16 v[124:127], v[228:231], a[156:159], v[124:127]
    s_waitcnt lgkmcnt(6)
    buffer_load_dwordx4 a[224:227], v28, s[8:11], s48 offen offset:2048 sc1
    v_mfma_f32_16x16x32_bf16 v[128:131], v[232:235], a[128:131], v[128:131]
    s_waitcnt lgkmcnt(4)
    ds_read_b64_tr_b16 v[224:225], v26 offset:96
    v_mfma_f32_16x16x32_bf16 v[128:131], v[236:239], a[144:147], v[128:131]
    v_mfma_f32_16x16x32_bf16 v[132:135], v[232:235], a[132:135], v[132:135]
    ds_read_b64_tr_b16 v[226:227], v26 offset:2656
    v_mfma_f32_16x16x32_bf16 v[132:135], v[236:239], a[148:151], v[132:135]
    v_mfma_f32_16x16x32_bf16 v[136:139], v[232:235], a[136:139], v[136:139]
    ds_read_b64_tr_b16 v[228:229], v26 offset:5216
    v_mfma_f32_16x16x32_bf16 v[136:139], v[236:239], a[152:155], v[136:139]
    buffer_load_dwordx4 a[240:243], v28, s[8:11], s48 offen offset:3072 sc1
    v_mfma_f32_16x16x32_bf16 v[140:143], v[232:235], a[140:143], v[140:143]
    ds_read_b64_tr_b16 v[230:231], v26 offset:7776
    v_mfma_f32_16x16x32_bf16 v[140:143], v[236:239], a[156:159], v[140:143]
    s_waitcnt lgkmcnt(6)
    v_mfma_f32_16x16x32_bf16 v[144:147], v[240:243], a[128:131], v[144:147]
    s_waitcnt lgkmcnt(4)
    ds_read_b64_tr_b16 v[232:233], v26 offset:10336
    v_mfma_f32_16x16x32_bf16 v[144:147], v[244:247], a[144:147], v[144:147]
    v_mfma_f32_16x16x32_bf16 v[148:151], v[240:243], a[132:135], v[148:151]
    ds_read_b64_tr_b16 v[234:235], v26 offset:12896
    v_mfma_f32_16x16x32_bf16 v[148:151], v[244:247], a[148:151], v[148:151]
    buffer_load_dwordx4 a[228:231], v29, s[8:11], s48 offen offset:2048 sc1
    v_mfma_f32_16x16x32_bf16 v[152:155], v[240:243], a[136:139], v[152:155]
    ds_read_b64_tr_b16 v[236:237], v26 offset:15456
    v_mfma_f32_16x16x32_bf16 v[152:155], v[244:247], a[152:155], v[152:155]
    v_mfma_f32_16x16x32_bf16 v[156:159], v[240:243], a[140:143], v[156:159]
    ds_read_b64_tr_b16 v[238:239], v26 offset:18016
    v_mfma_f32_16x16x32_bf16 v[156:159], v[244:247], a[156:159], v[156:159]
    s_waitcnt lgkmcnt(6)
    v_mfma_f32_16x16x32_bf16 v[160:163], v[224:227], a[128:131], v[160:163]
    s_waitcnt lgkmcnt(4)
    ds_read_b64_tr_b16 v[240:241], v26 offset:20608
    v_mfma_f32_16x16x32_bf16 v[160:163], v[228:231], a[144:147], v[160:163]
    buffer_load_dwordx4 a[244:247], v29, s[8:11], s48 offen offset:3072 sc1
    v_mfma_f32_16x16x32_bf16 v[164:167], v[224:227], a[132:135], v[164:167]
    ds_read_b64_tr_b16 v[242:243], v26 offset:23168
    v_mfma_f32_16x16x32_bf16 v[164:167], v[228:231], a[148:151], v[164:167]
    v_mfma_f32_16x16x32_bf16 v[168:171], v[224:227], a[136:139], v[168:171]
    ds_read_b64_tr_b16 v[244:245], v26 offset:25728
    v_mfma_f32_16x16x32_bf16 v[168:171], v[228:231], a[152:155], v[168:171]
    v_mfma_f32_16x16x32_bf16 v[172:175], v[224:227], a[140:143], v[172:175]
    ds_read_b64_tr_b16 v[246:247], v26 offset:28288
    v_mfma_f32_16x16x32_bf16 v[172:175], v[228:231], a[156:159], v[172:175]
    s_waitcnt lgkmcnt(6)
    buffer_load_dwordx4 a[232:235], v30, s[8:11], s48 offen offset:2048 sc1
    v_mfma_f32_16x16x32_bf16 v[176:179], v[232:235], a[128:131], v[176:179]
    s_waitcnt lgkmcnt(4)
    ds_read_b64_tr_b16 v[224:225], v26 offset:30848
    v_mfma_f32_16x16x32_bf16 v[176:179], v[236:239], a[144:147], v[176:179]
    v_mfma_f32_16x16x32_bf16 v[180:183], v[232:235], a[132:135], v[180:183]
    ds_read_b64_tr_b16 v[226:227], v26 offset:33408
    v_mfma_f32_16x16x32_bf16 v[180:183], v[236:239], a[148:151], v[180:183]
    v_mfma_f32_16x16x32_bf16 v[184:187], v[232:235], a[136:139], v[184:187]
    ds_read_b64_tr_b16 v[228:229], v26 offset:35968
    v_mfma_f32_16x16x32_bf16 v[184:187], v[236:239], a[152:155], v[184:187]
    buffer_load_dwordx4 a[248:251], v30, s[8:11], s48 offen offset:3072 sc1
    v_mfma_f32_16x16x32_bf16 v[188:191], v[232:235], a[140:143], v[188:191]
    ds_read_b64_tr_b16 v[230:231], v26 offset:38528
    v_mfma_f32_16x16x32_bf16 v[188:191], v[236:239], a[156:159], v[188:191]
    s_waitcnt vmcnt(31) lgkmcnt(6)
    v_mfma_f32_16x16x32_bf16 v[192:195], v[240:243], a[160:163], v[192:195]
    s_waitcnt vmcnt(30) lgkmcnt(4)
    ds_read_b64_tr_b16 v[232:233], v26 offset:20480
    v_mfma_f32_16x16x32_bf16 v[192:195], v[244:247], a[176:179], v[192:195]
    s_waitcnt vmcnt(29)
    v_mfma_f32_16x16x32_bf16 v[196:199], v[240:243], a[164:167], v[196:199]
    s_waitcnt vmcnt(28)
    ds_read_b64_tr_b16 v[234:235], v26 offset:23040
    v_mfma_f32_16x16x32_bf16 v[196:199], v[244:247], a[180:183], v[196:199]
    s_waitcnt vmcnt(27)
    buffer_load_dwordx4 a[236:239], v31, s[8:11], s48 offen offset:2048 sc1
    v_mfma_f32_16x16x32_bf16 v[200:203], v[240:243], a[168:171], v[200:203]
    s_waitcnt vmcnt(27)
    ds_read_b64_tr_b16 v[236:237], v26 offset:25600
    v_mfma_f32_16x16x32_bf16 v[200:203], v[244:247], a[184:187], v[200:203]
    s_waitcnt vmcnt(26)
    v_mfma_f32_16x16x32_bf16 v[204:207], v[240:243], a[172:175], v[204:207]
    s_waitcnt vmcnt(25)
    ds_read_b64_tr_b16 v[238:239], v26 offset:28160
    v_mfma_f32_16x16x32_bf16 v[204:207], v[244:247], a[188:191], v[204:207]
    s_waitcnt lgkmcnt(6)
    v_mfma_f32_16x16x32_bf16 v[208:211], v[224:227], a[160:163], v[208:211]
    s_waitcnt lgkmcnt(4)
    ds_read_b64_tr_b16 v[240:241], v26 offset:30720
    v_mfma_f32_16x16x32_bf16 v[208:211], v[228:231], a[176:179], v[208:211]
    buffer_load_dwordx4 a[252:255], v31, s[8:11], s48 offen offset:3072 sc1
    v_mfma_f32_16x16x32_bf16 v[212:215], v[224:227], a[164:167], v[212:215]
    ds_read_b64_tr_b16 v[242:243], v26 offset:33280
    v_mfma_f32_16x16x32_bf16 v[212:215], v[228:231], a[180:183], v[212:215]
    v_mfma_f32_16x16x32_bf16 v[216:219], v[224:227], a[168:171], v[216:219]
    ds_read_b64_tr_b16 v[244:245], v26 offset:35840
    v_mfma_f32_16x16x32_bf16 v[216:219], v[228:231], a[184:187], v[216:219]
    v_mfma_f32_16x16x32_bf16 v[220:223], v[224:227], a[172:175], v[220:223]
    s_add_u32 s52, s37, 4718592
    s_add_u32 m0, s36, 0
    ds_read_b64_tr_b16 v[246:247], v26 offset:38400
    v_mfma_f32_16x16x32_bf16 v[220:223], v[228:231], a[188:191], v[220:223]
    s_waitcnt lgkmcnt(6)
    buffer_load_dwordx4 v20, s[12:15], s52 offen offset:0 lds
    v_mfma_f32_16x16x32_bf16 v[64:67], v[232:235], a[160:163], v[64:67]
    s_waitcnt lgkmcnt(4)
    ds_read_b64_tr_b16 v[224:225], v26 offset:20512
    v_mfma_f32_16x16x32_bf16 v[64:67], v[236:239], a[176:179], v[64:67]
    v_mfma_f32_16x16x32_bf16 v[68:71], v[232:235], a[164:167], v[68:71]
    ds_read_b64_tr_b16 v[226:227], v26 offset:23072
    v_mfma_f32_16x16x32_bf16 v[68:71], v[236:239], a[180:183], v[68:71]
    v_mfma_f32_16x16x32_bf16 v[72:75], v[232:235], a[168:171], v[72:75]
    ds_read_b64_tr_b16 v[228:229], v26 offset:25632
    v_mfma_f32_16x16x32_bf16 v[72:75], v[236:239], a[184:187], v[72:75]
    buffer_load_dwordx4 v21, s[12:15], s52 offen offset:1024 lds
    v_mfma_f32_16x16x32_bf16 v[76:79], v[232:235], a[172:175], v[76:79]
    ds_read_b64_tr_b16 v[230:231], v26 offset:28192
    v_mfma_f32_16x16x32_bf16 v[76:79], v[236:239], a[188:191], v[76:79]
    s_waitcnt lgkmcnt(6)
    v_mfma_f32_16x16x32_bf16 v[80:83], v[240:243], a[160:163], v[80:83]
    s_waitcnt lgkmcnt(4)
    ds_read_b64_tr_b16 v[232:233], v26 offset:30752
    v_mfma_f32_16x16x32_bf16 v[80:83], v[244:247], a[176:179], v[80:83]
    v_mfma_f32_16x16x32_bf16 v[84:87], v[240:243], a[164:167], v[84:87]
    ds_read_b64_tr_b16 v[234:235], v26 offset:33312
    v_mfma_f32_16x16x32_bf16 v[84:87], v[244:247], a[180:183], v[84:87]
    buffer_load_dwordx4 v22, s[12:15], s52 offen offset:2048 lds
    v_mfma_f32_16x16x32_bf16 v[88:91], v[240:243], a[168:171], v[88:91]
    ds_read_b64_tr_b16 v[236:237], v26 offset:35872
    v_mfma_f32_16x16x32_bf16 v[88:91], v[244:247], a[184:187], v[88:91]
    v_mfma_f32_16x16x32_bf16 v[92:95], v[240:243], a[172:175], v[92:95]
    ds_read_b64_tr_b16 v[238:239], v26 offset:38432
    v_mfma_f32_16x16x32_bf16 v[92:95], v[244:247], a[188:191], v[92:95]
    s_waitcnt lgkmcnt(6)
    v_mfma_f32_16x16x32_bf16 v[96:99], v[224:227], a[160:163], v[96:99]
    s_waitcnt lgkmcnt(4)
    ds_read_b64_tr_b16 v[240:241], v26 offset:20544
    v_mfma_f32_16x16x32_bf16 v[96:99], v[228:231], a[176:179], v[96:99]
    buffer_load_dwordx4 v23, s[12:15], s52 offen offset:3072 lds
    v_mfma_f32_16x16x32_bf16 v[100:103], v[224:227], a[164:167], v[100:103]
    ds_read_b64_tr_b16 v[242:243], v26 offset:23104
    v_mfma_f32_16x16x32_bf16 v[100:103], v[228:231], a[180:183], v[100:103]
    v_mfma_f32_16x16x32_bf16 v[104:107], v[224:227], a[168:171], v[104:107]
    ds_read_b64_tr_b16 v[244:245], v26 offset:25664
    v_mfma_f32_16x16x32_bf16 v[104:107], v[228:231], a[184:187], v[104:107]
    v_mfma_f32_16x16x32_bf16 v[108:111], v[224:227], a[172:175], v[108:111]
    s_add_u32 m0, s36, 4096
    ds_read_b64_tr_b16 v[246:247], v26 offset:28224
    v_mfma_f32_16x16x32_bf16 v[108:111], v[228:231], a[188:191], v[108:111]
    s_waitcnt lgkmcnt(6)
    buffer_load_dwordx4 v24, s[12:15], s52 offen offset:0 lds
    v_mfma_f32_16x16x32_bf16 v[112:115], v[232:235], a[160:163], v[112:115]
    s_waitcnt lgkmcnt(4)
    ds_read_b64_tr_b16 v[224:225], v26 offset:30784
    v_bfe_u32 v254, v248, 0, 1
    v_mfma_f32_16x16x32_bf16 v[112:115], v[236:239], a[176:179], v[112:115]
    v_lshl_add_u32 v20, v254, 30, v20
    v_bfe_u32 v254, v248, 1, 1
    v_mfma_f32_16x16x32_bf16 v[116:119], v[232:235], a[164:167], v[116:119]
    ds_read_b64_tr_b16 v[226:227], v26 offset:33344
    v_lshl_add_u32 v21, v254, 30, v21
    v_mfma_f32_16x16x32_bf16 v[116:119], v[236:239], a[180:183], v[116:119]
    v_bfe_u32 v254, v248, 2, 1
    v_lshl_add_u32 v22, v254, 30, v22
    v_mfma_f32_16x16x32_bf16 v[120:123], v[232:235], a[168:171], v[120:123]
    ds_read_b64_tr_b16 v[228:229], v26 offset:35904
    v_bfe_u32 v254, v248, 3, 1
    v_mfma_f32_16x16x32_bf16 v[120:123], v[236:239], a[184:187], v[120:123]
    v_lshl_add_u32 v23, v254, 30, v23
    v_bfe_u32 v254, v248, 4, 1
    v_mfma_f32_16x16x32_bf16 v[124:127], v[232:235], a[172:175], v[124:127]
    ds_read_b64_tr_b16 v[230:231], v26 offset:38464
    v_lshl_add_u32 v24, v254, 30, v24
    v_mfma_f32_16x16x32_bf16 v[124:127], v[236:239], a[188:191], v[124:127]
    s_waitcnt lgkmcnt(6)
    v_mfma_f32_16x16x32_bf16 v[128:131], v[240:243], a[160:163], v[128:131]
    s_waitcnt lgkmcnt(4)
    s_add_u32 s52, s37, 128
    s_add_u32 m0, s36, 20480
    ds_read_b64_tr_b16 v[232:233], v26 offset:20576
    v_mfma_f32_16x16x32_bf16 v[128:131], v[244:247], a[176:179], v[128:131]
    buffer_load_dwordx4 v20, s[12:15], s52 offen offset:0 lds
    v_mfma_f32_16x16x32_bf16 v[132:135], v[240:243], a[164:167], v[132:135]
    ds_read_b64_tr_b16 v[234:235], v26 offset:23136
    v_mfma_f32_16x16x32_bf16 v[132:135], v[244:247], a[180:183], v[132:135]
    v_mfma_f32_16x16x32_bf16 v[136:139], v[240:243], a[168:171], v[136:139]
    ds_read_b64_tr_b16 v[236:237], v26 offset:25696
    v_mfma_f32_16x16x32_bf16 v[136:139], v[244:247], a[184:187], v[136:139]
    v_mfma_f32_16x16x32_bf16 v[140:143], v[240:243], a[172:175], v[140:143]
    ds_read_b64_tr_b16 v[238:239], v26 offset:28256
    v_mfma_f32_16x16x32_bf16 v[140:143], v[244:247], a[188:191], v[140:143]
    s_waitcnt lgkmcnt(6)
    buffer_load_dwordx4 v21, s[12:15], s52 offen offset:1024 lds
    v_mfma_f32_16x16x32_bf16 v[144:147], v[224:227], a[160:163], v[144:147]
    s_waitcnt lgkmcnt(4)
    ds_read_b64_tr_b16 v[240:241], v26 offset:30816
    v_mfma_f32_16x16x32_bf16 v[144:147], v[228:231], a[176:179], v[144:147]
    ds_read_b64_tr_b16 v[242:243], v26 offset:33376
    v_mfma_f32_16x16x32_bf16 v[148:151], v[224:227], a[164:167], v[148:151]
    ds_read_b64_tr_b16 v[244:245], v26 offset:35936
    v_mfma_f32_16x16x32_bf16 v[148:151], v[228:231], a[180:183], v[148:151]
    ds_read_b64_tr_b16 v[246:247], v26 offset:38496
    v_mfma_f32_16x16x32_bf16 v[152:155], v[224:227], a[168:171], v[152:155]
    v_add_u32 v27, 40960, v25
    v_mfma_f32_16x16x32_bf16 v[152:155], v[228:231], a[184:187], v[152:155]
    buffer_load_dwordx4 v22, s[12:15], s52 offen offset:2048 lds
    v_mfma_f32_16x16x32_bf16 v[156:159], v[224:227], a[172:175], v[156:159]
    v_mfma_f32_16x16x32_bf16 v[156:159], v[228:231], a[188:191], v[156:159]
    s_waitcnt lgkmcnt(0)
    v_mfma_f32_16x16x32_bf16 v[160:163], v[232:235], a[160:163], v[160:163]
    s_waitcnt vmcnt(24)
    s_barrier
    ds_read_b64_tr_b16 v[224:225], v27 offset:128
    v_mfma_f32_16x16x32_bf16 v[160:163], v[236:239], a[176:179], v[160:163]
    v_mfma_f32_16x16x32_bf16 v[164:167], v[232:235], a[164:167], v[164:167]
    ds_read_b64_tr_b16 v[226:227], v27 offset:2688
    v_mfma_f32_16x16x32_bf16 v[164:167], v[236:239], a[180:183], v[164:167]
    buffer_load_dwordx4 v23, s[12:15], s52 offen offset:3072 lds
    v_mfma_f32_16x16x32_bf16 v[168:171], v[232:235], a[168:171], v[168:171]
    ds_read_b64_tr_b16 v[228:229], v27 offset:5248
    v_mfma_f32_16x16x32_bf16 v[168:171], v[236:239], a[184:187], v[168:171]
    v_mfma_f32_16x16x32_bf16 v[172:175], v[232:235], a[172:175], v[172:175]
    ds_read_b64_tr_b16 v[230:231], v27 offset:7808
    v_mfma_f32_16x16x32_bf16 v[172:175], v[236:239], a[188:191], v[172:175]
    v_mfma_f32_16x16x32_bf16 v[176:179], v[240:243], a[160:163], v[176:179]
    s_add_u32 m0, s36, 24576
    ds_read_b64_tr_b16 v[232:233], v27 offset:10368
    v_mfma_f32_16x16x32_bf16 v[176:179], v[244:247], a[176:179], v[176:179]
    buffer_load_dwordx4 v24, s[12:15], s52 offen offset:0 lds
    v_mfma_f32_16x16x32_bf16 v[180:183], v[240:243], a[164:167], v[180:183]
    ds_read_b64_tr_b16 v[234:235], v27 offset:12928
    v_mfma_f32_16x16x32_bf16 v[180:183], v[244:247], a[180:183], v[180:183]
    v_mfma_f32_16x16x32_bf16 v[184:187], v[240:243], a[168:171], v[184:187]
    ds_read_b64_tr_b16 v[236:237], v27 offset:15488
    v_mfma_f32_16x16x32_bf16 v[184:187], v[244:247], a[184:187], v[184:187]
    v_mfma_f32_16x16x32_bf16 v[188:191], v[240:243], a[172:175], v[188:191]
    ds_read_b64_tr_b16 v[238:239], v27 offset:18048
    v_mfma_f32_16x16x32_bf16 v[188:191], v[244:247], a[188:191], v[188:191]
    s_waitcnt vmcnt(25) lgkmcnt(6)
    buffer_load_dwordx4 v[32:35], v28, s[8:11], s49 offen offset:0 sc1
    v_mfma_f32_16x16x32_bf16 v[192:195], v[224:227], a[192:195], v[192:195]
    s_waitcnt vmcnt(25) lgkmcnt(4)
    ds_read_b64_tr_b16 v[240:241], v27 offset:0
    v_mfma_f32_16x16x32_bf16 v[192:195], v[228:231], a[208:211], v[192:195]
    s_waitcnt vmcnt(24)
    v_mfma_f32_16x16x32_bf16 v[196:199], v[224:227], a[196:199], v[196:199]
    s_waitcnt vmcnt(23)
    ds_read_b64_tr_b16 v[242:243], v27 offset:2560
    v_mfma_f32_16x16x32_bf16 v[196:199], v[228:231], a[212:215], v[196:199]
    s_waitcnt vmcnt(22)
    v_mfma_f32_16x16x32_bf16 v[200:203], v[224:227], a[200:203], v[200:203]
    s_waitcnt vmcnt(21)
    ds_read_b64_tr_b16 v[244:245], v27 offset:5120
    v_mfma_f32_16x16x32_bf16 v[200:203], v[228:231], a[216:219], v[200:203]
    s_waitcnt vmcnt(20)
    buffer_load_dwordx4 v[48:51], v28, s[8:11], s49 offen offset:1024 sc1
    v_mfma_f32_16x16x32_bf16 v[204:207], v[224:227], a[204:207], v[204:207]
    s_waitcnt vmcnt(20)
    ds_read_b64_tr_b16 v[246:247], v27 offset:7680
    v_mfma_f32_16x16x32_bf16 v[204:207], v[228:231], a[220:223], v[204:207]
    s_waitcnt lgkmcnt(6)
    v_mfma_f32_16x16x32_bf16 v[208:211], v[232:235], a[192:195], v[208:211]
    s_waitcnt lgkmcnt(4)
    ds_read_b64_tr_b16 v[224:225], v27 offset:10240
    v_mfma_f32_16x16x32_bf16 v[208:211], v[236:239], a[208:211], v[208:211]
    v_mfma_f32_16x16x32_bf16 v[212:215], v[232:235], a[196:199], v[212:215]
    ds_read_b64_tr_b16 v[226:227], v27 offset:12800
    v_mfma_f32_16x16x32_bf16 v[212:215], v[236:239], a[212:215], v[212:215]
    buffer_load_dwordx4 v[36:39], v29, s[8:11], s49 offen offset:0 sc1
    v_mfma_f32_16x16x32_bf16 v[216:219], v[232:235], a[200:203], v[216:219]
    ds_read_b64_tr_b16 v[228:229], v27 offset:15360
    v_mfma_f32_16x16x32_bf16 v[216:219], v[236:239], a[216:219], v[216:219]
    v_mfma_f32_16x16x32_bf16 v[220:223], v[232:235], a[204:207], v[220:223]
    ds_read_b64_tr_b16 v[230:231], v27 offset:17920
    v_mfma_f32_16x16x32_bf16 v[220:223], v[236:239], a[220:223], v[220:223]
    s_waitcnt lgkmcnt(6)
    v_mfma_f32_16x16x32_bf16 v[64:67], v[240:243], a[192:195], v[64:67]
    s_waitcnt lgkmcnt(4)
    ds_read_b64_tr_b16 v[232:233], v27 offset:32
    v_mfma_f32_16x16x32_bf16 v[64:67], v[244:247], a[208:211], v[64:67]
    buffer_load_dwordx4 v[52:55], v29, s[8:11], s49 offen offset:1024 sc1
    v_mfma_f32_16x16x32_bf16 v[68:71], v[240:243], a[196:199], v[68:71]
    ds_read_b64_tr_b16 v[234:235], v27 offset:2592
    v_mfma_f32_16x16x32_bf16 v[68:71], v[244:247], a[212:215], v[68:71]
    v_mfma_f32_16x16x32_bf16 v[72:75], v[240:243], a[200:203], v[72:75]
    ds_read_b64_tr_b16 v[236:237], v27 offset:5152
    v_mfma_f32_16x16x32_bf16 v[72:75], v[244:247], a[216:219], v[72:75]
    v_mfma_f32_16x16x32_bf16 v[76:79], v[240:243], a[204:207], v[76:79]
    ds_read_b64_tr_b16 v[238:239], v27 offset:7712
    v_mfma_f32_16x16x32_bf16 v[76:79], v[244:247], a[220:223], v[76:79]
    s_waitcnt lgkmcnt(6)
    buffer_load_dwordx4 v[40:43], v30, s[8:11], s49 offen offset:0 sc1
    v_mfma_f32_16x16x32_bf16 v[80:83], v[224:227], a[192:195], v[80:83]
    s_waitcnt lgkmcnt(4)
    ds_read_b64_tr_b16 v[240:241], v27 offset:10272
    v_mfma_f32_16x16x32_bf16 v[80:83], v[228:231], a[208:211], v[80:83]
    v_mfma_f32_16x16x32_bf16 v[84:87], v[224:227], a[196:199], v[84:87]
    ds_read_b64_tr_b16 v[242:243], v27 offset:12832
    v_mfma_f32_16x16x32_bf16 v[84:87], v[228:231], a[212:215], v[84:87]
    v_mfma_f32_16x16x32_bf16 v[88:91], v[224:227], a[200:203], v[88:91]
    ds_read_b64_tr_b16 v[244:245], v27 offset:15392
    v_mfma_f32_16x16x32_bf16 v[88:91], v[228:231], a[216:219], v[88:91]
    buffer_load_dwordx4 v[56:59], v30, s[8:11], s49 offen offset:1024 sc1
    v_mfma_f32_16x16x32_bf16 v[92:95], v[224:227], a[204:207], v[92:95]
    ds_read_b64_tr_b16 v[246:247], v27 offset:17952
    v_mfma_f32_16x16x32_bf16 v[92:95], v[228:231], a[220:223], v[92:95]
    s_waitcnt lgkmcnt(6)
    v_mfma_f32_16x16x32_bf16 v[96:99], v[232:235], a[192:195], v[96:99]
    s_waitcnt lgkmcnt(4)
    ds_read_b64_tr_b16 v[224:225], v27 offset:64
    v_mfma_f32_16x16x32_bf16 v[96:99], v[236:239], a[208:211], v[96:99]
    v_mfma_f32_16x16x32_bf16 v[100:103], v[232:235], a[196:199], v[100:103]
    ds_read_b64_tr_b16 v[226:227], v27 offset:2624
    v_mfma_f32_16x16x32_bf16 v[100:103], v[236:239], a[212:215], v[100:103]
    buffer_load_dwordx4 v[44:47], v31, s[8:11], s49 offen offset:0 sc1
    v_mfma_f32_16x16x32_bf16 v[104:107], v[232:235], a[200:203], v[104:107]
    ds_read_b64_tr_b16 v[228:229], v27 offset:5184
    v_mfma_f32_16x16x32_bf16 v[104:107], v[236:239], a[216:219], v[104:107]
    v_mfma_f32_16x16x32_bf16 v[108:111], v[232:235], a[204:207], v[108:111]
    ds_read_b64_tr_b16 v[230:231], v27 offset:7744
    v_mfma_f32_16x16x32_bf16 v[108:111], v[236:239], a[220:223], v[108:111]
    s_waitcnt lgkmcnt(6)
    v_mfma_f32_16x16x32_bf16 v[112:115], v[240:243], a[192:195], v[112:115]
    s_waitcnt lgkmcnt(4)
    ds_read_b64_tr_b16 v[232:233], v27 offset:10304
    v_mfma_f32_16x16x32_bf16 v[112:115], v[244:247], a[208:211], v[112:115]
    buffer_load_dwordx4 v[60:63], v31, s[8:11], s49 offen offset:1024 sc1
    v_mfma_f32_16x16x32_bf16 v[116:119], v[240:243], a[196:199], v[116:119]
    ds_read_b64_tr_b16 v[234:235], v27 offset:12864
    v_mfma_f32_16x16x32_bf16 v[116:119], v[244:247], a[212:215], v[116:119]
    v_mfma_f32_16x16x32_bf16 v[120:123], v[240:243], a[200:203], v[120:123]
    ds_read_b64_tr_b16 v[236:237], v27 offset:15424
    v_mfma_f32_16x16x32_bf16 v[120:123], v[244:247], a[216:219], v[120:123]
    v_mfma_f32_16x16x32_bf16 v[124:127], v[240:243], a[204:207], v[124:127]
    s_mov_b32 m0, 122880
    s_add_u32 s52, s55, 0
    ds_read_b64_tr_b16 v[238:239], v27 offset:17984
    v_mfma_f32_16x16x32_bf16 v[124:127], v[244:247], a[220:223], v[124:127]
    s_waitcnt lgkmcnt(6)
    buffer_load_dwordx4 v255, s[12:15], s52 offen lds
    v_mfma_f32_16x16x32_bf16 v[128:131], v[224:227], a[192:195], v[128:131]
    s_waitcnt lgkmcnt(4)
    ds_read_b64_tr_b16 v[240:241], v27 offset:96
    v_mfma_f32_16x16x32_bf16 v[128:131], v[228:231], a[208:211], v[128:131]
    v_mfma_f32_16x16x32_bf16 v[132:135], v[224:227], a[196:199], v[132:135]
    ds_read_b64_tr_b16 v[242:243], v27 offset:2656
    v_mfma_f32_16x16x32_bf16 v[132:135], v[228:231], a[212:215], v[132:135]
    v_mfma_f32_16x16x32_bf16 v[136:139], v[224:227], a[200:203], v[136:139]
    s_add_u32 s52, s55, 18432
    ds_read_b64_tr_b16 v[244:245], v27 offset:5216
    v_mfma_f32_16x16x32_bf16 v[136:139], v[228:231], a[216:219], v[136:139]
    buffer_load_dwordx4 v255, s[12:15], s52 offen lds
    v_mfma_f32_16x16x32_bf16 v[140:143], v[224:227], a[204:207], v[140:143]
    ds_read_b64_tr_b16 v[246:247], v27 offset:7776
    v_mfma_f32_16x16x32_bf16 v[140:143], v[228:231], a[220:223], v[140:143]
    s_waitcnt lgkmcnt(6)
    v_mfma_f32_16x16x32_bf16 v[144:147], v[232:235], a[192:195], v[144:147]
    s_waitcnt lgkmcnt(4)
    ds_read_b64_tr_b16 v[224:225], v27 offset:10336
    v_mfma_f32_16x16x32_bf16 v[144:147], v[236:239], a[208:211], v[144:147]
    v_mfma_f32_16x16x32_bf16 v[148:151], v[232:235], a[196:199], v[148:151]
    s_add_u32 s52, s55, 36864
    ds_read_b64_tr_b16 v[226:227], v27 offset:12896
    v_mfma_f32_16x16x32_bf16 v[148:151], v[236:239], a[212:215], v[148:151]
    buffer_load_dwordx4 v255, s[12:15], s52 offen lds
    v_mfma_f32_16x16x32_bf16 v[152:155], v[232:235], a[200:203], v[152:155]
    ds_read_b64_tr_b16 v[228:229], v27 offset:15456
    v_mfma_f32_16x16x32_bf16 v[152:155], v[236:239], a[216:219], v[152:155]
    v_mfma_f32_16x16x32_bf16 v[156:159], v[232:235], a[204:207], v[156:159]
    ds_read_b64_tr_b16 v[230:231], v27 offset:18016
    v_mfma_f32_16x16x32_bf16 v[156:159], v[236:239], a[220:223], v[156:159]
    s_waitcnt lgkmcnt(6)
    v_mfma_f32_16x16x32_bf16 v[160:163], v[240:243], a[192:195], v[160:163]
    s_waitcnt lgkmcnt(4)
    s_add_u32 s52, s55, 55296
    ds_read_b64_tr_b16 v[232:233], v27 offset:20608
    v_mfma_f32_16x16x32_bf16 v[160:163], v[244:247], a[208:211], v[160:163]
    buffer_load_dwordx4 v255, s[12:15], s52 offen lds
    v_mfma_f32_16x16x32_bf16 v[164:167], v[240:243], a[196:199], v[164:167]
    ds_read_b64_tr_b16 v[234:235], v27 offset:23168
    v_mfma_f32_16x16x32_bf16 v[164:167], v[244:247], a[212:215], v[164:167]
    v_mfma_f32_16x16x32_bf16 v[168:171], v[240:243], a[200:203], v[168:171]
    ds_read_b64_tr_b16 v[236:237], v27 offset:25728
    v_mfma_f32_16x16x32_bf16 v[168:171], v[244:247], a[216:219], v[168:171]
    v_mfma_f32_16x16x32_bf16 v[172:175], v[240:243], a[204:207], v[172:175]
    s_add_u32 s52, s55, 73728
    ds_read_b64_tr_b16 v[238:239], v27 offset:28288
    v_mfma_f32_16x16x32_bf16 v[172:175], v[244:247], a[220:223], v[172:175]
    s_waitcnt lgkmcnt(6)
    buffer_load_dwordx4 v255, s[12:15], s52 offen lds
    v_mfma_f32_16x16x32_bf16 v[176:179], v[224:227], a[192:195], v[176:179]
    s_waitcnt lgkmcnt(4)
    ds_read_b64_tr_b16 v[240:241], v27 offset:30848
    v_mfma_f32_16x16x32_bf16 v[176:179], v[228:231], a[208:211], v[176:179]
    v_mfma_f32_16x16x32_bf16 v[180:183], v[224:227], a[196:199], v[180:183]
    ds_read_b64_tr_b16 v[242:243], v27 offset:33408
    v_mfma_f32_16x16x32_bf16 v[180:183], v[228:231], a[212:215], v[180:183]
    v_mfma_f32_16x16x32_bf16 v[184:187], v[224:227], a[200:203], v[184:187]
    s_add_u32 s52, s37, 589952
    s_add_u32 m0, s36, 81920
    ds_read_b64_tr_b16 v[244:245], v27 offset:35968
    v_mfma_f32_16x16x32_bf16 v[184:187], v[228:231], a[216:219], v[184:187]
    buffer_load_dwordx4 v20, s[12:15], s52 offen offset:0 lds
    v_mfma_f32_16x16x32_bf16 v[188:191], v[224:227], a[204:207], v[188:191]
    ds_read_b64_tr_b16 v[246:247], v27 offset:38528
    v_mfma_f32_16x16x32_bf16 v[188:191], v[228:231], a[220:223], v[188:191]
    s_waitcnt vmcnt(31) lgkmcnt(6)
    v_mfma_f32_16x16x32_bf16 v[192:195], v[232:235], a[224:227], v[192:195]
    s_waitcnt vmcnt(30) lgkmcnt(4)
    ds_read_b64_tr_b16 v[224:225], v27 offset:20480
    v_mfma_f32_16x16x32_bf16 v[192:195], v[236:239], a[240:243], v[192:195]
    s_waitcnt vmcnt(29)
    v_mfma_f32_16x16x32_bf16 v[196:199], v[232:235], a[228:231], v[196:199]
    s_waitcnt vmcnt(28)
    ds_read_b64_tr_b16 v[226:227], v27 offset:23040
    v_mfma_f32_16x16x32_bf16 v[196:199], v[236:239], a[244:247], v[196:199]
    s_waitcnt vmcnt(27)
    v_mfma_f32_16x16x32_bf16 v[200:203], v[232:235], a[232:235], v[200:203]
    s_waitcnt vmcnt(26)
    ds_read_b64_tr_b16 v[228:229], v27 offset:25600
    v_mfma_f32_16x16x32_bf16 v[200:203], v[236:239], a[248:251], v[200:203]
    s_waitcnt vmcnt(25)
    buffer_load_dwordx4 v21, s[12:15], s52 offen offset:1024 lds
    v_mfma_f32_16x16x32_bf16 v[204:207], v[232:235], a[236:239], v[204:207]
    s_waitcnt vmcnt(25)
    ds_read_b64_tr_b16 v[230:231], v27 offset:28160
    v_mfma_f32_16x16x32_bf16 v[204:207], v[236:239], a[252:255], v[204:207]
    s_waitcnt lgkmcnt(6)
    v_mfma_f32_16x16x32_bf16 v[208:211], v[240:243], a[224:227], v[208:211]
    s_waitcnt lgkmcnt(4)
    ds_read_b64_tr_b16 v[232:233], v27 offset:30720
    v_mfma_f32_16x16x32_bf16 v[208:211], v[244:247], a[240:243], v[208:211]
    v_mfma_f32_16x16x32_bf16 v[212:215], v[240:243], a[228:231], v[212:215]
    ds_read_b64_tr_b16 v[234:235], v27 offset:33280
    v_mfma_f32_16x16x32_bf16 v[212:215], v[244:247], a[244:247], v[212:215]
    v_mfma_f32_16x16x32_bf16 v[216:219], v[240:243], a[232:235], v[216:219]
    ds_read_b64_tr_b16 v[236:237], v27 offset:35840
    v_mfma_f32_16x16x32_bf16 v[216:219], v[244:247], a[248:251], v[216:219]
    buffer_load_dwordx4 v22, s[12:15], s52 offen offset:2048 lds
    v_mfma_f32_16x16x32_bf16 v[220:223], v[240:243], a[236:239], v[220:223]
    ds_read_b64_tr_b16 v[238:239], v27 offset:38400
    v_mfma_f32_16x16x32_bf16 v[220:223], v[244:247], a[252:255], v[220:223]
    s_waitcnt lgkmcnt(6)
    v_mfma_f32_16x16x32_bf16 v[64:67], v[224:227], a[224:227], v[64:67]
    s_waitcnt lgkmcnt(4)
    ds_read_b64_tr_b16 v[240:241], v27 offset:20512
    v_mfma_f32_16x16x32_bf16 v[64:67], v[228:231], a[240:243], v[64:67]
    v_mfma_f32_16x16x32_bf16 v[68:71], v[224:227], a[228:231], v[68:71]
    ds_read_b64_tr_b16 v[242:243], v27 offset:23072
    v_mfma_f32_16x16x32_bf16 v[68:71], v[228:231], a[244:247], v[68:71]
    v_mfma_f32_16x16x32_bf16 v[72:75], v[224:227], a[232:235], v[72:75]
    ds_read_b64_tr_b16 v[244:245], v27 offset:25632
    v_mfma_f32_16x16x32_bf16 v[72:75], v[228:231], a[248:251], v[72:75]
    buffer_load_dwordx4 v23, s[12:15], s52 offen offset:3072 lds
    v_mfma_f32_16x16x32_bf16 v[76:79], v[224:227], a[236:239], v[76:79]
    ds_read_b64_tr_b16 v[246:247], v27 offset:28192
    v_mfma_f32_16x16x32_bf16 v[76:79], v[228:231], a[252:255], v[76:79]
    s_waitcnt lgkmcnt(6)
    v_mfma_f32_16x16x32_bf16 v[80:83], v[232:235], a[224:227], v[80:83]
    s_waitcnt lgkmcnt(4)
    ds_read_b64_tr_b16 v[224:225], v27 offset:30752
    v_mfma_f32_16x16x32_bf16 v[80:83], v[236:239], a[240:243], v[80:83]
    v_mfma_f32_16x16x32_bf16 v[84:87], v[232:235], a[228:231], v[84:87]
    ds_read_b64_tr_b16 v[226:227], v27 offset:33312
    v_mfma_f32_16x16x32_bf16 v[84:87], v[236:239], a[244:247], v[84:87]
    v_mfma_f32_16x16x32_bf16 v[88:91], v[232:235], a[232:235], v[88:91]
    s_add_u32 m0, s36, 86016
    ds_read_b64_tr_b16 v[228:229], v27 offset:35872
    v_mfma_f32_16x16x32_bf16 v[88:91], v[236:239], a[248:251], v[88:91]
    buffer_load_dwordx4 v24, s[12:15], s52 offen offset:0 lds
    v_mfma_f32_16x16x32_bf16 v[92:95], v[232:235], a[236:239], v[92:95]
    ds_read_b64_tr_b16 v[230:231], v27 offset:38432
    v_mfma_f32_16x16x32_bf16 v[92:95], v[236:239], a[252:255], v[92:95]
    s_waitcnt lgkmcnt(6)
    v_mfma_f32_16x16x32_bf16 v[96:99], v[240:243], a[224:227], v[96:99]
    s_waitcnt lgkmcnt(4)
    ds_read_b64_tr_b16 v[232:233], v27 offset:20544
    v_mfma_f32_16x16x32_bf16 v[96:99], v[244:247], a[240:243], v[96:99]
    v_mfma_f32_16x16x32_bf16 v[100:103], v[240:243], a[228:231], v[100:103]
    ds_read_b64_tr_b16 v[234:235], v27 offset:23104
    v_mfma_f32_16x16x32_bf16 v[100:103], v[244:247], a[244:247], v[100:103]
    v_mfma_f32_16x16x32_bf16 v[104:107], v[240:243], a[232:235], v[104:107]
    s_add_u32 s52, s37, 1179776
    s_add_u32 m0, s36, 102400
    ds_read_b64_tr_b16 v[236:237], v27 offset:25664
    v_mfma_f32_16x16x32_bf16 v[104:107], v[244:247], a[248:251], v[104:107]
    buffer_load_dwordx4 v20, s[12:15], s52 offen offset:0 lds
    v_mfma_f32_16x16x32_bf16 v[108:111], v[240:243], a[236:239], v[108:111]
    ds_read_b64_tr_b16 v[238:239], v27 offset:28224
    v_mfma_f32_16x16x32_bf16 v[108:111], v[244:247], a[252:255], v[108:111]
    s_waitcnt lgkmcnt(6)
    v_mfma_f32_16x16x32_bf16 v[112:115], v[224:227], a[224:227], v[112:115]
    s_waitcnt lgkmcnt(4)
    ds_read_b64_tr_b16 v[240:241], v27 offset:30784
    v_mfma_f32_16x16x32_bf16 v[112:115], v[228:231], a[240:243], v[112:115]
    v_mfma_f32_16x16x32_bf16 v[116:119], v[224:227], a[228:231], v[116:119]
    ds_read_b64_tr_b16 v[242:243], v27 offset:33344
    v_mfma_f32_16x16x32_bf16 v[116:119], v[228:231], a[244:247], v[116:119]
    v_mfma_f32_16x16x32_bf16 v[120:123], v[224:227], a[232:235], v[120:123]
    ds_read_b64_tr_b16 v[244:245], v27 offset:35904
    v_mfma_f32_16x16x32_bf16 v[120:123], v[228:231], a[248:251], v[120:123]
    buffer_load_dwordx4 v21, s[12:15], s52 offen offset:1024 lds
    v_mfma_f32_16x16x32_bf16 v[124:127], v[224:227], a[236:239], v[124:127]
    ds_read_b64_tr_b16 v[246:247], v27 offset:38464
    v_mfma_f32_16x16x32_bf16 v[124:127], v[228:231], a[252:255], v[124:127]
    s_waitcnt lgkmcnt(6)
    v_mfma_f32_16x16x32_bf16 v[128:131], v[232:235], a[224:227], v[128:131]
    s_waitcnt lgkmcnt(4)
    ds_read_b64_tr_b16 v[224:225], v27 offset:20576
    v_mfma_f32_16x16x32_bf16 v[128:131], v[236:239], a[240:243], v[128:131]
    v_mfma_f32_16x16x32_bf16 v[132:135], v[232:235], a[228:231], v[132:135]
    ds_read_b64_tr_b16 v[226:227], v27 offset:23136
    v_mfma_f32_16x16x32_bf16 v[132:135], v[236:239], a[244:247], v[132:135]
    v_mfma_f32_16x16x32_bf16 v[136:139], v[232:235], a[232:235], v[136:139]
    ds_read_b64_tr_b16 v[228:229], v27 offset:25696
    v_mfma_f32_16x16x32_bf16 v[136:139], v[236:239], a[248:251], v[136:139]
    buffer_load_dwordx4 v22, s[12:15], s52 offen offset:2048 lds
    v_mfma_f32_16x16x32_bf16 v[140:143], v[232:235], a[236:239], v[140:143]
    ds_read_b64_tr_b16 v[230:231], v27 offset:28256
    v_mfma_f32_16x16x32_bf16 v[140:143], v[236:239], a[252:255], v[140:143]
    s_waitcnt lgkmcnt(6)
    v_mfma_f32_16x16x32_bf16 v[144:147], v[240:243], a[224:227], v[144:147]
    s_waitcnt lgkmcnt(4)
    ds_read_b64_tr_b16 v[232:233], v27 offset:30816
    v_mfma_f32_16x16x32_bf16 v[144:147], v[244:247], a[240:243], v[144:147]
    ds_read_b64_tr_b16 v[234:235], v27 offset:33376
    v_mfma_f32_16x16x32_bf16 v[148:151], v[240:243], a[228:231], v[148:151]
    ds_read_b64_tr_b16 v[236:237], v27 offset:35936
    v_mfma_f32_16x16x32_bf16 v[148:151], v[244:247], a[244:247], v[148:151]
    ds_read_b64_tr_b16 v[238:239], v27 offset:38496
    v_mfma_f32_16x16x32_bf16 v[152:155], v[240:243], a[232:235], v[152:155]
    v_add_u32 v26, 0, v25
    v_mfma_f32_16x16x32_bf16 v[152:155], v[244:247], a[248:251], v[152:155]
    buffer_load_dwordx4 v23, s[12:15], s52 offen offset:3072 lds
    v_mfma_f32_16x16x32_bf16 v[156:159], v[240:243], a[236:239], v[156:159]
    v_mfma_f32_16x16x32_bf16 v[156:159], v[244:247], a[252:255], v[156:159]
    s_waitcnt lgkmcnt(0)
    v_mfma_f32_16x16x32_bf16 v[160:163], v[224:227], a[224:227], v[160:163]
    s_waitcnt vmcnt(22)
    s_barrier
    ds_read_b64_tr_b16 v[240:241], v26 offset:128
    v_mfma_f32_16x16x32_bf16 v[160:163], v[228:231], a[240:243], v[160:163]
    v_mfma_f32_16x16x32_bf16 v[164:167], v[224:227], a[228:231], v[164:167]
    ds_read_b64_tr_b16 v[242:243], v26 offset:2688
    v_mfma_f32_16x16x32_bf16 v[164:167], v[228:231], a[244:247], v[164:167]
    v_mfma_f32_16x16x32_bf16 v[168:171], v[224:227], a[232:235], v[168:171]
    s_add_u32 m0, s36, 106496
    ds_read_b64_tr_b16 v[244:245], v26 offset:5248
    v_mfma_f32_16x16x32_bf16 v[168:171], v[228:231], a[248:251], v[168:171]
    buffer_load_dwordx4 v24, s[12:15], s52 offen offset:0 lds
    v_mfma_f32_16x16x32_bf16 v[172:175], v[224:227], a[236:239], v[172:175]
    ds_read_b64_tr_b16 v[246:247], v26 offset:7808
    v_mfma_f32_16x16x32_bf16 v[172:175], v[228:231], a[252:255], v[172:175]
    v_mfma_f32_16x16x32_bf16 v[176:179], v[232:235], a[224:227], v[176:179]
    ds_read_b64_tr_b16 v[224:225], v26 offset:10368
    v_mfma_f32_16x16x32_bf16 v[176:179], v[236:239], a[240:243], v[176:179]
    v_mfma_f32_16x16x32_bf16 v[180:183], v[232:235], a[228:231], v[180:183]
    ds_read_b64_tr_b16 v[226:227], v26 offset:12928
    v_mfma_f32_16x16x32_bf16 v[180:183], v[236:239], a[244:247], v[180:183]
    v_mfma_f32_16x16x32_bf16 v[184:187], v[232:235], a[232:235], v[184:187]
    s_add_u32 s52, s37, 1769600
    s_add_u32 m0, s36, 40960
    ds_read_b64_tr_b16 v[228:229], v26 offset:15488
    v_mfma_f32_16x16x32_bf16 v[184:187], v[236:239], a[248:251], v[184:187]
    buffer_load_dwordx4 v20, s[12:15], s52 offen offset:0 lds
    v_mfma_f32_16x16x32_bf16 v[188:191], v[232:235], a[236:239], v[188:191]
    ds_read_b64_tr_b16 v[230:231], v26 offset:18048
    v_mfma_f32_16x16x32_bf16 v[188:191], v[236:239], a[252:255], v[188:191]
    s_waitcnt vmcnt(23) lgkmcnt(6)
    v_mfma_f32_16x16x32_bf16 v[192:195], v[240:243], v[32:35], v[192:195]
    s_waitcnt vmcnt(22) lgkmcnt(4)
    ds_read_b64_tr_b16 v[232:233], v26 offset:0
    v_mfma_f32_16x16x32_bf16 v[192:195], v[244:247], v[48:51], v[192:195]
    s_waitcnt vmcnt(21)
    v_mfma_f32_16x16x32_bf16 v[196:199], v[240:243], v[36:39], v[196:199]
    s_waitcnt vmcnt(20)
    ds_read_b64_tr_b16 v[234:235], v26 offset:2560
    v_mfma_f32_16x16x32_bf16 v[196:199], v[244:247], v[52:55], v[196:199]
    s_waitcnt vmcnt(19)
    v_mfma_f32_16x16x32_bf16 v[200:203], v[240:243], v[40:43], v[200:203]
    s_waitcnt vmcnt(18)
    ds_read_b64_tr_b16 v[236:237], v26 offset:5120
    v_mfma_f32_16x16x32_bf16 v[200:203], v[244:247], v[56:59], v[200:203]
    s_waitcnt vmcnt(17)
    buffer_load_dwordx4 v21, s[12:15], s52 offen offset:1024 lds
    v_mfma_f32_16x16x32_bf16 v[204:207], v[240:243], v[44:47], v[204:207]
    s_waitcnt vmcnt(17)
    ds_read_b64_tr_b16 v[238:239], v26 offset:7680
    v_mfma_f32_16x16x32_bf16 v[204:207], v[244:247], v[60:63], v[204:207]
    s_waitcnt lgkmcnt(6)
    v_mfma_f32_16x16x32_bf16 v[208:211], v[224:227], v[32:35], v[208:211]
    s_waitcnt lgkmcnt(4)
    ds_read_b64_tr_b16 v[240:241], v26 offset:10240
    v_mfma_f32_16x16x32_bf16 v[208:211], v[228:231], v[48:51], v[208:211]
    v_mfma_f32_16x16x32_bf16 v[212:215], v[224:227], v[36:39], v[212:215]
    ds_read_b64_tr_b16 v[242:243], v26 offset:12800
    v_mfma_f32_16x16x32_bf16 v[212:215], v[228:231], v[52:55], v[212:215]
    v_mfma_f32_16x16x32_bf16 v[216:219], v[224:227], v[40:43], v[216:219]
    ds_read_b64_tr_b16 v[244:245], v26 offset:15360
    v_mfma_f32_16x16x32_bf16 v[216:219], v[228:231], v[56:59], v[216:219]
    buffer_load_dwordx4 v22, s[12:15], s52 offen offset:2048 lds
    v_mfma_f32_16x16x32_bf16 v[220:223], v[224:227], v[44:47], v[220:223]
    ds_read_b64_tr_b16 v[246:247], v26 offset:17920
    v_mfma_f32_16x16x32_bf16 v[220:223], v[228:231], v[60:63], v[220:223]
    s_waitcnt lgkmcnt(6)
    v_mfma_f32_16x16x32_bf16 v[64:67], v[232:235], v[32:35], v[64:67]
    s_waitcnt lgkmcnt(4)
    ds_read_b64_tr_b16 v[224:225], v26 offset:32
    v_mfma_f32_16x16x32_bf16 v[64:67], v[236:239], v[48:51], v[64:67]
    v_mul_f32 v192, v192, v208
    v_mul_f32 v193, v193, v209
    v_mfma_f32_16x16x32_bf16 v[68:71], v[232:235], v[36:39], v[68:71]
    ds_read_b64_tr_b16 v[226:227], v26 offset:2592
    v_mul_f32 v194, v194, v210
    v_mfma_f32_16x16x32_bf16 v[68:71], v[236:239], v[52:55], v[68:71]
    v_mul_f32 v195, v195, v211
    v_cvt_pk_bf16_f32 v192, v192, v193
    v_mfma_f32_16x16x32_bf16 v[72:75], v[232:235], v[40:43], v[72:75]
    ds_read_b64_tr_b16 v[228:229], v26 offset:5152
    v_cvt_pk_bf16_f32 v193, v194, v195
    v_mfma_f32_16x16x32_bf16 v[72:75], v[236:239], v[56:59], v[72:75]
    buffer_load_dwordx4 v23, s[12:15], s52 offen offset:3072 lds
    v_mul_f32 v196, v196, v212
    v_mul_f32 v197, v197, v213
    v_mfma_f32_16x16x32_bf16 v[76:79], v[232:235], v[44:47], v[76:79]
    ds_read_b64_tr_b16 v[230:231], v26 offset:7712
    v_mul_f32 v198, v198, v214
    v_mfma_f32_16x16x32_bf16 v[76:79], v[236:239], v[60:63], v[76:79]
    s_waitcnt lgkmcnt(6)
    v_mul_f32 v199, v199, v215
    v_cvt_pk_bf16_f32 v196, v196, v197
    v_mfma_f32_16x16x32_bf16 v[80:83], v[240:243], v[32:35], v[80:83]
    s_waitcnt lgkmcnt(4)
    ds_read_b64_tr_b16 v[232:233], v26 offset:10272
    v_cvt_pk_bf16_f32 v197, v198, v199
    v_mfma_f32_16x16x32_bf16 v[80:83], v[244:247], v[48:51], v[80:83]
    v_mul_f32 v200, v200, v216
    v_mul_f32 v201, v201, v217
    v_mfma_f32_16x16x32_bf16 v[84:87], v[240:243], v[36:39], v[84:87]
    ds_read_b64_tr_b16 v[234:235], v26 offset:12832
    v_mul_f32 v202, v202, v218
    v_mfma_f32_16x16x32_bf16 v[84:87], v[244:247], v[52:55], v[84:87]
    v_mul_f32 v203, v203, v219
    v_cvt_pk_bf16_f32 v200, v200, v201
    v_mfma_f32_16x16x32_bf16 v[88:91], v[240:243], v[40:43], v[88:91]
    s_add_u32 m0, s36, 45056
    ds_read_b64_tr_b16 v[236:237], v26 offset:15392
    v_cvt_pk_bf16_f32 v201, v202, v203
    v_mfma_f32_16x16x32_bf16 v[88:91], v[244:247], v[56:59], v[88:91]
    buffer_load_dwordx4 v24, s[12:15], s52 offen offset:0 lds
    v_mul_f32 v204, v204, v220
    v_mul_f32 v205, v205, v221
    v_mfma_f32_16x16x32_bf16 v[92:95], v[240:243], v[44:47], v[92:95]
    ds_read_b64_tr_b16 v[238:239], v26 offset:17952
    v_mul_f32 v206, v206, v222
    v_mfma_f32_16x16x32_bf16 v[92:95], v[244:247], v[60:63], v[92:95]
    s_waitcnt lgkmcnt(6)
    v_mul_f32 v207, v207, v223
    v_cvt_pk_bf16_f32 v204, v204, v205
    v_mfma_f32_16x16x32_bf16 v[96:99], v[224:227], v[32:35], v[96:99]
    s_waitcnt lgkmcnt(4)
    ds_read_b64_tr_b16 v[240:241], v26 offset:64
    v_cvt_pk_bf16_f32 v205, v206, v207
    v_mfma_f32_16x16x32_bf16 v[96:99], v[228:231], v[48:51], v[96:99]
    v_mul_f32 v64, v64, v80
    v_mul_f32 v65, v65, v81
    v_mfma_f32_16x16x32_bf16 v[100:103], v[224:227], v[36:39], v[100:103]
    ds_read_b64_tr_b16 v[242:243], v26 offset:2624
    v_mul_f32 v66, v66, v82
    v_mfma_f32_16x16x32_bf16 v[100:103], v[228:231], v[52:55], v[100:103]
    v_mul_f32 v67, v67, v83
    v_cvt_pk_bf16_f32 v208, v64, v65
    v_mfma_f32_16x16x32_bf16 v[104:107], v[224:227], v[40:43], v[104:107]
    s_add_u32 s52, s37, 2359424
    s_add_u32 m0, s36, 61440
    ds_read_b64_tr_b16 v[244:245], v26 offset:5184
    v_cvt_pk_bf16_f32 v209, v66, v67
    v_mfma_f32_16x16x32_bf16 v[104:107], v[228:231], v[56:59], v[104:107]
    buffer_load_dwordx4 v20, s[12:15], s52 offen offset:0 lds
    v_mul_f32 v68, v68, v84
    v_mul_f32 v69, v69, v85
    v_mfma_f32_16x16x32_bf16 v[108:111], v[224:227], v[44:47], v[108:111]
    ds_read_b64_tr_b16 v[246:247], v26 offset:7744
    v_mul_f32 v70, v70, v86
    v_mfma_f32_16x16x32_bf16 v[108:111], v[228:231], v[60:63], v[108:111]
    s_waitcnt lgkmcnt(6)
    v_mul_f32 v71, v71, v87
    v_cvt_pk_bf16_f32 v212, v68, v69
    v_mfma_f32_16x16x32_bf16 v[112:115], v[232:235], v[32:35], v[112:115]
    s_waitcnt lgkmcnt(4)
    ds_read_b64_tr_b16 v[224:225], v26 offset:10304
    v_cvt_pk_bf16_f32 v213, v70, v71
    v_mfma_f32_16x16x32_bf16 v[112:115], v[236:239], v[48:51], v[112:115]
    v_mul_f32 v72, v72, v88
    v_mul_f32 v73, v73, v89
    v_mfma_f32_16x16x32_bf16 v[116:119], v[232:235], v[36:39], v[116:119]
    ds_read_b64_tr_b16 v[226:227], v26 offset:12864
    v_mul_f32 v74, v74, v90
    v_mfma_f32_16x16x32_bf16 v[116:119], v[236:239], v[52:55], v[116:119]
    v_mul_f32 v75, v75, v91
    v_cvt_pk_bf16_f32 v216, v72, v73
    v_mfma_f32_16x16x32_bf16 v[120:123], v[232:235], v[40:43], v[120:123]
    ds_read_b64_tr_b16 v[228:229], v26 offset:15424
    v_cvt_pk_bf16_f32 v217, v74, v75
    v_mfma_f32_16x16x32_bf16 v[120:123], v[236:239], v[56:59], v[120:123]
    v_mul_f32 v76, v76, v92
    v_mul_f32 v77, v77, v93
    v_mfma_f32_16x16x32_bf16 v[124:127], v[232:235], v[44:47], v[124:127]
    ds_read_b64_tr_b16 v[230:231], v26 offset:17984
    v_mul_f32 v78, v78, v94
    v_mfma_f32_16x16x32_bf16 v[124:127], v[236:239], v[60:63], v[124:127]
    s_waitcnt lgkmcnt(6)
    v_mul_f32 v79, v79, v95
    v_cvt_pk_bf16_f32 v220, v76, v77
    v_mfma_f32_16x16x32_bf16 v[128:131], v[240:243], v[32:35], v[128:131]
    s_waitcnt lgkmcnt(4)
    ds_read_b64_tr_b16 v[232:233], v26 offset:96
    v_cvt_pk_bf16_f32 v221, v78, v79
    v_mfma_f32_16x16x32_bf16 v[128:131], v[244:247], v[48:51], v[128:131]
    buffer_load_dwordx4 v21, s[12:15], s52 offen offset:1024 lds
    v_mfma_f32_16x16x32_bf16 v[132:135], v[240:243], v[36:39], v[132:135]
    ds_read_b64_tr_b16 v[234:235], v26 offset:2656
    v_mul_f32 v96, v96, v112
    v_mfma_f32_16x16x32_bf16 v[132:135], v[244:247], v[52:55], v[132:135]
    v_mul_f32 v97, v97, v113
    v_mul_f32 v98, v98, v114
    v_mfma_f32_16x16x32_bf16 v[136:139], v[240:243], v[40:43], v[136:139]
    ds_read_b64_tr_b16 v[236:237], v26 offset:5216
    v_mul_f32 v99, v99, v115
    v_mfma_f32_16x16x32_bf16 v[136:139], v[244:247], v[56:59], v[136:139]
    v_cvt_pk_bf16_f32 v210, v96, v97
    v_cvt_pk_bf16_f32 v211, v98, v99
    v_mfma_f32_16x16x32_bf16 v[140:143], v[240:243], v[44:47], v[140:143]
    ds_read_b64_tr_b16 v[238:239], v26 offset:7776
    v_mul_f32 v100, v100, v116
    v_mfma_f32_16x16x32_bf16 v[140:143], v[244:247], v[60:63], v[140:143]
    s_waitcnt lgkmcnt(6)
    v_mul_f32 v101, v101, v117
    v_mul_f32 v102, v102, v118
    v_mfma_f32_16x16x32_bf16 v[144:147], v[224:227], v[32:35], v[144:147]
    s_waitcnt lgkmcnt(4)
    ds_read_b64_tr_b16 v[240:241], v26 offset:10336
    v_mul_f32 v103, v103, v119
    v_mfma_f32_16x16x32_bf16 v[144:147], v[228:231], v[48:51], v[144:147]
    buffer_load_dwordx4 v22, s[12:15], s52 offen offset:2048 lds
    v_cvt_pk_bf16_f32 v214, v100, v101
    v_cvt_pk_bf16_f32 v215, v102, v103
    v_mfma_f32_16x16x32_bf16 v[148:151], v[224:227], v[36:39], v[148:151]
    ds_read_b64_tr_b16 v[242:243], v26 offset:12896
    v_mul_f32 v104, v104, v120
    v_mfma_f32_16x16x32_bf16 v[148:151], v[228:231], v[52:55], v[148:151]
    v_mul_f32 v105, v105, v121
    v_mul_f32 v106, v106, v122
    v_mfma_f32_16x16x32_bf16 v[152:155], v[224:227], v[40:43], v[152:155]
    ds_read_b64_tr_b16 v[244:245], v26 offset:15456
    v_mul_f32 v107, v107, v123
    v_mfma_f32_16x16x32_bf16 v[152:155], v[228:231], v[56:59], v[152:155]
    v_cvt_pk_bf16_f32 v218, v104, v105
    v_cvt_pk_bf16_f32 v219, v106, v107
    v_mfma_f32_16x16x32_bf16 v[156:159], v[224:227], v[44:47], v[156:159]
    ds_read_b64_tr_b16 v[246:247], v26 offset:18016
    v_mul_f32 v108, v108, v124
    v_mfma_f32_16x16x32_bf16 v[156:159], v[228:231], v[60:63], v[156:159]
    s_waitcnt lgkmcnt(6)
    v_mul_f32 v109, v109, v125
    v_mul_f32 v110, v110, v126
    v_mfma_f32_16x16x32_bf16 v[160:163], v[232:235], v[32:35], v[160:163]
    s_waitcnt lgkmcnt(4)
    ds_read_b64_tr_b16 v[224:225], v26 offset:20480
    v_mul_f32 v111, v111, v127
    v_mfma_f32_16x16x32_bf16 v[160:163], v[236:239], v[48:51], v[160:163]
    v_cvt_pk_bf16_f32 v222, v108, v109
    v_cvt_pk_bf16_f32 v223, v110, v111
    v_mfma_f32_16x16x32_bf16 v[164:167], v[232:235], v[36:39], v[164:167]
    ds_read_b64_tr_b16 v[226:227], v26 offset:23040
    buffer_load_dwordx4 v23, s[12:15], s52 offen offset:3072 lds
    v_mfma_f32_16x16x32_bf16 v[164:167], v[236:239], v[52:55], v[164:167]
    v_mul_f32 v128, v128, v144
    v_mul_f32 v129, v129, v145
    v_mfma_f32_16x16x32_bf16 v[168:171], v[232:235], v[40:43], v[168:171]
    ds_read_b64_tr_b16 v[228:229], v26 offset:25600
    v_mul_f32 v130, v130, v146
    v_mfma_f32_16x16x32_bf16 v[168:171], v[236:239], v[56:59], v[168:171]
    v_mul_f32 v131, v131, v147
    v_cvt_pk_bf16_f32 v128, v128, v129
    v_mfma_f32_16x16x32_bf16 v[172:175], v[232:235], v[44:47], v[172:175]
    ds_read_b64_tr_b16 v[230:231], v26 offset:28160
    v_cvt_pk_bf16_f32 v129, v130, v131
    v_mfma_f32_16x16x32_bf16 v[172:175], v[236:239], v[60:63], v[172:175]
    s_waitcnt lgkmcnt(6)
    v_mul_f32 v132, v132, v148
    v_mul_f32 v133, v133, v149
    v_mfma_f32_16x16x32_bf16 v[176:179], v[240:243], v[32:35], v[176:179]
    s_waitcnt lgkmcnt(4)
    ds_read_b64_tr_b16 v[232:233], v26 offset:30720
    v_mul_f32 v134, v134, v150
    v_mfma_f32_16x16x32_bf16 v[176:179], v[244:247], v[48:51], v[176:179]
    s_add_u32 m0, s36, 65536
    v_mul_f32 v135, v135, v151
    v_cvt_pk_bf16_f32 v132, v132, v133
    v_mfma_f32_16x16x32_bf16 v[180:183], v[240:243], v[36:39], v[180:183]
    ds_read_b64_tr_b16 v[234:235], v26 offset:33280
    buffer_load_dwordx4 v24, s[12:15], s52 offen offset:0 lds
    v_cvt_pk_bf16_f32 v133, v134, v135
    v_mfma_f32_16x16x32_bf16 v[180:183], v[244:247], v[52:55], v[180:183]
    v_mul_f32 v136, v136, v152
    v_mul_f32 v137, v137, v153
    v_mfma_f32_16x16x32_bf16 v[184:187], v[240:243], v[40:43], v[184:187]
    ds_read_b64_tr_b16 v[236:237], v26 offset:35840
    v_mul_f32 v138, v138, v154
    v_mfma_f32_16x16x32_bf16 v[184:187], v[244:247], v[56:59], v[184:187]
    v_mul_f32 v139, v139, v155
    v_cvt_pk_bf16_f32 v136, v136, v137
    v_mfma_f32_16x16x32_bf16 v[188:191], v[240:243], v[44:47], v[188:191]
    ds_read_b64_tr_b16 v[238:239], v26 offset:38400
    v_cvt_pk_bf16_f32 v137, v138, v139
    v_mfma_f32_16x16x32_bf16 v[188:191], v[244:247], v[60:63], v[188:191]
    s_waitcnt lgkmcnt(6)
    v_mul_f32 v140, v140, v156
    v_mul_f32 v141, v141, v157
    v_mfma_f32_16x16x32_bf16 v[64:67], v[224:227], a[0:3], 0
    s_waitcnt lgkmcnt(4)
    ds_read_b64_tr_b16 v[240:241], v26 offset:20512
    v_mul_f32 v142, v142, v158
    v_mfma_f32_16x16x32_bf16 v[64:67], v[228:231], a[16:19], v[64:67]
    s_add_u32 s63, s58, 0
    v_mul_f32 v143, v143, v159
    v_cvt_pk_bf16_f32 v140, v140, v141
    v_mfma_f32_16x16x32_bf16 v[68:71], v[224:227], a[4:7], 0
    ds_read_b64_tr_b16 v[242:243], v26 offset:23072
    buffer_store_dwordx4 v[208:211], v1, s[32:35], s63 offen offset:0 sc1
    v_cvt_pk_bf16_f32 v141, v142, v143
    v_mfma_f32_16x16x32_bf16 v[68:71], v[228:231], a[20:23], v[68:71]
    v_mul_f32 v160, v160, v176
    v_mul_f32 v161, v161, v177
    v_mfma_f32_16x16x32_bf16 v[72:75], v[224:227], a[8:11], 0
    ds_read_b64_tr_b16 v[244:245], v26 offset:25632
    v_mul_f32 v162, v162, v178
    v_mfma_f32_16x16x32_bf16 v[72:75], v[228:231], a[24:27], v[72:75]
    v_mul_f32 v163, v163, v179
    v_cvt_pk_bf16_f32 v130, v160, v161
    v_mfma_f32_16x16x32_bf16 v[76:79], v[224:227], a[12:15], 0
    s_add_u32 s59, s58, 0
    ds_read_b64_tr_b16 v[246:247], v26 offset:28192
    v_cvt_pk_bf16_f32 v131, v162, v163
    v_mfma_f32_16x16x32_bf16 v[76:79], v[228:231], a[28:31], v[76:79]
    s_waitcnt lgkmcnt(6)
    buffer_store_dwordx4 v[128:131], v1, s[32:35], s59 offen offset:1024 sc1
    v_mfma_f32_16x16x32_bf16 v[80:83], v[232:235], a[0:3], 0
    s_waitcnt lgkmcnt(4)
    ds_read_b64_tr_b16 v[224:225], v26 offset:30752
    v_mul_f32 v164, v164, v180
    v_mfma_f32_16x16x32_bf16 v[80:83], v[236:239], a[16:19], v[80:83]
    s_add_u32 s63, s58, 147456
    v_mul_f32 v165, v165, v181
    v_mul_f32 v166, v166, v182
    v_mfma_f32_16x16x32_bf16 v[84:87], v[232:235], a[4:7], 0
    ds_read_b64_tr_b16 v[226:227], v26 offset:33312
    buffer_store_dwordx4 v[212:215], v1, s[32:35], s63 offen offset:0 sc1
    v_mul_f32 v167, v167, v183
    v_mfma_f32_16x16x32_bf16 v[84:87], v[236:239], a[20:23], v[84:87]
    v_cvt_pk_bf16_f32 v134, v164, v165
    v_cvt_pk_bf16_f32 v135, v166, v167
    v_mfma_f32_16x16x32_bf16 v[88:91], v[232:235], a[8:11], 0
    s_add_u32 s59, s58, 147456
    ds_read_b64_tr_b16 v[228:229], v26 offset:35872
    v_mul_f32 v168, v168, v184
    v_mfma_f32_16x16x32_bf16 v[88:91], v[236:239], a[24:27], v[88:91]
    buffer_store_dwordx4 v[132:135], v1, s[32:35], s59 offen offset:1024 sc1
    v_mfma_f32_16x16x32_bf16 v[92:95], v[232:235], a[12:15], 0
    ds_read_b64_tr_b16 v[230:231], v26 offset:38432
    v_mul_f32 v169, v169, v185
    v_mfma_f32_16x16x32_bf16 v[92:95], v[236:239], a[28:31], v[92:95]
    s_waitcnt lgkmcnt(6)
    v_mul_f32 v170, v170, v186
    v_mul_f32 v171, v171, v187
    v_mfma_f32_16x16x32_bf16 v[96:99], v[240:243], a[0:3], 0
    s_waitcnt lgkmcnt(4)
    ds_read_b64_tr_b16 v[232:233], v26 offset:20544
    v_cvt_pk_bf16_f32 v138, v168, v169
    v_mfma_f32_16x16x32_bf16 v[96:99], v[244:247], a[16:19], v[96:99]
    v_cvt_pk_bf16_f32 v139, v170, v171
    v_mul_f32 v172, v172, v188
    v_mfma_f32_16x16x32_bf16 v[100:103], v[240:243], a[4:7], 0
    s_add_u32 s59, s58, 294912
    ds_read_b64_tr_b16 v[234:235], v26 offset:23104
    v_mul_f32 v173, v173, v189
    v_mfma_f32_16x16x32_bf16 v[100:103], v[244:247], a[20:23], v[100:103]
    buffer_store_dwordx4 v[136:139], v1, s[32:35], s59 offen offset:1024 sc1
    v_mfma_f32_16x16x32_bf16 v[104:107], v[240:243], a[8:11], 0
    ds_read_b64_tr_b16 v[236:237], v26 offset:25664
    v_mul_f32 v174, v174, v190
    v_mfma_f32_16x16x32_bf16 v[104:107], v[244:247], a[24:27], v[104:107]
    v_mul_f32 v175, v175, v191
    v_cvt_pk_bf16_f32 v142, v172, v173
    v_mfma_f32_16x16x32_bf16 v[108:111], v[240:243], a[12:15], 0
    s_add_u32 s59, s58, 442368
    ds_read_b64_tr_b16 v[238:239], v26 offset:28224
    v_cvt_pk_bf16_f32 v143, v174, v175
    v_mfma_f32_16x16x32_bf16 v[108:111], v[244:247], a[28:31], v[108:111]
    s_waitcnt lgkmcnt(6)
    buffer_store_dwordx4 v[140:143], v1, s[32:35], s59 offen offset:1024 sc1
    v_mfma_f32_16x16x32_bf16 v[112:115], v[224:227], a[0:3], 0
    s_waitcnt lgkmcnt(4)
    ds_read_b64_tr_b16 v[240:241], v26 offset:30784
    v_mfma_f32_16x16x32_bf16 v[112:115], v[228:231], a[16:19], v[112:115]
    v_mfma_f32_16x16x32_bf16 v[116:119], v[224:227], a[4:7], 0
    ds_read_b64_tr_b16 v[242:243], v26 offset:33344
    v_mfma_f32_16x16x32_bf16 v[116:119], v[228:231], a[20:23], v[116:119]
    v_mfma_f32_16x16x32_bf16 v[120:123], v[224:227], a[8:11], 0
    ds_read_b64_tr_b16 v[244:245], v26 offset:35904
    v_mfma_f32_16x16x32_bf16 v[120:123], v[228:231], a[24:27], v[120:123]
    v_mfma_f32_16x16x32_bf16 v[124:127], v[224:227], a[12:15], 0
    ds_read_b64_tr_b16 v[246:247], v26 offset:38464
    v_mfma_f32_16x16x32_bf16 v[124:127], v[228:231], a[28:31], v[124:127]
    s_waitcnt lgkmcnt(6)
    v_mfma_f32_16x16x32_bf16 v[128:131], v[232:235], a[0:3], 0
    s_waitcnt lgkmcnt(4)
    ds_read_b64_tr_b16 v[224:225], v26 offset:20576
    v_mfma_f32_16x16x32_bf16 v[128:131], v[236:239], a[16:19], v[128:131]
    v_mfma_f32_16x16x32_bf16 v[132:135], v[232:235], a[4:7], 0
    ds_read_b64_tr_b16 v[226:227], v26 offset:23136
    v_mfma_f32_16x16x32_bf16 v[132:135], v[236:239], a[20:23], v[132:135]
    v_mfma_f32_16x16x32_bf16 v[136:139], v[232:235], a[8:11], 0
    ds_read_b64_tr_b16 v[228:229], v26 offset:25696
    v_mfma_f32_16x16x32_bf16 v[136:139], v[236:239], a[24:27], v[136:139]
    v_mfma_f32_16x16x32_bf16 v[140:143], v[232:235], a[12:15], 0
    ds_read_b64_tr_b16 v[230:231], v26 offset:28256
    v_mfma_f32_16x16x32_bf16 v[140:143], v[236:239], a[28:31], v[140:143]
    s_waitcnt lgkmcnt(6)
    v_mfma_f32_16x16x32_bf16 v[144:147], v[240:243], a[0:3], 0
    s_waitcnt lgkmcnt(4)
    ds_read_b64_tr_b16 v[232:233], v26 offset:30816
    v_mfma_f32_16x16x32_bf16 v[144:147], v[244:247], a[16:19], v[144:147]
    ds_read_b64_tr_b16 v[234:235], v26 offset:33376
    v_mfma_f32_16x16x32_bf16 v[148:151], v[240:243], a[4:7], 0
    ds_read_b64_tr_b16 v[236:237], v26 offset:35936
    v_mfma_f32_16x16x32_bf16 v[148:151], v[244:247], a[20:23], v[148:151]
    ds_read_b64_tr_b16 v[238:239], v26 offset:38496
    v_mfma_f32_16x16x32_bf16 v[152:155], v[240:243], a[8:11], 0
    v_add_u32 v27, 81920, v25
    v_mfma_f32_16x16x32_bf16 v[152:155], v[244:247], a[24:27], v[152:155]
    v_mfma_f32_16x16x32_bf16 v[156:159], v[240:243], a[12:15], 0
    v_mfma_f32_16x16x32_bf16 v[156:159], v[244:247], a[28:31], v[156:159]
    s_waitcnt lgkmcnt(0)
    v_mfma_f32_16x16x32_bf16 v[160:163], v[224:227], a[0:3], 0
    s_waitcnt vmcnt(16)
    s_barrier
    ds_read_b64_tr_b16 v[240:241], v27 offset:0
    v_mfma_f32_16x16x32_bf16 v[160:163], v[228:231], a[16:19], v[160:163]
    v_mfma_f32_16x16x32_bf16 v[164:167], v[224:227], a[4:7], 0
    s_add_u32 s52, s37, 2949248
    s_add_u32 m0, s36, 0
    ds_read_b64_tr_b16 v[242:243], v27 offset:2560
    v_mfma_f32_16x16x32_bf16 v[164:167], v[228:231], a[20:23], v[164:167]
    buffer_load_dwordx4 v20, s[12:15], s52 offen offset:0 lds
    v_mfma_f32_16x16x32_bf16 v[168:171], v[224:227], a[8:11], 0
    ds_read_b64_tr_b16 v[244:245], v27 offset:5120
    v_mfma_f32_16x16x32_bf16 v[168:171], v[228:231], a[24:27], v[168:171]
    v_mfma_f32_16x16x32_bf16 v[172:175], v[224:227], a[12:15], 0
    ds_read_b64_tr_b16 v[246:247], v27 offset:7680
    v_mfma_f32_16x16x32_bf16 v[172:175], v[228:231], a[28:31], v[172:175]
    v_mfma_f32_16x16x32_bf16 v[176:179], v[232:235], a[0:3], 0
    ds_read_b64_tr_b16 v[224:225], v27 offset:10240
    v_mfma_f32_16x16x32_bf16 v[176:179], v[236:239], a[16:19], v[176:179]
    v_mfma_f32_16x16x32_bf16 v[180:183], v[232:235], a[4:7], 0
    ds_read_b64_tr_b16 v[226:227], v27 offset:12800
    v_mfma_f32_16x16x32_bf16 v[180:183], v[236:239], a[20:23], v[180:183]
    buffer_load_dwordx4 v21, s[12:15], s52 offen offset:1024 lds
    v_mfma_f32_16x16x32_bf16 v[184:187], v[232:235], a[8:11], 0
    ds_read_b64_tr_b16 v[228:229], v27 offset:15360
    v_mfma_f32_16x16x32_bf16 v[184:187], v[236:239], a[24:27], v[184:187]
    v_mfma_f32_16x16x32_bf16 v[188:191], v[232:235], a[12:15], 0
    ds_read_b64_tr_b16 v[230:231], v27 offset:17920
    v_mfma_f32_16x16x32_bf16 v[188:191], v[236:239], a[28:31], v[188:191]
    s_waitcnt lgkmcnt(6)
    v_mfma_f32_16x16x32_bf16 v[64:67], v[240:243], a[32:35], v[64:67]
    s_waitcnt lgkmcnt(4)
    ds_read_b64_tr_b16 v[232:233], v27 offset:32
    v_mfma_f32_16x16x32_bf16 v[64:67], v[244:247], a[48:51], v[64:67]
    v_mfma_f32_16x16x32_bf16 v[68:71], v[240:243], a[36:39], v[68:71]
    ds_read_b64_tr_b16 v[234:235], v27 offset:2592
    v_mfma_f32_16x16x32_bf16 v[68:71], v[244:247], a[52:55], v[68:71]
    buffer_load_dwordx4 v22, s[12:15], s52 offen offset:2048 lds
    v_mfma_f32_16x16x32_bf16 v[72:75], v[240:243], a[40:43], v[72:75]
    ds_read_b64_tr_b16 v[236:237], v27 offset:5152
    v_mfma_f32_16x16x32_bf16 v[72:75], v[244:247], a[56:59], v[72:75]
    v_mfma_f32_16x16x32_bf16 v[76:79], v[240:243], a[44:47], v[76:79]
    ds_read_b64_tr_b16 v[238:239], v27 offset:7712
    v_mfma_f32_16x16x32_bf16 v[76:79], v[244:247], a[60:63], v[76:79]
    s_waitcnt lgkmcnt(6)
    v_mfma_f32_16x16x32_bf16 v[80:83], v[224:227], a[32:35], v[80:83]
    s_waitcnt lgkmcnt(4)
    ds_read_b64_tr_b16 v[240:241], v27 offset:10272
    v_mfma_f32_16x16x32_bf16 v[80:83], v[228:231], a[48:51], v[80:83]
    v_mfma_f32_16x16x32_bf16 v[84:87], v[224:227], a[36:39], v[84:87]
    ds_read_b64_tr_b16 v[242:243], v27 offset:12832
    v_mfma_f32_16x16x32_bf16 v[84:87], v[228:231], a[52:55], v[84:87]
    buffer_load_dwordx4 v23, s[12:15], s52 offen offset:3072 lds
    v_mfma_f32_16x16x32_bf16 v[88:91], v[224:227], a[40:43], v[88:91]
    ds_read_b64_tr_b16 v[244:245], v27 offset:15392
    v_mfma_f32_16x16x32_bf16 v[88:91], v[228:231], a[56:59], v[88:91]
    v_mfma_f32_16x16x32_bf16 v[92:95], v[224:227], a[44:47], v[92:95]
    ds_read_b64_tr_b16 v[246:247], v27 offset:17952
    v_mfma_f32_16x16x32_bf16 v[92:95], v[228:231], a[60:63], v[92:95]
    s_waitcnt lgkmcnt(6)
    v_mfma_f32_16x16x32_bf16 v[96:99], v[232:235], a[32:35], v[96:99]
    s_waitcnt lgkmcnt(4)
    ds_read_b64_tr_b16 v[224:225], v27 offset:64
    v_mfma_f32_16x16x32_bf16 v[96:99], v[236:239], a[48:51], v[96:99]
    v_mfma_f32_16x16x32_bf16 v[100:103], v[232:235], a[36:39], v[100:103]
    s_add_u32 m0, s36, 4096
    ds_read_b64_tr_b16 v[226:227], v27 offset:2624
    v_mfma_f32_16x16x32_bf16 v[100:103], v[236:239], a[52:55], v[100:103]
    buffer_load_dwordx4 v24, s[12:15], s52 offen offset:0 lds
    v_mfma_f32_16x16x32_bf16 v[104:107], v[232:235], a[40:43], v[104:107]
    ds_read_b64_tr_b16 v[228:229], v27 offset:5184
    v_mfma_f32_16x16x32_bf16 v[104:107], v[236:239], a[56:59], v[104:107]
    v_mfma_f32_16x16x32_bf16 v[108:111], v[232:235], a[44:47], v[108:111]
    ds_read_b64_tr_b16 v[230:231], v27 offset:7744
    v_mfma_f32_16x16x32_bf16 v[108:111], v[236:239], a[60:63], v[108:111]
    s_waitcnt lgkmcnt(6)
    v_mfma_f32_16x16x32_bf16 v[112:115], v[240:243], a[32:35], v[112:115]
    s_waitcnt lgkmcnt(4)
    ds_read_b64_tr_b16 v[232:233], v27 offset:10304
    v_mfma_f32_16x16x32_bf16 v[112:115], v[244:247], a[48:51], v[112:115]
    v_mfma_f32_16x16x32_bf16 v[116:119], v[240:243], a[36:39], v[116:119]
    s_add_u32 s63, s58, 294912
    ds_read_b64_tr_b16 v[234:235], v27 offset:12864
    v_mfma_f32_16x16x32_bf16 v[116:119], v[244:247], a[52:55], v[116:119]
    buffer_store_dwordx4 v[216:219], v1, s[32:35], s63 offen offset:0 sc1
    v_mfma_f32_16x16x32_bf16 v[120:123], v[240:243], a[40:43], v[120:123]
    ds_read_b64_tr_b16 v[236:237], v27 offset:15424
    v_mfma_f32_16x16x32_bf16 v[120:123], v[244:247], a[56:59], v[120:123]
    v_mfma_f32_16x16x32_bf16 v[124:127], v[240:243], a[44:47], v[124:127]
    ds_read_b64_tr_b16 v[238:239], v27 offset:17984
    v_mfma_f32_16x16x32_bf16 v[124:127], v[244:247], a[60:63], v[124:127]
    s_waitcnt lgkmcnt(6)
    v_mfma_f32_16x16x32_bf16 v[128:131], v[224:227], a[32:35], v[128:131]
    s_waitcnt lgkmcnt(4)
    ds_read_b64_tr_b16 v[240:241], v27 offset:96
    v_mfma_f32_16x16x32_bf16 v[128:131], v[228:231], a[48:51], v[128:131]
    v_mfma_f32_16x16x32_bf16 v[132:135], v[224:227], a[36:39], v[132:135]
    s_add_u32 s63, s58, 442368
    ds_read_b64_tr_b16 v[242:243], v27 offset:2656
    v_mfma_f32_16x16x32_bf16 v[132:135], v[228:231], a[52:55], v[132:135]
    buffer_store_dwordx4 v[220:223], v1, s[32:35], s63 offen offset:0 sc1
    v_mfma_f32_16x16x32_bf16 v[136:139], v[224:227], a[40:43], v[136:139]
    ds_read_b64_tr_b16 v[244:245], v27 offset:5216
    v_mfma_f32_16x16x32_bf16 v[136:139], v[228:231], a[56:59], v[136:139]
    v_mfma_f32_16x16x32_bf16 v[140:143], v[224:227], a[44:47], v[140:143]
    ds_read_b64_tr_b16 v[246:247], v27 offset:7776
    v_mfma_f32_16x16x32_bf16 v[140:143], v[228:231], a[60:63], v[140:143]
    s_waitcnt lgkmcnt(6)
    v_mfma_f32_16x16x32_bf16 v[144:147], v[232:235], a[32:35], v[144:147]
    s_waitcnt lgkmcnt(4)
    ds_read_b64_tr_b16 v[224:225], v27 offset:10336
    v_mfma_f32_16x16x32_bf16 v[144:147], v[236:239], a[48:51], v[144:147]
    v_mfma_f32_16x16x32_bf16 v[148:151], v[232:235], a[36:39], v[148:151]
    s_add_u32 s52, s37, 3539072
    s_add_u32 m0, s36, 20480
    ds_read_b64_tr_b16 v[226:227], v27 offset:12896
    v_mfma_f32_16x16x32_bf16 v[148:151], v[236:239], a[52:55], v[148:151]
    buffer_load_dwordx4 v20, s[12:15], s52 offen offset:0 lds
    v_lshlrev_b32 v254, 8, v253
    v_lshl_add_u32 v254, v252, 4, v254
    v_mfma_f32_16x16x32_bf16 v[152:155], v[232:235], a[40:43], v[152:155]
    ds_read_b64_tr_b16 v[228:229], v27 offset:15456
    v_xor_b32 v248, 0, v251
    v_mfma_f32_16x16x32_bf16 v[152:155], v[236:239], a[56:59], v[152:155]
    v_lshl_add_u32 v212, v248, 6, v254
    v_xor_b32 v248, 1, v251
    v_mfma_f32_16x16x32_bf16 v[156:159], v[232:235], a[44:47], v[156:159]
    ds_read_b64_tr_b16 v[230:231], v27 offset:18016
    v_lshl_add_u32 v213, v248, 6, v254
    v_mfma_f32_16x16x32_bf16 v[156:159], v[236:239], a[60:63], v[156:159]
    s_waitcnt lgkmcnt(6)
    v_xor_b32 v248, 2, v251
    v_lshl_add_u32 v214, v248, 6, v254
    v_mfma_f32_16x16x32_bf16 v[160:163], v[240:243], a[32:35], v[160:163]
    s_waitcnt lgkmcnt(4)
    ds_read_b64_tr_b16 v[232:233], v27 offset:20480
    v_xor_b32 v248, 3, v251
    v_mfma_f32_16x16x32_bf16 v[160:163], v[244:247], a[48:51], v[160:163]
    v_lshl_add_u32 v215, v248, 6, v254
    v_lshlrev_b32 v248, 2, v250
    v_mfma_f32_16x16x32_bf16 v[164:167], v[240:243], a[36:39], v[164:167]
    ds_read_b64_tr_b16 v[234:235], v27 offset:23040
    v_xor_b32 v248, v248, v249
    v_mfma_f32_16x16x32_bf16 v[164:167], v[244:247], a[52:55], v[164:167]
    v_lshlrev_b32 v254, 13, v250
    v_lshl_add_u32 v208, v248, 4, v254
    v_mfma_f32_16x16x32_bf16 v[168:171], v[240:243], a[40:43], v[168:171]
    ds_read_b64_tr_b16 v[236:237], v27 offset:25600
    v_add_u32 v209, 31744, v208
    v_mfma_f32_16x16x32_bf16 v[168:171], v[244:247], a[56:59], v[168:171]
    v_add_u32 v210, 63488, v208
    v_add_u32 v211, 95232, v208
    v_mfma_f32_16x16x32_bf16 v[172:175], v[240:243], a[44:47], v[172:175]
    ds_read_b64_tr_b16 v[238:239], v27 offset:28160
    v_mfma_f32_16x16x32_bf16 v[172:175], v[244:247], a[60:63], v[172:175]
    s_waitcnt lgkmcnt(6)
    buffer_load_dwordx4 v21, s[12:15], s52 offen offset:1024 lds
    v_mfma_f32_16x16x32_bf16 v[176:179], v[224:227], a[32:35], v[176:179]
    s_waitcnt lgkmcnt(4)
    ds_read_b64_tr_b16 v[240:241], v27 offset:30720
    v_mfma_f32_16x16x32_bf16 v[176:179], v[228:231], a[48:51], v[176:179]
    v_mfma_f32_16x16x32_bf16 v[180:183], v[224:227], a[36:39], v[180:183]
    ds_read_b64_tr_b16 v[242:243], v27 offset:33280
    v_mfma_f32_16x16x32_bf16 v[180:183], v[228:231], a[52:55], v[180:183]
    v_mfma_f32_16x16x32_bf16 v[184:187], v[224:227], a[40:43], v[184:187]
    ds_read_b64_tr_b16 v[244:245], v27 offset:35840
    v_mfma_f32_16x16x32_bf16 v[184:187], v[228:231], a[56:59], v[184:187]
    v_mfma_f32_16x16x32_bf16 v[188:191], v[224:227], a[44:47], v[188:191]
    ds_read_b64_tr_b16 v[246:247], v27 offset:38400
    v_mfma_f32_16x16x32_bf16 v[188:191], v[228:231], a[60:63], v[188:191]
    s_waitcnt lgkmcnt(6)
    buffer_load_dwordx4 v22, s[12:15], s52 offen offset:2048 lds
    v_mfma_f32_16x16x32_bf16 v[64:67], v[232:235], a[64:67], v[64:67]
    s_waitcnt lgkmcnt(4)
    ds_read_b64_tr_b16 v[224:225], v27 offset:20512
    v_mfma_f32_16x16x32_bf16 v[64:67], v[236:239], a[80:83], v[64:67]
    v_mfma_f32_16x16x32_bf16 v[68:71], v[232:235], a[68:71], v[68:71]
    ds_read_b64_tr_b16 v[226:227], v27 offset:23072
    v_mfma_f32_16x16x32_bf16 v[68:71], v[236:239], a[84:87], v[68:71]
    v_mfma_f32_16x16x32_bf16 v[72:75], v[232:235], a[72:75], v[72:75]
    ds_read_b64_tr_b16 v[228:229], v27 offset:25632
    v_mfma_f32_16x16x32_bf16 v[72:75], v[236:239], a[88:91], v[72:75]
    v_mfma_f32_16x16x32_bf16 v[76:79], v[232:235], a[76:79], v[76:79]
    ds_read_b64_tr_b16 v[230:231], v27 offset:28192
    v_mfma_f32_16x16x32_bf16 v[76:79], v[236:239], a[92:95], v[76:79]
    s_waitcnt lgkmcnt(6)
    buffer_load_dwordx4 v23, s[12:15], s52 offen offset:3072 lds
    v_mfma_f32_16x16x32_bf16 v[80:83], v[240:243], a[64:67], v[80:83]
    s_waitcnt lgkmcnt(4)
    ds_read_b64_tr_b16 v[232:233], v27 offset:30752
    v_mfma_f32_16x16x32_bf16 v[80:83], v[244:247], a[80:83], v[80:83]
    v_mfma_f32_16x16x32_bf16 v[84:87], v[240:243], a[68:71], v[84:87]
    ds_read_b64_tr_b16 v[234:235], v27 offset:33312
    v_mfma_f32_16x16x32_bf16 v[84:87], v[244:247], a[84:87], v[84:87]
    v_mfma_f32_16x16x32_bf16 v[88:91], v[240:243], a[72:75], v[88:91]
    ds_read_b64_tr_b16 v[236:237], v27 offset:35872
    v_mfma_f32_16x16x32_bf16 v[88:91], v[244:247], a[88:91], v[88:91]
    v_mfma_f32_16x16x32_bf16 v[92:95], v[240:243], a[76:79], v[92:95]
    s_add_u32 m0, s36, 24576
    ds_read_b64_tr_b16 v[238:239], v27 offset:38432
    v_mfma_f32_16x16x32_bf16 v[92:95], v[244:247], a[92:95], v[92:95]
    s_waitcnt lgkmcnt(6)
    buffer_load_dwordx4 v24, s[12:15], s52 offen offset:0 lds
    v_mfma_f32_16x16x32_bf16 v[96:99], v[224:227], a[64:67], v[96:99]
    s_waitcnt lgkmcnt(4)
    ds_read_b64_tr_b16 v[240:241], v27 offset:20544
    v_mfma_f32_16x16x32_bf16 v[96:99], v[228:231], a[80:83], v[96:99]
    v_mfma_f32_16x16x32_bf16 v[100:103], v[224:227], a[68:71], v[100:103]
    ds_read_b64_tr_b16 v[242:243], v27 offset:23104
    v_mfma_f32_16x16x32_bf16 v[100:103], v[228:231], a[84:87], v[100:103]
    v_mfma_f32_16x16x32_bf16 v[104:107], v[224:227], a[72:75], v[104:107]
    ds_read_b64_tr_b16 v[244:245], v27 offset:25664
    v_mfma_f32_16x16x32_bf16 v[104:107], v[228:231], a[88:91], v[104:107]
    v_mfma_f32_16x16x32_bf16 v[108:111], v[224:227], a[76:79], v[108:111]
    s_mov_b32 m0, 122880
    s_add_u32 s52, s50, 0
    ds_read_b64_tr_b16 v[246:247], v27 offset:28224
    v_mfma_f32_16x16x32_bf16 v[108:111], v[228:231], a[92:95], v[108:111]
    s_waitcnt lgkmcnt(6)
    buffer_load_dwordx4 v1, s[16:19], s52 offen lds
    v_mfma_f32_16x16x32_bf16 v[112:115], v[232:235], a[64:67], v[112:115]
    s_waitcnt lgkmcnt(4)
    ds_read_b64_tr_b16 v[224:225], v27 offset:30784
    v_mfma_f32_16x16x32_bf16 v[112:115], v[236:239], a[80:83], v[112:115]
    v_mfma_f32_16x16x32_bf16 v[116:119], v[232:235], a[68:71], v[116:119]
    ds_read_b64_tr_b16 v[226:227], v27 offset:33344
    v_mfma_f32_16x16x32_bf16 v[116:119], v[236:239], a[84:87], v[116:119]
    v_mfma_f32_16x16x32_bf16 v[120:123], v[232:235], a[72:75], v[120:123]
    ds_read_b64_tr_b16 v[228:229], v27 offset:35904
    v_mfma_f32_16x16x32_bf16 v[120:123], v[236:239], a[88:91], v[120:123]
    v_mfma_f32_16x16x32_bf16 v[124:127], v[232:235], a[76:79], v[124:127]
    s_add_u32 s52, s50, 8192
    ds_read_b64_tr_b16 v[230:231], v27 offset:38464
    v_mfma_f32_16x16x32_bf16 v[124:127], v[236:239], a[92:95], v[124:127]
    s_waitcnt lgkmcnt(6)
    buffer_load_dwordx4 v1, s[16:19], s52 offen lds
    v_mfma_f32_16x16x32_bf16 v[128:131], v[240:243], a[64:67], v[128:131]
    s_waitcnt lgkmcnt(4)
    ds_read_b64_tr_b16 v[232:233], v27 offset:20576
    v_mfma_f32_16x16x32_bf16 v[128:131], v[244:247], a[80:83], v[128:131]
    v_mfma_f32_16x16x32_bf16 v[132:135], v[240:243], a[68:71], v[132:135]
    ds_read_b64_tr_b16 v[234:235], v27 offset:23136
    v_mfma_f32_16x16x32_bf16 v[132:135], v[244:247], a[84:87], v[132:135]
    v_mfma_f32_16x16x32_bf16 v[136:139], v[240:243], a[72:75], v[136:139]
    ds_read_b64_tr_b16 v[236:237], v27 offset:25696
    v_mfma_f32_16x16x32_bf16 v[136:139], v[244:247], a[88:91], v[136:139]
    v_mfma_f32_16x16x32_bf16 v[140:143], v[240:243], a[76:79], v[140:143]
    s_add_u32 s52, s50, 16384
    ds_read_b64_tr_b16 v[238:239], v27 offset:28256
    v_mfma_f32_16x16x32_bf16 v[140:143], v[244:247], a[92:95], v[140:143]
    s_waitcnt lgkmcnt(6)
    buffer_load_dwordx4 v1, s[16:19], s52 offen lds
    v_mfma_f32_16x16x32_bf16 v[144:147], v[224:227], a[64:67], v[144:147]
    s_waitcnt lgkmcnt(4)
    ds_read_b64_tr_b16 v[240:241], v27 offset:30816
    v_mfma_f32_16x16x32_bf16 v[144:147], v[228:231], a[80:83], v[144:147]
    ds_read_b64_tr_b16 v[242:243], v27 offset:33376
    v_mfma_f32_16x16x32_bf16 v[148:151], v[224:227], a[68:71], v[148:151]
    ds_read_b64_tr_b16 v[244:245], v27 offset:35936
    v_mfma_f32_16x16x32_bf16 v[148:151], v[228:231], a[84:87], v[148:151]
    ds_read_b64_tr_b16 v[246:247], v27 offset:38496
    v_mfma_f32_16x16x32_bf16 v[152:155], v[224:227], a[72:75], v[152:155]
    v_add_u32 v26, 40960, v25
    v_mfma_f32_16x16x32_bf16 v[152:155], v[228:231], a[88:91], v[152:155]
    v_mfma_f32_16x16x32_bf16 v[156:159], v[224:227], a[76:79], v[156:159]
    s_add_u32 s52, s50, 24576
    v_mfma_f32_16x16x32_bf16 v[156:159], v[228:231], a[92:95], v[156:159]
    s_waitcnt lgkmcnt(0)
    buffer_load_dwordx4 v1, s[16:19], s52 offen lds
    v_mfma_f32_16x16x32_bf16 v[160:163], v[232:235], a[64:67], v[160:163]
    s_waitcnt vmcnt(22)
    s_barrier
    ds_read_b64_tr_b16 v[224:225], v26 offset:0
    v_mfma_f32_16x16x32_bf16 v[160:163], v[236:239], a[80:83], v[160:163]
    v_mfma_f32_16x16x32_bf16 v[164:167], v[232:235], a[68:71], v[164:167]
    ds_read_b64_tr_b16 v[226:227], v26 offset:2560
    v_mfma_f32_16x16x32_bf16 v[164:167], v[236:239], a[84:87], v[164:167]
    v_mfma_f32_16x16x32_bf16 v[168:171], v[232:235], a[72:75], v[168:171]
    ds_read_b64_tr_b16 v[228:229], v26 offset:5120
    v_mfma_f32_16x16x32_bf16 v[168:171], v[236:239], a[88:91], v[168:171]
    v_mfma_f32_16x16x32_bf16 v[172:175], v[232:235], a[76:79], v[172:175]
    s_add_u32 s52, s50, 32768
    ds_read_b64_tr_b16 v[230:231], v26 offset:7680
    v_mfma_f32_16x16x32_bf16 v[172:175], v[236:239], a[92:95], v[172:175]
    buffer_load_dwordx4 v1, s[16:19], s52 offen lds
    v_mfma_f32_16x16x32_bf16 v[176:179], v[240:243], a[64:67], v[176:179]
    ds_read_b64_tr_b16 v[232:233], v26 offset:10240
    v_mfma_f32_16x16x32_bf16 v[176:179], v[244:247], a[80:83], v[176:179]
    v_mfma_f32_16x16x32_bf16 v[180:183], v[240:243], a[68:71], v[180:183]
    ds_read_b64_tr_b16 v[234:235], v26 offset:12800
    v_mfma_f32_16x16x32_bf16 v[180:183], v[244:247], a[84:87], v[180:183]
    v_mfma_f32_16x16x32_bf16 v[184:187], v[240:243], a[72:75], v[184:187]
    ds_read_b64_tr_b16 v[236:237], v26 offset:15360
    v_mfma_f32_16x16x32_bf16 v[184:187], v[244:247], a[88:91], v[184:187]
    v_mfma_f32_16x16x32_bf16 v[188:191], v[240:243], a[76:79], v[188:191]
    s_add_u32 s52, s37, 4128896
    s_add_u32 m0, s36, 81920
    ds_read_b64_tr_b16 v[238:239], v26 offset:17920
    v_mfma_f32_16x16x32_bf16 v[188:191], v[244:247], a[92:95], v[188:191]
    s_waitcnt lgkmcnt(6)
    buffer_load_dwordx4 v20, s[12:15], s52 offen offset:0 lds
    v_mfma_f32_16x16x32_bf16 v[64:67], v[224:227], a[96:99], v[64:67]
    s_waitcnt lgkmcnt(4)
    ds_read_b64_tr_b16 v[240:241], v26 offset:32
    v_mfma_f32_16x16x32_bf16 v[64:67], v[228:231], a[112:115], v[64:67]
    v_mfma_f32_16x16x32_bf16 v[68:71], v[224:227], a[100:103], v[68:71]
    ds_read_b64_tr_b16 v[242:243], v26 offset:2592
    v_mfma_f32_16x16x32_bf16 v[68:71], v[228:231], a[116:119], v[68:71]
    v_mfma_f32_16x16x32_bf16 v[72:75], v[224:227], a[104:107], v[72:75]
    ds_read_b64_tr_b16 v[244:245], v26 offset:5152
    v_mfma_f32_16x16x32_bf16 v[72:75], v[228:231], a[120:123], v[72:75]
    v_mfma_f32_16x16x32_bf16 v[76:79], v[224:227], a[108:111], v[76:79]
    ds_read_b64_tr_b16 v[246:247], v26 offset:7712
    v_mfma_f32_16x16x32_bf16 v[76:79], v[228:231], a[124:127], v[76:79]
    s_waitcnt lgkmcnt(6)
    buffer_load_dwordx4 v21, s[12:15], s52 offen offset:1024 lds
    v_mfma_f32_16x16x32_bf16 v[80:83], v[232:235], a[96:99], v[80:83]
    s_waitcnt lgkmcnt(4)
    ds_read_b64_tr_b16 v[224:225], v26 offset:10272
    v_mfma_f32_16x16x32_bf16 v[80:83], v[236:239], a[112:115], v[80:83]
    v_mfma_f32_16x16x32_bf16 v[84:87], v[232:235], a[100:103], v[84:87]
    ds_read_b64_tr_b16 v[226:227], v26 offset:12832
    v_mfma_f32_16x16x32_bf16 v[84:87], v[236:239], a[116:119], v[84:87]
    v_mfma_f32_16x16x32_bf16 v[88:91], v[232:235], a[104:107], v[88:91]
    ds_read_b64_tr_b16 v[228:229], v26 offset:15392
    v_mfma_f32_16x16x32_bf16 v[88:91], v[236:239], a[120:123], v[88:91]
    v_mfma_f32_16x16x32_bf16 v[92:95], v[232:235], a[108:111], v[92:95]
    ds_read_b64_tr_b16 v[230:231], v26 offset:17952
    v_mfma_f32_16x16x32_bf16 v[92:95], v[236:239], a[124:127], v[92:95]
    s_waitcnt lgkmcnt(6)
    buffer_load_dwordx4 v22, s[12:15], s52 offen offset:2048 lds
    v_mfma_f32_16x16x32_bf16 v[96:99], v[240:243], a[96:99], v[96:99]
    s_waitcnt lgkmcnt(4)
    ds_read_b64_tr_b16 v[232:233], v26 offset:64
    v_mfma_f32_16x16x32_bf16 v[96:99], v[244:247], a[112:115], v[96:99]
    v_mfma_f32_16x16x32_bf16 v[100:103], v[240:243], a[100:103], v[100:103]
    ds_read_b64_tr_b16 v[234:235], v26 offset:2624
    v_mfma_f32_16x16x32_bf16 v[100:103], v[244:247], a[116:119], v[100:103]
    v_mfma_f32_16x16x32_bf16 v[104:107], v[240:243], a[104:107], v[104:107]
    ds_read_b64_tr_b16 v[236:237], v26 offset:5184
    v_mfma_f32_16x16x32_bf16 v[104:107], v[244:247], a[120:123], v[104:107]
    v_mfma_f32_16x16x32_bf16 v[108:111], v[240:243], a[108:111], v[108:111]
    ds_read_b64_tr_b16 v[238:239], v26 offset:7744
    v_mfma_f32_16x16x32_bf16 v[108:111], v[244:247], a[124:127], v[108:111]
    s_waitcnt lgkmcnt(6)
    buffer_load_dwordx4 v23, s[12:15], s52 offen offset:3072 lds
    v_mfma_f32_16x16x32_bf16 v[112:115], v[224:227], a[96:99], v[112:115]
    s_waitcnt lgkmcnt(4)
    ds_read_b64_tr_b16 v[240:241], v26 offset:10304
    v_mfma_f32_16x16x32_bf16 v[112:115], v[228:231], a[112:115], v[112:115]
    v_mfma_f32_16x16x32_bf16 v[116:119], v[224:227], a[100:103], v[116:119]
    ds_read_b64_tr_b16 v[242:243], v26 offset:12864
    v_mfma_f32_16x16x32_bf16 v[116:119], v[228:231], a[116:119], v[116:119]
    v_mfma_f32_16x16x32_bf16 v[120:123], v[224:227], a[104:107], v[120:123]
    ds_read_b64_tr_b16 v[244:245], v26 offset:15424
    v_mfma_f32_16x16x32_bf16 v[120:123], v[228:231], a[120:123], v[120:123]
    v_mfma_f32_16x16x32_bf16 v[124:127], v[224:227], a[108:111], v[124:127]
    s_add_u32 m0, s36, 86016
    ds_read_b64_tr_b16 v[246:247], v26 offset:17984
    v_mfma_f32_16x16x32_bf16 v[124:127], v[228:231], a[124:127], v[124:127]
    s_waitcnt lgkmcnt(6)
    buffer_load_dwordx4 v24, s[12:15], s52 offen offset:0 lds
    v_mfma_f32_16x16x32_bf16 v[128:131], v[232:235], a[96:99], v[128:131]
    s_waitcnt lgkmcnt(4)
    ds_read_b64_tr_b16 v[224:225], v26 offset:96
    v_mfma_f32_16x16x32_bf16 v[128:131], v[236:239], a[112:115], v[128:131]
    v_mfma_f32_16x16x32_bf16 v[132:135], v[232:235], a[100:103], v[132:135]
    ds_read_b64_tr_b16 v[226:227], v26 offset:2656
    v_mfma_f32_16x16x32_bf16 v[132:135], v[236:239], a[116:119], v[132:135]
    v_mfma_f32_16x16x32_bf16 v[136:139], v[232:235], a[104:107], v[136:139]
    ds_read_b64_tr_b16 v[228:229], v26 offset:5216
    v_mfma_f32_16x16x32_bf16 v[136:139], v[236:239], a[120:123], v[136:139]
    v_mfma_f32_16x16x32_bf16 v[140:143], v[232:235], a[108:111], v[140:143]
    s_add_u32 s52, s37, 4718720
    s_add_u32 m0, s36, 102400
    ds_read_b64_tr_b16 v[230:231], v26 offset:7776
    v_mfma_f32_16x16x32_bf16 v[140:143], v[236:239], a[124:127], v[140:143]
    s_waitcnt lgkmcnt(6)
    buffer_load_dwordx4 v20, s[12:15], s52 offen offset:0 lds
    v_mfma_f32_16x16x32_bf16 v[144:147], v[240:243], a[96:99], v[144:147]
    s_waitcnt lgkmcnt(4)
    ds_read_b64_tr_b16 v[232:233], v26 offset:10336
    v_mfma_f32_16x16x32_bf16 v[144:147], v[244:247], a[112:115], v[144:147]
    v_mfma_f32_16x16x32_bf16 v[148:151], v[240:243], a[100:103], v[148:151]
    ds_read_b64_tr_b16 v[234:235], v26 offset:12896
    v_mfma_f32_16x16x32_bf16 v[148:151], v[244:247], a[116:119], v[148:151]
    v_mfma_f32_16x16x32_bf16 v[152:155], v[240:243], a[104:107], v[152:155]
    ds_read_b64_tr_b16 v[236:237], v26 offset:15456
    v_mfma_f32_16x16x32_bf16 v[152:155], v[244:247], a[120:123], v[152:155]
    v_mfma_f32_16x16x32_bf16 v[156:159], v[240:243], a[108:111], v[156:159]
    ds_read_b64_tr_b16 v[238:239], v26 offset:18016
    v_mfma_f32_16x16x32_bf16 v[156:159], v[244:247], a[124:127], v[156:159]
    s_waitcnt lgkmcnt(6)
    buffer_load_dwordx4 v21, s[12:15], s52 offen offset:1024 lds
    v_mfma_f32_16x16x32_bf16 v[160:163], v[224:227], a[96:99], v[160:163]
    s_waitcnt lgkmcnt(4)
    ds_read_b64_tr_b16 v[240:241], v26 offset:20480
    v_mfma_f32_16x16x32_bf16 v[160:163], v[228:231], a[112:115], v[160:163]
    v_mfma_f32_16x16x32_bf16 v[164:167], v[224:227], a[100:103], v[164:167]
    ds_read_b64_tr_b16 v[242:243], v26 offset:23040
    v_mfma_f32_16x16x32_bf16 v[164:167], v[228:231], a[116:119], v[164:167]
    v_mfma_f32_16x16x32_bf16 v[168:171], v[224:227], a[104:107], v[168:171]
    ds_read_b64_tr_b16 v[244:245], v26 offset:25600
    v_mfma_f32_16x16x32_bf16 v[168:171], v[228:231], a[120:123], v[168:171]
    v_mfma_f32_16x16x32_bf16 v[172:175], v[224:227], a[108:111], v[172:175]
    ds_read_b64_tr_b16 v[246:247], v26 offset:28160
    v_mfma_f32_16x16x32_bf16 v[172:175], v[228:231], a[124:127], v[172:175]
    s_waitcnt lgkmcnt(6)
    buffer_load_dwordx4 v22, s[12:15], s52 offen offset:2048 lds
    v_mfma_f32_16x16x32_bf16 v[176:179], v[232:235], a[96:99], v[176:179]
    s_waitcnt lgkmcnt(4)
    ds_read_b64_tr_b16 v[224:225], v26 offset:30720
    v_mfma_f32_16x16x32_bf16 v[176:179], v[236:239], a[112:115], v[176:179]
    v_mfma_f32_16x16x32_bf16 v[180:183], v[232:235], a[100:103], v[180:183]
    ds_read_b64_tr_b16 v[226:227], v26 offset:33280
    v_mfma_f32_16x16x32_bf16 v[180:183], v[236:239], a[116:119], v[180:183]
    v_mfma_f32_16x16x32_bf16 v[184:187], v[232:235], a[104:107], v[184:187]
    ds_read_b64_tr_b16 v[228:229], v26 offset:35840
    v_mfma_f32_16x16x32_bf16 v[184:187], v[236:239], a[120:123], v[184:187]
    v_mfma_f32_16x16x32_bf16 v[188:191], v[232:235], a[108:111], v[188:191]
    ds_read_b64_tr_b16 v[230:231], v26 offset:38400
    v_mfma_f32_16x16x32_bf16 v[188:191], v[236:239], a[124:127], v[188:191]
    s_waitcnt lgkmcnt(6)
    buffer_load_dwordx4 v23, s[12:15], s52 offen offset:3072 lds
    v_mfma_f32_16x16x32_bf16 v[64:67], v[240:243], a[128:131], v[64:67]
    s_waitcnt lgkmcnt(4)
    ds_read_b64_tr_b16 v[232:233], v26 offset:20512
    v_mfma_f32_16x16x32_bf16 v[64:67], v[244:247], a[144:147], v[64:67]
    v_mfma_f32_16x16x32_bf16 v[68:71], v[240:243], a[132:135], v[68:71]
    ds_read_b64_tr_b16 v[234:235], v26 offset:23072
    v_mfma_f32_16x16x32_bf16 v[68:71], v[244:247], a[148:151], v[68:71]
    v_mfma_f32_16x16x32_bf16 v[72:75], v[240:243], a[136:139], v[72:75]
    ds_read_b64_tr_b16 v[236:237], v26 offset:25632
    v_mfma_f32_16x16x32_bf16 v[72:75], v[244:247], a[152:155], v[72:75]
    v_mfma_f32_16x16x32_bf16 v[76:79], v[240:243], a[140:143], v[76:79]
    s_add_u32 m0, s36, 106496
    ds_read_b64_tr_b16 v[238:239], v26 offset:28192
    v_mfma_f32_16x16x32_bf16 v[76:79], v[244:247], a[156:159], v[76:79]
    s_waitcnt lgkmcnt(6)
    buffer_load_dwordx4 v24, s[12:15], s52 offen offset:0 lds
    v_mfma_f32_16x16x32_bf16 v[80:83], v[224:227], a[128:131], v[80:83]
    s_waitcnt lgkmcnt(4)
    ds_read_b64_tr_b16 v[240:241], v26 offset:30752
    v_mfma_f32_16x16x32_bf16 v[80:83], v[228:231], a[144:147], v[80:83]
    v_mfma_f32_16x16x32_bf16 v[84:87], v[224:227], a[132:135], v[84:87]
    ds_read_b64_tr_b16 v[242:243], v26 offset:33312
    v_mfma_f32_16x16x32_bf16 v[84:87], v[228:231], a[148:151], v[84:87]
    v_mfma_f32_16x16x32_bf16 v[88:91], v[224:227], a[136:139], v[88:91]
    ds_read_b64_tr_b16 v[244:245], v26 offset:35872
    v_mfma_f32_16x16x32_bf16 v[88:91], v[228:231], a[152:155], v[88:91]
    v_mfma_f32_16x16x32_bf16 v[92:95], v[224:227], a[140:143], v[92:95]
    s_add_u32 s52, s40, 0
    s_add_u32 m0, s40, 147456
    ds_read_b64_tr_b16 v[246:247], v26 offset:38432
    v_mfma_f32_16x16x32_bf16 v[92:95], v[228:231], a[156:159], v[92:95]
    s_waitcnt lgkmcnt(6)
    buffer_load_dwordx4 v14, s[20:23], s52 offen offset:0 lds
    v_mfma_f32_16x16x32_bf16 v[96:99], v[232:235], a[128:131], v[96:99]
    s_waitcnt lgkmcnt(4)
    ds_read_b64_tr_b16 v[224:225], v26 offset:20544
    v_mfma_f32_16x16x32_bf16 v[96:99], v[236:239], a[144:147], v[96:99]
    v_mfma_f32_16x16x32_bf16 v[100:103], v[232:235], a[132:135], v[100:103]
    ds_read_b64_tr_b16 v[226:227], v26 offset:23104
    v_mfma_f32_16x16x32_bf16 v[100:103], v[236:239], a[148:151], v[100:103]
    v_mfma_f32_16x16x32_bf16 v[104:107], v[232:235], a[136:139], v[104:107]
    ds_read_b64_tr_b16 v[228:229], v26 offset:25664
    v_mfma_f32_16x16x32_bf16 v[104:107], v[236:239], a[152:155], v[104:107]
    v_mfma_f32_16x16x32_bf16 v[108:111], v[232:235], a[140:143], v[108:111]
    ds_read_b64_tr_b16 v[230:231], v26 offset:28224
    v_mfma_f32_16x16x32_bf16 v[108:111], v[236:239], a[156:159], v[108:111]
    s_waitcnt lgkmcnt(6)
    buffer_load_dwordx4 v15, s[20:23], s52 offen offset:1024 lds
    v_mfma_f32_16x16x32_bf16 v[112:115], v[240:243], a[128:131], v[112:115]
    s_waitcnt lgkmcnt(4)
    ds_read_b64_tr_b16 v[232:233], v26 offset:30784
    v_mfma_f32_16x16x32_bf16 v[112:115], v[244:247], a[144:147], v[112:115]
    v_mfma_f32_16x16x32_bf16 v[116:119], v[240:243], a[132:135], v[116:119]
    ds_read_b64_tr_b16 v[234:235], v26 offset:33344
    v_mfma_f32_16x16x32_bf16 v[116:119], v[244:247], a[148:151], v[116:119]
    v_mfma_f32_16x16x32_bf16 v[120:123], v[240:243], a[136:139], v[120:123]
    ds_read_b64_tr_b16 v[236:237], v26 offset:35904
    v_mfma_f32_16x16x32_bf16 v[120:123], v[244:247], a[152:155], v[120:123]
    v_mfma_f32_16x16x32_bf16 v[124:127], v[240:243], a[140:143], v[124:127]
    ds_read_b64_tr_b16 v[238:239], v26 offset:38464
    v_mfma_f32_16x16x32_bf16 v[124:127], v[244:247], a[156:159], v[124:127]
    s_waitcnt lgkmcnt(6)
    buffer_load_dwordx4 v16, s[20:23], s52 offen offset:2048 lds
    v_mfma_f32_16x16x32_bf16 v[128:131], v[224:227], a[128:131], v[128:131]
    s_waitcnt lgkmcnt(4)
    ds_read_b64_tr_b16 v[240:241], v26 offset:20576
    v_mfma_f32_16x16x32_bf16 v[128:131], v[228:231], a[144:147], v[128:131]
    v_mfma_f32_16x16x32_bf16 v[132:135], v[224:227], a[132:135], v[132:135]
    ds_read_b64_tr_b16 v[242:243], v26 offset:23136
    v_mfma_f32_16x16x32_bf16 v[132:135], v[228:231], a[148:151], v[132:135]
    v_mfma_f32_16x16x32_bf16 v[136:139], v[224:227], a[136:139], v[136:139]
    ds_read_b64_tr_b16 v[244:245], v26 offset:25696
    v_mfma_f32_16x16x32_bf16 v[136:139], v[228:231], a[152:155], v[136:139]
    v_mfma_f32_16x16x32_bf16 v[140:143], v[224:227], a[140:143], v[140:143]
    ds_read_b64_tr_b16 v[246:247], v26 offset:28256
    v_mfma_f32_16x16x32_bf16 v[140:143], v[228:231], a[156:159], v[140:143]
    s_waitcnt lgkmcnt(6)
    buffer_load_dwordx4 v17, s[20:23], s52 offen offset:3072 lds
    v_mfma_f32_16x16x32_bf16 v[144:147], v[232:235], a[128:131], v[144:147]
    s_waitcnt lgkmcnt(4)
    ds_read_b64_tr_b16 v[224:225], v26 offset:30816
    v_mfma_f32_16x16x32_bf16 v[144:147], v[236:239], a[144:147], v[144:147]
    ds_read_b64_tr_b16 v[226:227], v26 offset:33376
    v_mfma_f32_16x16x32_bf16 v[148:151], v[232:235], a[132:135], v[148:151]
    ds_read_b64_tr_b16 v[228:229], v26 offset:35936
    v_mfma_f32_16x16x32_bf16 v[148:151], v[236:239], a[148:151], v[148:151]
    ds_read_b64_tr_b16 v[230:231], v26 offset:38496
    v_mfma_f32_16x16x32_bf16 v[152:155], v[232:235], a[136:139], v[152:155]
    v_add_u32 v27, 0, v25
    v_mfma_f32_16x16x32_bf16 v[152:155], v[236:239], a[152:155], v[152:155]
    v_mfma_f32_16x16x32_bf16 v[156:159], v[232:235], a[140:143], v[156:159]
    s_add_u32 s52, s40, 16384
    s_add_u32 m0, s40, 131072
    v_mfma_f32_16x16x32_bf16 v[156:159], v[236:239], a[156:159], v[156:159]
    s_waitcnt lgkmcnt(0)
    buffer_load_dwordx4 v14, s[20:23], s52 offen offset:0 lds
    v_mfma_f32_16x16x32_bf16 v[160:163], v[240:243], a[128:131], v[160:163]
    s_waitcnt vmcnt(20)
    s_barrier
    ds_read_b64_tr_b16 v[232:233], v27 offset:0
    v_mfma_f32_16x16x32_bf16 v[160:163], v[244:247], a[144:147], v[160:163]
    v_mfma_f32_16x16x32_bf16 v[164:167], v[240:243], a[132:135], v[164:167]
    ds_read_b64_tr_b16 v[234:235], v27 offset:2560
    v_mfma_f32_16x16x32_bf16 v[164:167], v[244:247], a[148:151], v[164:167]
    v_mfma_f32_16x16x32_bf16 v[168:171], v[240:243], a[136:139], v[168:171]
    ds_read_b64_tr_b16 v[236:237], v27 offset:5120
    v_mfma_f32_16x16x32_bf16 v[168:171], v[244:247], a[152:155], v[168:171]
    v_mfma_f32_16x16x32_bf16 v[172:175], v[240:243], a[140:143], v[172:175]
    ds_read_b64_tr_b16 v[238:239], v27 offset:7680
    v_mfma_f32_16x16x32_bf16 v[172:175], v[244:247], a[156:159], v[172:175]
    buffer_load_dwordx4 v15, s[20:23], s52 offen offset:1024 lds
    v_mfma_f32_16x16x32_bf16 v[176:179], v[224:227], a[128:131], v[176:179]
    ds_read_b64_tr_b16 v[240:241], v27 offset:10240
    v_mfma_f32_16x16x32_bf16 v[176:179], v[228:231], a[144:147], v[176:179]
    v_mfma_f32_16x16x32_bf16 v[180:183], v[224:227], a[132:135], v[180:183]
    ds_read_b64_tr_b16 v[242:243], v27 offset:12800
    v_mfma_f32_16x16x32_bf16 v[180:183], v[228:231], a[148:151], v[180:183]
    v_mfma_f32_16x16x32_bf16 v[184:187], v[224:227], a[136:139], v[184:187]
    ds_read_b64_tr_b16 v[244:245], v27 offset:15360
    v_mfma_f32_16x16x32_bf16 v[184:187], v[228:231], a[152:155], v[184:187]
    v_mfma_f32_16x16x32_bf16 v[188:191], v[224:227], a[140:143], v[188:191]
    ds_read_b64_tr_b16 v[246:247], v27 offset:17920
    v_mfma_f32_16x16x32_bf16 v[188:191], v[228:231], a[156:159], v[188:191]
    s_waitcnt lgkmcnt(6)
    buffer_load_dwordx4 v16, s[20:23], s52 offen offset:2048 lds
    v_mfma_f32_16x16x32_bf16 v[64:67], v[232:235], a[160:163], v[64:67]
    s_waitcnt lgkmcnt(4)
    ds_read_b64_tr_b16 v[224:225], v27 offset:32
    v_mfma_f32_16x16x32_bf16 v[64:67], v[236:239], a[176:179], v[64:67]
    v_mfma_f32_16x16x32_bf16 v[68:71], v[232:235], a[164:167], v[68:71]
    ds_read_b64_tr_b16 v[226:227], v27 offset:2592
    v_mfma_f32_16x16x32_bf16 v[68:71], v[236:239], a[180:183], v[68:71]
    v_mfma_f32_16x16x32_bf16 v[72:75], v[232:235], a[168:171], v[72:75]
    ds_read_b64_tr_b16 v[228:229], v27 offset:5152
    v_mfma_f32_16x16x32_bf16 v[72:75], v[236:239], a[184:187], v[72:75]
    v_mfma_f32_16x16x32_bf16 v[76:79], v[232:235], a[172:175], v[76:79]
    ds_read_b64_tr_b16 v[230:231], v27 offset:7712
    v_mfma_f32_16x16x32_bf16 v[76:79], v[236:239], a[188:191], v[76:79]
    s_waitcnt lgkmcnt(6)
    buffer_load_dwordx4 v17, s[20:23], s52 offen offset:3072 lds
    v_mfma_f32_16x16x32_bf16 v[80:83], v[240:243], a[160:163], v[80:83]
    s_waitcnt lgkmcnt(4)
    ds_read_b64_tr_b16 v[232:233], v27 offset:10272
    v_mfma_f32_16x16x32_bf16 v[80:83], v[244:247], a[176:179], v[80:83]
    v_mfma_f32_16x16x32_bf16 v[84:87], v[240:243], a[164:167], v[84:87]
    ds_read_b64_tr_b16 v[234:235], v27 offset:12832
    v_mfma_f32_16x16x32_bf16 v[84:87], v[244:247], a[180:183], v[84:87]
    v_mfma_f32_16x16x32_bf16 v[88:91], v[240:243], a[168:171], v[88:91]
    ds_read_b64_tr_b16 v[236:237], v27 offset:15392
    v_mfma_f32_16x16x32_bf16 v[88:91], v[244:247], a[184:187], v[88:91]
    v_mfma_f32_16x16x32_bf16 v[92:95], v[240:243], a[172:175], v[92:95]
    s_add_u32 s52, s39, 0
    s_add_u32 m0, s40, 40960
    ds_read_b64_tr_b16 v[238:239], v27 offset:17952
    v_mfma_f32_16x16x32_bf16 v[92:95], v[244:247], a[188:191], v[92:95]
    s_waitcnt lgkmcnt(6)
    buffer_load_dwordx4 v208, s[16:19], s52 offen offset:0 lds
    v_mfma_f32_16x16x32_bf16 v[96:99], v[224:227], a[160:163], v[96:99]
    s_waitcnt lgkmcnt(4)
    ds_read_b64_tr_b16 v[240:241], v27 offset:64
    v_mfma_f32_16x16x32_bf16 v[96:99], v[228:231], a[176:179], v[96:99]
    v_mfma_f32_16x16x32_bf16 v[100:103], v[224:227], a[164:167], v[100:103]
    ds_read_b64_tr_b16 v[242:243], v27 offset:2624
    v_mfma_f32_16x16x32_bf16 v[100:103], v[228:231], a[180:183], v[100:103]
    v_mfma_f32_16x16x32_bf16 v[104:107], v[224:227], a[168:171], v[104:107]
    ds_read_b64_tr_b16 v[244:245], v27 offset:5184
    v_mfma_f32_16x16x32_bf16 v[104:107], v[228:231], a[184:187], v[104:107]
    v_mfma_f32_16x16x32_bf16 v[108:111], v[224:227], a[172:175], v[108:111]
    ds_read_b64_tr_b16 v[246:247], v27 offset:7744
    v_mfma_f32_16x16x32_bf16 v[108:111], v[228:231], a[188:191], v[108:111]
    s_waitcnt lgkmcnt(6)
    buffer_load_dwordx4 v209, s[16:19], s52 offen offset:1024 lds
    v_mfma_f32_16x16x32_bf16 v[112:115], v[232:235], a[160:163], v[112:115]
    s_waitcnt lgkmcnt(4)
    ds_read_b64_tr_b16 v[224:225], v27 offset:10304
    v_mfma_f32_16x16x32_bf16 v[112:115], v[236:239], a[176:179], v[112:115]
    v_mfma_f32_16x16x32_bf16 v[116:119], v[232:235], a[164:167], v[116:119]
    ds_read_b64_tr_b16 v[226:227], v27 offset:12864
    v_mfma_f32_16x16x32_bf16 v[116:119], v[236:239], a[180:183], v[116:119]
    v_mfma_f32_16x16x32_bf16 v[120:123], v[232:235], a[168:171], v[120:123]
    ds_read_b64_tr_b16 v[228:229], v27 offset:15424
    v_mfma_f32_16x16x32_bf16 v[120:123], v[236:239], a[184:187], v[120:123]
    v_mfma_f32_16x16x32_bf16 v[124:127], v[232:235], a[172:175], v[124:127]
    ds_read_b64_tr_b16 v[230:231], v27 offset:17984
    v_mfma_f32_16x16x32_bf16 v[124:127], v[236:239], a[188:191], v[124:127]
    s_waitcnt lgkmcnt(6)
    buffer_load_dwordx4 v210, s[16:19], s52 offen offset:2048 lds
    v_mfma_f32_16x16x32_bf16 v[128:131], v[240:243], a[160:163], v[128:131]
    s_waitcnt lgkmcnt(4)
    ds_read_b64_tr_b16 v[232:233], v27 offset:96
    v_mfma_f32_16x16x32_bf16 v[128:131], v[244:247], a[176:179], v[128:131]
    v_mfma_f32_16x16x32_bf16 v[132:135], v[240:243], a[164:167], v[132:135]
    ds_read_b64_tr_b16 v[234:235], v27 offset:2656
    v_mfma_f32_16x16x32_bf16 v[132:135], v[244:247], a[180:183], v[132:135]
    v_mfma_f32_16x16x32_bf16 v[136:139], v[240:243], a[168:171], v[136:139]
    ds_read_b64_tr_b16 v[236:237], v27 offset:5216
    v_mfma_f32_16x16x32_bf16 v[136:139], v[244:247], a[184:187], v[136:139]
    v_mfma_f32_16x16x32_bf16 v[140:143], v[240:243], a[172:175], v[140:143]
    ds_read_b64_tr_b16 v[238:239], v27 offset:7776
    v_mfma_f32_16x16x32_bf16 v[140:143], v[244:247], a[188:191], v[140:143]
    s_waitcnt lgkmcnt(6)
    buffer_load_dwordx4 v211, s[16:19], s52 offen offset:3072 lds
    v_mfma_f32_16x16x32_bf16 v[144:147], v[224:227], a[160:163], v[144:147]
    s_waitcnt lgkmcnt(4)
    ds_read_b64_tr_b16 v[240:241], v27 offset:10336
    v_mfma_f32_16x16x32_bf16 v[144:147], v[228:231], a[176:179], v[144:147]
    v_mfma_f32_16x16x32_bf16 v[148:151], v[224:227], a[164:167], v[148:151]
    ds_read_b64_tr_b16 v[242:243], v27 offset:12896
    v_mfma_f32_16x16x32_bf16 v[148:151], v[228:231], a[180:183], v[148:151]
    v_mfma_f32_16x16x32_bf16 v[152:155], v[224:227], a[168:171], v[152:155]
    ds_read_b64_tr_b16 v[244:245], v27 offset:15456
    v_mfma_f32_16x16x32_bf16 v[152:155], v[228:231], a[184:187], v[152:155]
    v_mfma_f32_16x16x32_bf16 v[156:159], v[224:227], a[172:175], v[156:159]
    ds_read_b64_tr_b16 v[246:247], v27 offset:18016
    v_mfma_f32_16x16x32_bf16 v[156:159], v[228:231], a[188:191], v[156:159]
    s_waitcnt lgkmcnt(6)
    v_mfma_f32_16x16x32_bf16 v[160:163], v[232:235], a[160:163], v[160:163]
    s_waitcnt lgkmcnt(4)
    ds_read_b64_tr_b16 v[224:225], v27 offset:20480
    v_mfma_f32_16x16x32_bf16 v[160:163], v[236:239], a[176:179], v[160:163]
    v_mfma_f32_16x16x32_bf16 v[164:167], v[232:235], a[164:167], v[164:167]
    ds_read_b64_tr_b16 v[226:227], v27 offset:23040
    v_mfma_f32_16x16x32_bf16 v[164:167], v[236:239], a[180:183], v[164:167]
    v_mfma_f32_16x16x32_bf16 v[168:171], v[232:235], a[168:171], v[168:171]
    ds_read_b64_tr_b16 v[228:229], v27 offset:25600
    v_mfma_f32_16x16x32_bf16 v[168:171], v[236:239], a[184:187], v[168:171]
    v_mfma_f32_16x16x32_bf16 v[172:175], v[232:235], a[172:175], v[172:175]
    ds_read_b64_tr_b16 v[230:231], v27 offset:28160
    v_mfma_f32_16x16x32_bf16 v[172:175], v[236:239], a[188:191], v[172:175]
    s_waitcnt lgkmcnt(6)
    v_mfma_f32_16x16x32_bf16 v[176:179], v[240:243], a[160:163], v[176:179]
    s_waitcnt lgkmcnt(4)
    ds_read_b64_tr_b16 v[232:233], v27 offset:30720
    v_mfma_f32_16x16x32_bf16 v[176:179], v[244:247], a[176:179], v[176:179]
    v_mfma_f32_16x16x32_bf16 v[180:183], v[240:243], a[164:167], v[180:183]
    ds_read_b64_tr_b16 v[234:235], v27 offset:33280
    v_mfma_f32_16x16x32_bf16 v[180:183], v[244:247], a[180:183], v[180:183]
    v_mfma_f32_16x16x32_bf16 v[184:187], v[240:243], a[168:171], v[184:187]
    ds_read_b64_tr_b16 v[236:237], v27 offset:35840
    v_mfma_f32_16x16x32_bf16 v[184:187], v[244:247], a[184:187], v[184:187]
    v_mfma_f32_16x16x32_bf16 v[188:191], v[240:243], a[172:175], v[188:191]
    ds_read_b64_tr_b16 v[238:239], v27 offset:38400
    v_mfma_f32_16x16x32_bf16 v[188:191], v[244:247], a[188:191], v[188:191]
    s_waitcnt lgkmcnt(6)
    v_mfma_f32_16x16x32_bf16 v[64:67], v[224:227], a[192:195], v[64:67]
    s_waitcnt lgkmcnt(4)
    ds_read_b64_tr_b16 v[240:241], v27 offset:20512
    v_mfma_f32_16x16x32_bf16 v[64:67], v[228:231], a[208:211], v[64:67]
    v_mfma_f32_16x16x32_bf16 v[68:71], v[224:227], a[196:199], v[68:71]
    ds_read_b64_tr_b16 v[242:243], v27 offset:23072
    v_mfma_f32_16x16x32_bf16 v[68:71], v[228:231], a[212:215], v[68:71]
    v_mfma_f32_16x16x32_bf16 v[72:75], v[224:227], a[200:203], v[72:75]
    ds_read_b64_tr_b16 v[244:245], v27 offset:25632
    v_mfma_f32_16x16x32_bf16 v[72:75], v[228:231], a[216:219], v[72:75]
    v_mfma_f32_16x16x32_bf16 v[76:79], v[224:227], a[204:207], v[76:79]
    ds_read_b64_tr_b16 v[246:247], v27 offset:28192
    v_mfma_f32_16x16x32_bf16 v[76:79], v[228:231], a[220:223], v[76:79]
    s_waitcnt lgkmcnt(6)
    v_mfma_f32_16x16x32_bf16 v[80:83], v[232:235], a[192:195], v[80:83]
    s_waitcnt lgkmcnt(4)
    ds_read_b64_tr_b16 v[224:225], v27 offset:30752
    v_mfma_f32_16x16x32_bf16 v[80:83], v[236:239], a[208:211], v[80:83]
    v_mfma_f32_16x16x32_bf16 v[84:87], v[232:235], a[196:199], v[84:87]
    ds_read_b64_tr_b16 v[226:227], v27 offset:33312
    v_mfma_f32_16x16x32_bf16 v[84:87], v[236:239], a[212:215], v[84:87]
    v_mfma_f32_16x16x32_bf16 v[88:91], v[232:235], a[200:203], v[88:91]
    ds_read_b64_tr_b16 v[228:229], v27 offset:35872
    v_mfma_f32_16x16x32_bf16 v[88:91], v[236:239], a[216:219], v[88:91]
    v_mfma_f32_16x16x32_bf16 v[92:95], v[232:235], a[204:207], v[92:95]
    ds_read_b64_tr_b16 v[230:231], v27 offset:38432
    v_mfma_f32_16x16x32_bf16 v[92:95], v[236:239], a[220:223], v[92:95]
    s_waitcnt lgkmcnt(6)
    v_mfma_f32_16x16x32_bf16 v[96:99], v[240:243], a[192:195], v[96:99]
    s_waitcnt lgkmcnt(4)
    ds_read_b64_tr_b16 v[232:233], v27 offset:20544
    v_mfma_f32_16x16x32_bf16 v[96:99], v[244:247], a[208:211], v[96:99]
    v_mfma_f32_16x16x32_bf16 v[100:103], v[240:243], a[196:199], v[100:103]
    ds_read_b64_tr_b16 v[234:235], v27 offset:23104
    v_mfma_f32_16x16x32_bf16 v[100:103], v[244:247], a[212:215], v[100:103]
    v_mfma_f32_16x16x32_bf16 v[104:107], v[240:243], a[200:203], v[104:107]
    ds_read_b64_tr_b16 v[236:237], v27 offset:25664
    v_mfma_f32_16x16x32_bf16 v[104:107], v[244:247], a[216:219], v[104:107]
    v_mfma_f32_16x16x32_bf16 v[108:111], v[240:243], a[204:207], v[108:111]
    ds_read_b64_tr_b16 v[238:239], v27 offset:28224
    v_mfma_f32_16x16x32_bf16 v[108:111], v[244:247], a[220:223], v[108:111]
    s_waitcnt lgkmcnt(6)
    v_mfma_f32_16x16x32_bf16 v[112:115], v[224:227], a[192:195], v[112:115]
    s_waitcnt lgkmcnt(4)
    ds_read_b64_tr_b16 v[240:241], v27 offset:30784
    v_mfma_f32_16x16x32_bf16 v[112:115], v[228:231], a[208:211], v[112:115]
    v_mfma_f32_16x16x32_bf16 v[116:119], v[224:227], a[196:199], v[116:119]
    ds_read_b64_tr_b16 v[242:243], v27 offset:33344
    v_mfma_f32_16x16x32_bf16 v[116:119], v[228:231], a[212:215], v[116:119]
    v_mfma_f32_16x16x32_bf16 v[120:123], v[224:227], a[200:203], v[120:123]
    ds_read_b64_tr_b16 v[244:245], v27 offset:35904
    v_mfma_f32_16x16x32_bf16 v[120:123], v[228:231], a[216:219], v[120:123]
    v_mfma_f32_16x16x32_bf16 v[124:127], v[224:227], a[204:207], v[124:127]
    ds_read_b64_tr_b16 v[246:247], v27 offset:38464
    v_mfma_f32_16x16x32_bf16 v[124:127], v[228:231], a[220:223], v[124:127]
    s_waitcnt lgkmcnt(6)
    v_mfma_f32_16x16x32_bf16 v[128:131], v[232:235], a[192:195], v[128:131]
    s_waitcnt lgkmcnt(4)
    ds_read_b64_tr_b16 v[224:225], v27 offset:20576
    v_mfma_f32_16x16x32_bf16 v[128:131], v[236:239], a[208:211], v[128:131]
    v_mfma_f32_16x16x32_bf16 v[132:135], v[232:235], a[196:199], v[132:135]
    ds_read_b64_tr_b16 v[226:227], v27 offset:23136
    v_mfma_f32_16x16x32_bf16 v[132:135], v[236:239], a[212:215], v[132:135]
    v_mfma_f32_16x16x32_bf16 v[136:139], v[232:235], a[200:203], v[136:139]
    ds_read_b64_tr_b16 v[228:229], v27 offset:25696
    v_mfma_f32_16x16x32_bf16 v[136:139], v[236:239], a[216:219], v[136:139]
    v_mfma_f32_16x16x32_bf16 v[140:143], v[232:235], a[204:207], v[140:143]
    ds_read_b64_tr_b16 v[230:231], v27 offset:28256
    v_mfma_f32_16x16x32_bf16 v[140:143], v[236:239], a[220:223], v[140:143]
    s_waitcnt lgkmcnt(6)
    v_mfma_f32_16x16x32_bf16 v[144:147], v[240:243], a[192:195], v[144:147]
    s_waitcnt lgkmcnt(4)
    ds_read_b64_tr_b16 v[232:233], v27 offset:30816
    v_mfma_f32_16x16x32_bf16 v[144:147], v[244:247], a[208:211], v[144:147]
    ds_read_b64_tr_b16 v[234:235], v27 offset:33376
    v_mfma_f32_16x16x32_bf16 v[148:151], v[240:243], a[196:199], v[148:151]
    ds_read_b64_tr_b16 v[236:237], v27 offset:35936
    v_mfma_f32_16x16x32_bf16 v[148:151], v[244:247], a[212:215], v[148:151]
    ds_read_b64_tr_b16 v[238:239], v27 offset:38496
    v_mfma_f32_16x16x32_bf16 v[152:155], v[240:243], a[200:203], v[152:155]
    v_add_u32 v26, 81920, v25
    v_mfma_f32_16x16x32_bf16 v[152:155], v[244:247], a[216:219], v[152:155]
    v_mfma_f32_16x16x32_bf16 v[156:159], v[240:243], a[204:207], v[156:159]
    v_mfma_f32_16x16x32_bf16 v[156:159], v[244:247], a[220:223], v[156:159]
    s_waitcnt lgkmcnt(0)
    v_mfma_f32_16x16x32_bf16 v[160:163], v[224:227], a[192:195], v[160:163]
    s_waitcnt vmcnt(12)
    s_barrier
    ds_read_b64_tr_b16 v[240:241], v26 offset:0
    v_mfma_f32_16x16x32_bf16 v[160:163], v[228:231], a[208:211], v[160:163]
    v_mfma_f32_16x16x32_bf16 v[164:167], v[224:227], a[196:199], v[164:167]
    s_add_u32 s52, s39, 524288
    s_add_u32 m0, s40, 0
    ds_read_b64_tr_b16 v[242:243], v26 offset:2560
    v_mfma_f32_16x16x32_bf16 v[164:167], v[228:231], a[212:215], v[164:167]
    buffer_load_dwordx4 v208, s[16:19], s52 offen offset:0 lds
    v_mfma_f32_16x16x32_bf16 v[168:171], v[224:227], a[200:203], v[168:171]
    ds_read_b64_tr_b16 v[244:245], v26 offset:5120
    v_mfma_f32_16x16x32_bf16 v[168:171], v[228:231], a[216:219], v[168:171]
    v_mfma_f32_16x16x32_bf16 v[172:175], v[224:227], a[204:207], v[172:175]
    ds_read_b64_tr_b16 v[246:247], v26 offset:7680
    v_mfma_f32_16x16x32_bf16 v[172:175], v[228:231], a[220:223], v[172:175]
    v_mfma_f32_16x16x32_bf16 v[176:179], v[232:235], a[192:195], v[176:179]
    ds_read_b64_tr_b16 v[224:225], v26 offset:10240
    v_mfma_f32_16x16x32_bf16 v[176:179], v[236:239], a[208:211], v[176:179]
    v_mfma_f32_16x16x32_bf16 v[180:183], v[232:235], a[196:199], v[180:183]
    ds_read_b64_tr_b16 v[226:227], v26 offset:12800
    v_mfma_f32_16x16x32_bf16 v[180:183], v[236:239], a[212:215], v[180:183]
    buffer_load_dwordx4 v209, s[16:19], s52 offen offset:1024 lds
    v_mfma_f32_16x16x32_bf16 v[184:187], v[232:235], a[200:203], v[184:187]
    ds_read_b64_tr_b16 v[228:229], v26 offset:15360
    v_mfma_f32_16x16x32_bf16 v[184:187], v[236:239], a[216:219], v[184:187]
    v_mfma_f32_16x16x32_bf16 v[188:191], v[232:235], a[204:207], v[188:191]
    ds_read_b64_tr_b16 v[230:231], v26 offset:17920
    v_mfma_f32_16x16x32_bf16 v[188:191], v[236:239], a[220:223], v[188:191]
    s_waitcnt lgkmcnt(6)
    v_mfma_f32_16x16x32_bf16 v[64:67], v[240:243], a[224:227], v[64:67]
    s_waitcnt lgkmcnt(4)
    ds_read_b64_tr_b16 v[232:233], v26 offset:32
    v_mfma_f32_16x16x32_bf16 v[64:67], v[244:247], a[240:243], v[64:67]
    v_mfma_f32_16x16x32_bf16 v[68:71], v[240:243], a[228:231], v[68:71]
    ds_read_b64_tr_b16 v[234:235], v26 offset:2592
    v_mfma_f32_16x16x32_bf16 v[68:71], v[244:247], a[244:247], v[68:71]
    buffer_load_dwordx4 v210, s[16:19], s52 offen offset:2048 lds
    v_mfma_f32_16x16x32_bf16 v[72:75], v[240:243], a[232:235], v[72:75]
    ds_read_b64_tr_b16 v[236:237], v26 offset:5152
    v_mfma_f32_16x16x32_bf16 v[72:75], v[244:247], a[248:251], v[72:75]
    v_mfma_f32_16x16x32_bf16 v[76:79], v[240:243], a[236:239], v[76:79]
    ds_read_b64_tr_b16 v[238:239], v26 offset:7712
    v_mfma_f32_16x16x32_bf16 v[76:79], v[244:247], a[252:255], v[76:79]
    s_waitcnt lgkmcnt(6)
    v_mfma_f32_16x16x32_bf16 v[80:83], v[224:227], a[224:227], v[80:83]
    s_waitcnt lgkmcnt(4)
    ds_read_b64_tr_b16 v[240:241], v26 offset:10272
    v_mfma_f32_16x16x32_bf16 v[80:83], v[228:231], a[240:243], v[80:83]
    v_mfma_f32_16x16x32_bf16 v[84:87], v[224:227], a[228:231], v[84:87]
    ds_read_b64_tr_b16 v[242:243], v26 offset:12832
    v_mfma_f32_16x16x32_bf16 v[84:87], v[228:231], a[244:247], v[84:87]
    buffer_load_dwordx4 v211, s[16:19], s52 offen offset:3072 lds
    v_mfma_f32_16x16x32_bf16 v[88:91], v[224:227], a[232:235], v[88:91]
    ds_read_b64_tr_b16 v[244:245], v26 offset:15392
    v_mfma_f32_16x16x32_bf16 v[88:91], v[228:231], a[248:251], v[88:91]
    v_mfma_f32_16x16x32_bf16 v[92:95], v[224:227], a[236:239], v[92:95]
    ds_read_b64_tr_b16 v[246:247], v26 offset:17952
    v_mfma_f32_16x16x32_bf16 v[92:95], v[228:231], a[252:255], v[92:95]
    s_waitcnt lgkmcnt(6)
    v_mfma_f32_16x16x32_bf16 v[96:99], v[232:235], a[224:227], v[96:99]
    s_waitcnt lgkmcnt(4)
    ds_read_b64_tr_b16 v[224:225], v26 offset:64
    v_mfma_f32_16x16x32_bf16 v[96:99], v[236:239], a[240:243], v[96:99]
    v_mfma_f32_16x16x32_bf16 v[100:103], v[232:235], a[228:231], v[100:103]
    s_add_u32 s52, s39, 1048576
    s_add_u32 m0, s40, 16384
    ds_read_b64_tr_b16 v[226:227], v26 offset:2624
    v_mfma_f32_16x16x32_bf16 v[100:103], v[236:239], a[244:247], v[100:103]
    buffer_load_dwordx4 v208, s[16:19], s52 offen offset:0 lds
    v_mfma_f32_16x16x32_bf16 v[104:107], v[232:235], a[232:235], v[104:107]
    ds_read_b64_tr_b16 v[228:229], v26 offset:5184
    v_mfma_f32_16x16x32_bf16 v[104:107], v[236:239], a[248:251], v[104:107]
    v_mfma_f32_16x16x32_bf16 v[108:111], v[232:235], a[236:239], v[108:111]
    ds_read_b64_tr_b16 v[230:231], v26 offset:7744
    v_mfma_f32_16x16x32_bf16 v[108:111], v[236:239], a[252:255], v[108:111]
    s_waitcnt lgkmcnt(6)
    v_mfma_f32_16x16x32_bf16 v[112:115], v[240:243], a[224:227], v[112:115]
    s_waitcnt lgkmcnt(4)
    ds_read_b64_tr_b16 v[232:233], v26 offset:10304
    v_mfma_f32_16x16x32_bf16 v[112:115], v[244:247], a[240:243], v[112:115]
    v_mfma_f32_16x16x32_bf16 v[116:119], v[240:243], a[228:231], v[116:119]
    ds_read_b64_tr_b16 v[234:235], v26 offset:12864
    v_mfma_f32_16x16x32_bf16 v[116:119], v[244:247], a[244:247], v[116:119]
    buffer_load_dwordx4 v209, s[16:19], s52 offen offset:1024 lds
    v_mfma_f32_16x16x32_bf16 v[120:123], v[240:243], a[232:235], v[120:123]
    ds_read_b64_tr_b16 v[236:237], v26 offset:15424
    v_mfma_f32_16x16x32_bf16 v[120:123], v[244:247], a[248:251], v[120:123]
    v_mfma_f32_16x16x32_bf16 v[124:127], v[240:243], a[236:239], v[124:127]
    ds_read_b64_tr_b16 v[238:239], v26 offset:17984
    v_mfma_f32_16x16x32_bf16 v[124:127], v[244:247], a[252:255], v[124:127]
    s_waitcnt lgkmcnt(6)
    v_mfma_f32_16x16x32_bf16 v[128:131], v[224:227], a[224:227], v[128:131]
    s_waitcnt lgkmcnt(4)
    ds_read_b64_tr_b16 v[240:241], v26 offset:96
    v_mfma_f32_16x16x32_bf16 v[128:131], v[228:231], a[240:243], v[128:131]
    v_mfma_f32_16x16x32_bf16 v[132:135], v[224:227], a[228:231], v[132:135]
    ds_read_b64_tr_b16 v[242:243], v26 offset:2656
    v_mfma_f32_16x16x32_bf16 v[132:135], v[228:231], a[244:247], v[132:135]
    buffer_load_dwordx4 v210, s[16:19], s52 offen offset:2048 lds
    v_mfma_f32_16x16x32_bf16 v[136:139], v[224:227], a[232:235], v[136:139]
    ds_read_b64_tr_b16 v[244:245], v26 offset:5216
    v_mfma_f32_16x16x32_bf16 v[136:139], v[228:231], a[248:251], v[136:139]
    v_mfma_f32_16x16x32_bf16 v[140:143], v[224:227], a[236:239], v[140:143]
    ds_read_b64_tr_b16 v[246:247], v26 offset:7776
    v_mfma_f32_16x16x32_bf16 v[140:143], v[228:231], a[252:255], v[140:143]
    s_waitcnt lgkmcnt(6)
    v_mfma_f32_16x16x32_bf16 v[144:147], v[232:235], a[224:227], v[144:147]
    s_waitcnt lgkmcnt(4)
    ds_read_b64_tr_b16 v[224:225], v26 offset:10336
    v_mfma_f32_16x16x32_bf16 v[144:147], v[236:239], a[240:243], v[144:147]
    v_mfma_f32_16x16x32_bf16 v[148:151], v[232:235], a[228:231], v[148:151]
    ds_read_b64_tr_b16 v[226:227], v26 offset:12896
    v_mfma_f32_16x16x32_bf16 v[148:151], v[236:239], a[244:247], v[148:151]
    buffer_load_dwordx4 v211, s[16:19], s52 offen offset:3072 lds
    v_mfma_f32_16x16x32_bf16 v[152:155], v[232:235], a[232:235], v[152:155]
    ds_read_b64_tr_b16 v[228:229], v26 offset:15456
    v_mfma_f32_16x16x32_bf16 v[152:155], v[236:239], a[248:251], v[152:155]
    v_mfma_f32_16x16x32_bf16 v[156:159], v[232:235], a[236:239], v[156:159]
    ds_read_b64_tr_b16 v[230:231], v26 offset:18016
    v_mfma_f32_16x16x32_bf16 v[156:159], v[236:239], a[252:255], v[156:159]
    s_waitcnt lgkmcnt(6)
    v_mfma_f32_16x16x32_bf16 v[160:163], v[240:243], a[224:227], v[160:163]
    s_waitcnt lgkmcnt(4)
    ds_read_b64_tr_b16 v[232:233], v26 offset:20480
    v_mfma_f32_16x16x32_bf16 v[160:163], v[244:247], a[240:243], v[160:163]
    v_mfma_f32_16x16x32_bf16 v[164:167], v[240:243], a[228:231], v[164:167]
    ds_read_b64_tr_b16 v[234:235], v26 offset:23040
    v_mfma_f32_16x16x32_bf16 v[164:167], v[244:247], a[244:247], v[164:167]
    v_mfma_f32_16x16x32_bf16 v[168:171], v[240:243], a[232:235], v[168:171]
    ds_read_b64_tr_b16 v[236:237], v26 offset:25600
    v_mfma_f32_16x16x32_bf16 v[168:171], v[244:247], a[248:251], v[168:171]
    v_mfma_f32_16x16x32_bf16 v[172:175], v[240:243], a[236:239], v[172:175]
    ds_read_b64_tr_b16 v[238:239], v26 offset:28160
    v_mfma_f32_16x16x32_bf16 v[172:175], v[244:247], a[252:255], v[172:175]
    s_waitcnt lgkmcnt(6)
    v_mfma_f32_16x16x32_bf16 v[176:179], v[224:227], a[224:227], v[176:179]
    s_waitcnt lgkmcnt(4)
    ds_read_b64_tr_b16 v[240:241], v26 offset:30720
    v_mfma_f32_16x16x32_bf16 v[176:179], v[228:231], a[240:243], v[176:179]
    v_mfma_f32_16x16x32_bf16 v[180:183], v[224:227], a[228:231], v[180:183]
    ds_read_b64_tr_b16 v[242:243], v26 offset:33280
    v_mfma_f32_16x16x32_bf16 v[180:183], v[228:231], a[244:247], v[180:183]
    v_mfma_f32_16x16x32_bf16 v[184:187], v[224:227], a[232:235], v[184:187]
    ds_read_b64_tr_b16 v[244:245], v26 offset:35840
    v_mfma_f32_16x16x32_bf16 v[184:187], v[228:231], a[248:251], v[184:187]
    v_mfma_f32_16x16x32_bf16 v[188:191], v[224:227], a[236:239], v[188:191]
    ds_read_b64_tr_b16 v[246:247], v26 offset:38400
    v_mfma_f32_16x16x32_bf16 v[188:191], v[228:231], a[252:255], v[188:191]
    s_waitcnt lgkmcnt(6)
    v_mfma_f32_16x16x32_bf16 v[64:67], v[232:235], v[32:35], v[64:67]
    s_waitcnt lgkmcnt(4)
    ds_read_b64_tr_b16 v[224:225], v26 offset:20512
    v_mfma_f32_16x16x32_bf16 v[64:67], v[236:239], v[48:51], v[64:67]
    v_mfma_f32_16x16x32_bf16 v[68:71], v[232:235], v[36:39], v[68:71]
    ds_read_b64_tr_b16 v[226:227], v26 offset:23072
    v_mfma_f32_16x16x32_bf16 v[68:71], v[236:239], v[52:55], v[68:71]
    v_mfma_f32_16x16x32_bf16 v[72:75], v[232:235], v[40:43], v[72:75]
    ds_read_b64_tr_b16 v[228:229], v26 offset:25632
    v_mfma_f32_16x16x32_bf16 v[72:75], v[236:239], v[56:59], v[72:75]
    v_mfma_f32_16x16x32_bf16 v[76:79], v[232:235], v[44:47], v[76:79]
    ds_read_b64_tr_b16 v[230:231], v26 offset:28192
    v_mfma_f32_16x16x32_bf16 v[76:79], v[236:239], v[60:63], v[76:79]
    s_waitcnt lgkmcnt(6)
    v_mfma_f32_16x16x32_bf16 v[80:83], v[240:243], v[32:35], v[80:83]
    s_waitcnt lgkmcnt(4)
    ds_read_b64_tr_b16 v[232:233], v26 offset:30752
    v_mfma_f32_16x16x32_bf16 v[80:83], v[244:247], v[48:51], v[80:83]
    v_mfma_f32_16x16x32_bf16 v[84:87], v[240:243], v[36:39], v[84:87]
    ds_read_b64_tr_b16 v[234:235], v26 offset:33312
    v_mfma_f32_16x16x32_bf16 v[84:87], v[244:247], v[52:55], v[84:87]
    v_mfma_f32_16x16x32_bf16 v[88:91], v[240:243], v[40:43], v[88:91]
    ds_read_b64_tr_b16 v[236:237], v26 offset:35872
    v_mfma_f32_16x16x32_bf16 v[88:91], v[244:247], v[56:59], v[88:91]
    v_mfma_f32_16x16x32_bf16 v[92:95], v[240:243], v[44:47], v[92:95]
    ds_read_b64_tr_b16 v[238:239], v26 offset:38432
    v_mfma_f32_16x16x32_bf16 v[92:95], v[244:247], v[60:63], v[92:95]
    s_waitcnt lgkmcnt(6)
    v_mfma_f32_16x16x32_bf16 v[96:99], v[224:227], v[32:35], v[96:99]
    s_waitcnt lgkmcnt(4)
    ds_read_b64_tr_b16 v[240:241], v26 offset:20544
    v_mfma_f32_16x16x32_bf16 v[96:99], v[228:231], v[48:51], v[96:99]
    v_mul_f32 v64, v64, v80
    v_mul_f32 v65, v65, v81
    v_mfma_f32_16x16x32_bf16 v[100:103], v[224:227], v[36:39], v[100:103]
    ds_read_b64_tr_b16 v[242:243], v26 offset:23104
    v_mul_f32 v66, v66, v82
    v_mfma_f32_16x16x32_bf16 v[100:103], v[228:231], v[52:55], v[100:103]
    v_mul_f32 v67, v67, v83
    v_cvt_pk_bf16_f32 v64, v64, v65
    v_mfma_f32_16x16x32_bf16 v[104:107], v[224:227], v[40:43], v[104:107]
    ds_read_b64_tr_b16 v[244:245], v26 offset:25664
    v_cvt_pk_bf16_f32 v65, v66, v67
    v_mfma_f32_16x16x32_bf16 v[104:107], v[228:231], v[56:59], v[104:107]
    v_mul_f32 v68, v68, v84
    v_mul_f32 v69, v69, v85
    v_mfma_f32_16x16x32_bf16 v[108:111], v[224:227], v[44:47], v[108:111]
    ds_read_b64_tr_b16 v[246:247], v26 offset:28224
    v_mul_f32 v70, v70, v86
    v_mfma_f32_16x16x32_bf16 v[108:111], v[228:231], v[60:63], v[108:111]
    s_waitcnt lgkmcnt(6)
    v_mul_f32 v71, v71, v87
    v_cvt_pk_bf16_f32 v68, v68, v69
    v_mfma_f32_16x16x32_bf16 v[112:115], v[232:235], v[32:35], v[112:115]
    s_waitcnt lgkmcnt(4)
    ds_read_b64_tr_b16 v[224:225], v26 offset:30784
    v_cvt_pk_bf16_f32 v69, v70, v71
    v_mfma_f32_16x16x32_bf16 v[112:115], v[236:239], v[48:51], v[112:115]
    v_mul_f32 v72, v72, v88
    v_mul_f32 v73, v73, v89
    v_mfma_f32_16x16x32_bf16 v[116:119], v[232:235], v[36:39], v[116:119]
    ds_read_b64_tr_b16 v[226:227], v26 offset:33344
    v_mul_f32 v74, v74, v90
    v_mfma_f32_16x16x32_bf16 v[116:119], v[236:239], v[52:55], v[116:119]
    v_mul_f32 v75, v75, v91
    v_cvt_pk_bf16_f32 v72, v72, v73
    v_mfma_f32_16x16x32_bf16 v[120:123], v[232:235], v[40:43], v[120:123]
    ds_read_b64_tr_b16 v[228:229], v26 offset:35904
    v_cvt_pk_bf16_f32 v73, v74, v75
    v_mfma_f32_16x16x32_bf16 v[120:123], v[236:239], v[56:59], v[120:123]
    v_mul_f32 v76, v76, v92
    v_mul_f32 v77, v77, v93
    v_mfma_f32_16x16x32_bf16 v[124:127], v[232:235], v[44:47], v[124:127]
    ds_read_b64_tr_b16 v[230:231], v26 offset:38464
    v_mul_f32 v78, v78, v94
    v_mfma_f32_16x16x32_bf16 v[124:127], v[236:239], v[60:63], v[124:127]
    s_waitcnt lgkmcnt(6)
    v_mul_f32 v79, v79, v95
    v_cvt_pk_bf16_f32 v76, v76, v77
    v_mfma_f32_16x16x32_bf16 v[128:131], v[240:243], v[32:35], v[128:131]
    s_waitcnt lgkmcnt(4)
    ds_read_b64_tr_b16 v[232:233], v26 offset:20576
    v_cvt_pk_bf16_f32 v77, v78, v79
    v_mfma_f32_16x16x32_bf16 v[128:131], v[244:247], v[48:51], v[128:131]
    v_mul_f32 v96, v96, v112
    v_mul_f32 v97, v97, v113
    v_mfma_f32_16x16x32_bf16 v[132:135], v[240:243], v[36:39], v[132:135]
    ds_read_b64_tr_b16 v[234:235], v26 offset:23136
    v_mul_f32 v98, v98, v114
    v_mfma_f32_16x16x32_bf16 v[132:135], v[244:247], v[52:55], v[132:135]
    v_mul_f32 v99, v99, v115
    v_cvt_pk_bf16_f32 v66, v96, v97
    v_mfma_f32_16x16x32_bf16 v[136:139], v[240:243], v[40:43], v[136:139]
    s_add_u32 s59, s58, 0
    ds_read_b64_tr_b16 v[236:237], v26 offset:25696
    v_cvt_pk_bf16_f32 v67, v98, v99
    v_mfma_f32_16x16x32_bf16 v[136:139], v[244:247], v[56:59], v[136:139]
    buffer_store_dwordx4 v[64:67], v1, s[32:35], s59 offen offset:2048 sc1
    v_mfma_f32_16x16x32_bf16 v[140:143], v[240:243], v[44:47], v[140:143]
    ds_read_b64_tr_b16 v[238:239], v26 offset:28256
    v_mul_f32 v100, v100, v116
    v_mfma_f32_16x16x32_bf16 v[140:143], v[244:247], v[60:63], v[140:143]
    s_waitcnt lgkmcnt(6)
    v_mul_f32 v101, v101, v117
    v_mul_f32 v102, v102, v118
    v_mfma_f32_16x16x32_bf16 v[144:147], v[224:227], v[32:35], v[144:147]
    s_waitcnt lgkmcnt(4)
    ds_read_b64_tr_b16 v[240:241], v26 offset:30816
    v_mul_f32 v103, v103, v119
    v_mfma_f32_16x16x32_bf16 v[144:147], v[228:231], v[48:51], v[144:147]
    ds_read_b64_tr_b16 v[242:243], v26 offset:33376
    v_cvt_pk_bf16_f32 v70, v100, v101
    v_mfma_f32_16x16x32_bf16 v[148:151], v[224:227], v[36:39], v[148:151]
    ds_read_b64_tr_b16 v[244:245], v26 offset:35936
    v_cvt_pk_bf16_f32 v71, v102, v103
    v_mfma_f32_16x16x32_bf16 v[148:151], v[228:231], v[52:55], v[148:151]
    ds_read_b64_tr_b16 v[246:247], v26 offset:38496
    v_mul_f32 v104, v104, v120
    v_mfma_f32_16x16x32_bf16 v[152:155], v[224:227], v[40:43], v[152:155]
    v_add_u32 v220, 40960, v212
    v_mul_f32 v105, v105, v121
    v_mfma_f32_16x16x32_bf16 v[152:155], v[228:231], v[56:59], v[152:155]
    v_add_u32 v221, 40960, v213
    v_mul_f32 v106, v106, v122
    v_mfma_f32_16x16x32_bf16 v[156:159], v[224:227], v[44:47], v[156:159]
    v_add_u32 v222, 40960, v214
    v_mul_f32 v107, v107, v123
    v_mfma_f32_16x16x32_bf16 v[156:159], v[228:231], v[60:63], v[156:159]
    s_waitcnt lgkmcnt(0)
    v_add_u32 v223, 40960, v215
    v_cvt_pk_bf16_f32 v74, v104, v105
    v_mfma_f32_16x16x32_bf16 v[160:163], v[232:235], v[32:35], v[160:163]
    s_waitcnt vmcnt(9)
    s_barrier
    s_add_u32 s59, s58, 147456
    ds_read_b64_tr_b16 v[224:225], v220 offset:0
    v_mfma_f32_16x16x32_bf16 v[160:163], v[236:239], v[48:51], v[160:163]
    buffer_store_dwordx4 v[68:71], v1, s[32:35], s59 offen offset:2048 sc1
    v_mfma_f32_16x16x32_bf16 v[164:167], v[232:235], v[36:39], v[164:167]
    ds_read_b64_tr_b16 v[226:227], v220 offset:4096
    v_cvt_pk_bf16_f32 v75, v106, v107
    v_mfma_f32_16x16x32_bf16 v[164:167], v[236:239], v[52:55], v[164:167]
    v_mul_f32 v108, v108, v124
    v_mul_f32 v109, v109, v125
    v_mfma_f32_16x16x32_bf16 v[168:171], v[232:235], v[40:43], v[168:171]
    s_add_u32 s59, s58, 294912
    ds_read_b64_tr_b16 v[228:229], v220 offset:8192
    v_mul_f32 v110, v110, v126
    v_mfma_f32_16x16x32_bf16 v[168:171], v[236:239], v[56:59], v[168:171]
    buffer_store_dwordx4 v[72:75], v1, s[32:35], s59 offen offset:2048 sc1
    v_mfma_f32_16x16x32_bf16 v[172:175], v[232:235], v[44:47], v[172:175]
    ds_read_b64_tr_b16 v[230:231], v220 offset:12288
    v_mul_f32 v111, v111, v127
    v_mfma_f32_16x16x32_bf16 v[172:175], v[236:239], v[60:63], v[172:175]
    v_cvt_pk_bf16_f32 v78, v108, v109
    v_cvt_pk_bf16_f32 v79, v110, v111
    v_mfma_f32_16x16x32_bf16 v[176:179], v[240:243], v[32:35], v[176:179]
    s_add_u32 s59, s58, 442368
    ds_read_b64_tr_b16 v[232:233], v220 offset:8
    v_mul_f32 v128, v128, v144
    v_mfma_f32_16x16x32_bf16 v[176:179], v[244:247], v[48:51], v[176:179]
    buffer_store_dwordx4 v[76:79], v1, s[32:35], s59 offen offset:2048 sc1
    v_mfma_f32_16x16x32_bf16 v[180:183], v[240:243], v[36:39], v[180:183]
    ds_read_b64_tr_b16 v[234:235], v220 offset:4104
    v_mul_f32 v129, v129, v145
    v_mfma_f32_16x16x32_bf16 v[180:183], v[244:247], v[52:55], v[180:183]
    s_add_u32 s52, s39, 1572864
    s_add_u32 m0, s40, 81920
    v_mul_f32 v130, v130, v146
    v_mul_f32 v131, v131, v147
    v_mfma_f32_16x16x32_bf16 v[184:187], v[240:243], v[40:43], v[184:187]
    ds_read_b64_tr_b16 v[236:237], v220 offset:8200
    buffer_load_dwordx4 v208, s[16:19], s52 offen offset:0 lds
    v_cvt_pk_bf16_f32 v128, v128, v129
    v_mfma_f32_16x16x32_bf16 v[184:187], v[244:247], v[56:59], v[184:187]
    v_cvt_pk_bf16_f32 v129, v130, v131
    v_mul_f32 v132, v132, v148
    v_mfma_f32_16x16x32_bf16 v[188:191], v[240:243], v[44:47], v[188:191]
    ds_read_b64_tr_b16 v[238:239], v220 offset:12296
    v_mul_f32 v133, v133, v149
    v_mfma_f32_16x16x32_bf16 v[188:191], v[244:247], v[60:63], v[188:191]
    s_waitcnt lgkmcnt(6)
    v_mul_f32 v134, v134, v150
    v_mul_f32 v135, v135, v151
    v_mfma_f32_16x16x32_bf16 v[64:67], v[224:227], a[0:3], 0
    s_waitcnt lgkmcnt(4)
    ds_read_b64_tr_b16 v[240:241], v221 offset:0
    v_cvt_pk_bf16_f32 v132, v132, v133
    v_mfma_f32_16x16x32_bf16 v[64:67], v[228:231], a[16:19], v[64:67]
    v_cvt_pk_bf16_f32 v133, v134, v135
    v_mul_f32 v136, v136, v152
    v_mfma_f32_16x16x32_bf16 v[68:71], v[224:227], a[4:7], 0
    ds_read_b64_tr_b16 v[242:243], v221 offset:4096
    v_mul_f32 v137, v137, v153
    v_mfma_f32_16x16x32_bf16 v[68:71], v[228:231], a[20:23], v[68:71]
    v_mul_f32 v138, v138, v154
    v_mul_f32 v139, v139, v155
    v_mfma_f32_16x16x32_bf16 v[72:75], v[224:227], a[8:11], 0
    ds_read_b64_tr_b16 v[244:245], v221 offset:8192
    buffer_load_dwordx4 v209, s[16:19], s52 offen offset:1024 lds
    v_cvt_pk_bf16_f32 v136, v136, v137
    v_mfma_f32_16x16x32_bf16 v[72:75], v[228:231], a[24:27], v[72:75]
    v_cvt_pk_bf16_f32 v137, v138, v139
    v_mul_f32 v140, v140, v156
    v_mfma_f32_16x16x32_bf16 v[76:79], v[224:227], a[12:15], 0
    ds_read_b64_tr_b16 v[246:247], v221 offset:12288
    v_mul_f32 v141, v141, v157
    v_mfma_f32_16x16x32_bf16 v[76:79], v[228:231], a[28:31], v[76:79]
    s_waitcnt lgkmcnt(6)
    v_mul_f32 v142, v142, v158
    v_mul_f32 v143, v143, v159
    v_mfma_f32_16x16x32_bf16 v[80:83], v[232:235], a[0:3], 0
    s_waitcnt lgkmcnt(4)
    ds_read_b64_tr_b16 v[224:225], v221 offset:8
    v_cvt_pk_bf16_f32 v140, v140, v141
    v_mfma_f32_16x16x32_bf16 v[80:83], v[236:239], a[16:19], v[80:83]
    v_cvt_pk_bf16_f32 v141, v142, v143
    v_mul_f32 v160, v160, v176
    v_mfma_f32_16x16x32_bf16 v[84:87], v[232:235], a[4:7], 0
    ds_read_b64_tr_b16 v[226:227], v221 offset:4104
    v_mul_f32 v161, v161, v177
    v_mfma_f32_16x16x32_bf16 v[84:87], v[236:239], a[20:23], v[84:87]
    v_mul_f32 v162, v162, v178
    v_mul_f32 v163, v163, v179
    v_mfma_f32_16x16x32_bf16 v[88:91], v[232:235], a[8:11], 0
    ds_read_b64_tr_b16 v[228:229], v221 offset:8200
    buffer_load_dwordx4 v210, s[16:19], s52 offen offset:2048 lds
    v_cvt_pk_bf16_f32 v130, v160, v161
    v_mfma_f32_16x16x32_bf16 v[88:91], v[236:239], a[24:27], v[88:91]
    v_cvt_pk_bf16_f32 v131, v162, v163
    v_mul_f32 v164, v164, v180
    v_mfma_f32_16x16x32_bf16 v[92:95], v[232:235], a[12:15], 0
    s_add_u32 s59, s58, 0
    ds_read_b64_tr_b16 v[230:231], v221 offset:12296
    v_mul_f32 v165, v165, v181
    v_mfma_f32_16x16x32_bf16 v[92:95], v[236:239], a[28:31], v[92:95]
    s_waitcnt lgkmcnt(6)
    buffer_store_dwordx4 v[128:131], v1, s[32:35], s59 offen offset:3072 sc1
    v_mfma_f32_16x16x32_bf16 v[96:99], v[240:243], a[0:3], 0
    s_waitcnt lgkmcnt(4)
    ds_read_b64_tr_b16 v[232:233], v222 offset:0
    v_mul_f32 v166, v166, v182
    v_mfma_f32_16x16x32_bf16 v[96:99], v[244:247], a[16:19], v[96:99]
    v_mul_f32 v167, v167, v183
    v_cvt_pk_bf16_f32 v134, v164, v165
    v_mfma_f32_16x16x32_bf16 v[100:103], v[240:243], a[4:7], 0
    s_add_u32 s59, s58, 147456
    ds_read_b64_tr_b16 v[234:235], v222 offset:4096
    v_cvt_pk_bf16_f32 v135, v166, v167
    v_mfma_f32_16x16x32_bf16 v[100:103], v[244:247], a[20:23], v[100:103]
    buffer_store_dwordx4 v[132:135], v1, s[32:35], s59 offen offset:3072 sc1
    v_mfma_f32_16x16x32_bf16 v[104:107], v[240:243], a[8:11], 0
    ds_read_b64_tr_b16 v[236:237], v222 offset:8192
    v_mul_f32 v168, v168, v184
    v_mfma_f32_16x16x32_bf16 v[104:107], v[244:247], a[24:27], v[104:107]
    v_mul_f32 v169, v169, v185
    v_mul_f32 v170, v170, v186
    v_mfma_f32_16x16x32_bf16 v[108:111], v[240:243], a[12:15], 0
    ds_read_b64_tr_b16 v[238:239], v222 offset:12288
    buffer_load_dwordx4 v211, s[16:19], s52 offen offset:3072 lds
    v_mul_f32 v171, v171, v187
    v_mfma_f32_16x16x32_bf16 v[108:111], v[244:247], a[28:31], v[108:111]
    s_waitcnt lgkmcnt(6)
    v_cvt_pk_bf16_f32 v138, v168, v169
    v_cvt_pk_bf16_f32 v139, v170, v171
    v_mfma_f32_16x16x32_bf16 v[112:115], v[224:227], a[0:3], 0
    s_waitcnt lgkmcnt(4)
    s_add_u32 s59, s58, 294912
    ds_read_b64_tr_b16 v[240:241], v222 offset:8
    v_mul_f32 v172, v172, v188
    v_mfma_f32_16x16x32_bf16 v[112:115], v[228:231], a[16:19], v[112:115]
    buffer_store_dwordx4 v[136:139], v1, s[32:35], s59 offen offset:3072 sc1
    v_mfma_f32_16x16x32_bf16 v[116:119], v[224:227], a[4:7], 0
    ds_read_b64_tr_b16 v[242:243], v222 offset:4104
    v_mul_f32 v173, v173, v189
    v_mfma_f32_16x16x32_bf16 v[116:119], v[228:231], a[20:23], v[116:119]
    v_mul_f32 v174, v174, v190
    v_mul_f32 v175, v175, v191
    v_mfma_f32_16x16x32_bf16 v[120:123], v[224:227], a[8:11], 0
    ds_read_b64_tr_b16 v[244:245], v222 offset:8200
    v_cvt_pk_bf16_f32 v142, v172, v173
    v_mfma_f32_16x16x32_bf16 v[120:123], v[228:231], a[24:27], v[120:123]
    v_cvt_pk_bf16_f32 v143, v174, v175
    v_mfma_f32_16x16x32_bf16 v[124:127], v[224:227], a[12:15], 0
    s_add_u32 s59, s58, 442368
    ds_read_b64_tr_b16 v[246:247], v222 offset:12296
    v_mfma_f32_16x16x32_bf16 v[124:127], v[228:231], a[28:31], v[124:127]
    s_waitcnt lgkmcnt(6)
    buffer_store_dwordx4 v[140:143], v1, s[32:35], s59 offen offset:3072 sc1
    v_mfma_f32_16x16x32_bf16 v[128:131], v[232:235], a[0:3], 0
    s_waitcnt lgkmcnt(4)
    ds_read_b64_tr_b16 v[224:225], v223 offset:0
    v_mfma_f32_16x16x32_bf16 v[128:131], v[236:239], a[16:19], v[128:131]
    v_mfma_f32_16x16x32_bf16 v[132:135], v[232:235], a[4:7], 0
    s_add_u32 s52, s39, 2097152
    s_add_u32 m0, s40, 98304
    ds_read_b64_tr_b16 v[226:227], v223 offset:4096
    v_mfma_f32_16x16x32_bf16 v[132:135], v[236:239], a[20:23], v[132:135]
    buffer_load_dwordx4 v208, s[16:19], s52 offen offset:0 lds
    v_mfma_f32_16x16x32_bf16 v[136:139], v[232:235], a[8:11], 0
    ds_read_b64_tr_b16 v[228:229], v223 offset:8192
    v_mfma_f32_16x16x32_bf16 v[136:139], v[236:239], a[24:27], v[136:139]
    v_mfma_f32_16x16x32_bf16 v[140:143], v[232:235], a[12:15], 0
    ds_read_b64_tr_b16 v[230:231], v223 offset:12288
    v_mfma_f32_16x16x32_bf16 v[140:143], v[236:239], a[28:31], v[140:143]
    s_waitcnt lgkmcnt(6)
    v_mfma_f32_16x16x32_bf16 v[144:147], v[240:243], a[0:3], 0
    s_waitcnt lgkmcnt(4)
    ds_read_b64_tr_b16 v[232:233], v223 offset:8
    v_mfma_f32_16x16x32_bf16 v[144:147], v[244:247], a[16:19], v[144:147]
    ds_read_b64_tr_b16 v[234:235], v223 offset:4104
    v_mfma_f32_16x16x32_bf16 v[148:151], v[240:243], a[4:7], 0
    ds_read_b64_tr_b16 v[236:237], v223 offset:8200
    v_mfma_f32_16x16x32_bf16 v[148:151], v[244:247], a[20:23], v[148:151]
    ds_read_b64_tr_b16 v[238:239], v223 offset:12296
    buffer_load_dwordx4 v209, s[16:19], s52 offen offset:1024 lds
    v_mfma_f32_16x16x32_bf16 v[152:155], v[240:243], a[8:11], 0
    v_add_u32 v216, 0, v212
    v_mfma_f32_16x16x32_bf16 v[152:155], v[244:247], a[24:27], v[152:155]
    v_add_u32 v217, 0, v213
    v_mfma_f32_16x16x32_bf16 v[156:159], v[240:243], a[12:15], 0
    v_add_u32 v218, 0, v214
    v_mfma_f32_16x16x32_bf16 v[156:159], v[244:247], a[28:31], v[156:159]
    s_waitcnt lgkmcnt(0)
    v_add_u32 v219, 0, v215
    v_mfma_f32_16x16x32_bf16 v[160:163], v[224:227], a[0:3], 0
    s_waitcnt vmcnt(14)
    s_barrier
    ds_read_b64_tr_b16 v[240:241], v216 offset:0
    v_mfma_f32_16x16x32_bf16 v[160:163], v[228:231], a[16:19], v[160:163]
    v_mfma_f32_16x16x32_bf16 v[164:167], v[224:227], a[4:7], 0
    ds_read_b64_tr_b16 v[242:243], v216 offset:4096
    v_mfma_f32_16x16x32_bf16 v[164:167], v[228:231], a[20:23], v[164:167]
    buffer_load_dwordx4 v210, s[16:19], s52 offen offset:2048 lds
    v_mfma_f32_16x16x32_bf16 v[168:171], v[224:227], a[8:11], 0
    ds_read_b64_tr_b16 v[244:245], v216 offset:8192
    v_mfma_f32_16x16x32_bf16 v[168:171], v[228:231], a[24:27], v[168:171]
    v_mfma_f32_16x16x32_bf16 v[172:175], v[224:227], a[12:15], 0
    ds_read_b64_tr_b16 v[246:247], v216 offset:12288
    v_mfma_f32_16x16x32_bf16 v[172:175], v[228:231], a[28:31], v[172:175]
    v_mfma_f32_16x16x32_bf16 v[176:179], v[232:235], a[0:3], 0
    ds_read_b64_tr_b16 v[224:225], v216 offset:8
    v_mfma_f32_16x16x32_bf16 v[176:179], v[236:239], a[16:19], v[176:179]
    v_mfma_f32_16x16x32_bf16 v[180:183], v[232:235], a[4:7], 0
    ds_read_b64_tr_b16 v[226:227], v216 offset:4104
    v_mfma_f32_16x16x32_bf16 v[180:183], v[236:239], a[20:23], v[180:183]
    buffer_load_dwordx4 v211, s[16:19], s52 offen offset:3072 lds
    v_mfma_f32_16x16x32_bf16 v[184:187], v[232:235], a[8:11], 0
    ds_read_b64_tr_b16 v[228:229], v216 offset:8200
    v_mfma_f32_16x16x32_bf16 v[184:187], v[236:239], a[24:27], v[184:187]
    v_mfma_f32_16x16x32_bf16 v[188:191], v[232:235], a[12:15], 0
    ds_read_b64_tr_b16 v[230:231], v216 offset:12296
    v_mfma_f32_16x16x32_bf16 v[188:191], v[236:239], a[28:31], v[188:191]
    s_waitcnt lgkmcnt(6)
    v_mfma_f32_16x16x32_bf16 v[64:67], v[240:243], a[32:35], v[64:67]
    s_waitcnt lgkmcnt(4)
    ds_read_b64_tr_b16 v[232:233], v217 offset:0
    v_add_u32 v248, 0, v0
    v_mfma_f32_16x16x32_bf16 v[64:67], v[244:247], a[48:51], v[64:67]
    v_mul_u32_u24 v254, 3641, v248
    v_lshrrev_b32 v254, 16, v254
    v_mfma_f32_16x16x32_bf16 v[68:71], v[240:243], a[36:39], v[68:71]
    s_add_u32 s52, s39, 2621440
    s_add_u32 m0, s40, 40960
    ds_read_b64_tr_b16 v[234:235], v217 offset:4096
    v_mfma_f32_16x16x32_bf16 v[68:71], v[244:247], a[52:55], v[68:71]
    buffer_load_dwordx4 v208, s[16:19], s52 offen offset:0 lds
    v_mfma_f32_16x16x32_bf16 v[72:75], v[240:243], a[40:43], v[72:75]
    ds_read_b64_tr_b16 v[236:237], v217 offset:8192
    v_mul_u32_u24 v255, 18, v254
    v_mfma_f32_16x16x32_bf16 v[72:75], v[244:247], a[56:59], v[72:75]
    v_sub_u32 v255, v248, v255
    v_mul_u32_u24 v254, 1152, v254
    v_mfma_f32_16x16x32_bf16 v[76:79], v[240:243], a[44:47], v[76:79]
    ds_read_b64_tr_b16 v[238:239], v217 offset:12288
    v_lshl_add_u32 v254, v255, 4, v254
    v_mfma_f32_16x16x32_bf16 v[76:79], v[244:247], a[60:63], v[76:79]
    s_waitcnt lgkmcnt(6)
    v_subrev_u32 v20, 0, v254
    v_add_u32 v248, 64, v0
    v_mfma_f32_16x16x32_bf16 v[80:83], v[224:227], a[32:35], v[80:83]
    s_waitcnt lgkmcnt(4)
    ds_read_b64_tr_b16 v[240:241], v217 offset:8
    v_mul_u32_u24 v254, 3641, v248
    v_mfma_f32_16x16x32_bf16 v[80:83], v[228:231], a[48:51], v[80:83]
    v_lshrrev_b32 v254, 16, v254
    v_mul_u32_u24 v255, 18, v254
    v_mfma_f32_16x16x32_bf16 v[84:87], v[224:227], a[36:39], v[84:87]
    ds_read_b64_tr_b16 v[242:243], v217 offset:4104
    v_sub_u32 v255, v248, v255
    v_mfma_f32_16x16x32_bf16 v[84:87], v[228:231], a[52:55], v[84:87]
    buffer_load_dwordx4 v209, s[16:19], s52 offen offset:1024 lds
    v_mfma_f32_16x16x32_bf16 v[88:91], v[224:227], a[40:43], v[88:91]
    ds_read_b64_tr_b16 v[244:245], v217 offset:8200
    v_mul_u32_u24 v254, 1152, v254
    v_mfma_f32_16x16x32_bf16 v[88:91], v[228:231], a[56:59], v[88:91]
    v_lshl_add_u32 v254, v255, 4, v254
    v_subrev_u32 v21, 1024, v254
    v_mfma_f32_16x16x32_bf16 v[92:95], v[224:227], a[44:47], v[92:95]
    ds_read_b64_tr_b16 v[246:247], v217 offset:12296
    v_add_u32 v248, 128, v0
    v_mfma_f32_16x16x32_bf16 v[92:95], v[228:231], a[60:63], v[92:95]
    s_waitcnt lgkmcnt(6)
    v_mul_u32_u24 v254, 3641, v248
    v_lshrrev_b32 v254, 16, v254
    v_mfma_f32_16x16x32_bf16 v[96:99], v[232:235], a[32:35], v[96:99]
    s_waitcnt lgkmcnt(4)
    ds_read_b64_tr_b16 v[224:225], v218 offset:0
    v_mul_u32_u24 v255, 18, v254
    v_mfma_f32_16x16x32_bf16 v[96:99], v[236:239], a[48:51], v[96:99]
    v_sub_u32 v255, v248, v255
    v_mul_u32_u24 v254, 1152, v254
    v_mfma_f32_16x16x32_bf16 v[100:103], v[232:235], a[36:39], v[100:103]
    ds_read_b64_tr_b16 v[226:227], v218 offset:4096
    v_lshl_add_u32 v254, v255, 4, v254
    v_mfma_f32_16x16x32_bf16 v[100:103], v[236:239], a[52:55], v[100:103]
    buffer_load_dwordx4 v210, s[16:19], s52 offen offset:2048 lds
    v_mfma_f32_16x16x32_bf16 v[104:107], v[232:235], a[40:43], v[104:107]
    ds_read_b64_tr_b16 v[228:229], v218 offset:8192
    v_subrev_u32 v22, 2048, v254
    v_mfma_f32_16x16x32_bf16 v[104:107], v[236:239], a[56:59], v[104:107]
    v_add_u32 v248, 192, v0
    v_mul_u32_u24 v254, 3641, v248
    v_mfma_f32_16x16x32_bf16 v[108:111], v[232:235], a[44:47], v[108:111]
    ds_read_b64_tr_b16 v[230:231], v218 offset:12288
    v_lshrrev_b32 v254, 16, v254
    v_mfma_f32_16x16x32_bf16 v[108:111], v[236:239], a[60:63], v[108:111]
    s_waitcnt lgkmcnt(6)
    v_mul_u32_u24 v255, 18, v254
    v_sub_u32 v255, v248, v255
    v_mfma_f32_16x16x32_bf16 v[112:115], v[240:243], a[32:35], v[112:115]
    s_waitcnt lgkmcnt(4)
    ds_read_b64_tr_b16 v[232:233], v218 offset:8
    v_mul_u32_u24 v254, 1152, v254
    v_mfma_f32_16x16x32_bf16 v[112:115], v[244:247], a[48:51], v[112:115]
    v_lshl_add_u32 v254, v255, 4, v254
    v_subrev_u32 v23, 3072, v254
    v_mfma_f32_16x16x32_bf16 v[116:119], v[240:243], a[36:39], v[116:119]
    ds_read_b64_tr_b16 v[234:235], v218 offset:4104
    v_add_u32 v248, 256, v0
    v_mfma_f32_16x16x32_bf16 v[116:119], v[244:247], a[52:55], v[116:119]
    buffer_load_dwordx4 v211, s[16:19], s52 offen offset:3072 lds
    v_mfma_f32_16x16x32_bf16 v[120:123], v[240:243], a[40:43], v[120:123]
    ds_read_b64_tr_b16 v[236:237], v218 offset:8200
    v_mul_u32_u24 v254, 3641, v248
    v_mfma_f32_16x16x32_bf16 v[120:123], v[244:247], a[56:59], v[120:123]
    v_lshrrev_b32 v254, 16, v254
    v_mul_u32_u24 v255, 18, v254
    v_mfma_f32_16x16x32_bf16 v[124:127], v[240:243], a[44:47], v[124:127]
    ds_read_b64_tr_b16 v[238:239], v218 offset:12296
    v_sub_u32 v255, v248, v255
    v_mfma_f32_16x16x32_bf16 v[124:127], v[244:247], a[60:63], v[124:127]
    s_waitcnt lgkmcnt(6)
    v_mul_u32_u24 v254, 1152, v254
    v_lshl_add_u32 v254, v255, 4, v254
    v_mfma_f32_16x16x32_bf16 v[128:131], v[224:227], a[32:35], v[128:131]
    s_waitcnt lgkmcnt(4)
    ds_read_b64_tr_b16 v[240:241], v219 offset:0
    v_subrev_u32 v24, 0, v254
    v_mfma_f32_16x16x32_bf16 v[128:131], v[228:231], a[48:51], v[128:131]
    v_add_u32 v248, 320, v0
    v_mul_u32_u24 v254, 3641, v248
    v_mfma_f32_16x16x32_bf16 v[132:135], v[224:227], a[36:39], v[132:135]
    s_add_u32 s52, s39, 3145728
    s_add_u32 m0, s40, 57344
    ds_read_b64_tr_b16 v[242:243], v219 offset:4096
    v_mfma_f32_16x16x32_bf16 v[132:135], v[228:231], a[52:55], v[132:135]
    buffer_load_dwordx4 v208, s[16:19], s52 offen offset:0 lds
    v_mfma_f32_16x16x32_bf16 v[136:139], v[224:227], a[40:43], v[136:139]
    ds_read_b64_tr_b16 v[244:245], v219 offset:8192
    v_lshrrev_b32 v254, 16, v254
    v_mfma_f32_16x16x32_bf16 v[136:139], v[228:231], a[56:59], v[136:139]
    v_mul_u32_u24 v255, 18, v254
    v_sub_u32 v255, v248, v255
    v_mfma_f32_16x16x32_bf16 v[140:143], v[224:227], a[44:47], v[140:143]
    ds_read_b64_tr_b16 v[246:247], v219 offset:12288
    v_mul_u32_u24 v254, 1152, v254
    v_mfma_f32_16x16x32_bf16 v[140:143], v[228:231], a[60:63], v[140:143]
    s_waitcnt lgkmcnt(6)
    v_lshl_add_u32 v254, v255, 4, v254
    v_subrev_u32 v25, 1024, v254
    v_mfma_f32_16x16x32_bf16 v[144:147], v[232:235], a[32:35], v[144:147]
    s_waitcnt lgkmcnt(4)
    ds_read_b64_tr_b16 v[224:225], v219 offset:8
    v_add_u32 v248, 384, v0
    v_mfma_f32_16x16x32_bf16 v[144:147], v[236:239], a[48:51], v[144:147]
    v_mul_u32_u24 v254, 3641, v248
    v_lshrrev_b32 v254, 16, v254
    v_mfma_f32_16x16x32_bf16 v[148:151], v[232:235], a[36:39], v[148:151]
    ds_read_b64_tr_b16 v[226:227], v219 offset:4104
    v_mul_u32_u24 v255, 18, v254
    v_mfma_f32_16x16x32_bf16 v[148:151], v[236:239], a[52:55], v[148:151]
    buffer_load_dwordx4 v209, s[16:19], s52 offen offset:1024 lds
    v_mfma_f32_16x16x32_bf16 v[152:155], v[232:235], a[40:43], v[152:155]
    ds_read_b64_tr_b16 v[228:229], v219 offset:8200
    v_sub_u32 v255, v248, v255
    v_mfma_f32_16x16x32_bf16 v[152:155], v[236:239], a[56:59], v[152:155]
    v_mul_u32_u24 v254, 1152, v254
    v_lshl_add_u32 v254, v255, 4, v254
    v_mfma_f32_16x16x32_bf16 v[156:159], v[232:235], a[44:47], v[156:159]
    ds_read_b64_tr_b16 v[230:231], v219 offset:12296
    v_subrev_u32 v26, 2048, v254
    v_mfma_f32_16x16x32_bf16 v[156:159], v[236:239], a[60:63], v[156:159]
    s_waitcnt lgkmcnt(6)
    v_add_u32 v248, 448, v0
    v_mul_u32_u24 v254, 3641, v248
    v_mfma_f32_16x16x32_bf16 v[160:163], v[240:243], a[32:35], v[160:163]
    s_waitcnt lgkmcnt(4)
    ds_read_b64_tr_b16 v[232:233], v216 offset:16384
    v_lshrrev_b32 v254, 16, v254
    v_mfma_f32_16x16x32_bf16 v[160:163], v[244:247], a[48:51], v[160:163]
    v_mul_u32_u24 v255, 18, v254
    v_sub_u32 v255, v248, v255
    v_mfma_f32_16x16x32_bf16 v[164:167], v[240:243], a[36:39], v[164:167]
    ds_read_b64_tr_b16 v[234:235], v216 offset:20480
    v_mul_u32_u24 v254, 1152, v254
    v_mfma_f32_16x16x32_bf16 v[164:167], v[244:247], a[52:55], v[164:167]
    buffer_load_dwordx4 v210, s[16:19], s52 offen offset:2048 lds
    v_mfma_f32_16x16x32_bf16 v[168:171], v[240:243], a[40:43], v[168:171]
    ds_read_b64_tr_b16 v[236:237], v216 offset:24576
    v_lshl_add_u32 v254, v255, 4, v254
    v_mfma_f32_16x16x32_bf16 v[168:171], v[244:247], a[56:59], v[168:171]
    v_subrev_u32 v27, 3072, v254
    v_add_u32 v248, 512, v0
    v_mfma_f32_16x16x32_bf16 v[172:175], v[240:243], a[44:47], v[172:175]
    ds_read_b64_tr_b16 v[238:239], v216 offset:28672
    v_mul_u32_u24 v254, 3641, v248
    v_mfma_f32_16x16x32_bf16 v[172:175], v[244:247], a[60:63], v[172:175]
    s_waitcnt lgkmcnt(6)
    v_lshrrev_b32 v254, 16, v254
    v_mul_u32_u24 v255, 18, v254
    v_mfma_f32_16x16x32_bf16 v[176:179], v[224:227], a[32:35], v[176:179]
    s_waitcnt lgkmcnt(4)
    ds_read_b64_tr_b16 v[240:241], v216 offset:16392
    v_sub_u32 v255, v248, v255
    v_mfma_f32_16x16x32_bf16 v[176:179], v[228:231], a[48:51], v[176:179]
    v_mul_u32_u24 v254, 1152, v254
    v_lshl_add_u32 v254, v255, 4, v254
    v_mfma_f32_16x16x32_bf16 v[180:183], v[224:227], a[36:39], v[180:183]
    ds_read_b64_tr_b16 v[242:243], v216 offset:20488
    v_subrev_u32 v28, 0, v254
    v_mfma_f32_16x16x32_bf16 v[180:183], v[228:231], a[52:55], v[180:183]
    buffer_load_dwordx4 v211, s[16:19], s52 offen offset:3072 lds
    v_mfma_f32_16x16x32_bf16 v[184:187], v[224:227], a[40:43], v[184:187]
    ds_read_b64_tr_b16 v[244:245], v216 offset:24584
    v_mul_u32_u24 v254, 288, v253
    v_mfma_f32_16x16x32_bf16 v[184:187], v[228:231], a[56:59], v[184:187]
    v_lshl_add_u32 v254, v252, 3, v254
    v_add_u32 v29, 122880, v254
    v_mfma_f32_16x16x32_bf16 v[188:191], v[224:227], a[44:47], v[188:191]
    ds_read_b64_tr_b16 v[246:247], v216 offset:28680
    v_add_u32 v30, 86016, v254
    v_mfma_f32_16x16x32_bf16 v[188:191], v[228:231], a[60:63], v[188:191]
    s_waitcnt lgkmcnt(6)
    v_add_u32 v31, 49152, v254
    v_mfma_f32_16x16x32_bf16 v[64:67], v[232:235], a[64:67], v[64:67]
    s_waitcnt lgkmcnt(4)
    ds_read_b64_tr_b16 v[224:225], v217 offset:16384
    v_mfma_f32_16x16x32_bf16 v[64:67], v[236:239], a[80:83], v[64:67]
    v_mfma_f32_16x16x32_bf16 v[68:71], v[232:235], a[68:71], v[68:71]
    ds_read_b64_tr_b16 v[226:227], v217 offset:20480
    v_mfma_f32_16x16x32_bf16 v[68:71], v[236:239], a[84:87], v[68:71]
    v_mfma_f32_16x16x32_bf16 v[72:75], v[232:235], a[72:75], v[72:75]
    ds_read_b64_tr_b16 v[228:229], v217 offset:24576
    v_mfma_f32_16x16x32_bf16 v[72:75], v[236:239], a[88:91], v[72:75]
    v_mfma_f32_16x16x32_bf16 v[76:79], v[232:235], a[76:79], v[76:79]
    ds_read_b64_tr_b16 v[230:231], v217 offset:28672
    v_mfma_f32_16x16x32_bf16 v[76:79], v[236:239], a[92:95], v[76:79]
    s_waitcnt lgkmcnt(6)
    v_mfma_f32_16x16x32_bf16 v[80:83], v[240:243], a[64:67], v[80:83]
    s_waitcnt lgkmcnt(4)
    ds_read_b64_tr_b16 v[232:233], v217 offset:16392
    v_mfma_f32_16x16x32_bf16 v[80:83], v[244:247], a[80:83], v[80:83]
    v_mfma_f32_16x16x32_bf16 v[84:87], v[240:243], a[68:71], v[84:87]
    ds_read_b64_tr_b16 v[234:235], v217 offset:20488
    v_mfma_f32_16x16x32_bf16 v[84:87], v[244:247], a[84:87], v[84:87]
    v_mfma_f32_16x16x32_bf16 v[88:91], v[240:243], a[72:75], v[88:91]
    ds_read_b64_tr_b16 v[236:237], v217 offset:24584
    v_mfma_f32_16x16x32_bf16 v[88:91], v[244:247], a[88:91], v[88:91]
    v_mfma_f32_16x16x32_bf16 v[92:95], v[240:243], a[76:79], v[92:95]
    ds_read_b64_tr_b16 v[238:239], v217 offset:28680
    v_mfma_f32_16x16x32_bf16 v[92:95], v[244:247], a[92:95], v[92:95]
    s_waitcnt lgkmcnt(6)
    v_mfma_f32_16x16x32_bf16 v[96:99], v[224:227], a[64:67], v[96:99]
    s_waitcnt lgkmcnt(4)
    ds_read_b64_tr_b16 v[240:241], v218 offset:16384
    v_mfma_f32_16x16x32_bf16 v[96:99], v[228:231], a[80:83], v[96:99]
    v_mfma_f32_16x16x32_bf16 v[100:103], v[224:227], a[68:71], v[100:103]
    ds_read_b64_tr_b16 v[242:243], v218 offset:20480
    v_mfma_f32_16x16x32_bf16 v[100:103], v[228:231], a[84:87], v[100:103]
    v_mfma_f32_16x16x32_bf16 v[104:107], v[224:227], a[72:75], v[104:107]
    ds_read_b64_tr_b16 v[244:245], v218 offset:24576
    v_mfma_f32_16x16x32_bf16 v[104:107], v[228:231], a[88:91], v[104:107]
    v_mfma_f32_16x16x32_bf16 v[108:111], v[224:227], a[76:79], v[108:111]
    ds_read_b64_tr_b16 v[246:247], v218 offset:28672
    v_mfma_f32_16x16x32_bf16 v[108:111], v[228:231], a[92:95], v[108:111]
    s_waitcnt lgkmcnt(6)
    v_mfma_f32_16x16x32_bf16 v[112:115], v[232:235], a[64:67], v[112:115]
    s_waitcnt lgkmcnt(4)
    ds_read_b64_tr_b16 v[224:225], v218 offset:16392
    v_mfma_f32_16x16x32_bf16 v[112:115], v[236:239], a[80:83], v[112:115]
    v_mfma_f32_16x16x32_bf16 v[116:119], v[232:235], a[68:71], v[116:119]
    ds_read_b64_tr_b16 v[226:227], v218 offset:20488
    v_mfma_f32_16x16x32_bf16 v[116:119], v[236:239], a[84:87], v[116:119]
    v_mfma_f32_16x16x32_bf16 v[120:123], v[232:235], a[72:75], v[120:123]
    ds_read_b64_tr_b16 v[228:229], v218 offset:24584
    v_mfma_f32_16x16x32_bf16 v[120:123], v[236:239], a[88:91], v[120:123]
    v_mfma_f32_16x16x32_bf16 v[124:127], v[232:235], a[76:79], v[124:127]
    ds_read_b64_tr_b16 v[230:231], v218 offset:28680
    v_mfma_f32_16x16x32_bf16 v[124:127], v[236:239], a[92:95], v[124:127]
    s_waitcnt lgkmcnt(6)
    v_mfma_f32_16x16x32_bf16 v[128:131], v[240:243], a[64:67], v[128:131]
    s_waitcnt lgkmcnt(4)
    ds_read_b64_tr_b16 v[232:233], v219 offset:16384
    v_mfma_f32_16x16x32_bf16 v[128:131], v[244:247], a[80:83], v[128:131]
    v_mfma_f32_16x16x32_bf16 v[132:135], v[240:243], a[68:71], v[132:135]
    ds_read_b64_tr_b16 v[234:235], v219 offset:20480
    v_mfma_f32_16x16x32_bf16 v[132:135], v[244:247], a[84:87], v[132:135]
    v_mfma_f32_16x16x32_bf16 v[136:139], v[240:243], a[72:75], v[136:139]
    ds_read_b64_tr_b16 v[236:237], v219 offset:24576
    v_mfma_f32_16x16x32_bf16 v[136:139], v[244:247], a[88:91], v[136:139]
    v_mfma_f32_16x16x32_bf16 v[140:143], v[240:243], a[76:79], v[140:143]
    ds_read_b64_tr_b16 v[238:239], v219 offset:28672
    v_mfma_f32_16x16x32_bf16 v[140:143], v[244:247], a[92:95], v[140:143]
    s_waitcnt lgkmcnt(6)
    v_mfma_f32_16x16x32_bf16 v[144:147], v[224:227], a[64:67], v[144:147]
    s_waitcnt lgkmcnt(4)
    ds_read_b64_tr_b16 v[240:241], v219 offset:16392
    v_mfma_f32_16x16x32_bf16 v[144:147], v[228:231], a[80:83], v[144:147]
    ds_read_b64_tr_b16 v[242:243], v219 offset:20488
    v_mfma_f32_16x16x32_bf16 v[148:151], v[224:227], a[68:71], v[148:151]
    ds_read_b64_tr_b16 v[244:245], v219 offset:24584
    v_mfma_f32_16x16x32_bf16 v[148:151], v[228:231], a[84:87], v[148:151]
    ds_read_b64_tr_b16 v[246:247], v219 offset:28680
    v_mfma_f32_16x16x32_bf16 v[152:155], v[224:227], a[72:75], v[152:155]
    v_add_u32 v220, 81920, v212
    v_mfma_f32_16x16x32_bf16 v[152:155], v[228:231], a[88:91], v[152:155]
    v_add_u32 v221, 81920, v213
    v_mfma_f32_16x16x32_bf16 v[156:159], v[224:227], a[76:79], v[156:159]
    v_add_u32 v222, 81920, v214
    v_mfma_f32_16x16x32_bf16 v[156:159], v[228:231], a[92:95], v[156:159]
    s_waitcnt lgkmcnt(0)
    v_add_u32 v223, 81920, v215
    v_mfma_f32_16x16x32_bf16 v[160:163], v[232:235], a[64:67], v[160:163]
    s_waitcnt vmcnt(8)
    s_barrier
    ds_read_b64_tr_b16 v[224:225], v220 offset:0
    v_mfma_f32_16x16x32_bf16 v[160:163], v[236:239], a[80:83], v[160:163]
    v_mfma_f32_16x16x32_bf16 v[164:167], v[232:235], a[68:71], v[164:167]
    s_add_u32 s52, s39, 3670016
    s_add_u32 m0, s40, 0
    ds_read_b64_tr_b16 v[226:227], v220 offset:4096
    v_mfma_f32_16x16x32_bf16 v[164:167], v[236:239], a[84:87], v[164:167]
    buffer_load_dwordx4 v208, s[16:19], s52 offen offset:0 lds
    v_mfma_f32_16x16x32_bf16 v[168:171], v[232:235], a[72:75], v[168:171]
    ds_read_b64_tr_b16 v[228:229], v220 offset:8192
    v_mfma_f32_16x16x32_bf16 v[168:171], v[236:239], a[88:91], v[168:171]
    v_mfma_f32_16x16x32_bf16 v[172:175], v[232:235], a[76:79], v[172:175]
    ds_read_b64_tr_b16 v[230:231], v220 offset:12288
    v_mfma_f32_16x16x32_bf16 v[172:175], v[236:239], a[92:95], v[172:175]
    v_mfma_f32_16x16x32_bf16 v[176:179], v[240:243], a[64:67], v[176:179]
    ds_read_b64_tr_b16 v[232:233], v220 offset:8
    v_mfma_f32_16x16x32_bf16 v[176:179], v[244:247], a[80:83], v[176:179]
    v_mfma_f32_16x16x32_bf16 v[180:183], v[240:243], a[68:71], v[180:183]
    ds_read_b64_tr_b16 v[234:235], v220 offset:4104
    v_mfma_f32_16x16x32_bf16 v[180:183], v[244:247], a[84:87], v[180:183]
    buffer_load_dwordx4 v209, s[16:19], s52 offen offset:1024 lds
    v_mfma_f32_16x16x32_bf16 v[184:187], v[240:243], a[72:75], v[184:187]
    ds_read_b64_tr_b16 v[236:237], v220 offset:8200
    v_mfma_f32_16x16x32_bf16 v[184:187], v[244:247], a[88:91], v[184:187]
    v_mfma_f32_16x16x32_bf16 v[188:191], v[240:243], a[76:79], v[188:191]
    ds_read_b64_tr_b16 v[238:239], v220 offset:12296
    v_mfma_f32_16x16x32_bf16 v[188:191], v[244:247], a[92:95], v[188:191]
    s_waitcnt lgkmcnt(6)
    v_mfma_f32_16x16x32_bf16 v[64:67], v[224:227], a[96:99], v[64:67]
    s_waitcnt lgkmcnt(4)
    ds_read_b64_tr_b16 v[240:241], v221 offset:0
    v_mfma_f32_16x16x32_bf16 v[64:67], v[228:231], a[112:115], v[64:67]
    v_mfma_f32_16x16x32_bf16 v[68:71], v[224:227], a[100:103], v[68:71]
    ds_read_b64_tr_b16 v[242:243], v221 offset:4096
    v_mfma_f32_16x16x32_bf16 v[68:71], v[228:231], a[116:119], v[68:71]
    buffer_load_dwordx4 v210, s[16:19], s52 offen offset:2048 lds
    v_mfma_f32_16x16x32_bf16 v[72:75], v[224:227], a[104:107], v[72:75]
    ds_read_b64_tr_b16 v[244:245], v221 offset:8192
    v_mfma_f32_16x16x32_bf16 v[72:75], v[228:231], a[120:123], v[72:75]
    v_mfma_f32_16x16x32_bf16 v[76:79], v[224:227], a[108:111], v[76:79]
    ds_read_b64_tr_b16 v[246:247], v221 offset:12288
    v_mfma_f32_16x16x32_bf16 v[76:79], v[228:231], a[124:127], v[76:79]
    s_waitcnt lgkmcnt(6)
    v_mfma_f32_16x16x32_bf16 v[80:83], v[232:235], a[96:99], v[80:83]
    s_waitcnt lgkmcnt(4)
    ds_read_b64_tr_b16 v[224:225], v221 offset:8
    v_mfma_f32_16x16x32_bf16 v[80:83], v[236:239], a[112:115], v[80:83]
    v_mfma_f32_16x16x32_bf16 v[84:87], v[232:235], a[100:103], v[84:87]
    ds_read_b64_tr_b16 v[226:227], v221 offset:4104
    v_mfma_f32_16x16x32_bf16 v[84:87], v[236:239], a[116:119], v[84:87]
    buffer_load_dwordx4 v211, s[16:19], s52 offen offset:3072 lds
    v_mfma_f32_16x16x32_bf16 v[88:91], v[232:235], a[104:107], v[88:91]
    ds_read_b64_tr_b16 v[228:229], v221 offset:8200
    v_mfma_f32_16x16x32_bf16 v[88:91], v[236:239], a[120:123], v[88:91]
    v_mfma_f32_16x16x32_bf16 v[92:95], v[232:235], a[108:111], v[92:95]
    ds_read_b64_tr_b16 v[230:231], v221 offset:12296
    v_mfma_f32_16x16x32_bf16 v[92:95], v[236:239], a[124:127], v[92:95]
    s_waitcnt lgkmcnt(6)
    v_mfma_f32_16x16x32_bf16 v[96:99], v[240:243], a[96:99], v[96:99]
    s_waitcnt lgkmcnt(4)
    ds_read_b64_tr_b16 v[232:233], v222 offset:0
    v_mfma_f32_16x16x32_bf16 v[96:99], v[244:247], a[112:115], v[96:99]
    v_mfma_f32_16x16x32_bf16 v[100:103], v[240:243], a[100:103], v[100:103]
    s_add_u32 s52, s39, 4194304
    s_add_u32 m0, s40, 16384
    ds_read_b64_tr_b16 v[234:235], v222 offset:4096
    v_mfma_f32_16x16x32_bf16 v[100:103], v[244:247], a[116:119], v[100:103]
    buffer_load_dwordx4 v208, s[16:19], s52 offen offset:0 lds
    v_mfma_f32_16x16x32_bf16 v[104:107], v[240:243], a[104:107], v[104:107]
    ds_read_b64_tr_b16 v[236:237], v222 offset:8192
    v_mfma_f32_16x16x32_bf16 v[104:107], v[244:247], a[120:123], v[104:107]
    v_mfma_f32_16x16x32_bf16 v[108:111], v[240:243], a[108:111], v[108:111]
    ds_read_b64_tr_b16 v[238:239], v222 offset:12288
    v_mfma_f32_16x16x32_bf16 v[108:111], v[244:247], a[124:127], v[108:111]
    s_waitcnt lgkmcnt(6)
    v_mfma_f32_16x16x32_bf16 v[112:115], v[224:227], a[96:99], v[112:115]
    s_waitcnt lgkmcnt(4)
    ds_read_b64_tr_b16 v[240:241], v222 offset:8
    v_mfma_f32_16x16x32_bf16 v[112:115], v[228:231], a[112:115], v[112:115]
    v_mfma_f32_16x16x32_bf16 v[116:119], v[224:227], a[100:103], v[116:119]
    ds_read_b64_tr_b16 v[242:243], v222 offset:4104
    v_mfma_f32_16x16x32_bf16 v[116:119], v[228:231], a[116:119], v[116:119]
    buffer_load_dwordx4 v209, s[16:19], s52 offen offset:1024 lds
    v_mfma_f32_16x16x32_bf16 v[120:123], v[224:227], a[104:107], v[120:123]
    ds_read_b64_tr_b16 v[244:245], v222 offset:8200
    v_mfma_f32_16x16x32_bf16 v[120:123], v[228:231], a[120:123], v[120:123]
    v_mfma_f32_16x16x32_bf16 v[124:127], v[224:227], a[108:111], v[124:127]
    ds_read_b64_tr_b16 v[246:247], v222 offset:12296
    v_mfma_f32_16x16x32_bf16 v[124:127], v[228:231], a[124:127], v[124:127]
    s_waitcnt lgkmcnt(6)
    v_mfma_f32_16x16x32_bf16 v[128:131], v[232:235], a[96:99], v[128:131]
    s_waitcnt lgkmcnt(4)
    ds_read_b64_tr_b16 v[224:225], v223 offset:0
    v_mfma_f32_16x16x32_bf16 v[128:131], v[236:239], a[112:115], v[128:131]
    v_mfma_f32_16x16x32_bf16 v[132:135], v[232:235], a[100:103], v[132:135]
    ds_read_b64_tr_b16 v[226:227], v223 offset:4096
    v_mfma_f32_16x16x32_bf16 v[132:135], v[236:239], a[116:119], v[132:135]
    buffer_load_dwordx4 v210, s[16:19], s52 offen offset:2048 lds
    v_mfma_f32_16x16x32_bf16 v[136:139], v[232:235], a[104:107], v[136:139]
    ds_read_b64_tr_b16 v[228:229], v223 offset:8192
    v_mfma_f32_16x16x32_bf16 v[136:139], v[236:239], a[120:123], v[136:139]
    v_mfma_f32_16x16x32_bf16 v[140:143], v[232:235], a[108:111], v[140:143]
    ds_read_b64_tr_b16 v[230:231], v223 offset:12288
    v_mfma_f32_16x16x32_bf16 v[140:143], v[236:239], a[124:127], v[140:143]
    s_waitcnt lgkmcnt(6)
    v_mfma_f32_16x16x32_bf16 v[144:147], v[240:243], a[96:99], v[144:147]
    s_waitcnt lgkmcnt(4)
    ds_read_b64_tr_b16 v[232:233], v223 offset:8
    v_mfma_f32_16x16x32_bf16 v[144:147], v[244:247], a[112:115], v[144:147]
    v_mfma_f32_16x16x32_bf16 v[148:151], v[240:243], a[100:103], v[148:151]
    ds_read_b64_tr_b16 v[234:235], v223 offset:4104
    v_mfma_f32_16x16x32_bf16 v[148:151], v[244:247], a[116:119], v[148:151]
    buffer_load_dwordx4 v211, s[16:19], s52 offen offset:3072 lds
    v_mfma_f32_16x16x32_bf16 v[152:155], v[240:243], a[104:107], v[152:155]
    ds_read_b64_tr_b16 v[236:237], v223 offset:8200
    v_mfma_f32_16x16x32_bf16 v[152:155], v[244:247], a[120:123], v[152:155]
    v_mfma_f32_16x16x32_bf16 v[156:159], v[240:243], a[108:111], v[156:159]
    ds_read_b64_tr_b16 v[238:239], v223 offset:12296
    v_mfma_f32_16x16x32_bf16 v[156:159], v[244:247], a[124:127], v[156:159]
    s_waitcnt lgkmcnt(6)
    v_mfma_f32_16x16x32_bf16 v[160:163], v[224:227], a[96:99], v[160:163]
    s_waitcnt lgkmcnt(4)
    ds_read_b64_tr_b16 v[240:241], v220 offset:16384
    v_mfma_f32_16x16x32_bf16 v[160:163], v[228:231], a[112:115], v[160:163]
    v_mfma_f32_16x16x32_bf16 v[164:167], v[224:227], a[100:103], v[164:167]
    ds_read_b64_tr_b16 v[242:243], v220 offset:20480
    v_mfma_f32_16x16x32_bf16 v[164:167], v[228:231], a[116:119], v[164:167]
    v_mfma_f32_16x16x32_bf16 v[168:171], v[224:227], a[104:107], v[168:171]
    ds_read_b64_tr_b16 v[244:245], v220 offset:24576
    v_mfma_f32_16x16x32_bf16 v[168:171], v[228:231], a[120:123], v[168:171]
    v_mfma_f32_16x16x32_bf16 v[172:175], v[224:227], a[108:111], v[172:175]
    ds_read_b64_tr_b16 v[246:247], v220 offset:28672
    v_mfma_f32_16x16x32_bf16 v[172:175], v[228:231], a[124:127], v[172:175]
    s_waitcnt lgkmcnt(6)
    v_mfma_f32_16x16x32_bf16 v[176:179], v[232:235], a[96:99], v[176:179]
    s_waitcnt lgkmcnt(4)
    ds_read_b64_tr_b16 v[224:225], v220 offset:16392
    v_mfma_f32_16x16x32_bf16 v[176:179], v[236:239], a[112:115], v[176:179]
    v_mfma_f32_16x16x32_bf16 v[180:183], v[232:235], a[100:103], v[180:183]
    ds_read_b64_tr_b16 v[226:227], v220 offset:20488
    v_mfma_f32_16x16x32_bf16 v[180:183], v[236:239], a[116:119], v[180:183]
    v_mfma_f32_16x16x32_bf16 v[184:187], v[232:235], a[104:107], v[184:187]
    ds_read_b64_tr_b16 v[228:229], v220 offset:24584
    v_mfma_f32_16x16x32_bf16 v[184:187], v[236:239], a[120:123], v[184:187]
    v_mfma_f32_16x16x32_bf16 v[188:191], v[232:235], a[108:111], v[188:191]
    ds_read_b64_tr_b16 v[230:231], v220 offset:28680
    v_mfma_f32_16x16x32_bf16 v[188:191], v[236:239], a[124:127], v[188:191]
    s_waitcnt lgkmcnt(6)
    v_mfma_f32_16x16x32_bf16 v[64:67], v[240:243], a[128:131], v[64:67]
    s_waitcnt lgkmcnt(4)
    ds_read_b64_tr_b16 v[232:233], v221 offset:16384
    v_mfma_f32_16x16x32_bf16 v[64:67], v[244:247], a[144:147], v[64:67]
    v_accvgpr_write_b32 a0, 0
    v_accvgpr_write_b32 a1, 0
    v_mfma_f32_16x16x32_bf16 v[68:71], v[240:243], a[132:135], v[68:71]
    ds_read_b64_tr_b16 v[234:235], v221 offset:20480
    v_accvgpr_write_b32 a2, 0
    v_mfma_f32_16x16x32_bf16 v[68:71], v[244:247], a[148:151], v[68:71]
    v_accvgpr_write_b32 a3, 0
    v_accvgpr_write_b32 a4, 0
    v_mfma_f32_16x16x32_bf16 v[72:75], v[240:243], a[136:139], v[72:75]
    ds_read_b64_tr_b16 v[236:237], v221 offset:24576
    v_accvgpr_write_b32 a5, 0
    v_mfma_f32_16x16x32_bf16 v[72:75], v[244:247], a[152:155], v[72:75]
    v_accvgpr_write_b32 a6, 0
    v_accvgpr_write_b32 a7, 0
    v_mfma_f32_16x16x32_bf16 v[76:79], v[240:243], a[140:143], v[76:79]
    ds_read_b64_tr_b16 v[238:239], v221 offset:28672
    v_accvgpr_write_b32 a8, 0
    v_mfma_f32_16x16x32_bf16 v[76:79], v[244:247], a[156:159], v[76:79]
    s_waitcnt lgkmcnt(6)
    v_accvgpr_write_b32 a9, 0
    v_accvgpr_write_b32 a10, 0
    v_mfma_f32_16x16x32_bf16 v[80:83], v[224:227], a[128:131], v[80:83]
    s_waitcnt lgkmcnt(4)
    ds_read_b64_tr_b16 v[240:241], v221 offset:16392
    v_accvgpr_write_b32 a11, 0
    v_mfma_f32_16x16x32_bf16 v[80:83], v[228:231], a[144:147], v[80:83]
    v_accvgpr_write_b32 a12, 0
    v_accvgpr_write_b32 a13, 0
    v_mfma_f32_16x16x32_bf16 v[84:87], v[224:227], a[132:135], v[84:87]
    ds_read_b64_tr_b16 v[242:243], v221 offset:20488
    v_accvgpr_write_b32 a14, 0
    v_mfma_f32_16x16x32_bf16 v[84:87], v[228:231], a[148:151], v[84:87]
    v_accvgpr_write_b32 a15, 0
    v_accvgpr_write_b32 a16, 0
    v_mfma_f32_16x16x32_bf16 v[88:91], v[224:227], a[136:139], v[88:91]
    ds_read_b64_tr_b16 v[244:245], v221 offset:24584
    v_accvgpr_write_b32 a17, 0
    v_mfma_f32_16x16x32_bf16 v[88:91], v[228:231], a[152:155], v[88:91]
    v_accvgpr_write_b32 a18, 0
    v_accvgpr_write_b32 a19, 0
    v_mfma_f32_16x16x32_bf16 v[92:95], v[224:227], a[140:143], v[92:95]
    ds_read_b64_tr_b16 v[246:247], v221 offset:28680
    v_accvgpr_write_b32 a20, 0
    v_mfma_f32_16x16x32_bf16 v[92:95], v[228:231], a[156:159], v[92:95]
    s_waitcnt lgkmcnt(6)
    v_accvgpr_write_b32 a21, 0
    v_accvgpr_write_b32 a22, 0
    v_mfma_f32_16x16x32_bf16 v[96:99], v[232:235], a[128:131], v[96:99]
    s_waitcnt lgkmcnt(4)
    ds_read_b64_tr_b16 v[224:225], v222 offset:16384
    v_accvgpr_write_b32 a23, 0
    v_mfma_f32_16x16x32_bf16 v[96:99], v[236:239], a[144:147], v[96:99]
    v_accvgpr_write_b32 a24, 0
    v_accvgpr_write_b32 a25, 0
    v_mfma_f32_16x16x32_bf16 v[100:103], v[232:235], a[132:135], v[100:103]
    ds_read_b64_tr_b16 v[226:227], v222 offset:20480
    v_accvgpr_write_b32 a26, 0
    v_mfma_f32_16x16x32_bf16 v[100:103], v[236:239], a[148:151], v[100:103]
    v_accvgpr_write_b32 a27, 0
    v_accvgpr_write_b32 a28, 0
    v_mfma_f32_16x16x32_bf16 v[104:107], v[232:235], a[136:139], v[104:107]
    ds_read_b64_tr_b16 v[228:229], v222 offset:24576
    v_accvgpr_write_b32 a29, 0
    v_mfma_f32_16x16x32_bf16 v[104:107], v[236:239], a[152:155], v[104:107]
    v_accvgpr_write_b32 a30, 0
    v_accvgpr_write_b32 a31, 0
    v_mfma_f32_16x16x32_bf16 v[108:111], v[232:235], a[140:143], v[108:111]
    ds_read_b64_tr_b16 v[230:231], v222 offset:28672
    v_accvgpr_write_b32 a32, 0
    v_mfma_f32_16x16x32_bf16 v[108:111], v[236:239], a[156:159], v[108:111]
    s_waitcnt lgkmcnt(6)
    v_accvgpr_write_b32 a33, 0
    v_accvgpr_write_b32 a34, 0
    v_mfma_f32_16x16x32_bf16 v[112:115], v[240:243], a[128:131], v[112:115]
    s_waitcnt lgkmcnt(4)
    ds_read_b64_tr_b16 v[232:233], v222 offset:16392
    v_accvgpr_write_b32 a35, 0
    v_mfma_f32_16x16x32_bf16 v[112:115], v[244:247], a[144:147], v[112:115]
    v_accvgpr_write_b32 a36, 0
    v_accvgpr_write_b32 a37, 0
    v_mfma_f32_16x16x32_bf16 v[116:119], v[240:243], a[132:135], v[116:119]
    ds_read_b64_tr_b16 v[234:235], v222 offset:20488
    v_accvgpr_write_b32 a38, 0
    v_mfma_f32_16x16x32_bf16 v[116:119], v[244:247], a[148:151], v[116:119]
    v_accvgpr_write_b32 a39, 0
    v_accvgpr_write_b32 a40, 0
    v_mfma_f32_16x16x32_bf16 v[120:123], v[240:243], a[136:139], v[120:123]
    ds_read_b64_tr_b16 v[236:237], v222 offset:24584
    v_accvgpr_write_b32 a41, 0
    v_mfma_f32_16x16x32_bf16 v[120:123], v[244:247], a[152:155], v[120:123]
    v_accvgpr_write_b32 a42, 0
    v_accvgpr_write_b32 a43, 0
    v_mfma_f32_16x16x32_bf16 v[124:127], v[240:243], a[140:143], v[124:127]
    ds_read_b64_tr_b16 v[238:239], v222 offset:28680
    v_accvgpr_write_b32 a44, 0
    v_mfma_f32_16x16x32_bf16 v[124:127], v[244:247], a[156:159], v[124:127]
    s_waitcnt lgkmcnt(6)
    v_accvgpr_write_b32 a45, 0
    v_accvgpr_write_b32 a46, 0
    v_mfma_f32_16x16x32_bf16 v[128:131], v[224:227], a[128:131], v[128:131]
    s_waitcnt lgkmcnt(4)
    ds_read_b64_tr_b16 v[240:241], v223 offset:16384
    v_accvgpr_write_b32 a47, 0
    v_mfma_f32_16x16x32_bf16 v[128:131], v[228:231], a[144:147], v[128:131]
    v_accvgpr_write_b32 a48, 0
    v_accvgpr_write_b32 a49, 0
    v_mfma_f32_16x16x32_bf16 v[132:135], v[224:227], a[132:135], v[132:135]
    ds_read_b64_tr_b16 v[242:243], v223 offset:20480
    v_accvgpr_write_b32 a50, 0
    v_mfma_f32_16x16x32_bf16 v[132:135], v[228:231], a[148:151], v[132:135]
    v_accvgpr_write_b32 a51, 0
    v_accvgpr_write_b32 a52, 0
    v_mfma_f32_16x16x32_bf16 v[136:139], v[224:227], a[136:139], v[136:139]
    ds_read_b64_tr_b16 v[244:245], v223 offset:24576
    v_accvgpr_write_b32 a53, 0
    v_mfma_f32_16x16x32_bf16 v[136:139], v[228:231], a[152:155], v[136:139]
    v_accvgpr_write_b32 a54, 0
    v_accvgpr_write_b32 a55, 0
    v_mfma_f32_16x16x32_bf16 v[140:143], v[224:227], a[140:143], v[140:143]
    ds_read_b64_tr_b16 v[246:247], v223 offset:28672
    v_accvgpr_write_b32 a56, 0
    v_mfma_f32_16x16x32_bf16 v[140:143], v[228:231], a[156:159], v[140:143]
    s_waitcnt lgkmcnt(6)
    v_accvgpr_write_b32 a57, 0
    v_accvgpr_write_b32 a58, 0
    v_mfma_f32_16x16x32_bf16 v[144:147], v[232:235], a[128:131], v[144:147]
    s_waitcnt lgkmcnt(4)
    ds_read_b64_tr_b16 v[224:225], v223 offset:16392
    v_accvgpr_write_b32 a59, 0
    v_mfma_f32_16x16x32_bf16 v[144:147], v[236:239], a[144:147], v[144:147]
    ds_read_b64_tr_b16 v[226:227], v223 offset:20488
    v_accvgpr_write_b32 a60, 0
    v_mfma_f32_16x16x32_bf16 v[148:151], v[232:235], a[132:135], v[148:151]
    ds_read_b64_tr_b16 v[228:229], v223 offset:24584
    v_accvgpr_write_b32 a61, 0
    v_mfma_f32_16x16x32_bf16 v[148:151], v[236:239], a[148:151], v[148:151]
    ds_read_b64_tr_b16 v[230:231], v223 offset:28680
    v_accvgpr_write_b32 a62, 0
    v_mfma_f32_16x16x32_bf16 v[152:155], v[232:235], a[136:139], v[152:155]
    v_add_u32 v216, 40960, v212
    v_accvgpr_write_b32 a63, 0
    v_mfma_f32_16x16x32_bf16 v[152:155], v[236:239], a[152:155], v[152:155]
    v_add_u32 v217, 40960, v213
    v_accvgpr_write_b32 a64, 0
    v_mfma_f32_16x16x32_bf16 v[156:159], v[232:235], a[140:143], v[156:159]
    v_add_u32 v218, 40960, v214
    v_accvgpr_write_b32 a65, 0
    v_mfma_f32_16x16x32_bf16 v[156:159], v[236:239], a[156:159], v[156:159]
    s_waitcnt lgkmcnt(0)
    v_add_u32 v219, 40960, v215
    v_accvgpr_write_b32 a66, 0
    v_mfma_f32_16x16x32_bf16 v[160:163], v[240:243], a[128:131], v[160:163]
    s_waitcnt vmcnt(8)
    s_barrier
    ds_read_b64_tr_b16 v[232:233], v216 offset:0
    v_mfma_f32_16x16x32_bf16 v[160:163], v[244:247], a[144:147], v[160:163]
    v_accvgpr_write_b32 a67, 0
    v_accvgpr_write_b32 a68, 0
    v_mfma_f32_16x16x32_bf16 v[164:167], v[240:243], a[132:135], v[164:167]
    s_add_u32 s52, s40, 0
    s_add_u32 m0, s40, 81920
    ds_read_b64_tr_b16 v[234:235], v216 offset:4096
    v_mfma_f32_16x16x32_bf16 v[164:167], v[244:247], a[148:151], v[164:167]
    buffer_load_dwordx4 v18, s[24:27], s52 offen offset:0 lds
    v_mfma_f32_16x16x32_bf16 v[168:171], v[240:243], a[136:139], v[168:171]
    ds_read_b64_tr_b16 v[236:237], v216 offset:8192
    v_accvgpr_write_b32 a69, 0
    v_mfma_f32_16x16x32_bf16 v[168:171], v[244:247], a[152:155], v[168:171]
    v_accvgpr_write_b32 a70, 0
    v_accvgpr_write_b32 a71, 0
    v_mfma_f32_16x16x32_bf16 v[172:175], v[240:243], a[140:143], v[172:175]
    ds_read_b64_tr_b16 v[238:239], v216 offset:12288
    v_accvgpr_write_b32 a72, 0
    v_mfma_f32_16x16x32_bf16 v[172:175], v[244:247], a[156:159], v[172:175]
    v_accvgpr_write_b32 a73, 0
    v_accvgpr_write_b32 a74, 0
    v_mfma_f32_16x16x32_bf16 v[176:179], v[224:227], a[128:131], v[176:179]
    ds_read_b64_tr_b16 v[240:241], v216 offset:8
    v_accvgpr_write_b32 a75, 0
    v_mfma_f32_16x16x32_bf16 v[176:179], v[228:231], a[144:147], v[176:179]
    v_accvgpr_write_b32 a76, 0
    v_accvgpr_write_b32 a77, 0
    v_mfma_f32_16x16x32_bf16 v[180:183], v[224:227], a[132:135], v[180:183]
    ds_read_b64_tr_b16 v[242:243], v216 offset:4104
    v_accvgpr_write_b32 a78, 0
    v_mfma_f32_16x16x32_bf16 v[180:183], v[228:231], a[148:151], v[180:183]
    buffer_load_dwordx4 v19, s[24:27], s52 offen offset:1024 lds
    v_mfma_f32_16x16x32_bf16 v[184:187], v[224:227], a[136:139], v[184:187]
    ds_read_b64_tr_b16 v[244:245], v216 offset:8200
    v_accvgpr_write_b32 a79, 0
    v_mfma_f32_16x16x32_bf16 v[184:187], v[228:231], a[152:155], v[184:187]
    v_accvgpr_write_b32 a80, 0
    v_accvgpr_write_b32 a81, 0
    v_mfma_f32_16x16x32_bf16 v[188:191], v[224:227], a[140:143], v[188:191]
    ds_read_b64_tr_b16 v[246:247], v216 offset:12296
    v_accvgpr_write_b32 a82, 0
    v_mfma_f32_16x16x32_bf16 v[188:191], v[228:231], a[156:159], v[188:191]
    s_waitcnt lgkmcnt(6)
    v_accvgpr_write_b32 a83, 0
    v_accvgpr_write_b32 a84, 0
    v_mfma_f32_16x16x32_bf16 v[64:67], v[232:235], a[160:163], v[64:67]
    s_waitcnt lgkmcnt(4)
    ds_read_b64_tr_b16 v[224:225], v217 offset:0
    v_accvgpr_write_b32 a85, 0
    v_mfma_f32_16x16x32_bf16 v[64:67], v[236:239], a[176:179], v[64:67]
    v_accvgpr_write_b32 a86, 0
    v_accvgpr_write_b32 a87, 0
    v_mfma_f32_16x16x32_bf16 v[68:71], v[232:235], a[164:167], v[68:71]
    ds_read_b64_tr_b16 v[226:227], v217 offset:4096
    v_accvgpr_write_b32 a88, 0
    v_mfma_f32_16x16x32_bf16 v[68:71], v[236:239], a[180:183], v[68:71]
    buffer_load_dwordx4 v18, s[24:27], s52 offen offset:2048 lds
    v_mfma_f32_16x16x32_bf16 v[72:75], v[232:235], a[168:171], v[72:75]
    ds_read_b64_tr_b16 v[228:229], v217 offset:8192
    v_accvgpr_write_b32 a89, 0
    v_mfma_f32_16x16x32_bf16 v[72:75], v[236:239], a[184:187], v[72:75]
    v_accvgpr_write_b32 a90, 0
    v_accvgpr_write_b32 a91, 0
    v_mfma_f32_16x16x32_bf16 v[76:79], v[232:235], a[172:175], v[76:79]
    ds_read_b64_tr_b16 v[230:231], v217 offset:12288
    v_accvgpr_write_b32 a92, 0
    v_mfma_f32_16x16x32_bf16 v[76:79], v[236:239], a[188:191], v[76:79]
    s_waitcnt lgkmcnt(6)
    v_accvgpr_write_b32 a93, 0
    v_accvgpr_write_b32 a94, 0
    v_mfma_f32_16x16x32_bf16 v[80:83], v[240:243], a[160:163], v[80:83]
    s_waitcnt lgkmcnt(4)
    ds_read_b64_tr_b16 v[232:233], v217 offset:8
    v_accvgpr_write_b32 a95, 0
    v_mfma_f32_16x16x32_bf16 v[80:83], v[244:247], a[176:179], v[80:83]
    v_accvgpr_write_b32 a96, 0
    v_accvgpr_write_b32 a97, 0
    v_mfma_f32_16x16x32_bf16 v[84:87], v[240:243], a[164:167], v[84:87]
    ds_read_b64_tr_b16 v[234:235], v217 offset:4104
    v_accvgpr_write_b32 a98, 0
    v_mfma_f32_16x16x32_bf16 v[84:87], v[244:247], a[180:183], v[84:87]
    buffer_load_dwordx4 v19, s[24:27], s52 offen offset:3072 lds
    v_mfma_f32_16x16x32_bf16 v[88:91], v[240:243], a[168:171], v[88:91]
    ds_read_b64_tr_b16 v[236:237], v217 offset:8200
    v_accvgpr_write_b32 a99, 0
    v_mfma_f32_16x16x32_bf16 v[88:91], v[244:247], a[184:187], v[88:91]
    v_accvgpr_write_b32 a100, 0
    v_accvgpr_write_b32 a101, 0
    v_mfma_f32_16x16x32_bf16 v[92:95], v[240:243], a[172:175], v[92:95]
    ds_read_b64_tr_b16 v[238:239], v217 offset:12296
    v_accvgpr_write_b32 a102, 0
    v_mfma_f32_16x16x32_bf16 v[92:95], v[244:247], a[188:191], v[92:95]
    s_waitcnt lgkmcnt(6)
    v_accvgpr_write_b32 a103, 0
    v_accvgpr_write_b32 a104, 0
    v_mfma_f32_16x16x32_bf16 v[96:99], v[224:227], a[160:163], v[96:99]
    s_waitcnt lgkmcnt(4)
    ds_read_b64_tr_b16 v[240:241], v218 offset:0
    v_accvgpr_write_b32 a105, 0
    v_mfma_f32_16x16x32_bf16 v[96:99], v[228:231], a[176:179], v[96:99]
    v_accvgpr_write_b32 a106, 0
    v_accvgpr_write_b32 a107, 0
    v_mfma_f32_16x16x32_bf16 v[100:103], v[224:227], a[164:167], v[100:103]
    s_add_u32 s52, s40, 32768
    s_add_u32 m0, s40, 114688
    ds_read_b64_tr_b16 v[242:243], v218 offset:4096
    v_mfma_f32_16x16x32_bf16 v[100:103], v[228:231], a[180:183], v[100:103]
    buffer_load_dwordx4 v14, s[20:23], s52 offen offset:0 lds
    v_mfma_f32_16x16x32_bf16 v[104:107], v[224:227], a[168:171], v[104:107]
    ds_read_b64_tr_b16 v[244:245], v218 offset:8192
    v_accvgpr_write_b32 a108, 0
    v_mfma_f32_16x16x32_bf16 v[104:107], v[228:231], a[184:187], v[104:107]
    v_accvgpr_write_b32 a109, 0
    v_accvgpr_write_b32 a110, 0
    v_mfma_f32_16x16x32_bf16 v[108:111], v[224:227], a[172:175], v[108:111]
    ds_read_b64_tr_b16 v[246:247], v218 offset:12288
    v_accvgpr_write_b32 a111, 0
    v_mfma_f32_16x16x32_bf16 v[108:111], v[228:231], a[188:191], v[108:111]
    s_waitcnt lgkmcnt(6)
    v_accvgpr_write_b32 a112, 0
    v_accvgpr_write_b32 a113, 0
    v_mfma_f32_16x16x32_bf16 v[112:115], v[232:235], a[160:163], v[112:115]
    s_waitcnt lgkmcnt(4)
    ds_read_b64_tr_b16 v[224:225], v218 offset:8
    v_accvgpr_write_b32 a114, 0
    v_mfma_f32_16x16x32_bf16 v[112:115], v[236:239], a[176:179], v[112:115]
    v_accvgpr_write_b32 a115, 0
    v_accvgpr_write_b32 a116, 0
    v_mfma_f32_16x16x32_bf16 v[116:119], v[232:235], a[164:167], v[116:119]
    ds_read_b64_tr_b16 v[226:227], v218 offset:4104
    v_accvgpr_write_b32 a117, 0
    v_mfma_f32_16x16x32_bf16 v[116:119], v[236:239], a[180:183], v[116:119]
    buffer_load_dwordx4 v15, s[20:23], s52 offen offset:1024 lds
    v_mfma_f32_16x16x32_bf16 v[120:123], v[232:235], a[168:171], v[120:123]
    ds_read_b64_tr_b16 v[228:229], v218 offset:8200
    v_accvgpr_write_b32 a118, 0
    v_mfma_f32_16x16x32_bf16 v[120:123], v[236:239], a[184:187], v[120:123]
    v_accvgpr_write_b32 a119, 0
    v_accvgpr_write_b32 a120, 0
    v_mfma_f32_16x16x32_bf16 v[124:127], v[232:235], a[172:175], v[124:127]
    ds_read_b64_tr_b16 v[230:231], v218 offset:12296
    v_accvgpr_write_b32 a121, 0
    v_mfma_f32_16x16x32_bf16 v[124:127], v[236:239], a[188:191], v[124:127]
    s_waitcnt lgkmcnt(6)
    v_accvgpr_write_b32 a122, 0
    v_accvgpr_write_b32 a123, 0
    v_mfma_f32_16x16x32_bf16 v[128:131], v[240:243], a[160:163], v[128:131]
    s_waitcnt lgkmcnt(4)
    ds_read_b64_tr_b16 v[232:233], v219 offset:0
    v_accvgpr_write_b32 a124, 0
    v_mfma_f32_16x16x32_bf16 v[128:131], v[244:247], a[176:179], v[128:131]
    v_accvgpr_write_b32 a125, 0
    v_accvgpr_write_b32 a126, 0
    v_mfma_f32_16x16x32_bf16 v[132:135], v[240:243], a[164:167], v[132:135]
    ds_read_b64_tr_b16 v[234:235], v219 offset:4096
    v_accvgpr_write_b32 a127, 0
    v_mfma_f32_16x16x32_bf16 v[132:135], v[244:247], a[180:183], v[132:135]
    buffer_load_dwordx4 v16, s[20:23], s52 offen offset:2048 lds
    v_mfma_f32_16x16x32_bf16 v[136:139], v[240:243], a[168:171], v[136:139]
    ds_read_b64_tr_b16 v[236:237], v219 offset:8192
    v_mfma_f32_16x16x32_bf16 v[136:139], v[244:247], a[184:187], v[136:139]
    v_mfma_f32_16x16x32_bf16 v[140:143], v[240:243], a[172:175], v[140:143]
    ds_read_b64_tr_b16 v[238:239], v219 offset:12288
    v_mfma_f32_16x16x32_bf16 v[140:143], v[244:247], a[188:191], v[140:143]
    s_waitcnt lgkmcnt(6)
    v_mfma_f32_16x16x32_bf16 v[144:147], v[224:227], a[160:163], v[144:147]
    s_waitcnt lgkmcnt(4)
    ds_read_b64_tr_b16 v[240:241], v219 offset:8
    v_mfma_f32_16x16x32_bf16 v[144:147], v[228:231], a[176:179], v[144:147]
    v_mfma_f32_16x16x32_bf16 v[148:151], v[224:227], a[164:167], v[148:151]
    ds_read_b64_tr_b16 v[242:243], v219 offset:4104
    v_mfma_f32_16x16x32_bf16 v[148:151], v[228:231], a[180:183], v[148:151]
    buffer_load_dwordx4 v17, s[20:23], s52 offen offset:3072 lds
    v_mfma_f32_16x16x32_bf16 v[152:155], v[224:227], a[168:171], v[152:155]
    ds_read_b64_tr_b16 v[244:245], v219 offset:8200
    v_mfma_f32_16x16x32_bf16 v[152:155], v[228:231], a[184:187], v[152:155]
    v_mfma_f32_16x16x32_bf16 v[156:159], v[224:227], a[172:175], v[156:159]
    ds_read_b64_tr_b16 v[246:247], v219 offset:12296
    v_mfma_f32_16x16x32_bf16 v[156:159], v[228:231], a[188:191], v[156:159]
    s_waitcnt lgkmcnt(6)
    v_mfma_f32_16x16x32_bf16 v[160:163], v[232:235], a[160:163], v[160:163]
    s_waitcnt lgkmcnt(4)
    ds_read_b64_tr_b16 v[224:225], v216 offset:16384
    v_mfma_f32_16x16x32_bf16 v[160:163], v[236:239], a[176:179], v[160:163]
    v_mfma_f32_16x16x32_bf16 v[164:167], v[232:235], a[164:167], v[164:167]
    s_add_u32 s52, s40, 49152
    s_add_u32 m0, s40, 98304
    ds_read_b64_tr_b16 v[226:227], v216 offset:20480
    v_mfma_f32_16x16x32_bf16 v[164:167], v[236:239], a[180:183], v[164:167]
    buffer_load_dwordx4 v14, s[20:23], s52 offen offset:0 lds
    v_mfma_f32_16x16x32_bf16 v[168:171], v[232:235], a[168:171], v[168:171]
    ds_read_b64_tr_b16 v[228:229], v216 offset:24576
    v_mfma_f32_16x16x32_bf16 v[168:171], v[236:239], a[184:187], v[168:171]
    v_mfma_f32_16x16x32_bf16 v[172:175], v[232:235], a[172:175], v[172:175]
    ds_read_b64_tr_b16 v[230:231], v216 offset:28672
    v_mfma_f32_16x16x32_bf16 v[172:175], v[236:239], a[188:191], v[172:175]
    s_waitcnt lgkmcnt(6)
    v_mfma_f32_16x16x32_bf16 v[176:179], v[240:243], a[160:163], v[176:179]
    s_waitcnt lgkmcnt(4)
    ds_read_b64_tr_b16 v[232:233], v216 offset:16392
    v_mfma_f32_16x16x32_bf16 v[176:179], v[244:247], a[176:179], v[176:179]
    v_mfma_f32_16x16x32_bf16 v[180:183], v[240:243], a[164:167], v[180:183]
    ds_read_b64_tr_b16 v[234:235], v216 offset:20488
    v_mfma_f32_16x16x32_bf16 v[180:183], v[244:247], a[180:183], v[180:183]
    buffer_load_dwordx4 v15, s[20:23], s52 offen offset:1024 lds
    v_mfma_f32_16x16x32_bf16 v[184:187], v[240:243], a[168:171], v[184:187]
    ds_read_b64_tr_b16 v[236:237], v216 offset:24584
    v_mfma_f32_16x16x32_bf16 v[184:187], v[244:247], a[184:187], v[184:187]
    v_mfma_f32_16x16x32_bf16 v[188:191], v[240:243], a[172:175], v[188:191]
    ds_read_b64_tr_b16 v[238:239], v216 offset:28680
    v_mfma_f32_16x16x32_bf16 v[188:191], v[244:247], a[188:191], v[188:191]
    s_waitcnt lgkmcnt(6)
    v_mfma_f32_16x16x32_bf16 v[64:67], v[224:227], a[192:195], v[64:67]
    s_waitcnt lgkmcnt(4)
    ds_read_b64_tr_b16 v[240:241], v217 offset:16384
    v_mfma_f32_16x16x32_bf16 v[64:67], v[228:231], a[208:211], v[64:67]
    v_mfma_f32_16x16x32_bf16 v[68:71], v[224:227], a[196:199], v[68:71]
    ds_read_b64_tr_b16 v[242:243], v217 offset:20480
    v_mfma_f32_16x16x32_bf16 v[68:71], v[228:231], a[212:215], v[68:71]
    buffer_load_dwordx4 v16, s[20:23], s52 offen offset:2048 lds
    v_mfma_f32_16x16x32_bf16 v[72:75], v[224:227], a[200:203], v[72:75]
    ds_read_b64_tr_b16 v[244:245], v217 offset:24576
    v_mfma_f32_16x16x32_bf16 v[72:75], v[228:231], a[216:219], v[72:75]
    v_mfma_f32_16x16x32_bf16 v[76:79], v[224:227], a[204:207], v[76:79]
    ds_read_b64_tr_b16 v[246:247], v217 offset:28672
    v_mfma_f32_16x16x32_bf16 v[76:79], v[228:231], a[220:223], v[76:79]
    s_waitcnt lgkmcnt(6)
    v_mfma_f32_16x16x32_bf16 v[80:83], v[232:235], a[192:195], v[80:83]
    s_waitcnt lgkmcnt(4)
    ds_read_b64_tr_b16 v[224:225], v217 offset:16392
    v_mfma_f32_16x16x32_bf16 v[80:83], v[236:239], a[208:211], v[80:83]
    v_mfma_f32_16x16x32_bf16 v[84:87], v[232:235], a[196:199], v[84:87]
    ds_read_b64_tr_b16 v[226:227], v217 offset:20488
    v_mfma_f32_16x16x32_bf16 v[84:87], v[236:239], a[212:215], v[84:87]
    buffer_load_dwordx4 v17, s[20:23], s52 offen offset:3072 lds
    v_mfma_f32_16x16x32_bf16 v[88:91], v[232:235], a[200:203], v[88:91]
    ds_read_b64_tr_b16 v[228:229], v217 offset:24584
    v_mfma_f32_16x16x32_bf16 v[88:91], v[236:239], a[216:219], v[88:91]
    v_mfma_f32_16x16x32_bf16 v[92:95], v[232:235], a[204:207], v[92:95]
    ds_read_b64_tr_b16 v[230:231], v217 offset:28680
    v_mfma_f32_16x16x32_bf16 v[92:95], v[236:239], a[220:223], v[92:95]
    s_waitcnt lgkmcnt(6)
    v_mfma_f32_16x16x32_bf16 v[96:99], v[240:243], a[192:195], v[96:99]
    s_waitcnt lgkmcnt(4)
    ds_read_b64_tr_b16 v[232:233], v218 offset:16384
    v_mfma_f32_16x16x32_bf16 v[96:99], v[244:247], a[208:211], v[96:99]
    v_mfma_f32_16x16x32_bf16 v[100:103], v[240:243], a[196:199], v[100:103]
    ds_read_b64_tr_b16 v[234:235], v218 offset:20480
    v_mfma_f32_16x16x32_bf16 v[100:103], v[244:247], a[212:215], v[100:103]
    v_mfma_f32_16x16x32_bf16 v[104:107], v[240:243], a[200:203], v[104:107]
    ds_read_b64_tr_b16 v[236:237], v218 offset:24576
    v_mfma_f32_16x16x32_bf16 v[104:107], v[244:247], a[216:219], v[104:107]
    v_mfma_f32_16x16x32_bf16 v[108:111], v[240:243], a[204:207], v[108:111]
    ds_read_b64_tr_b16 v[238:239], v218 offset:28672
    v_mfma_f32_16x16x32_bf16 v[108:111], v[244:247], a[220:223], v[108:111]
    s_waitcnt lgkmcnt(6)
    v_mfma_f32_16x16x32_bf16 v[112:115], v[224:227], a[192:195], v[112:115]
    s_waitcnt lgkmcnt(4)
    ds_read_b64_tr_b16 v[240:241], v218 offset:16392
    v_mfma_f32_16x16x32_bf16 v[112:115], v[228:231], a[208:211], v[112:115]
    v_mfma_f32_16x16x32_bf16 v[116:119], v[224:227], a[196:199], v[116:119]
    ds_read_b64_tr_b16 v[242:243], v218 offset:20488
    v_mfma_f32_16x16x32_bf16 v[116:119], v[228:231], a[212:215], v[116:119]
    v_mfma_f32_16x16x32_bf16 v[120:123], v[224:227], a[200:203], v[120:123]
    ds_read_b64_tr_b16 v[244:245], v218 offset:24584
    v_mfma_f32_16x16x32_bf16 v[120:123], v[228:231], a[216:219], v[120:123]
    v_mfma_f32_16x16x32_bf16 v[124:127], v[224:227], a[204:207], v[124:127]
    ds_read_b64_tr_b16 v[246:247], v218 offset:28680
    v_mfma_f32_16x16x32_bf16 v[124:127], v[228:231], a[220:223], v[124:127]
    s_waitcnt lgkmcnt(6)
    v_mfma_f32_16x16x32_bf16 v[128:131], v[232:235], a[192:195], v[128:131]
    s_waitcnt lgkmcnt(4)
    ds_read_b64_tr_b16 v[224:225], v219 offset:16384
    v_mfma_f32_16x16x32_bf16 v[128:131], v[236:239], a[208:211], v[128:131]
    v_mfma_f32_16x16x32_bf16 v[132:135], v[232:235], a[196:199], v[132:135]
    ds_read_b64_tr_b16 v[226:227], v219 offset:20480
    v_mfma_f32_16x16x32_bf16 v[132:135], v[236:239], a[212:215], v[132:135]
    v_mfma_f32_16x16x32_bf16 v[136:139], v[232:235], a[200:203], v[136:139]
    ds_read_b64_tr_b16 v[228:229], v219 offset:24576
    v_mfma_f32_16x16x32_bf16 v[136:139], v[236:239], a[216:219], v[136:139]
    v_mfma_f32_16x16x32_bf16 v[140:143], v[232:235], a[204:207], v[140:143]
    ds_read_b64_tr_b16 v[230:231], v219 offset:28672
    v_mfma_f32_16x16x32_bf16 v[140:143], v[236:239], a[220:223], v[140:143]
    s_waitcnt lgkmcnt(6)
    v_mfma_f32_16x16x32_bf16 v[144:147], v[240:243], a[192:195], v[144:147]
    s_waitcnt lgkmcnt(4)
    ds_read_b64_tr_b16 v[232:233], v219 offset:16392
    v_mfma_f32_16x16x32_bf16 v[144:147], v[244:247], a[208:211], v[144:147]
    ds_read_b64_tr_b16 v[234:235], v219 offset:20488
    v_mfma_f32_16x16x32_bf16 v[148:151], v[240:243], a[196:199], v[148:151]
    ds_read_b64_tr_b16 v[236:237], v219 offset:24584
    v_mfma_f32_16x16x32_bf16 v[148:151], v[244:247], a[212:215], v[148:151]
    ds_read_b64_tr_b16 v[238:239], v219 offset:28680
    v_mfma_f32_16x16x32_bf16 v[152:155], v[240:243], a[200:203], v[152:155]
    v_add_u32 v220, 0, v212
    v_mfma_f32_16x16x32_bf16 v[152:155], v[244:247], a[216:219], v[152:155]
    v_add_u32 v221, 0, v213
    v_mfma_f32_16x16x32_bf16 v[156:159], v[240:243], a[204:207], v[156:159]
    v_add_u32 v222, 0, v214
    v_mfma_f32_16x16x32_bf16 v[156:159], v[244:247], a[220:223], v[156:159]
    s_waitcnt lgkmcnt(0)
    v_add_u32 v223, 0, v215
    v_mfma_f32_16x16x32_bf16 v[160:163], v[224:227], a[192:195], v[160:163]
    s_waitcnt vmcnt(12)
    s_barrier
    ds_read_b64_tr_b16 v[240:241], v220 offset:0
    v_mfma_f32_16x16x32_bf16 v[160:163], v[228:231], a[208:211], v[160:163]
    v_mfma_f32_16x16x32_bf16 v[164:167], v[224:227], a[196:199], v[164:167]
    s_add_u32 s52, s40, 16384
    s_add_u32 m0, s40, 65536
    ds_read_b64_tr_b16 v[242:243], v220 offset:4096
    v_mfma_f32_16x16x32_bf16 v[164:167], v[228:231], a[212:215], v[164:167]
    buffer_load_dwordx4 v18, s[24:27], s52 offen offset:0 lds
    v_mfma_f32_16x16x32_bf16 v[168:171], v[224:227], a[200:203], v[168:171]
    ds_read_b64_tr_b16 v[244:245], v220 offset:8192
    v_mfma_f32_16x16x32_bf16 v[168:171], v[228:231], a[216:219], v[168:171]
    v_mfma_f32_16x16x32_bf16 v[172:175], v[224:227], a[204:207], v[172:175]
    ds_read_b64_tr_b16 v[246:247], v220 offset:12288
    v_mfma_f32_16x16x32_bf16 v[172:175], v[228:231], a[220:223], v[172:175]
    v_mfma_f32_16x16x32_bf16 v[176:179], v[232:235], a[192:195], v[176:179]
    ds_read_b64_tr_b16 v[224:225], v220 offset:16384
    v_mfma_f32_16x16x32_bf16 v[176:179], v[236:239], a[208:211], v[176:179]
    v_mfma_f32_16x16x32_bf16 v[180:183], v[232:235], a[196:199], v[180:183]
    ds_read_b64_tr_b16 v[226:227], v220 offset:20480
    v_mfma_f32_16x16x32_bf16 v[180:183], v[236:239], a[212:215], v[180:183]
    buffer_load_dwordx4 v19, s[24:27], s52 offen offset:1024 lds
    v_mfma_f32_16x16x32_bf16 v[184:187], v[232:235], a[200:203], v[184:187]
    ds_read_b64_tr_b16 v[228:229], v220 offset:24576
    v_mfma_f32_16x16x32_bf16 v[184:187], v[236:239], a[216:219], v[184:187]
    v_mfma_f32_16x16x32_bf16 v[188:191], v[232:235], a[204:207], v[188:191]
    ds_read_b64_tr_b16 v[230:231], v220 offset:28672
    v_mfma_f32_16x16x32_bf16 v[188:191], v[236:239], a[220:223], v[188:191]
    s_waitcnt lgkmcnt(6)
    v_mfma_f32_16x16x32_bf16 v[64:67], v[240:243], a[224:227], v[64:67]
    s_waitcnt lgkmcnt(4)
    ds_read_b64_tr_b16 v[232:233], v220 offset:8
    v_mfma_f32_16x16x32_bf16 v[64:67], v[244:247], a[240:243], v[64:67]
    v_mfma_f32_16x16x32_bf16 v[68:71], v[240:243], a[228:231], v[68:71]
    ds_read_b64_tr_b16 v[234:235], v220 offset:4104
    v_mfma_f32_16x16x32_bf16 v[68:71], v[244:247], a[244:247], v[68:71]
    buffer_load_dwordx4 v18, s[24:27], s52 offen offset:2048 lds
    v_mfma_f32_16x16x32_bf16 v[72:75], v[240:243], a[232:235], v[72:75]
    ds_read_b64_tr_b16 v[236:237], v220 offset:8200
    v_mfma_f32_16x16x32_bf16 v[72:75], v[244:247], a[248:251], v[72:75]
    v_mfma_f32_16x16x32_bf16 v[76:79], v[240:243], a[236:239], v[76:79]
    ds_read_b64_tr_b16 v[238:239], v220 offset:12296
    v_mfma_f32_16x16x32_bf16 v[76:79], v[244:247], a[252:255], v[76:79]
    s_waitcnt lgkmcnt(6)
    v_mfma_f32_16x16x32_bf16 v[64:67], v[224:227], v[32:35], v[64:67]
    s_waitcnt lgkmcnt(4)
    ds_read_b64_tr_b16 v[240:241], v220 offset:16392
    v_mfma_f32_16x16x32_bf16 v[64:67], v[228:231], v[48:51], v[64:67]
    v_mfma_f32_16x16x32_bf16 v[68:71], v[224:227], v[36:39], v[68:71]
    ds_read_b64_tr_b16 v[242:243], v220 offset:20488
    v_mfma_f32_16x16x32_bf16 v[68:71], v[228:231], v[52:55], v[68:71]
    buffer_load_dwordx4 v19, s[24:27], s52 offen offset:3072 lds
    v_mfma_f32_16x16x32_bf16 v[72:75], v[224:227], v[40:43], v[72:75]
    ds_read_b64_tr_b16 v[244:245], v220 offset:24584
    v_mfma_f32_16x16x32_bf16 v[72:75], v[228:231], v[56:59], v[72:75]
    v_mfma_f32_16x16x32_bf16 v[76:79], v[224:227], v[44:47], v[76:79]
    ds_read_b64_tr_b16 v[246:247], v220 offset:28680
    v_mfma_f32_16x16x32_bf16 v[76:79], v[228:231], v[60:63], v[76:79]
    s_waitcnt lgkmcnt(6)
    v_mfma_f32_16x16x32_bf16 v[80:83], v[232:235], a[224:227], v[80:83]
    s_waitcnt lgkmcnt(4)
    ds_read_b64_tr_b16 v[224:225], v221 offset:0
    v_mfma_f32_16x16x32_bf16 v[80:83], v[236:239], a[240:243], v[80:83]
    v_cvt_pk_bf16_f32 v64, v64, v65
    v_cvt_pk_bf16_f32 v65, v66, v67
    v_mfma_f32_16x16x32_bf16 v[84:87], v[232:235], a[228:231], v[84:87]
    s_add_u32 s52, s40, 32768
    s_add_u32 m0, s40, 49152
    ds_read_b64_tr_b16 v[226:227], v221 offset:4096
    v_mfma_f32_16x16x32_bf16 v[84:87], v[236:239], a[244:247], v[84:87]
    buffer_load_dwordx4 v18, s[24:27], s52 offen offset:0 lds
    v_mfma_f32_16x16x32_bf16 v[88:91], v[232:235], a[232:235], v[88:91]
    ds_read_b64_tr_b16 v[228:229], v221 offset:8192
    v_cvt_pk_bf16_f32 v68, v68, v69
    v_mfma_f32_16x16x32_bf16 v[88:91], v[236:239], a[248:251], v[88:91]
    v_cvt_pk_bf16_f32 v69, v70, v71
    v_cvt_pk_bf16_f32 v72, v72, v73
    v_mfma_f32_16x16x32_bf16 v[92:95], v[232:235], a[236:239], v[92:95]
    ds_read_b64_tr_b16 v[230:231], v221 offset:12288
    v_cvt_pk_bf16_f32 v73, v74, v75
    v_mfma_f32_16x16x32_bf16 v[92:95], v[236:239], a[252:255], v[92:95]
    s_waitcnt lgkmcnt(6)
    v_cvt_pk_bf16_f32 v76, v76, v77
    v_cvt_pk_bf16_f32 v77, v78, v79
    v_mfma_f32_16x16x32_bf16 v[80:83], v[240:243], v[32:35], v[80:83]
    s_waitcnt lgkmcnt(4)
    ds_read_b64_tr_b16 v[232:233], v221 offset:16384
    v_mfma_f32_16x16x32_bf16 v[80:83], v[244:247], v[48:51], v[80:83]
    v_mfma_f32_16x16x32_bf16 v[84:87], v[240:243], v[36:39], v[84:87]
    ds_read_b64_tr_b16 v[234:235], v221 offset:20480
    v_mfma_f32_16x16x32_bf16 v[84:87], v[244:247], v[52:55], v[84:87]
    buffer_load_dwordx4 v19, s[24:27], s52 offen offset:1024 lds
    v_mfma_f32_16x16x32_bf16 v[88:91], v[240:243], v[40:43], v[88:91]
    ds_read_b64_tr_b16 v[236:237], v221 offset:24576
    v_mfma_f32_16x16x32_bf16 v[88:91], v[244:247], v[56:59], v[88:91]
    v_mfma_f32_16x16x32_bf16 v[92:95], v[240:243], v[44:47], v[92:95]
    ds_read_b64_tr_b16 v[238:239], v221 offset:28672
    v_mfma_f32_16x16x32_bf16 v[92:95], v[244:247], v[60:63], v[92:95]
    s_waitcnt lgkmcnt(6)
    v_mfma_f32_16x16x32_bf16 v[96:99], v[224:227], a[224:227], v[96:99]
    s_waitcnt lgkmcnt(4)
    ds_read_b64_tr_b16 v[240:241], v221 offset:8
    v_mfma_f32_16x16x32_bf16 v[96:99], v[228:231], a[240:243], v[96:99]
    v_cvt_pk_bf16_f32 v66, v80, v81
    v_cvt_pk_bf16_f32 v67, v82, v83
    v_mfma_f32_16x16x32_bf16 v[100:103], v[224:227], a[228:231], v[100:103]
    ds_read_b64_tr_b16 v[242:243], v221 offset:4104
    v_cvt_pk_bf16_f32 v70, v84, v85
    v_mfma_f32_16x16x32_bf16 v[100:103], v[228:231], a[244:247], v[100:103]
    buffer_load_dwordx4 v18, s[24:27], s52 offen offset:2048 lds
    v_mfma_f32_16x16x32_bf16 v[104:107], v[224:227], a[232:235], v[104:107]
    ds_read_b64_tr_b16 v[244:245], v221 offset:8200
    v_cvt_pk_bf16_f32 v71, v86, v87
    v_mfma_f32_16x16x32_bf16 v[104:107], v[228:231], a[248:251], v[104:107]
    v_cvt_pk_bf16_f32 v74, v88, v89
    v_cvt_pk_bf16_f32 v75, v90, v91
    v_mfma_f32_16x16x32_bf16 v[108:111], v[224:227], a[236:239], v[108:111]
    ds_read_b64_tr_b16 v[246:247], v221 offset:12296
    v_cvt_pk_bf16_f32 v78, v92, v93
    v_mfma_f32_16x16x32_bf16 v[108:111], v[228:231], a[252:255], v[108:111]
    s_waitcnt lgkmcnt(6)
    v_cvt_pk_bf16_f32 v79, v94, v95
    v_mfma_f32_16x16x32_bf16 v[96:99], v[232:235], v[32:35], v[96:99]
    s_waitcnt lgkmcnt(4)
    ds_read_b64_tr_b16 v[224:225], v221 offset:16392
    v_mfma_f32_16x16x32_bf16 v[96:99], v[236:239], v[48:51], v[96:99]
    v_mfma_f32_16x16x32_bf16 v[100:103], v[232:235], v[36:39], v[100:103]
    ds_read_b64_tr_b16 v[226:227], v221 offset:20488
    v_mfma_f32_16x16x32_bf16 v[100:103], v[236:239], v[52:55], v[100:103]
    buffer_load_dwordx4 v19, s[24:27], s52 offen offset:3072 lds
    v_mfma_f32_16x16x32_bf16 v[104:107], v[232:235], v[40:43], v[104:107]
    ds_read_b64_tr_b16 v[228:229], v221 offset:24584
    v_mfma_f32_16x16x32_bf16 v[104:107], v[236:239], v[56:59], v[104:107]
    v_mfma_f32_16x16x32_bf16 v[108:111], v[232:235], v[44:47], v[108:111]
    ds_read_b64_tr_b16 v[230:231], v221 offset:28680
    v_mfma_f32_16x16x32_bf16 v[108:111], v[236:239], v[60:63], v[108:111]
    s_waitcnt lgkmcnt(6)
    v_mfma_f32_16x16x32_bf16 v[112:115], v[240:243], a[224:227], v[112:115]
    s_waitcnt lgkmcnt(4)
    ds_read_b64_tr_b16 v[232:233], v222 offset:0
    v_mfma_f32_16x16x32_bf16 v[112:115], v[244:247], a[240:243], v[112:115]
    v_cvt_pk_bf16_f32 v96, v96, v97
    v_cvt_pk_bf16_f32 v97, v98, v99
    v_mfma_f32_16x16x32_bf16 v[116:119], v[240:243], a[228:231], v[116:119]
    s_add_u32 s63, s57, 0
    ds_read_b64_tr_b16 v[234:235], v222 offset:4096
    v_cvt_pk_bf16_f32 v100, v100, v101
    v_mfma_f32_16x16x32_bf16 v[116:119], v[244:247], a[244:247], v[116:119]
    buffer_store_dwordx2 v[192:193], v1, s[32:35], s63 offen sc1
    v_mfma_f32_16x16x32_bf16 v[120:123], v[240:243], a[232:235], v[120:123]
    ds_read_b64_tr_b16 v[236:237], v222 offset:8192
    v_cvt_pk_bf16_f32 v101, v102, v103
    v_mfma_f32_16x16x32_bf16 v[120:123], v[244:247], a[248:251], v[120:123]
    v_cvt_pk_bf16_f32 v104, v104, v105
    v_cvt_pk_bf16_f32 v105, v106, v107
    v_mfma_f32_16x16x32_bf16 v[124:127], v[240:243], a[236:239], v[124:127]
    ds_read_b64_tr_b16 v[238:239], v222 offset:12288
    v_cvt_pk_bf16_f32 v108, v108, v109
    v_mfma_f32_16x16x32_bf16 v[124:127], v[244:247], a[252:255], v[124:127]
    s_waitcnt lgkmcnt(6)
    v_cvt_pk_bf16_f32 v109, v110, v111
    v_mfma_f32_16x16x32_bf16 v[112:115], v[224:227], v[32:35], v[112:115]
    s_waitcnt lgkmcnt(4)
    ds_read_b64_tr_b16 v[240:241], v222 offset:16384
    v_mfma_f32_16x16x32_bf16 v[112:115], v[228:231], v[48:51], v[112:115]
    v_mfma_f32_16x16x32_bf16 v[116:119], v[224:227], v[36:39], v[116:119]
    s_add_u32 s63, s57, 147456
    ds_read_b64_tr_b16 v[242:243], v222 offset:20480
    v_mfma_f32_16x16x32_bf16 v[116:119], v[228:231], v[52:55], v[116:119]
    buffer_store_dwordx2 v[196:197], v1, s[32:35], s63 offen sc1
    v_mfma_f32_16x16x32_bf16 v[120:123], v[224:227], v[40:43], v[120:123]
    ds_read_b64_tr_b16 v[244:245], v222 offset:24576
    v_mfma_f32_16x16x32_bf16 v[120:123], v[228:231], v[56:59], v[120:123]
    v_mfma_f32_16x16x32_bf16 v[124:127], v[224:227], v[44:47], v[124:127]
    ds_read_b64_tr_b16 v[246:247], v222 offset:28672
    v_mfma_f32_16x16x32_bf16 v[124:127], v[228:231], v[60:63], v[124:127]
    s_waitcnt lgkmcnt(6)
    v_mfma_f32_16x16x32_bf16 v[128:131], v[232:235], a[224:227], v[128:131]
    s_waitcnt lgkmcnt(4)
    ds_read_b64_tr_b16 v[224:225], v222 offset:8
    v_mfma_f32_16x16x32_bf16 v[128:131], v[236:239], a[240:243], v[128:131]
    v_cvt_pk_bf16_f32 v98, v112, v113
    v_cvt_pk_bf16_f32 v99, v114, v115
    v_mfma_f32_16x16x32_bf16 v[132:135], v[232:235], a[228:231], v[132:135]
    s_add_u32 s63, s57, 294912
    ds_read_b64_tr_b16 v[226:227], v222 offset:4104
    v_cvt_pk_bf16_f32 v102, v116, v117
    v_mfma_f32_16x16x32_bf16 v[132:135], v[236:239], a[244:247], v[132:135]
    buffer_store_dwordx2 v[200:201], v1, s[32:35], s63 offen sc1
    v_mfma_f32_16x16x32_bf16 v[136:139], v[232:235], a[232:235], v[136:139]
    ds_read_b64_tr_b16 v[228:229], v222 offset:8200
    v_cvt_pk_bf16_f32 v103, v118, v119
    v_mfma_f32_16x16x32_bf16 v[136:139], v[236:239], a[248:251], v[136:139]
    v_cvt_pk_bf16_f32 v106, v120, v121
    v_cvt_pk_bf16_f32 v107, v122, v123
    v_mfma_f32_16x16x32_bf16 v[140:143], v[232:235], a[236:239], v[140:143]
    ds_read_b64_tr_b16 v[230:231], v222 offset:12296
    v_cvt_pk_bf16_f32 v110, v124, v125
    v_mfma_f32_16x16x32_bf16 v[140:143], v[236:239], a[252:255], v[140:143]
    s_waitcnt lgkmcnt(6)
    v_cvt_pk_bf16_f32 v111, v126, v127
    v_mfma_f32_16x16x32_bf16 v[128:131], v[240:243], v[32:35], v[128:131]
    s_waitcnt lgkmcnt(4)
    ds_read_b64_tr_b16 v[232:233], v222 offset:16392
    v_mfma_f32_16x16x32_bf16 v[128:131], v[244:247], v[48:51], v[128:131]
    v_mfma_f32_16x16x32_bf16 v[132:135], v[240:243], v[36:39], v[132:135]
    s_add_u32 s63, s57, 442368
    ds_read_b64_tr_b16 v[234:235], v222 offset:20488
    v_mfma_f32_16x16x32_bf16 v[132:135], v[244:247], v[52:55], v[132:135]
    buffer_store_dwordx2 v[204:205], v1, s[32:35], s63 offen sc1
    v_mfma_f32_16x16x32_bf16 v[136:139], v[240:243], v[40:43], v[136:139]
    ds_read_b64_tr_b16 v[236:237], v222 offset:24584
    v_mfma_f32_16x16x32_bf16 v[136:139], v[244:247], v[56:59], v[136:139]
    v_mfma_f32_16x16x32_bf16 v[140:143], v[240:243], v[44:47], v[140:143]
    ds_read_b64_tr_b16 v[238:239], v222 offset:28680
    v_mfma_f32_16x16x32_bf16 v[140:143], v[244:247], v[60:63], v[140:143]
    s_waitcnt lgkmcnt(6)
    v_mfma_f32_16x16x32_bf16 v[144:147], v[224:227], a[224:227], v[144:147]
    s_waitcnt lgkmcnt(4)
    ds_read_b64_tr_b16 v[240:241], v223 offset:0
    v_mfma_f32_16x16x32_bf16 v[144:147], v[228:231], a[240:243], v[144:147]
    v_cvt_pk_bf16_f32 v128, v128, v129
    v_cvt_pk_bf16_f32 v129, v130, v131
    v_mfma_f32_16x16x32_bf16 v[148:151], v[224:227], a[228:231], v[148:151]
    ds_read_b64_tr_b16 v[242:243], v223 offset:4096
    v_cvt_pk_bf16_f32 v132, v132, v133
    v_mfma_f32_16x16x32_bf16 v[148:151], v[228:231], a[244:247], v[148:151]
    v_cvt_pk_bf16_f32 v133, v134, v135
    v_cvt_pk_bf16_f32 v136, v136, v137
    v_mfma_f32_16x16x32_bf16 v[152:155], v[224:227], a[232:235], v[152:155]
    ds_read_b64_tr_b16 v[244:245], v223 offset:8192
    v_cvt_pk_bf16_f32 v137, v138, v139
    v_mfma_f32_16x16x32_bf16 v[152:155], v[228:231], a[248:251], v[152:155]
    v_cvt_pk_bf16_f32 v140, v140, v141
    v_cvt_pk_bf16_f32 v141, v142, v143
    v_mfma_f32_16x16x32_bf16 v[156:159], v[224:227], a[236:239], v[156:159]
    ds_read_b64_tr_b16 v[246:247], v223 offset:12288
    v_mfma_f32_16x16x32_bf16 v[156:159], v[228:231], a[252:255], v[156:159]
    s_waitcnt lgkmcnt(6)
    v_mfma_f32_16x16x32_bf16 v[144:147], v[232:235], v[32:35], v[144:147]
    s_waitcnt lgkmcnt(4)
    ds_read_b64_tr_b16 v[224:225], v223 offset:16384
    v_mfma_f32_16x16x32_bf16 v[144:147], v[236:239], v[48:51], v[144:147]
    v_mfma_f32_16x16x32_bf16 v[148:151], v[232:235], v[36:39], v[148:151]
    ds_read_b64_tr_b16 v[226:227], v223 offset:20480
    v_mfma_f32_16x16x32_bf16 v[148:151], v[236:239], v[52:55], v[148:151]
    v_mfma_f32_16x16x32_bf16 v[152:155], v[232:235], v[40:43], v[152:155]
    ds_read_b64_tr_b16 v[228:229], v223 offset:24576
    v_mfma_f32_16x16x32_bf16 v[152:155], v[236:239], v[56:59], v[152:155]
    v_mfma_f32_16x16x32_bf16 v[156:159], v[232:235], v[44:47], v[156:159]
    ds_read_b64_tr_b16 v[230:231], v223 offset:28672
    v_mfma_f32_16x16x32_bf16 v[156:159], v[236:239], v[60:63], v[156:159]
    s_waitcnt lgkmcnt(6)
    v_mfma_f32_16x16x32_bf16 v[160:163], v[240:243], a[224:227], v[160:163]
    s_waitcnt lgkmcnt(4)
    ds_read_b64_tr_b16 v[232:233], v223 offset:8
    v_mfma_f32_16x16x32_bf16 v[160:163], v[244:247], a[240:243], v[160:163]
    v_cvt_pk_bf16_f32 v130, v144, v145
    v_cvt_pk_bf16_f32 v131, v146, v147
    v_mfma_f32_16x16x32_bf16 v[164:167], v[240:243], a[228:231], v[164:167]
    ds_read_b64_tr_b16 v[234:235], v223 offset:4104
    v_cvt_pk_bf16_f32 v134, v148, v149
    v_mfma_f32_16x16x32_bf16 v[164:167], v[244:247], a[244:247], v[164:167]
    v_cvt_pk_bf16_f32 v135, v150, v151
    v_cvt_pk_bf16_f32 v138, v152, v153
    v_mfma_f32_16x16x32_bf16 v[168:171], v[240:243], a[232:235], v[168:171]
    ds_read_b64_tr_b16 v[236:237], v223 offset:8200
    v_cvt_pk_bf16_f32 v139, v154, v155
    v_mfma_f32_16x16x32_bf16 v[168:171], v[244:247], a[248:251], v[168:171]
    v_cvt_pk_bf16_f32 v142, v156, v157
    v_cvt_pk_bf16_f32 v143, v158, v159
    v_mfma_f32_16x16x32_bf16 v[172:175], v[240:243], a[236:239], v[172:175]
    ds_read_b64_tr_b16 v[238:239], v223 offset:12296
    v_mfma_f32_16x16x32_bf16 v[172:175], v[244:247], a[252:255], v[172:175]
    s_waitcnt lgkmcnt(6)
    v_mfma_f32_16x16x32_bf16 v[160:163], v[224:227], v[32:35], v[160:163]
    s_waitcnt lgkmcnt(4)
    ds_read_b64_tr_b16 v[240:241], v223 offset:16392
    v_mfma_f32_16x16x32_bf16 v[160:163], v[228:231], v[48:51], v[160:163]
    v_mfma_f32_16x16x32_bf16 v[164:167], v[224:227], v[36:39], v[164:167]
    ds_read_b64_tr_b16 v[242:243], v223 offset:20488
    v_mfma_f32_16x16x32_bf16 v[164:167], v[228:231], v[52:55], v[164:167]
    v_mfma_f32_16x16x32_bf16 v[168:171], v[224:227], v[40:43], v[168:171]
    ds_read_b64_tr_b16 v[244:245], v223 offset:24584
    v_mfma_f32_16x16x32_bf16 v[168:171], v[228:231], v[56:59], v[168:171]
    v_mfma_f32_16x16x32_bf16 v[172:175], v[224:227], v[44:47], v[172:175]
    ds_read_b64_tr_b16 v[246:247], v223 offset:28680
    v_mfma_f32_16x16x32_bf16 v[172:175], v[228:231], v[60:63], v[172:175]
    s_waitcnt lgkmcnt(6)
    v_mfma_f32_16x16x32_bf16 v[176:179], v[232:235], a[224:227], v[176:179]
    s_waitcnt lgkmcnt(4)
    ds_read_b128 a[128:131], v2 offset:49152
    v_mfma_f32_16x16x32_bf16 v[176:179], v[236:239], a[240:243], v[176:179]
    ds_read_b128 a[132:135], v3 offset:49152
    v_cvt_pk_bf16_f32 v160, v160, v161
    v_mfma_f32_16x16x32_bf16 v[180:183], v[232:235], a[228:231], v[180:183]
    ds_read_b128 a[136:139], v4 offset:49152
    v_cvt_pk_bf16_f32 v161, v162, v163
    v_mfma_f32_16x16x32_bf16 v[180:183], v[236:239], a[244:247], v[180:183]
    ds_read_b128 a[140:143], v5 offset:49152
    v_cvt_pk_bf16_f32 v164, v164, v165
    v_mfma_f32_16x16x32_bf16 v[184:187], v[232:235], a[232:235], v[184:187]
    ds_read_b128 a[144:147], v2 offset:53248
    v_cvt_pk_bf16_f32 v165, v166, v167
    v_mfma_f32_16x16x32_bf16 v[184:187], v[236:239], a[248:251], v[184:187]
    ds_read_b128 a[148:151], v3 offset:53248
    v_cvt_pk_bf16_f32 v168, v168, v169
    v_mfma_f32_16x16x32_bf16 v[188:191], v[232:235], a[236:239], v[188:191]
    ds_read_b128 a[152:155], v4 offset:53248
    v_cvt_pk_bf16_f32 v169, v170, v171
    v_mfma_f32_16x16x32_bf16 v[188:191], v[236:239], a[252:255], v[188:191]
    s_waitcnt lgkmcnt(9)
    ds_read_b128 a[156:159], v5 offset:53248
    v_cvt_pk_bf16_f32 v172, v172, v173
    v_mfma_f32_16x16x32_bf16 v[176:179], v[240:243], v[32:35], v[176:179]
    s_waitcnt lgkmcnt(8)
    ds_read_b128 a[160:163], v2 offset:57344
    v_cvt_pk_bf16_f32 v173, v174, v175
    v_mfma_f32_16x16x32_bf16 v[176:179], v[244:247], v[48:51], v[176:179]
    ds_read_b128 a[164:167], v3 offset:57344
    v_mfma_f32_16x16x32_bf16 v[180:183], v[240:243], v[36:39], v[180:183]
    ds_read_b128 a[168:171], v4 offset:57344
    v_mfma_f32_16x16x32_bf16 v[180:183], v[244:247], v[52:55], v[180:183]
    ds_read_b128 a[172:175], v5 offset:57344
    v_mfma_f32_16x16x32_bf16 v[184:187], v[240:243], v[40:43], v[184:187]
    ds_read_b128 a[176:179], v2 offset:61440
    v_mfma_f32_16x16x32_bf16 v[184:187], v[244:247], v[56:59], v[184:187]
    ds_read_b128 a[180:183], v3 offset:61440
    v_mfma_f32_16x16x32_bf16 v[188:191], v[240:243], v[44:47], v[188:191]
    ds_read_b128 a[184:187], v4 offset:61440
    v_mfma_f32_16x16x32_bf16 v[188:191], v[244:247], v[60:63], v[188:191]
    ds_read_b128 a[188:191], v5 offset:61440
    v_cvt_pk_bf16_f32 v162, v176, v177
    v_cvt_pk_bf16_f32 v163, v178, v179
    v_cvt_pk_bf16_f32 v166, v180, v181
    v_cvt_pk_bf16_f32 v167, v182, v183
    v_cvt_pk_bf16_f32 v170, v184, v185
    v_cvt_pk_bf16_f32 v171, v186, v187
    s_nop 0
    v_cvt_pk_bf16_f32 v174, v188, v189
    v_cvt_pk_bf16_f32 v175, v190, v191
    s_waitcnt lgkmcnt(15)
    v_mfma_f32_16x16x32_bf16 v[80:83], a[128:131], v[64:67], 0
    s_waitcnt lgkmcnt(14)
    s_add_u32 s41, s40, 65536
    s_add_u32 s42, s40, 49152
    v_mfma_f32_16x16x32_bf16 v[80:83], a[132:135], v[96:99], v[80:83]
    s_waitcnt lgkmcnt(13)
    s_and_b32 s37, s7, 3
    s_cmp_lt_u32 s7, 4
    v_mfma_f32_16x16x32_bf16 v[80:83], a[136:139], v[128:131], v[80:83]
    s_waitcnt lgkmcnt(12)
    s_cselect_b32 s36, 32, 36
    s_cselect_b32 s8, s64, s68
    v_mfma_f32_16x16x32_bf16 v[80:83], a[140:143], v[160:163], v[80:83]
    s_cselect_b32 s9, s65, s69
    s_cselect_b32 s38, 8, 32
    v_mfma_f32_16x16x32_bf16 v[84:87], a[128:131], v[68:71], 0
    s_mov_b32 s11, 0x00020000
    s_lshl_b32 s39, s5, 4
    v_mfma_f32_16x16x32_bf16 v[84:87], a[132:135], v[100:103], v[84:87]
    s_min_u32 s52, s7, 4
    s_add_u32 s39, s39, s52
    v_mfma_f32_16x16x32_bf16 v[84:87], a[136:139], v[132:135], v[84:87]
    s_lshl_b32 s39, s39, 7
    s_mul_i32 s37, s37, s36
    v_mfma_f32_16x16x32_bf16 v[84:87], a[140:143], v[164:167], v[84:87]
    s_add_u32 s10, s37, s36
    s_mul_i32 s10, s10, 36864
    v_mfma_f32_16x16x32_bf16 v[88:91], a[128:131], v[72:75], 0
    s_add_u32 s78, s37, s3
    s_mul_i32 s78, s78, 36864
    v_mfma_f32_16x16x32_bf16 v[88:91], a[132:135], v[104:107], v[88:91]
    s_mul_i32 s52, s6, 288
    s_add_u32 s78, s78, s52
    v_mfma_f32_16x16x32_bf16 v[88:91], a[136:139], v[136:139], v[88:91]
    s_mul_i32 s79, s3, 9216
    s_add_u32 s79, s79, 49152
    v_mfma_f32_16x16x32_bf16 v[88:91], a[140:143], v[168:171], v[88:91]
    v_mfma_f32_16x16x32_bf16 v[92:95], a[128:131], v[76:79], 0
    v_mov_b32 v240, 0
    v_mov_b32 v241, 0
    v_mfma_f32_16x16x32_bf16 v[92:95], a[132:135], v[108:111], v[92:95]
    v_mov_b32 v242, 0
    v_mov_b32 v243, 0
    v_mfma_f32_16x16x32_bf16 v[92:95], a[136:139], v[140:143], v[92:95]
    v_mfma_f32_16x16x32_bf16 v[92:95], a[140:143], v[172:175], v[92:95]
    v_max3_f32 v32, v80, v81, v82
    v_max_f32 v32, v32, v83
    v_max3_f32 v33, v84, v85, v86
    v_max_f32 v33, v33, v87
    v_max3_f32 v34, v88, v89, v90
    v_max_f32 v34, v34, v91
    s_nop 1
    v_max3_f32 v35, v92, v93, v94
    v_max_f32 v35, v35, v95
L_at_negm:
    v_mov_b32 v36, v32
    v_mov_b32 v37, v33
    v_mov_b32 v38, v34
    v_mov_b32 v39, v35
    v_permlane16_swap_b32 v32, v36
    v_permlane16_swap_b32 v33, v37
    v_permlane16_swap_b32 v34, v38
    v_permlane16_swap_b32 v35, v39
    v_max_f32 v32, v32, v36
    v_max_f32 v33, v33, v37
    v_max_f32 v34, v34, v38
    v_max_f32 v35, v35, v39
    v_mov_b32 v36, v32
    v_mov_b32 v37, v33
    v_mov_b32 v38, v34
    v_mov_b32 v39, v35
    v_permlane32_swap_b32 v32, v36
    v_permlane32_swap_b32 v33, v37
    v_permlane32_swap_b32 v34, v38
    v_permlane32_swap_b32 v35, v39
    v_max_f32 v32, v32, v36
    v_max_f32 v33, v33, v37
    v_max_f32 v34, v34, v38
    v_max_f32 v35, v35, v39
    v_sub_f32 v224, 0, v32
    v_sub_f32 v225, 0, v32
    v_sub_f32 v226, 0, v32
    v_sub_f32 v227, 0, v32
    v_sub_f32 v228, 0, v33
    v_sub_f32 v229, 0, v33
    v_sub_f32 v230, 0, v33
    v_sub_f32 v231, 0, v33
    v_sub_f32 v232, 0, v34
    v_sub_f32 v233, 0, v34
    v_sub_f32 v234, 0, v34
    v_sub_f32 v235, 0, v34
    v_sub_f32 v236, 0, v35
    v_sub_f32 v237, 0, v35
    v_sub_f32 v238, 0, v35
    v_sub_f32 v239, 0, v35
    s_mov_b32 s43, 0
    v_mfma_f32_16x16x32_bf16 v[80:83], a[128:131], v[64:67], v[224:227]
    v_mov_b32 v248, 0
    v_mfma_f32_16x16x32_bf16 v[80:83], a[132:135], v[96:99], v[80:83]
    v_mov_b32 v249, 0
    v_mfma_f32_16x16x32_bf16 v[80:83], a[136:139], v[128:131], v[80:83]
    v_mov_b32 v250, 0
    v_mfma_f32_16x16x32_bf16 v[80:83], a[140:143], v[160:163], v[80:83]
    v_mov_b32 v251, 0
    v_mfma_f32_16x16x32_bf16 v[84:87], a[140:143], v[164:167], v[228:231]
    v_mov_b32 v252, 0
    v_mfma_f32_16x16x32_bf16 v[84:87], a[136:139], v[132:135], v[84:87]
    v_mov_b32 v253, 0
    v_mfma_f32_16x16x32_bf16 v[84:87], a[132:135], v[100:103], v[84:87]
    v_mov_b32 v254, 0
    v_mfma_f32_16x16x32_bf16 v[84:87], a[128:131], v[68:71], v[84:87]
    v_mov_b32 v255, 0
    v_mfma_f32_16x16x32_bf16 v[88:91], a[128:131], v[72:75], v[232:235]
    v_and_b32 v242, 15, v0
    v_mov_b32 v243, 0x3f803f80
    v_mfma_f32_16x16x32_bf16 v[88:91], a[132:135], v[104:107], v[88:91]
    v_cmp_eq_u32 vcc, 0, v242
    v_mfma_f32_16x16x32_bf16 v[88:91], a[136:139], v[136:139], v[88:91]
    v_mfma_f32_16x16x32_bf16 v[88:91], a[140:143], v[168:171], v[88:91]
    v_cndmask_b32 v244, 0, v243, vcc
    v_cndmask_b32 v245, 0, v243, vcc
    v_mfma_f32_16x16x32_bf16 v[92:95], a[140:143], v[172:175], v[236:239]
    v_cndmask_b32 v246, 0, v243, vcc
    v_cndmask_b32 v247, 0, v243, vcc
    v_mfma_f32_16x16x32_bf16 v[92:95], a[136:139], v[140:143], v[92:95]
    v_mfma_f32_16x16x32_bf16 v[92:95], a[132:135], v[108:111], v[92:95]
    v_mfma_f32_16x16x32_bf16 v[92:95], a[128:131], v[76:79], v[92:95]
    s_waitcnt lgkmcnt(11)
    v_mfma_f32_16x16x32_bf16 v[112:115], a[144:147], v[64:67], v[224:227]
    s_waitcnt lgkmcnt(10)
    v_mfma_f32_16x16x32_bf16 v[112:115], a[148:151], v[96:99], v[112:115]
    s_waitcnt lgkmcnt(9)
    v_exp_f32 v80, v80
    v_mfma_f32_16x16x32_bf16 v[112:115], a[152:155], v[128:131], v[112:115]
    s_waitcnt lgkmcnt(8)
    v_add_f32 v240, v240, v80
    v_mfma_f32_16x16x32_bf16 v[112:115], a[156:159], v[160:163], v[112:115]
    v_exp_f32 v81, v81
    v_mfma_f32_16x16x32_bf16 v[116:119], a[156:159], v[164:167], v[228:231]
    v_add_f32 v240, v240, v81
    v_mfma_f32_16x16x32_bf16 v[116:119], a[152:155], v[132:135], v[116:119]
    v_exp_f32 v82, v82
    v_mfma_f32_16x16x32_bf16 v[116:119], a[148:151], v[100:103], v[116:119]
    v_cvt_pk_bf16_f32 v32, v80, v81
    v_mfma_f32_16x16x32_bf16 v[116:119], a[144:147], v[68:71], v[116:119]
    v_exp_f32 v83, v83
    v_mfma_f32_16x16x32_bf16 v[120:123], a[144:147], v[72:75], v[232:235]
    v_add_f32 v240, v240, v82
    v_mfma_f32_16x16x32_bf16 v[120:123], a[148:151], v[104:107], v[120:123]
    v_exp_f32 v84, v84
    v_mfma_f32_16x16x32_bf16 v[120:123], a[152:155], v[136:139], v[120:123]
    v_add_f32 v240, v240, v83
    v_mfma_f32_16x16x32_bf16 v[120:123], a[156:159], v[168:171], v[120:123]
    v_exp_f32 v85, v85
    v_mfma_f32_16x16x32_bf16 v[124:127], a[156:159], v[172:175], v[236:239]
    v_cvt_pk_bf16_f32 v33, v82, v83
    v_mfma_f32_16x16x32_bf16 v[124:127], a[152:155], v[140:143], v[124:127]
    v_exp_f32 v86, v86
    v_mfma_f32_16x16x32_bf16 v[124:127], a[148:151], v[108:111], v[124:127]
    v_add_f32 v241, v241, v84
    v_mfma_f32_16x16x32_bf16 v[124:127], a[144:147], v[76:79], v[124:127]
    s_waitcnt lgkmcnt(7)
    v_exp_f32 v87, v87
    v_mfma_f32_16x16x32_bf16 v[144:147], a[160:163], v[64:67], v[224:227]
    s_waitcnt lgkmcnt(6)
    v_mfma_f32_16x16x32_bf16 v[144:147], a[164:167], v[96:99], v[144:147]
    s_waitcnt lgkmcnt(5)
    v_exp_f32 v88, v88
    v_mfma_f32_16x16x32_bf16 v[144:147], a[168:171], v[128:131], v[144:147]
    s_waitcnt lgkmcnt(4)
    v_add_f32 v241, v241, v85
    v_mfma_f32_16x16x32_bf16 v[144:147], a[172:175], v[160:163], v[144:147]
    v_exp_f32 v89, v89
    v_mfma_f32_16x16x32_bf16 v[148:151], a[172:175], v[164:167], v[228:231]
    v_cvt_pk_bf16_f32 v36, v84, v85
    v_mfma_f32_16x16x32_bf16 v[148:151], a[168:171], v[132:135], v[148:151]
    v_exp_f32 v90, v90
    v_mfma_f32_16x16x32_bf16 v[148:151], a[164:167], v[100:103], v[148:151]
    v_add_f32 v241, v241, v86
    v_mfma_f32_16x16x32_bf16 v[148:151], a[160:163], v[68:71], v[148:151]
    v_exp_f32 v91, v91
    v_mfma_f32_16x16x32_bf16 v[152:155], a[160:163], v[72:75], v[232:235]
    v_add_f32 v241, v241, v87
    v_mfma_f32_16x16x32_bf16 v[152:155], a[164:167], v[104:107], v[152:155]
    v_exp_f32 v92, v92
    v_mfma_f32_16x16x32_bf16 v[152:155], a[168:171], v[136:139], v[152:155]
    v_cvt_pk_bf16_f32 v37, v86, v87
    v_mfma_f32_16x16x32_bf16 v[152:155], a[172:175], v[168:171], v[152:155]
    v_exp_f32 v93, v93
    v_mfma_f32_16x16x32_bf16 v[156:159], a[172:175], v[172:175], v[236:239]
    v_cvt_pk_bf16_f32 v40, v88, v89
    v_mfma_f32_16x16x32_bf16 v[156:159], a[168:171], v[140:143], v[156:159]
    v_exp_f32 v94, v94
    v_mfma_f32_16x16x32_bf16 v[156:159], a[164:167], v[108:111], v[156:159]
    v_cvt_pk_bf16_f32 v41, v90, v91
    v_mfma_f32_16x16x32_bf16 v[156:159], a[160:163], v[76:79], v[156:159]
    s_waitcnt lgkmcnt(3)
    v_exp_f32 v95, v95
    v_mfma_f32_16x16x32_bf16 v[176:179], a[176:179], v[64:67], v[224:227]
    s_waitcnt lgkmcnt(2)
    v_mfma_f32_16x16x32_bf16 v[176:179], a[180:183], v[96:99], v[176:179]
    s_waitcnt lgkmcnt(1)
    v_exp_f32 v112, v112
    v_mfma_f32_16x16x32_bf16 v[176:179], a[184:187], v[128:131], v[176:179]
    s_waitcnt lgkmcnt(0)
    v_cvt_pk_bf16_f32 v44, v92, v93
    v_mfma_f32_16x16x32_bf16 v[176:179], a[188:191], v[160:163], v[176:179]
    v_exp_f32 v113, v113
    v_mfma_f32_16x16x32_bf16 v[180:183], a[188:191], v[164:167], v[228:231]
    v_cvt_pk_bf16_f32 v45, v94, v95
    v_mfma_f32_16x16x32_bf16 v[180:183], a[184:187], v[132:135], v[180:183]
    v_exp_f32 v114, v114
    v_mfma_f32_16x16x32_bf16 v[180:183], a[180:183], v[100:103], v[180:183]
    v_add_f32 v240, v240, v112
    v_mfma_f32_16x16x32_bf16 v[180:183], a[176:179], v[68:71], v[180:183]
    v_exp_f32 v115, v115
    v_mfma_f32_16x16x32_bf16 v[184:187], a[176:179], v[72:75], v[232:235]
    v_add_f32 v240, v240, v113
    v_mfma_f32_16x16x32_bf16 v[184:187], a[180:183], v[104:107], v[184:187]
    v_exp_f32 v116, v116
    v_mfma_f32_16x16x32_bf16 v[184:187], a[184:187], v[136:139], v[184:187]
    v_cvt_pk_bf16_f32 v34, v112, v113
    v_mfma_f32_16x16x32_bf16 v[184:187], a[188:191], v[168:171], v[184:187]
    v_exp_f32 v117, v117
    v_mfma_f32_16x16x32_bf16 v[188:191], a[188:191], v[172:175], v[236:239]
    v_add_f32 v240, v240, v114
    v_mfma_f32_16x16x32_bf16 v[188:191], a[184:187], v[140:143], v[188:191]
    v_exp_f32 v118, v118
    v_mfma_f32_16x16x32_bf16 v[188:191], a[180:183], v[108:111], v[188:191]
    v_add_f32 v240, v240, v115
    v_mfma_f32_16x16x32_bf16 v[188:191], a[176:179], v[76:79], v[188:191]
    v_exp_f32 v119, v119
    v_exp_f32 v120, v120
    v_cvt_pk_bf16_f32 v35, v114, v115
    v_exp_f32 v121, v121
    v_add_f32 v241, v241, v116
    v_exp_f32 v122, v122
    v_add_f32 v241, v241, v117
    v_exp_f32 v123, v123
    v_cvt_pk_bf16_f32 v38, v116, v117
    v_exp_f32 v124, v124
    v_add_f32 v241, v241, v118
    v_exp_f32 v125, v125
    v_add_f32 v241, v241, v119
    v_exp_f32 v126, v126
    v_cvt_pk_bf16_f32 v39, v118, v119
    v_exp_f32 v127, v127
    v_exp_f32 v144, v144
    v_cvt_pk_bf16_f32 v42, v120, v121
    v_exp_f32 v145, v145
    v_cvt_pk_bf16_f32 v43, v122, v123
    v_exp_f32 v146, v146
    v_cvt_pk_bf16_f32 v46, v124, v125
    v_cvt_pk_bf16_f32 v47, v126, v127
    v_exp_f32 v147, v147
    v_add_f32 v240, v240, v144
    v_add_f32 v240, v240, v145
    v_exp_f32 v148, v148
    v_cvt_pk_bf16_f32 v48, v144, v145
    v_add_f32 v240, v240, v146
    s_waitcnt lgkmcnt(0)
    s_waitcnt vmcnt(16)
    v_exp_f32 v149, v149
    s_barrier
    v_add_f32 v240, v240, v147
    v_exp_f32 v150, v150
    ds_read_b128 a[128:131], v2 offset:32768
    v_cvt_pk_bf16_f32 v49, v146, v147
    v_exp_f32 v151, v151
    ds_read_b128 a[132:135], v3 offset:32768
    v_add_f32 v241, v241, v148
    v_exp_f32 v152, v152
    v_add_f32 v241, v241, v149
    v_cvt_pk_bf16_f32 v52, v148, v149
    s_add_u32 m0, s40, 147456
    v_exp_f32 v153, v153
    buffer_load_dwordx4 v14, s[20:23], s41 offen offset:0 lds
    v_exp_f32 v154, v154
    ds_read_b128 a[136:139], v4 offset:32768
    v_add_f32 v241, v241, v150
    v_exp_f32 v155, v155
    ds_read_b128 a[140:143], v5 offset:32768
    v_add_f32 v241, v241, v151
    v_exp_f32 v156, v156
    v_cvt_pk_bf16_f32 v53, v150, v151
    v_cvt_pk_bf16_f32 v56, v152, v153
    v_exp_f32 v157, v157
    ds_read_b128 a[144:147], v2 offset:36864
    v_cvt_pk_bf16_f32 v57, v154, v155
    v_exp_f32 v158, v158
    ds_read_b128 a[148:151], v3 offset:36864
    v_cvt_pk_bf16_f32 v60, v156, v157
    v_exp_f32 v159, v159
    s_nop 0
    v_cvt_pk_bf16_f32 v61, v158, v159
    v_exp_f32 v176, v176
    ds_read_b128 a[152:155], v4 offset:36864
    v_add_f32 v240, v240, v176
    v_exp_f32 v177, v177
    buffer_load_dwordx4 v15, s[20:23], s41 offen offset:1024 lds
    v_exp_f32 v178, v178
    ds_read_b128 a[156:159], v5 offset:36864
    v_add_f32 v240, v240, v177
    v_exp_f32 v179, v179
    v_cvt_pk_bf16_f32 v50, v176, v177
    v_add_f32 v240, v240, v178
    v_exp_f32 v180, v180
    ds_read_b128 a[160:163], v2 offset:40960
    v_add_f32 v240, v240, v179
    v_exp_f32 v181, v181
    ds_read_b128 a[164:167], v3 offset:40960
    v_cvt_pk_bf16_f32 v51, v178, v179
    v_exp_f32 v182, v182
    v_add_f32 v241, v241, v180
    v_add_f32 v241, v241, v181
    v_exp_f32 v183, v183
    ds_read_b128 a[168:171], v4 offset:40960
    v_cvt_pk_bf16_f32 v54, v180, v181
    ds_read_b128 a[172:175], v5 offset:40960
    v_add_f32 v241, v241, v182
    v_add_f32 v241, v241, v183
    v_cvt_pk_bf16_f32 v55, v182, v183
    ds_read_b128 a[176:179], v2 offset:45056
L_at_loop:
    s_waitcnt lgkmcnt(12)
    v_mfma_f32_16x16x32_bf16 v[80:83], a[128:131], v[64:67], v[224:227]
    s_waitcnt lgkmcnt(11)
    buffer_load_dwordx4 v16, s[20:23], s41 offen offset:2048 lds
    v_mfma_f32_16x16x32_bf16 v[80:83], a[132:135], v[96:99], v[80:83]
    s_waitcnt lgkmcnt(10)
    v_exp_f32 v184, v184
    v_mfma_f32_16x16x32_bf16 v[80:83], a[136:139], v[128:131], v[80:83]
    s_waitcnt lgkmcnt(9)
    ds_read_b128 a[180:183], v3 offset:45056
    v_mfma_f32_16x16x32_bf16 v[80:83], a[140:143], v[160:163], v[80:83]
    v_exp_f32 v185, v185
    v_mfma_f32_16x16x32_bf16 v[84:87], a[140:143], v[164:167], v[228:231]
    v_cvt_pk_bf16_f32 v58, v184, v185
    v_mfma_f32_16x16x32_bf16 v[84:87], a[136:139], v[132:135], v[84:87]
    v_exp_f32 v186, v186
    v_mfma_f32_16x16x32_bf16 v[84:87], a[132:135], v[100:103], v[84:87]
    ds_read_b128 a[184:187], v4 offset:45056
    v_mfma_f32_16x16x32_bf16 v[84:87], a[128:131], v[68:71], v[84:87]
    v_exp_f32 v187, v187
    v_mfma_f32_16x16x32_bf16 v[88:91], a[128:131], v[72:75], v[232:235]
    ds_read_b128 a[188:191], v5 offset:45056
    v_cvt_pk_bf16_f32 v59, v186, v187
    v_mfma_f32_16x16x32_bf16 v[88:91], a[132:135], v[104:107], v[88:91]
    v_exp_f32 v188, v188
    v_mfma_f32_16x16x32_bf16 v[88:91], a[136:139], v[136:139], v[88:91]
    v_mfma_f32_16x16x32_bf16 v[88:91], a[140:143], v[168:171], v[88:91]
    v_exp_f32 v189, v189
    v_mfma_f32_16x16x32_bf16 v[92:95], a[140:143], v[172:175], v[236:239]
    ds_read_b64_tr_b16 a[192:193], v6 offset:49152
    v_cvt_pk_bf16_f32 v62, v188, v189
    v_mfma_f32_16x16x32_bf16 v[92:95], a[136:139], v[140:143], v[92:95]
    v_exp_f32 v190, v190
    v_mfma_f32_16x16x32_bf16 v[92:95], a[132:135], v[108:111], v[92:95]
    ds_read_b64_tr_b16 a[194:195], v6 offset:53248
    v_mfma_f32_16x16x32_bf16 v[92:95], a[128:131], v[76:79], v[92:95]
    s_waitcnt lgkmcnt(13)
    v_exp_f32 v191, v191
    v_mfma_f32_16x16x32_bf16 v[112:115], a[144:147], v[64:67], v[224:227]
    s_waitcnt lgkmcnt(12)
    buffer_load_dwordx4 v17, s[20:23], s41 offen offset:3072 lds
    v_cvt_pk_bf16_f32 v63, v190, v191
    v_mfma_f32_16x16x32_bf16 v[112:115], a[148:151], v[96:99], v[112:115]
    s_waitcnt lgkmcnt(11)
    s_add_u32 s41, s41, 16384
    v_exp_f32 v80, v80
    v_mfma_f32_16x16x32_bf16 v[112:115], a[152:155], v[128:131], v[112:115]
    s_waitcnt lgkmcnt(10)
    ds_read_b64_tr_b16 a[196:197], v6 offset:57344
    v_add_f32 v240, v240, v80
    v_mfma_f32_16x16x32_bf16 v[112:115], a[156:159], v[160:163], v[112:115]
    v_exp_f32 v81, v81
    v_mfma_f32_16x16x32_bf16 v[116:119], a[156:159], v[164:167], v[228:231]
    ds_read_b64_tr_b16 a[198:199], v6 offset:61440
    v_add_f32 v240, v240, v81
    v_mfma_f32_16x16x32_bf16 v[116:119], a[152:155], v[132:135], v[116:119]
    v_exp_f32 v82, v82
    v_mfma_f32_16x16x32_bf16 v[116:119], a[148:151], v[100:103], v[116:119]
    ds_read_b64_tr_b16 a[200:201], v7 offset:49152
    v_cvt_pk_bf16_f32 v192, v80, v81
    v_mfma_f32_16x16x32_bf16 v[116:119], a[144:147], v[68:71], v[116:119]
    s_mov_b32 m0, 1024
    v_exp_f32 v83, v83
    v_mfma_f32_16x16x32_bf16 v[120:123], a[144:147], v[72:75], v[232:235]
    ds_read_b64_tr_b16 a[202:203], v7 offset:53248
    buffer_load_dwordx4 v1, s[64:67], s61 offen lds
    v_add_f32 v240, v240, v82
    v_mfma_f32_16x16x32_bf16 v[120:123], a[148:151], v[104:107], v[120:123]
    v_exp_f32 v84, v84
    v_mfma_f32_16x16x32_bf16 v[120:123], a[152:155], v[136:139], v[120:123]
    ds_read_b64_tr_b16 a[204:205], v7 offset:57344
    v_add_f32 v240, v240, v83
    v_mfma_f32_16x16x32_bf16 v[120:123], a[156:159], v[168:171], v[120:123]
    v_exp_f32 v85, v85
    v_mfma_f32_16x16x32_bf16 v[124:127], a[156:159], v[172:175], v[236:239]
    ds_read_b64_tr_b16 a[206:207], v7 offset:61440
    v_cvt_pk_bf16_f32 v193, v82, v83
    v_mfma_f32_16x16x32_bf16 v[124:127], a[152:155], v[140:143], v[124:127]
    v_exp_f32 v86, v86
    v_mfma_f32_16x16x32_bf16 v[124:127], a[148:151], v[108:111], v[124:127]
    ds_read_b64_tr_b16 a[208:209], v8 offset:49152
    v_add_f32 v241, v241, v84
    v_mfma_f32_16x16x32_bf16 v[124:127], a[144:147], v[76:79], v[124:127]
    s_waitcnt lgkmcnt(15)
    s_add_u32 m0, s40, 32768
    v_exp_f32 v87, v87
    v_mfma_f32_16x16x32_bf16 v[144:147], a[160:163], v[64:67], v[224:227]
    s_waitcnt lgkmcnt(15)
    buffer_load_dwordx4 v18, s[24:27], s42 offen offset:0 lds
    v_mfma_f32_16x16x32_bf16 v[144:147], a[164:167], v[96:99], v[144:147]
    s_waitcnt lgkmcnt(14)
    v_exp_f32 v88, v88
    v_mfma_f32_16x16x32_bf16 v[144:147], a[168:171], v[128:131], v[144:147]
    s_waitcnt lgkmcnt(13)
    ds_read_b64_tr_b16 a[210:211], v8 offset:53248
    v_add_f32 v241, v241, v85
    v_mfma_f32_16x16x32_bf16 v[144:147], a[172:175], v[160:163], v[144:147]
    v_exp_f32 v89, v89
    v_mfma_f32_16x16x32_bf16 v[148:151], a[172:175], v[164:167], v[228:231]
    ds_read_b64_tr_b16 a[212:213], v8 offset:57344
    v_cvt_pk_bf16_f32 v196, v84, v85
    v_mfma_f32_16x16x32_bf16 v[148:151], a[168:171], v[132:135], v[148:151]
    v_exp_f32 v90, v90
    v_mfma_f32_16x16x32_bf16 v[148:151], a[164:167], v[100:103], v[148:151]
    ds_read_b64_tr_b16 a[214:215], v8 offset:61440
    v_add_f32 v241, v241, v86
    v_mfma_f32_16x16x32_bf16 v[148:151], a[160:163], v[68:71], v[148:151]
    v_exp_f32 v91, v91
    v_mfma_f32_16x16x32_bf16 v[152:155], a[160:163], v[72:75], v[232:235]
    ds_read_b64_tr_b16 a[216:217], v9 offset:49152
    v_add_f32 v241, v241, v87
    v_mfma_f32_16x16x32_bf16 v[152:155], a[164:167], v[104:107], v[152:155]
    v_exp_f32 v92, v92
    v_mfma_f32_16x16x32_bf16 v[152:155], a[168:171], v[136:139], v[152:155]
    ds_read_b64_tr_b16 a[218:219], v9 offset:53248
    v_cvt_pk_bf16_f32 v197, v86, v87
    v_mfma_f32_16x16x32_bf16 v[152:155], a[172:175], v[168:171], v[152:155]
    v_exp_f32 v93, v93
    v_mfma_f32_16x16x32_bf16 v[156:159], a[172:175], v[172:175], v[236:239]
    ds_read_b64_tr_b16 a[220:221], v9 offset:57344
    v_cvt_pk_bf16_f32 v200, v88, v89
    v_mfma_f32_16x16x32_bf16 v[156:159], a[168:171], v[140:143], v[156:159]
    v_exp_f32 v94, v94
    v_mfma_f32_16x16x32_bf16 v[156:159], a[164:167], v[108:111], v[156:159]
    ds_read_b64_tr_b16 a[222:223], v9 offset:61440
    v_cvt_pk_bf16_f32 v201, v90, v91
    v_mfma_f32_16x16x32_bf16 v[156:159], a[160:163], v[76:79], v[156:159]
    s_waitcnt lgkmcnt(15)
    v_exp_f32 v95, v95
    v_mfma_f32_16x16x32_bf16 v[176:179], a[176:179], v[64:67], v[224:227]
    s_waitcnt lgkmcnt(15)
    buffer_load_dwordx4 v19, s[24:27], s42 offen offset:1024 lds
    v_mfma_f32_16x16x32_bf16 v[176:179], a[180:183], v[96:99], v[176:179]
    s_waitcnt lgkmcnt(15)
    v_exp_f32 v112, v112
    v_mfma_f32_16x16x32_bf16 v[176:179], a[184:187], v[128:131], v[176:179]
    s_waitcnt lgkmcnt(15)
    ds_read_b64_tr_b16 a[224:225], v10 offset:49152
    v_cvt_pk_bf16_f32 v204, v92, v93
    v_mfma_f32_16x16x32_bf16 v[176:179], a[188:191], v[160:163], v[176:179]
    v_exp_f32 v113, v113
    v_mfma_f32_16x16x32_bf16 v[180:183], a[188:191], v[164:167], v[228:231]
    ds_read_b64_tr_b16 a[226:227], v10 offset:53248
    v_cvt_pk_bf16_f32 v205, v94, v95
    v_mfma_f32_16x16x32_bf16 v[180:183], a[184:187], v[132:135], v[180:183]
    v_exp_f32 v114, v114
    v_mfma_f32_16x16x32_bf16 v[180:183], a[180:183], v[100:103], v[180:183]
    ds_read_b64_tr_b16 a[228:229], v10 offset:57344
    v_add_f32 v240, v240, v112
    v_mfma_f32_16x16x32_bf16 v[180:183], a[176:179], v[68:71], v[180:183]
    v_exp_f32 v115, v115
    v_mfma_f32_16x16x32_bf16 v[184:187], a[176:179], v[72:75], v[232:235]
    ds_read_b64_tr_b16 a[230:231], v10 offset:61440
    v_add_f32 v240, v240, v113
    v_mfma_f32_16x16x32_bf16 v[184:187], a[180:183], v[104:107], v[184:187]
    v_exp_f32 v116, v116
    v_mfma_f32_16x16x32_bf16 v[184:187], a[184:187], v[136:139], v[184:187]
    ds_read_b64_tr_b16 a[232:233], v11 offset:49152
    v_cvt_pk_bf16_f32 v194, v112, v113
    v_mfma_f32_16x16x32_bf16 v[184:187], a[188:191], v[168:171], v[184:187]
    v_exp_f32 v117, v117
    v_mfma_f32_16x16x32_bf16 v[188:191], a[188:191], v[172:175], v[236:239]
    ds_read_b64_tr_b16 a[234:235], v11 offset:53248
    v_add_f32 v240, v240, v114
    v_mfma_f32_16x16x32_bf16 v[188:191], a[184:187], v[140:143], v[188:191]
    v_exp_f32 v118, v118
    v_mfma_f32_16x16x32_bf16 v[188:191], a[180:183], v[108:111], v[188:191]
    ds_read_b64_tr_b16 a[236:237], v11 offset:57344
    v_add_f32 v240, v240, v115
    v_mfma_f32_16x16x32_bf16 v[188:191], a[176:179], v[76:79], v[188:191]
    s_waitcnt lgkmcnt(15)
    v_exp_f32 v119, v119
    v_mfma_f32_16x16x32_bf16 a[0:3], a[192:195], v[32:35], a[0:3]
    s_waitcnt lgkmcnt(15)
    buffer_load_dwordx4 v18, s[24:27], s42 offen offset:2048 lds
    v_mfma_f32_16x16x32_bf16 a[0:3], a[196:199], v[48:51], a[0:3]
    v_exp_f32 v120, v120
    v_mfma_f32_16x16x32_bf16 a[4:7], a[192:195], v[36:39], a[4:7]
    ds_read_b64_tr_b16 a[238:239], v11 offset:61440
    v_cvt_pk_bf16_f32 v195, v114, v115
    v_mfma_f32_16x16x32_bf16 a[4:7], a[196:199], v[52:55], a[4:7]
    v_exp_f32 v121, v121
    v_mfma_f32_16x16x32_bf16 a[8:11], a[192:195], v[40:43], a[8:11]
    ds_read_b64_tr_b16 a[240:241], v12 offset:49152
    v_add_f32 v241, v241, v116
    v_mfma_f32_16x16x32_bf16 a[8:11], a[196:199], v[56:59], a[8:11]
    v_exp_f32 v122, v122
    v_mfma_f32_16x16x32_bf16 a[12:15], a[192:195], v[44:47], a[12:15]
    ds_read_b64_tr_b16 a[242:243], v12 offset:53248
    v_add_f32 v241, v241, v117
    v_mfma_f32_16x16x32_bf16 a[12:15], a[196:199], v[60:63], a[12:15]
    s_waitcnt lgkmcnt(15)
    v_exp_f32 v123, v123
    v_mfma_f32_16x16x32_bf16 a[16:19], a[200:203], v[32:35], a[16:19]
    s_waitcnt lgkmcnt(15)
    ds_read_b64_tr_b16 a[244:245], v12 offset:57344
    v_cvt_pk_bf16_f32 v198, v116, v117
    v_mfma_f32_16x16x32_bf16 a[16:19], a[204:207], v[48:51], a[16:19]
    v_exp_f32 v124, v124
    v_mfma_f32_16x16x32_bf16 a[20:23], a[200:203], v[36:39], a[20:23]
    ds_read_b64_tr_b16 a[246:247], v12 offset:61440
    v_add_f32 v241, v241, v118
    v_mfma_f32_16x16x32_bf16 a[20:23], a[204:207], v[52:55], a[20:23]
    v_exp_f32 v125, v125
    v_mfma_f32_16x16x32_bf16 a[24:27], a[200:203], v[40:43], a[24:27]
    ds_read_b64_tr_b16 a[248:249], v13 offset:49152
    v_add_f32 v241, v241, v119
    v_mfma_f32_16x16x32_bf16 a[24:27], a[204:207], v[56:59], a[24:27]
    v_exp_f32 v126, v126
    v_mfma_f32_16x16x32_bf16 a[28:31], a[200:203], v[44:47], a[28:31]
    ds_read_b64_tr_b16 a[250:251], v13 offset:53248
    v_cvt_pk_bf16_f32 v199, v118, v119
    v_mfma_f32_16x16x32_bf16 a[28:31], a[204:207], v[60:63], a[28:31]
    s_waitcnt lgkmcnt(15)
    v_exp_f32 v127, v127
    v_mfma_f32_16x16x32_bf16 a[32:35], a[208:211], v[32:35], a[32:35]
    s_waitcnt lgkmcnt(15)
    buffer_load_dwordx4 v19, s[24:27], s42 offen offset:3072 lds
    v_mfma_f32_16x16x32_bf16 a[32:35], a[212:215], v[48:51], a[32:35]
    s_add_u32 s42, s42, 16384
    v_exp_f32 v144, v144
    v_mfma_f32_16x16x32_bf16 a[36:39], a[208:211], v[36:39], a[36:39]
    ds_read_b64_tr_b16 a[252:253], v13 offset:57344
    v_cvt_pk_bf16_f32 v202, v120, v121
    v_mfma_f32_16x16x32_bf16 a[36:39], a[212:215], v[52:55], a[36:39]
    v_exp_f32 v145, v145
    v_mfma_f32_16x16x32_bf16 a[40:43], a[208:211], v[40:43], a[40:43]
    ds_read_b64_tr_b16 a[254:255], v13 offset:61440
    v_cvt_pk_bf16_f32 v203, v122, v123
    v_mfma_f32_16x16x32_bf16 a[40:43], a[212:215], v[56:59], a[40:43]
    v_exp_f32 v146, v146
    v_mfma_f32_16x16x32_bf16 a[44:47], a[208:211], v[44:47], a[44:47]
    v_cvt_pk_bf16_f32 v206, v124, v125
    v_cvt_pk_bf16_f32 v207, v126, v127
    v_mfma_f32_16x16x32_bf16 a[44:47], a[212:215], v[60:63], a[44:47]
    s_waitcnt lgkmcnt(15)
    v_exp_f32 v147, v147
    v_mfma_f32_16x16x32_bf16 a[48:51], a[216:219], v[32:35], a[48:51]
    s_waitcnt lgkmcnt(15)
    v_add_f32 v240, v240, v144
    v_add_f32 v240, v240, v145
    v_mfma_f32_16x16x32_bf16 a[48:51], a[220:223], v[48:51], a[48:51]
    v_exp_f32 v148, v148
    v_mfma_f32_16x16x32_bf16 a[52:55], a[216:219], v[36:39], a[52:55]
    v_cvt_pk_bf16_f32 v208, v144, v145
    v_add_f32 v240, v240, v146
    v_mfma_f32_16x16x32_bf16 a[52:55], a[220:223], v[52:55], a[52:55]
    s_waitcnt lgkmcnt(0)
    s_waitcnt vmcnt(17)
    v_exp_f32 v149, v149
    v_mfma_f32_16x16x32_bf16 a[56:59], a[216:219], v[40:43], a[56:59]
    s_barrier
    v_add_f32 v240, v240, v147
    v_mfma_f32_16x16x32_bf16 a[56:59], a[220:223], v[56:59], a[56:59]
    v_exp_f32 v150, v150
    v_mfma_f32_16x16x32_bf16 a[60:63], a[216:219], v[44:47], a[60:63]
    ds_read_b128 a[128:131], v2 offset:16384
    v_cvt_pk_bf16_f32 v209, v146, v147
    v_mfma_f32_16x16x32_bf16 a[60:63], a[220:223], v[60:63], a[60:63]
    v_exp_f32 v151, v151
    v_mfma_f32_16x16x32_bf16 a[64:67], a[224:227], v[32:35], a[64:67]
    ds_read_b128 a[132:135], v3 offset:16384
    v_add_f32 v241, v241, v148
    v_mfma_f32_16x16x32_bf16 a[64:67], a[228:231], v[48:51], a[64:67]
    v_exp_f32 v152, v152
    v_mfma_f32_16x16x32_bf16 a[68:71], a[224:227], v[36:39], a[68:71]
    v_add_f32 v241, v241, v149
    v_cvt_pk_bf16_f32 v212, v148, v149
    v_mfma_f32_16x16x32_bf16 a[68:71], a[228:231], v[52:55], a[68:71]
    s_add_u32 m0, s40, 131072
    v_exp_f32 v153, v153
    v_mfma_f32_16x16x32_bf16 a[72:75], a[224:227], v[40:43], a[72:75]
    buffer_load_dwordx4 v14, s[20:23], s41 offen offset:0 lds
    v_mfma_f32_16x16x32_bf16 a[72:75], a[228:231], v[56:59], a[72:75]
    v_exp_f32 v154, v154
    v_mfma_f32_16x16x32_bf16 a[76:79], a[224:227], v[44:47], a[76:79]
    ds_read_b128 a[136:139], v4 offset:16384
    v_add_f32 v241, v241, v150
    v_mfma_f32_16x16x32_bf16 a[76:79], a[228:231], v[60:63], a[76:79]
    v_exp_f32 v155, v155
    v_mfma_f32_16x16x32_bf16 a[80:83], a[232:235], v[32:35], a[80:83]
    ds_read_b128 a[140:143], v5 offset:16384
    v_add_f32 v241, v241, v151
    v_mfma_f32_16x16x32_bf16 a[80:83], a[236:239], v[48:51], a[80:83]
    v_exp_f32 v156, v156
    v_mfma_f32_16x16x32_bf16 a[84:87], a[232:235], v[36:39], a[84:87]
    v_cvt_pk_bf16_f32 v213, v150, v151
    v_cvt_pk_bf16_f32 v216, v152, v153
    v_mfma_f32_16x16x32_bf16 a[84:87], a[236:239], v[52:55], a[84:87]
    v_exp_f32 v157, v157
    v_mfma_f32_16x16x32_bf16 a[88:91], a[232:235], v[40:43], a[88:91]
    ds_read_b128 a[144:147], v2 offset:20480
    v_cvt_pk_bf16_f32 v217, v154, v155
    v_mfma_f32_16x16x32_bf16 a[88:91], a[236:239], v[56:59], a[88:91]
    v_exp_f32 v158, v158
    v_mfma_f32_16x16x32_bf16 a[92:95], a[232:235], v[44:47], a[92:95]
    ds_read_b128 a[148:151], v3 offset:20480
    v_cvt_pk_bf16_f32 v220, v156, v157
    v_mfma_f32_16x16x32_bf16 a[92:95], a[236:239], v[60:63], a[92:95]
    v_exp_f32 v159, v159
    v_mfma_f32_16x16x32_bf16 a[96:99], a[240:243], v[32:35], a[96:99]
    v_cvt_pk_bf16_f32 v221, v158, v159
    v_mfma_f32_16x16x32_bf16 a[96:99], a[244:247], v[48:51], a[96:99]
    v_exp_f32 v176, v176
    v_mfma_f32_16x16x32_bf16 a[100:103], a[240:243], v[36:39], a[100:103]
    ds_read_b128 a[152:155], v4 offset:20480
    v_add_f32 v240, v240, v176
    v_mfma_f32_16x16x32_bf16 a[100:103], a[244:247], v[52:55], a[100:103]
    v_exp_f32 v177, v177
    v_mfma_f32_16x16x32_bf16 a[104:107], a[240:243], v[40:43], a[104:107]
    buffer_load_dwordx4 v15, s[20:23], s41 offen offset:1024 lds
    v_mfma_f32_16x16x32_bf16 a[104:107], a[244:247], v[56:59], a[104:107]
    v_exp_f32 v178, v178
    v_mfma_f32_16x16x32_bf16 a[108:111], a[240:243], v[44:47], a[108:111]
    ds_read_b128 a[156:159], v5 offset:20480
    v_add_f32 v240, v240, v177
    v_mfma_f32_16x16x32_bf16 a[108:111], a[244:247], v[60:63], a[108:111]
    v_exp_f32 v179, v179
    v_mfma_f32_16x16x32_bf16 a[112:115], a[248:251], v[32:35], a[112:115]
    v_cvt_pk_bf16_f32 v210, v176, v177
    v_add_f32 v240, v240, v178
    v_mfma_f32_16x16x32_bf16 a[112:115], a[252:255], v[48:51], a[112:115]
    v_exp_f32 v180, v180
    v_mfma_f32_16x16x32_bf16 a[116:119], a[248:251], v[36:39], a[116:119]
    ds_read_b128 a[160:163], v2 offset:24576
    v_add_f32 v240, v240, v179
    v_mfma_f32_16x16x32_bf16 a[116:119], a[252:255], v[52:55], a[116:119]
    v_exp_f32 v181, v181
    v_mfma_f32_16x16x32_bf16 a[120:123], a[248:251], v[40:43], a[120:123]
    ds_read_b128 a[164:167], v3 offset:24576
    v_cvt_pk_bf16_f32 v211, v178, v179
    v_mfma_f32_16x16x32_bf16 a[120:123], a[252:255], v[56:59], a[120:123]
    v_exp_f32 v182, v182
    v_mfma_f32_16x16x32_bf16 a[124:127], a[248:251], v[44:47], a[124:127]
    v_add_f32 v241, v241, v180
    v_add_f32 v241, v241, v181
    v_mfma_f32_16x16x32_bf16 a[124:127], a[252:255], v[60:63], a[124:127]
    v_exp_f32 v183, v183
    v_mfma_f32_16x16x32_bf16 v[248:251], v[244:247], v[44:47], v[248:251]
    ds_read_b128 a[168:171], v4 offset:24576
    v_cvt_pk_bf16_f32 v214, v180, v181
    v_mfma_f32_16x16x32_bf16 v[248:251], v[244:247], v[60:63], v[248:251]
    ds_read_b128 a[172:175], v5 offset:24576
    v_add_f32 v241, v241, v182
    v_mfma_f32_16x16x32_bf16 v[252:255], v[244:247], v[40:43], v[252:255]
    v_add_f32 v241, v241, v183
    v_cvt_pk_bf16_f32 v215, v182, v183
    v_mfma_f32_16x16x32_bf16 v[252:255], v[244:247], v[56:59], v[252:255]
    s_waitcnt lgkmcnt(11)
    ds_read_b128 a[176:179], v2 offset:28672
    v_mfma_f32_16x16x32_bf16 v[80:83], a[128:131], v[64:67], v[224:227]
    s_waitcnt lgkmcnt(11)
    buffer_load_dwordx4 v16, s[20:23], s41 offen offset:2048 lds
    v_mfma_f32_16x16x32_bf16 v[80:83], a[132:135], v[96:99], v[80:83]
    s_waitcnt lgkmcnt(10)
    v_exp_f32 v184, v184
    v_mfma_f32_16x16x32_bf16 v[80:83], a[136:139], v[128:131], v[80:83]
    s_waitcnt lgkmcnt(9)
    ds_read_b128 a[180:183], v3 offset:28672
    v_mfma_f32_16x16x32_bf16 v[80:83], a[140:143], v[160:163], v[80:83]
    v_exp_f32 v185, v185
    v_mfma_f32_16x16x32_bf16 v[84:87], a[140:143], v[164:167], v[228:231]
    v_cvt_pk_bf16_f32 v218, v184, v185
    v_mfma_f32_16x16x32_bf16 v[84:87], a[136:139], v[132:135], v[84:87]
    v_exp_f32 v186, v186
    v_mfma_f32_16x16x32_bf16 v[84:87], a[132:135], v[100:103], v[84:87]
    ds_read_b128 a[184:187], v4 offset:28672
    v_mfma_f32_16x16x32_bf16 v[84:87], a[128:131], v[68:71], v[84:87]
    v_exp_f32 v187, v187
    v_mfma_f32_16x16x32_bf16 v[88:91], a[128:131], v[72:75], v[232:235]
    ds_read_b128 a[188:191], v5 offset:28672
    v_cvt_pk_bf16_f32 v219, v186, v187
    v_mfma_f32_16x16x32_bf16 v[88:91], a[132:135], v[104:107], v[88:91]
    v_exp_f32 v188, v188
    v_mfma_f32_16x16x32_bf16 v[88:91], a[136:139], v[136:139], v[88:91]
    v_mfma_f32_16x16x32_bf16 v[88:91], a[140:143], v[168:171], v[88:91]
    v_exp_f32 v189, v189
    v_mfma_f32_16x16x32_bf16 v[92:95], a[140:143], v[172:175], v[236:239]
    ds_read_b64_tr_b16 a[192:193], v6 offset:32768
    v_cvt_pk_bf16_f32 v222, v188, v189
    v_mfma_f32_16x16x32_bf16 v[92:95], a[136:139], v[140:143], v[92:95]
    v_exp_f32 v190, v190
    v_mfma_f32_16x16x32_bf16 v[92:95], a[132:135], v[108:111], v[92:95]
    ds_read_b64_tr_b16 a[194:195], v6 offset:36864
    v_mfma_f32_16x16x32_bf16 v[92:95], a[128:131], v[76:79], v[92:95]
    s_waitcnt lgkmcnt(13)
    v_exp_f32 v191, v191
    v_mfma_f32_16x16x32_bf16 v[112:115], a[144:147], v[64:67], v[224:227]
    s_waitcnt lgkmcnt(12)
    buffer_load_dwordx4 v17, s[20:23], s41 offen offset:3072 lds
    v_cvt_pk_bf16_f32 v223, v190, v191
    v_mfma_f32_16x16x32_bf16 v[112:115], a[148:151], v[96:99], v[112:115]
    s_waitcnt lgkmcnt(11)
    s_add_u32 s41, s41, 16384
    v_exp_f32 v80, v80
    v_mfma_f32_16x16x32_bf16 v[112:115], a[152:155], v[128:131], v[112:115]
    s_waitcnt lgkmcnt(10)
    ds_read_b64_tr_b16 a[196:197], v6 offset:40960
    v_add_f32 v240, v240, v80
    v_mfma_f32_16x16x32_bf16 v[112:115], a[156:159], v[160:163], v[112:115]
    v_exp_f32 v81, v81
    v_mfma_f32_16x16x32_bf16 v[116:119], a[156:159], v[164:167], v[228:231]
    ds_read_b64_tr_b16 a[198:199], v6 offset:45056
    v_add_f32 v240, v240, v81
    v_mfma_f32_16x16x32_bf16 v[116:119], a[152:155], v[132:135], v[116:119]
    v_exp_f32 v82, v82
    v_mfma_f32_16x16x32_bf16 v[116:119], a[148:151], v[100:103], v[116:119]
    ds_read_b64_tr_b16 a[200:201], v7 offset:32768
    v_cvt_pk_bf16_f32 v32, v80, v81
    v_mfma_f32_16x16x32_bf16 v[116:119], a[144:147], v[68:71], v[116:119]
    v_exp_f32 v83, v83
    v_mfma_f32_16x16x32_bf16 v[120:123], a[144:147], v[72:75], v[232:235]
    ds_read_b64_tr_b16 a[202:203], v7 offset:36864
    v_add_f32 v240, v240, v82
    v_mfma_f32_16x16x32_bf16 v[120:123], a[148:151], v[104:107], v[120:123]
    v_exp_f32 v84, v84
    v_mfma_f32_16x16x32_bf16 v[120:123], a[152:155], v[136:139], v[120:123]
    ds_read_b64_tr_b16 a[204:205], v7 offset:40960
    v_add_f32 v240, v240, v83
    v_mfma_f32_16x16x32_bf16 v[120:123], a[156:159], v[168:171], v[120:123]
    v_exp_f32 v85, v85
    v_mfma_f32_16x16x32_bf16 v[124:127], a[156:159], v[172:175], v[236:239]
    ds_read_b64_tr_b16 a[206:207], v7 offset:45056
    v_cvt_pk_bf16_f32 v33, v82, v83
    v_mfma_f32_16x16x32_bf16 v[124:127], a[152:155], v[140:143], v[124:127]
    v_exp_f32 v86, v86
    v_mfma_f32_16x16x32_bf16 v[124:127], a[148:151], v[108:111], v[124:127]
    ds_read_b64_tr_b16 a[208:209], v8 offset:32768
    v_add_f32 v241, v241, v84
    v_mfma_f32_16x16x32_bf16 v[124:127], a[144:147], v[76:79], v[124:127]
    s_waitcnt lgkmcnt(15)
    s_add_u32 m0, s40, 81920
    v_exp_f32 v87, v87
    v_mfma_f32_16x16x32_bf16 v[144:147], a[160:163], v[64:67], v[224:227]
    s_waitcnt lgkmcnt(15)
    buffer_load_dwordx4 v18, s[24:27], s42 offen offset:0 lds
    v_mfma_f32_16x16x32_bf16 v[144:147], a[164:167], v[96:99], v[144:147]
    s_waitcnt lgkmcnt(14)
    v_exp_f32 v88, v88
    v_mfma_f32_16x16x32_bf16 v[144:147], a[168:171], v[128:131], v[144:147]
    s_waitcnt lgkmcnt(13)
    ds_read_b64_tr_b16 a[210:211], v8 offset:36864
    v_add_f32 v241, v241, v85
    v_mfma_f32_16x16x32_bf16 v[144:147], a[172:175], v[160:163], v[144:147]
    v_exp_f32 v89, v89
    v_mfma_f32_16x16x32_bf16 v[148:151], a[172:175], v[164:167], v[228:231]
    ds_read_b64_tr_b16 a[212:213], v8 offset:40960
    v_cvt_pk_bf16_f32 v36, v84, v85
    v_mfma_f32_16x16x32_bf16 v[148:151], a[168:171], v[132:135], v[148:151]
    v_exp_f32 v90, v90
    v_mfma_f32_16x16x32_bf16 v[148:151], a[164:167], v[100:103], v[148:151]
    ds_read_b64_tr_b16 a[214:215], v8 offset:45056
    v_add_f32 v241, v241, v86
    v_mfma_f32_16x16x32_bf16 v[148:151], a[160:163], v[68:71], v[148:151]
    v_exp_f32 v91, v91
    v_mfma_f32_16x16x32_bf16 v[152:155], a[160:163], v[72:75], v[232:235]
    ds_read_b64_tr_b16 a[216:217], v9 offset:32768
    v_add_f32 v241, v241, v87
    v_mfma_f32_16x16x32_bf16 v[152:155], a[164:167], v[104:107], v[152:155]
    v_exp_f32 v92, v92
    v_mfma_f32_16x16x32_bf16 v[152:155], a[168:171], v[136:139], v[152:155]
    ds_read_b64_tr_b16 a[218:219], v9 offset:36864
    v_cvt_pk_bf16_f32 v37, v86, v87
    v_mfma_f32_16x16x32_bf16 v[152:155], a[172:175], v[168:171], v[152:155]
    v_exp_f32 v93, v93
    v_mfma_f32_16x16x32_bf16 v[156:159], a[172:175], v[172:175], v[236:239]
    ds_read_b64_tr_b16 a[220:221], v9 offset:40960
    v_cvt_pk_bf16_f32 v40, v88, v89
    v_mfma_f32_16x16x32_bf16 v[156:159], a[168:171], v[140:143], v[156:159]
    v_exp_f32 v94, v94
    v_mfma_f32_16x16x32_bf16 v[156:159], a[164:167], v[108:111], v[156:159]
    ds_read_b64_tr_b16 a[222:223], v9 offset:45056
    v_cvt_pk_bf16_f32 v41, v90, v91
    v_mfma_f32_16x16x32_bf16 v[156:159], a[160:163], v[76:79], v[156:159]
    s_waitcnt lgkmcnt(15)
    v_exp_f32 v95, v95
    v_mfma_f32_16x16x32_bf16 v[176:179], a[176:179], v[64:67], v[224:227]
    s_waitcnt lgkmcnt(15)
    buffer_load_dwordx4 v19, s[24:27], s42 offen offset:1024 lds
    v_mfma_f32_16x16x32_bf16 v[176:179], a[180:183], v[96:99], v[176:179]
    s_waitcnt lgkmcnt(15)
    v_exp_f32 v112, v112
    v_mfma_f32_16x16x32_bf16 v[176:179], a[184:187], v[128:131], v[176:179]
    s_waitcnt lgkmcnt(15)
    ds_read_b64_tr_b16 a[224:225], v10 offset:32768
    v_cvt_pk_bf16_f32 v44, v92, v93
    v_mfma_f32_16x16x32_bf16 v[176:179], a[188:191], v[160:163], v[176:179]
    v_exp_f32 v113, v113
    v_mfma_f32_16x16x32_bf16 v[180:183], a[188:191], v[164:167], v[228:231]
    ds_read_b64_tr_b16 a[226:227], v10 offset:36864
    v_cvt_pk_bf16_f32 v45, v94, v95
    v_mfma_f32_16x16x32_bf16 v[180:183], a[184:187], v[132:135], v[180:183]
    v_exp_f32 v114, v114
    v_mfma_f32_16x16x32_bf16 v[180:183], a[180:183], v[100:103], v[180:183]
    ds_read_b64_tr_b16 a[228:229], v10 offset:40960
    v_add_f32 v240, v240, v112
    v_mfma_f32_16x16x32_bf16 v[180:183], a[176:179], v[68:71], v[180:183]
    v_exp_f32 v115, v115
    v_mfma_f32_16x16x32_bf16 v[184:187], a[176:179], v[72:75], v[232:235]
    ds_read_b64_tr_b16 a[230:231], v10 offset:45056
    v_add_f32 v240, v240, v113
    v_mfma_f32_16x16x32_bf16 v[184:187], a[180:183], v[104:107], v[184:187]
    v_exp_f32 v116, v116
    v_mfma_f32_16x16x32_bf16 v[184:187], a[184:187], v[136:139], v[184:187]
    ds_read_b64_tr_b16 a[232:233], v11 offset:32768
    v_cvt_pk_bf16_f32 v34, v112, v113
    v_mfma_f32_16x16x32_bf16 v[184:187], a[188:191], v[168:171], v[184:187]
    v_exp_f32 v117, v117
    v_mfma_f32_16x16x32_bf16 v[188:191], a[188:191], v[172:175], v[236:239]
    ds_read_b64_tr_b16 a[234:235], v11 offset:36864
    v_add_f32 v240, v240, v114
    v_mfma_f32_16x16x32_bf16 v[188:191], a[184:187], v[140:143], v[188:191]
    v_exp_f32 v118, v118
    v_mfma_f32_16x16x32_bf16 v[188:191], a[180:183], v[108:111], v[188:191]
    ds_read_b64_tr_b16 a[236:237], v11 offset:40960
    v_add_f32 v240, v240, v115
    v_mfma_f32_16x16x32_bf16 v[188:191], a[176:179], v[76:79], v[188:191]
    s_waitcnt lgkmcnt(15)
    v_exp_f32 v119, v119
    v_mfma_f32_16x16x32_bf16 a[0:3], a[192:195], v[192:195], a[0:3]
    s_waitcnt lgkmcnt(15)
    buffer_load_dwordx4 v18, s[24:27], s42 offen offset:2048 lds
    v_mfma_f32_16x16x32_bf16 a[0:3], a[196:199], v[208:211], a[0:3]
    v_exp_f32 v120, v120
    v_mfma_f32_16x16x32_bf16 a[4:7], a[192:195], v[196:199], a[4:7]
    ds_read_b64_tr_b16 a[238:239], v11 offset:45056
    v_cvt_pk_bf16_f32 v35, v114, v115
    v_mfma_f32_16x16x32_bf16 a[4:7], a[196:199], v[212:215], a[4:7]
    v_exp_f32 v121, v121
    v_mfma_f32_16x16x32_bf16 a[8:11], a[192:195], v[200:203], a[8:11]
    ds_read_b64_tr_b16 a[240:241], v12 offset:32768
    v_add_f32 v241, v241, v116
    v_mfma_f32_16x16x32_bf16 a[8:11], a[196:199], v[216:219], a[8:11]
    v_exp_f32 v122, v122
    v_mfma_f32_16x16x32_bf16 a[12:15], a[192:195], v[204:207], a[12:15]
    ds_read_b64_tr_b16 a[242:243], v12 offset:36864
    v_add_f32 v241, v241, v117
    v_mfma_f32_16x16x32_bf16 a[12:15], a[196:199], v[220:223], a[12:15]
    s_waitcnt lgkmcnt(15)
    v_exp_f32 v123, v123
    v_mfma_f32_16x16x32_bf16 a[16:19], a[200:203], v[192:195], a[16:19]
    s_waitcnt lgkmcnt(15)
    ds_read_b64_tr_b16 a[244:245], v12 offset:40960
    v_cvt_pk_bf16_f32 v38, v116, v117
    v_mfma_f32_16x16x32_bf16 a[16:19], a[204:207], v[208:211], a[16:19]
    v_exp_f32 v124, v124
    v_mfma_f32_16x16x32_bf16 a[20:23], a[200:203], v[196:199], a[20:23]
    ds_read_b64_tr_b16 a[246:247], v12 offset:45056
    v_add_f32 v241, v241, v118
    v_mfma_f32_16x16x32_bf16 a[20:23], a[204:207], v[212:215], a[20:23]
    v_exp_f32 v125, v125
    v_mfma_f32_16x16x32_bf16 a[24:27], a[200:203], v[200:203], a[24:27]
    ds_read_b64_tr_b16 a[248:249], v13 offset:32768
    v_add_f32 v241, v241, v119
    v_mfma_f32_16x16x32_bf16 a[24:27], a[204:207], v[216:219], a[24:27]
    v_exp_f32 v126, v126
    v_mfma_f32_16x16x32_bf16 a[28:31], a[200:203], v[204:207], a[28:31]
    ds_read_b64_tr_b16 a[250:251], v13 offset:36864
    v_cvt_pk_bf16_f32 v39, v118, v119
    v_mfma_f32_16x16x32_bf16 a[28:31], a[204:207], v[220:223], a[28:31]
    s_waitcnt lgkmcnt(15)
    v_exp_f32 v127, v127
    v_mfma_f32_16x16x32_bf16 a[32:35], a[208:211], v[192:195], a[32:35]
    s_waitcnt lgkmcnt(15)
    buffer_load_dwordx4 v19, s[24:27], s42 offen offset:3072 lds
    v_mfma_f32_16x16x32_bf16 a[32:35], a[212:215], v[208:211], a[32:35]
    s_add_u32 s42, s42, 16384
    v_exp_f32 v144, v144
    v_mfma_f32_16x16x32_bf16 a[36:39], a[208:211], v[196:199], a[36:39]
    ds_read_b64_tr_b16 a[252:253], v13 offset:40960
    v_cvt_pk_bf16_f32 v42, v120, v121
    v_mfma_f32_16x16x32_bf16 a[36:39], a[212:215], v[212:215], a[36:39]
    v_exp_f32 v145, v145
    v_mfma_f32_16x16x32_bf16 a[40:43], a[208:211], v[200:203], a[40:43]
    ds_read_b64_tr_b16 a[254:255], v13 offset:45056
    v_cvt_pk_bf16_f32 v43, v122, v123
    v_mfma_f32_16x16x32_bf16 a[40:43], a[212:215], v[216:219], a[40:43]
    v_exp_f32 v146, v146
    v_mfma_f32_16x16x32_bf16 a[44:47], a[208:211], v[204:207], a[44:47]
    v_cvt_pk_bf16_f32 v46, v124, v125
    v_cvt_pk_bf16_f32 v47, v126, v127
    v_mfma_f32_16x16x32_bf16 a[44:47], a[212:215], v[220:223], a[44:47]
    s_waitcnt lgkmcnt(15)
    v_exp_f32 v147, v147
    v_mfma_f32_16x16x32_bf16 a[48:51], a[216:219], v[192:195], a[48:51]
    s_waitcnt lgkmcnt(15)
    v_add_f32 v240, v240, v144
    v_add_f32 v240, v240, v145
    v_mfma_f32_16x16x32_bf16 a[48:51], a[220:223], v[208:211], a[48:51]
    v_exp_f32 v148, v148
    v_mfma_f32_16x16x32_bf16 a[52:55], a[216:219], v[196:199], a[52:55]
    v_cvt_pk_bf16_f32 v48, v144, v145
    v_add_f32 v240, v240, v146
    v_mfma_f32_16x16x32_bf16 a[52:55], a[220:223], v[212:215], a[52:55]
    s_waitcnt lgkmcnt(0)
    s_waitcnt vmcnt(17)
    v_exp_f32 v149, v149
    v_mfma_f32_16x16x32_bf16 a[56:59], a[216:219], v[200:203], a[56:59]
    s_barrier
    v_add_f32 v240, v240, v147
    v_mfma_f32_16x16x32_bf16 a[56:59], a[220:223], v[216:219], a[56:59]
    v_exp_f32 v150, v150
    v_mfma_f32_16x16x32_bf16 a[60:63], a[216:219], v[204:207], a[60:63]
    ds_read_b128 a[128:131], v2 offset:0
    v_cvt_pk_bf16_f32 v49, v146, v147
    v_mfma_f32_16x16x32_bf16 a[60:63], a[220:223], v[220:223], a[60:63]
    v_exp_f32 v151, v151
    v_mfma_f32_16x16x32_bf16 a[64:67], a[224:227], v[192:195], a[64:67]
    ds_read_b128 a[132:135], v3 offset:0
    v_add_f32 v241, v241, v148
    v_mfma_f32_16x16x32_bf16 a[64:67], a[228:231], v[208:211], a[64:67]
    v_exp_f32 v152, v152
    v_mfma_f32_16x16x32_bf16 a[68:71], a[224:227], v[196:199], a[68:71]
    v_add_f32 v241, v241, v149
    v_cvt_pk_bf16_f32 v52, v148, v149
    v_mfma_f32_16x16x32_bf16 a[68:71], a[228:231], v[212:215], a[68:71]
    s_add_u32 m0, s40, 114688
    v_exp_f32 v153, v153
    v_mfma_f32_16x16x32_bf16 a[72:75], a[224:227], v[200:203], a[72:75]
    buffer_load_dwordx4 v14, s[20:23], s41 offen offset:0 lds
    v_mfma_f32_16x16x32_bf16 a[72:75], a[228:231], v[216:219], a[72:75]
    v_exp_f32 v154, v154
    v_mfma_f32_16x16x32_bf16 a[76:79], a[224:227], v[204:207], a[76:79]
    ds_read_b128 a[136:139], v4 offset:0
    v_add_f32 v241, v241, v150
    v_mfma_f32_16x16x32_bf16 a[76:79], a[228:231], v[220:223], a[76:79]
    v_exp_f32 v155, v155
    v_mfma_f32_16x16x32_bf16 a[80:83], a[232:235], v[192:195], a[80:83]
    ds_read_b128 a[140:143], v5 offset:0
    v_add_f32 v241, v241, v151
    v_mfma_f32_16x16x32_bf16 a[80:83], a[236:239], v[208:211], a[80:83]
    v_exp_f32 v156, v156
    v_mfma_f32_16x16x32_bf16 a[84:87], a[232:235], v[196:199], a[84:87]
    v_cvt_pk_bf16_f32 v53, v150, v151
    v_cvt_pk_bf16_f32 v56, v152, v153
    v_mfma_f32_16x16x32_bf16 a[84:87], a[236:239], v[212:215], a[84:87]
    v_exp_f32 v157, v157
    v_mfma_f32_16x16x32_bf16 a[88:91], a[232:235], v[200:203], a[88:91]
    ds_read_b128 a[144:147], v2 offset:4096
    v_cvt_pk_bf16_f32 v57, v154, v155
    v_mfma_f32_16x16x32_bf16 a[88:91], a[236:239], v[216:219], a[88:91]
    v_exp_f32 v158, v158
    v_mfma_f32_16x16x32_bf16 a[92:95], a[232:235], v[204:207], a[92:95]
    ds_read_b128 a[148:151], v3 offset:4096
    v_cvt_pk_bf16_f32 v60, v156, v157
    v_mfma_f32_16x16x32_bf16 a[92:95], a[236:239], v[220:223], a[92:95]
    v_exp_f32 v159, v159
    v_mfma_f32_16x16x32_bf16 a[96:99], a[240:243], v[192:195], a[96:99]
    v_cvt_pk_bf16_f32 v61, v158, v159
    v_mfma_f32_16x16x32_bf16 a[96:99], a[244:247], v[208:211], a[96:99]
    v_exp_f32 v176, v176
    v_mfma_f32_16x16x32_bf16 a[100:103], a[240:243], v[196:199], a[100:103]
    ds_read_b128 a[152:155], v4 offset:4096
    v_add_f32 v240, v240, v176
    v_mfma_f32_16x16x32_bf16 a[100:103], a[244:247], v[212:215], a[100:103]
    v_exp_f32 v177, v177
    v_mfma_f32_16x16x32_bf16 a[104:107], a[240:243], v[200:203], a[104:107]
    buffer_load_dwordx4 v15, s[20:23], s41 offen offset:1024 lds
    v_mfma_f32_16x16x32_bf16 a[104:107], a[244:247], v[216:219], a[104:107]
    v_exp_f32 v178, v178
    v_mfma_f32_16x16x32_bf16 a[108:111], a[240:243], v[204:207], a[108:111]
    ds_read_b128 a[156:159], v5 offset:4096
    v_add_f32 v240, v240, v177
    v_mfma_f32_16x16x32_bf16 a[108:111], a[244:247], v[220:223], a[108:111]
    v_exp_f32 v179, v179
    v_mfma_f32_16x16x32_bf16 a[112:115], a[248:251], v[192:195], a[112:115]
    v_cvt_pk_bf16_f32 v50, v176, v177
    v_add_f32 v240, v240, v178
    v_mfma_f32_16x16x32_bf16 a[112:115], a[252:255], v[208:211], a[112:115]
    v_exp_f32 v180, v180
    v_mfma_f32_16x16x32_bf16 a[116:119], a[248:251], v[196:199], a[116:119]
    ds_read_b128 a[160:163], v2 offset:8192
    v_add_f32 v240, v240, v179
    v_mfma_f32_16x16x32_bf16 a[116:119], a[252:255], v[212:215], a[116:119]
    v_exp_f32 v181, v181
    v_mfma_f32_16x16x32_bf16 a[120:123], a[248:251], v[200:203], a[120:123]
    ds_read_b128 a[164:167], v3 offset:8192
    v_cvt_pk_bf16_f32 v51, v178, v179
    v_mfma_f32_16x16x32_bf16 a[120:123], a[252:255], v[216:219], a[120:123]
    v_exp_f32 v182, v182
    v_mfma_f32_16x16x32_bf16 a[124:127], a[248:251], v[204:207], a[124:127]
    v_add_f32 v241, v241, v180
    v_add_f32 v241, v241, v181
    v_mfma_f32_16x16x32_bf16 a[124:127], a[252:255], v[220:223], a[124:127]
    v_exp_f32 v183, v183
    v_mfma_f32_16x16x32_bf16 v[248:251], v[244:247], v[204:207], v[248:251]
    ds_read_b128 a[168:171], v4 offset:8192
    v_cvt_pk_bf16_f32 v54, v180, v181
    v_mfma_f32_16x16x32_bf16 v[248:251], v[244:247], v[220:223], v[248:251]
    ds_read_b128 a[172:175], v5 offset:8192
    v_add_f32 v241, v241, v182
    v_mfma_f32_16x16x32_bf16 v[252:255], v[244:247], v[200:203], v[252:255]
    v_add_f32 v241, v241, v183
    v_cvt_pk_bf16_f32 v55, v182, v183
    v_mfma_f32_16x16x32_bf16 v[252:255], v[244:247], v[216:219], v[252:255]
    s_waitcnt lgkmcnt(11)
    ds_read_b128 a[176:179], v2 offset:12288
    v_mfma_f32_16x16x32_bf16 v[80:83], a[128:131], v[64:67], v[224:227]
    s_waitcnt lgkmcnt(11)
    buffer_load_dwordx4 v16, s[20:23], s41 offen offset:2048 lds
    v_mfma_f32_16x16x32_bf16 v[80:83], a[132:135], v[96:99], v[80:83]
    s_waitcnt lgkmcnt(10)
    v_exp_f32 v184, v184
    v_mfma_f32_16x16x32_bf16 v[80:83], a[136:139], v[128:131], v[80:83]
    s_waitcnt lgkmcnt(9)
    ds_read_b128 a[180:183], v3 offset:12288
    v_mfma_f32_16x16x32_bf16 v[80:83], a[140:143], v[160:163], v[80:83]
    v_exp_f32 v185, v185
    v_mfma_f32_16x16x32_bf16 v[84:87], a[140:143], v[164:167], v[228:231]
    v_cvt_pk_bf16_f32 v58, v184, v185
    v_mfma_f32_16x16x32_bf16 v[84:87], a[136:139], v[132:135], v[84:87]
    v_exp_f32 v186, v186
    v_mfma_f32_16x16x32_bf16 v[84:87], a[132:135], v[100:103], v[84:87]
    ds_read_b128 a[184:187], v4 offset:12288
    v_mfma_f32_16x16x32_bf16 v[84:87], a[128:131], v[68:71], v[84:87]
    v_exp_f32 v187, v187
    v_mfma_f32_16x16x32_bf16 v[88:91], a[128:131], v[72:75], v[232:235]
    ds_read_b128 a[188:191], v5 offset:12288
    v_cvt_pk_bf16_f32 v59, v186, v187
    v_mfma_f32_16x16x32_bf16 v[88:91], a[132:135], v[104:107], v[88:91]
    v_exp_f32 v188, v188
    v_mfma_f32_16x16x32_bf16 v[88:91], a[136:139], v[136:139], v[88:91]
    v_mfma_f32_16x16x32_bf16 v[88:91], a[140:143], v[168:171], v[88:91]
    v_exp_f32 v189, v189
    v_mfma_f32_16x16x32_bf16 v[92:95], a[140:143], v[172:175], v[236:239]
    ds_read_b64_tr_b16 a[192:193], v6 offset:16384
    v_cvt_pk_bf16_f32 v62, v188, v189
    v_mfma_f32_16x16x32_bf16 v[92:95], a[136:139], v[140:143], v[92:95]
    v_exp_f32 v190, v190
    v_mfma_f32_16x16x32_bf16 v[92:95], a[132:135], v[108:111], v[92:95]
    ds_read_b64_tr_b16 a[194:195], v6 offset:20480
    v_mfma_f32_16x16x32_bf16 v[92:95], a[128:131], v[76:79], v[92:95]
    s_waitcnt lgkmcnt(13)
    v_exp_f32 v191, v191
    v_mfma_f32_16x16x32_bf16 v[112:115], a[144:147], v[64:67], v[224:227]
    s_waitcnt lgkmcnt(12)
    buffer_load_dwordx4 v17, s[20:23], s41 offen offset:3072 lds
    v_cvt_pk_bf16_f32 v63, v190, v191
    v_mfma_f32_16x16x32_bf16 v[112:115], a[148:151], v[96:99], v[112:115]
    s_waitcnt lgkmcnt(11)
    s_add_u32 s41, s41, 16384
    v_exp_f32 v80, v80
    v_mfma_f32_16x16x32_bf16 v[112:115], a[152:155], v[128:131], v[112:115]
    s_waitcnt lgkmcnt(10)
    ds_read_b64_tr_b16 a[196:197], v6 offset:24576
    v_add_f32 v240, v240, v80
    v_mfma_f32_16x16x32_bf16 v[112:115], a[156:159], v[160:163], v[112:115]
    v_exp_f32 v81, v81
    v_mfma_f32_16x16x32_bf16 v[116:119], a[156:159], v[164:167], v[228:231]
    ds_read_b64_tr_b16 a[198:199], v6 offset:28672
    v_add_f32 v240, v240, v81
    v_mfma_f32_16x16x32_bf16 v[116:119], a[152:155], v[132:135], v[116:119]
    v_exp_f32 v82, v82
    v_mfma_f32_16x16x32_bf16 v[116:119], a[148:151], v[100:103], v[116:119]
    ds_read_b64_tr_b16 a[200:201], v7 offset:16384
    v_cvt_pk_bf16_f32 v192, v80, v81
    v_mfma_f32_16x16x32_bf16 v[116:119], a[144:147], v[68:71], v[116:119]
    s_mov_b32 m0, 1024
    v_exp_f32 v83, v83
    v_mfma_f32_16x16x32_bf16 v[120:123], a[144:147], v[72:75], v[232:235]
    ds_read_b64_tr_b16 a[202:203], v7 offset:20480
    buffer_load_dwordx4 v1, s[68:71], s61 offen lds
    v_add_f32 v240, v240, v82
    v_mfma_f32_16x16x32_bf16 v[120:123], a[148:151], v[104:107], v[120:123]
    s_add_u32 s61, s61, 0x100000
    v_exp_f32 v84, v84
    v_mfma_f32_16x16x32_bf16 v[120:123], a[152:155], v[136:139], v[120:123]
    ds_read_b64_tr_b16 a[204:205], v7 offset:24576
    v_add_f32 v240, v240, v83
    v_mfma_f32_16x16x32_bf16 v[120:123], a[156:159], v[168:171], v[120:123]
    v_exp_f32 v85, v85
    v_mfma_f32_16x16x32_bf16 v[124:127], a[156:159], v[172:175], v[236:239]
    ds_read_b64_tr_b16 a[206:207], v7 offset:28672
    v_cvt_pk_bf16_f32 v193, v82, v83
    v_mfma_f32_16x16x32_bf16 v[124:127], a[152:155], v[140:143], v[124:127]
    v_exp_f32 v86, v86
    v_mfma_f32_16x16x32_bf16 v[124:127], a[148:151], v[108:111], v[124:127]
    ds_read_b64_tr_b16 a[208:209], v8 offset:16384
    v_add_f32 v241, v241, v84
    v_mfma_f32_16x16x32_bf16 v[124:127], a[144:147], v[76:79], v[124:127]
    s_waitcnt lgkmcnt(15)
    s_add_u32 m0, s40, 65536
    v_exp_f32 v87, v87
    v_mfma_f32_16x16x32_bf16 v[144:147], a[160:163], v[64:67], v[224:227]
    s_waitcnt lgkmcnt(15)
    buffer_load_dwordx4 v18, s[24:27], s42 offen offset:0 lds
    v_mfma_f32_16x16x32_bf16 v[144:147], a[164:167], v[96:99], v[144:147]
    s_waitcnt lgkmcnt(14)
    v_exp_f32 v88, v88
    v_mfma_f32_16x16x32_bf16 v[144:147], a[168:171], v[128:131], v[144:147]
    s_waitcnt lgkmcnt(13)
    ds_read_b64_tr_b16 a[210:211], v8 offset:20480
    v_add_f32 v241, v241, v85
    v_mfma_f32_16x16x32_bf16 v[144:147], a[172:175], v[160:163], v[144:147]
    v_exp_f32 v89, v89
    v_mfma_f32_16x16x32_bf16 v[148:151], a[172:175], v[164:167], v[228:231]
    ds_read_b64_tr_b16 a[212:213], v8 offset:24576
    v_cvt_pk_bf16_f32 v196, v84, v85
    v_mfma_f32_16x16x32_bf16 v[148:151], a[168:171], v[132:135], v[148:151]
    v_exp_f32 v90, v90
    v_mfma_f32_16x16x32_bf16 v[148:151], a[164:167], v[100:103], v[148:151]
    ds_read_b64_tr_b16 a[214:215], v8 offset:28672
    v_add_f32 v241, v241, v86
    v_mfma_f32_16x16x32_bf16 v[148:151], a[160:163], v[68:71], v[148:151]
    v_exp_f32 v91, v91
    v_mfma_f32_16x16x32_bf16 v[152:155], a[160:163], v[72:75], v[232:235]
    ds_read_b64_tr_b16 a[216:217], v9 offset:16384
    v_add_f32 v241, v241, v87
    v_mfma_f32_16x16x32_bf16 v[152:155], a[164:167], v[104:107], v[152:155]
    v_exp_f32 v92, v92
    v_mfma_f32_16x16x32_bf16 v[152:155], a[168:171], v[136:139], v[152:155]
    ds_read_b64_tr_b16 a[218:219], v9 offset:20480
    v_cvt_pk_bf16_f32 v197, v86, v87
    v_mfma_f32_16x16x32_bf16 v[152:155], a[172:175], v[168:171], v[152:155]
    v_exp_f32 v93, v93
    v_mfma_f32_16x16x32_bf16 v[156:159], a[172:175], v[172:175], v[236:239]
    ds_read_b64_tr_b16 a[220:221], v9 offset:24576
    v_cvt_pk_bf16_f32 v200, v88, v89
    v_mfma_f32_16x16x32_bf16 v[156:159], a[168:171], v[140:143], v[156:159]
    v_exp_f32 v94, v94
    v_mfma_f32_16x16x32_bf16 v[156:159], a[164:167], v[108:111], v[156:159]
    ds_read_b64_tr_b16 a[222:223], v9 offset:28672
    v_cvt_pk_bf16_f32 v201, v90, v91
    v_mfma_f32_16x16x32_bf16 v[156:159], a[160:163], v[76:79], v[156:159]
    s_waitcnt lgkmcnt(15)
    v_exp_f32 v95, v95
    v_mfma_f32_16x16x32_bf16 v[176:179], a[176:179], v[64:67], v[224:227]
    s_waitcnt lgkmcnt(15)
    buffer_load_dwordx4 v19, s[24:27], s42 offen offset:1024 lds
    v_mfma_f32_16x16x32_bf16 v[176:179], a[180:183], v[96:99], v[176:179]
    s_waitcnt lgkmcnt(15)
    v_exp_f32 v112, v112
    v_mfma_f32_16x16x32_bf16 v[176:179], a[184:187], v[128:131], v[176:179]
    s_waitcnt lgkmcnt(15)
    ds_read_b64_tr_b16 a[224:225], v10 offset:16384
    v_cvt_pk_bf16_f32 v204, v92, v93
    v_mfma_f32_16x16x32_bf16 v[176:179], a[188:191], v[160:163], v[176:179]
    v_exp_f32 v113, v113
    v_mfma_f32_16x16x32_bf16 v[180:183], a[188:191], v[164:167], v[228:231]
    ds_read_b64_tr_b16 a[226:227], v10 offset:20480
    v_cvt_pk_bf16_f32 v205, v94, v95
    v_mfma_f32_16x16x32_bf16 v[180:183], a[184:187], v[132:135], v[180:183]
    v_exp_f32 v114, v114
    v_mfma_f32_16x16x32_bf16 v[180:183], a[180:183], v[100:103], v[180:183]
    ds_read_b64_tr_b16 a[228:229], v10 offset:24576
    v_add_f32 v240, v240, v112
    v_mfma_f32_16x16x32_bf16 v[180:183], a[176:179], v[68:71], v[180:183]
    v_exp_f32 v115, v115
    v_mfma_f32_16x16x32_bf16 v[184:187], a[176:179], v[72:75], v[232:235]
    ds_read_b64_tr_b16 a[230:231], v10 offset:28672
    v_add_f32 v240, v240, v113
    v_mfma_f32_16x16x32_bf16 v[184:187], a[180:183], v[104:107], v[184:187]
    v_exp_f32 v116, v116
    v_mfma_f32_16x16x32_bf16 v[184:187], a[184:187], v[136:139], v[184:187]
    ds_read_b64_tr_b16 a[232:233], v11 offset:16384
    v_cvt_pk_bf16_f32 v194, v112, v113
    v_mfma_f32_16x16x32_bf16 v[184:187], a[188:191], v[168:171], v[184:187]
    v_exp_f32 v117, v117
    v_mfma_f32_16x16x32_bf16 v[188:191], a[188:191], v[172:175], v[236:239]
    ds_read_b64_tr_b16 a[234:235], v11 offset:20480
    v_add_f32 v240, v240, v114
    v_mfma_f32_16x16x32_bf16 v[188:191], a[184:187], v[140:143], v[188:191]
    v_exp_f32 v118, v118
    v_mfma_f32_16x16x32_bf16 v[188:191], a[180:183], v[108:111], v[188:191]
    ds_read_b64_tr_b16 a[236:237], v11 offset:24576
    v_add_f32 v240, v240, v115
    v_mfma_f32_16x16x32_bf16 v[188:191], a[176:179], v[76:79], v[188:191]
    s_waitcnt lgkmcnt(15)
    v_exp_f32 v119, v119
    v_mfma_f32_16x16x32_bf16 a[0:3], a[192:195], v[32:35], a[0:3]
    s_waitcnt lgkmcnt(15)
    buffer_load_dwordx4 v18, s[24:27], s42 offen offset:2048 lds
    v_mfma_f32_16x16x32_bf16 a[0:3], a[196:199], v[48:51], a[0:3]
    v_exp_f32 v120, v120
    v_mfma_f32_16x16x32_bf16 a[4:7], a[192:195], v[36:39], a[4:7]
    ds_read_b64_tr_b16 a[238:239], v11 offset:28672
    v_cvt_pk_bf16_f32 v195, v114, v115
    v_mfma_f32_16x16x32_bf16 a[4:7], a[196:199], v[52:55], a[4:7]
    v_exp_f32 v121, v121
    v_mfma_f32_16x16x32_bf16 a[8:11], a[192:195], v[40:43], a[8:11]
    ds_read_b64_tr_b16 a[240:241], v12 offset:16384
    v_add_f32 v241, v241, v116
    v_mfma_f32_16x16x32_bf16 a[8:11], a[196:199], v[56:59], a[8:11]
    v_exp_f32 v122, v122
    v_mfma_f32_16x16x32_bf16 a[12:15], a[192:195], v[44:47], a[12:15]
    ds_read_b64_tr_b16 a[242:243], v12 offset:20480
    v_add_f32 v241, v241, v117
    v_mfma_f32_16x16x32_bf16 a[12:15], a[196:199], v[60:63], a[12:15]
    s_waitcnt lgkmcnt(15)
    v_exp_f32 v123, v123
    v_mfma_f32_16x16x32_bf16 a[16:19], a[200:203], v[32:35], a[16:19]
    s_waitcnt lgkmcnt(15)
    ds_read_b64_tr_b16 a[244:245], v12 offset:24576
    v_cvt_pk_bf16_f32 v198, v116, v117
    v_mfma_f32_16x16x32_bf16 a[16:19], a[204:207], v[48:51], a[16:19]
    v_exp_f32 v124, v124
    v_mfma_f32_16x16x32_bf16 a[20:23], a[200:203], v[36:39], a[20:23]
    ds_read_b64_tr_b16 a[246:247], v12 offset:28672
    v_add_f32 v241, v241, v118
    v_mfma_f32_16x16x32_bf16 a[20:23], a[204:207], v[52:55], a[20:23]
    v_exp_f32 v125, v125
    v_mfma_f32_16x16x32_bf16 a[24:27], a[200:203], v[40:43], a[24:27]
    ds_read_b64_tr_b16 a[248:249], v13 offset:16384
    v_add_f32 v241, v241, v119
    v_mfma_f32_16x16x32_bf16 a[24:27], a[204:207], v[56:59], a[24:27]
    v_exp_f32 v126, v126
    v_mfma_f32_16x16x32_bf16 a[28:31], a[200:203], v[44:47], a[28:31]
    ds_read_b64_tr_b16 a[250:251], v13 offset:20480
    v_cvt_pk_bf16_f32 v199, v118, v119
    v_mfma_f32_16x16x32_bf16 a[28:31], a[204:207], v[60:63], a[28:31]
    s_waitcnt lgkmcnt(15)
    v_exp_f32 v127, v127
    v_mfma_f32_16x16x32_bf16 a[32:35], a[208:211], v[32:35], a[32:35]
    s_waitcnt lgkmcnt(15)
    buffer_load_dwordx4 v19, s[24:27], s42 offen offset:3072 lds
    v_mfma_f32_16x16x32_bf16 a[32:35], a[212:215], v[48:51], a[32:35]
    s_add_u32 s42, s42, 16384
    v_exp_f32 v144, v144
    v_mfma_f32_16x16x32_bf16 a[36:39], a[208:211], v[36:39], a[36:39]
    ds_read_b64_tr_b16 a[252:253], v13 offset:24576
    v_cvt_pk_bf16_f32 v202, v120, v121
    v_mfma_f32_16x16x32_bf16 a[36:39], a[212:215], v[52:55], a[36:39]
    v_exp_f32 v145, v145
    v_mfma_f32_16x16x32_bf16 a[40:43], a[208:211], v[40:43], a[40:43]
    ds_read_b64_tr_b16 a[254:255], v13 offset:28672
    v_cvt_pk_bf16_f32 v203, v122, v123
    v_mfma_f32_16x16x32_bf16 a[40:43], a[212:215], v[56:59], a[40:43]
    v_exp_f32 v146, v146
    v_mfma_f32_16x16x32_bf16 a[44:47], a[208:211], v[44:47], a[44:47]
    v_cvt_pk_bf16_f32 v206, v124, v125
    v_cvt_pk_bf16_f32 v207, v126, v127
    v_mfma_f32_16x16x32_bf16 a[44:47], a[212:215], v[60:63], a[44:47]
    s_waitcnt lgkmcnt(15)
    v_exp_f32 v147, v147
    v_mfma_f32_16x16x32_bf16 a[48:51], a[216:219], v[32:35], a[48:51]
    s_waitcnt lgkmcnt(15)
    v_add_f32 v240, v240, v144
    v_add_f32 v240, v240, v145
    v_mfma_f32_16x16x32_bf16 a[48:51], a[220:223], v[48:51], a[48:51]
    v_exp_f32 v148, v148
    v_mfma_f32_16x16x32_bf16 a[52:55], a[216:219], v[36:39], a[52:55]
    v_cvt_pk_bf16_f32 v208, v144, v145
    v_add_f32 v240, v240, v146
    v_mfma_f32_16x16x32_bf16 a[52:55], a[220:223], v[52:55], a[52:55]
    s_waitcnt lgkmcnt(0)
    s_waitcnt vmcnt(17)
    v_exp_f32 v149, v149
    v_mfma_f32_16x16x32_bf16 a[56:59], a[216:219], v[40:43], a[56:59]
    s_barrier
    v_add_f32 v240, v240, v147
    v_mfma_f32_16x16x32_bf16 a[56:59], a[220:223], v[56:59], a[56:59]
    v_exp_f32 v150, v150
    v_mfma_f32_16x16x32_bf16 a[60:63], a[216:219], v[44:47], a[60:63]
    ds_read_b128 a[128:131], v2 offset:49152
    v_cvt_pk_bf16_f32 v209, v146, v147
    v_mfma_f32_16x16x32_bf16 a[60:63], a[220:223], v[60:63], a[60:63]
    v_exp_f32 v151, v151
    v_mfma_f32_16x16x32_bf16 a[64:67], a[224:227], v[32:35], a[64:67]
    ds_read_b128 a[132:135], v3 offset:49152
    v_add_f32 v241, v241, v148
    v_mfma_f32_16x16x32_bf16 a[64:67], a[228:231], v[48:51], a[64:67]
    v_exp_f32 v152, v152
    v_mfma_f32_16x16x32_bf16 a[68:71], a[224:227], v[36:39], a[68:71]
    v_add_f32 v241, v241, v149
    v_cvt_pk_bf16_f32 v212, v148, v149
    v_mfma_f32_16x16x32_bf16 a[68:71], a[228:231], v[52:55], a[68:71]
    s_add_u32 m0, s40, 98304
    v_exp_f32 v153, v153
    v_mfma_f32_16x16x32_bf16 a[72:75], a[224:227], v[40:43], a[72:75]
    buffer_load_dwordx4 v14, s[20:23], s41 offen offset:0 lds
    v_mfma_f32_16x16x32_bf16 a[72:75], a[228:231], v[56:59], a[72:75]
    v_exp_f32 v154, v154
    v_mfma_f32_16x16x32_bf16 a[76:79], a[224:227], v[44:47], a[76:79]
    ds_read_b128 a[136:139], v4 offset:49152
    v_add_f32 v241, v241, v150
    v_mfma_f32_16x16x32_bf16 a[76:79], a[228:231], v[60:63], a[76:79]
    v_exp_f32 v155, v155
    v_mfma_f32_16x16x32_bf16 a[80:83], a[232:235], v[32:35], a[80:83]
    ds_read_b128 a[140:143], v5 offset:49152
    v_add_f32 v241, v241, v151
    v_mfma_f32_16x16x32_bf16 a[80:83], a[236:239], v[48:51], a[80:83]
    v_exp_f32 v156, v156
    v_mfma_f32_16x16x32_bf16 a[84:87], a[232:235], v[36:39], a[84:87]
    v_cvt_pk_bf16_f32 v213, v150, v151
    v_cvt_pk_bf16_f32 v216, v152, v153
    v_mfma_f32_16x16x32_bf16 a[84:87], a[236:239], v[52:55], a[84:87]
    v_exp_f32 v157, v157
    v_mfma_f32_16x16x32_bf16 a[88:91], a[232:235], v[40:43], a[88:91]
    ds_read_b128 a[144:147], v2 offset:53248
    v_cvt_pk_bf16_f32 v217, v154, v155
    v_mfma_f32_16x16x32_bf16 a[88:91], a[236:239], v[56:59], a[88:91]
    v_exp_f32 v158, v158
    v_mfma_f32_16x16x32_bf16 a[92:95], a[232:235], v[44:47], a[92:95]
    ds_read_b128 a[148:151], v3 offset:53248
    v_cvt_pk_bf16_f32 v220, v156, v157
    v_mfma_f32_16x16x32_bf16 a[92:95], a[236:239], v[60:63], a[92:95]
    v_exp_f32 v159, v159
    v_mfma_f32_16x16x32_bf16 a[96:99], a[240:243], v[32:35], a[96:99]
    v_cvt_pk_bf16_f32 v221, v158, v159
    v_mfma_f32_16x16x32_bf16 a[96:99], a[244:247], v[48:51], a[96:99]
    v_exp_f32 v176, v176
    v_mfma_f32_16x16x32_bf16 a[100:103], a[240:243], v[36:39], a[100:103]
    ds_read_b128 a[152:155], v4 offset:53248
    v_add_f32 v240, v240, v176
    v_mfma_f32_16x16x32_bf16 a[100:103], a[244:247], v[52:55], a[100:103]
    v_exp_f32 v177, v177
    v_mfma_f32_16x16x32_bf16 a[104:107], a[240:243], v[40:43], a[104:107]
    buffer_load_dwordx4 v15, s[20:23], s41 offen offset:1024 lds
    v_mfma_f32_16x16x32_bf16 a[104:107], a[244:247], v[56:59], a[104:107]
    v_exp_f32 v178, v178
    v_mfma_f32_16x16x32_bf16 a[108:111], a[240:243], v[44:47], a[108:111]
    ds_read_b128 a[156:159], v5 offset:53248
    v_add_f32 v240, v240, v177
    v_mfma_f32_16x16x32_bf16 a[108:111], a[244:247], v[60:63], a[108:111]
    v_exp_f32 v179, v179
    v_mfma_f32_16x16x32_bf16 a[112:115], a[248:251], v[32:35], a[112:115]
    v_cvt_pk_bf16_f32 v210, v176, v177
    v_add_f32 v240, v240, v178
    v_mfma_f32_16x16x32_bf16 a[112:115], a[252:255], v[48:51], a[112:115]
    v_exp_f32 v180, v180
    v_mfma_f32_16x16x32_bf16 a[116:119], a[248:251], v[36:39], a[116:119]
    ds_read_b128 a[160:163], v2 offset:57344
    v_add_f32 v240, v240, v179
    v_mfma_f32_16x16x32_bf16 a[116:119], a[252:255], v[52:55], a[116:119]
    v_exp_f32 v181, v181
    v_mfma_f32_16x16x32_bf16 a[120:123], a[248:251], v[40:43], a[120:123]
    ds_read_b128 a[164:167], v3 offset:57344
    v_cvt_pk_bf16_f32 v211, v178, v179
    v_mfma_f32_16x16x32_bf16 a[120:123], a[252:255], v[56:59], a[120:123]
    v_exp_f32 v182, v182
    v_mfma_f32_16x16x32_bf16 a[124:127], a[248:251], v[44:47], a[124:127]
    v_add_f32 v241, v241, v180
    v_add_f32 v241, v241, v181
    v_mfma_f32_16x16x32_bf16 a[124:127], a[252:255], v[60:63], a[124:127]
    v_exp_f32 v183, v183
    v_mfma_f32_16x16x32_bf16 v[248:251], v[244:247], v[44:47], v[248:251]
    ds_read_b128 a[168:171], v4 offset:57344
    v_cvt_pk_bf16_f32 v214, v180, v181
    v_mfma_f32_16x16x32_bf16 v[248:251], v[244:247], v[60:63], v[248:251]
    ds_read_b128 a[172:175], v5 offset:57344
    v_add_f32 v241, v241, v182
    v_mfma_f32_16x16x32_bf16 v[252:255], v[244:247], v[40:43], v[252:255]
    v_add_f32 v241, v241, v183
    v_cvt_pk_bf16_f32 v215, v182, v183
    v_mfma_f32_16x16x32_bf16 v[252:255], v[244:247], v[56:59], v[252:255]
    s_waitcnt lgkmcnt(11)
    ds_read_b128 a[176:179], v2 offset:61440
    v_mfma_f32_16x16x32_bf16 v[80:83], a[128:131], v[64:67], v[224:227]
    s_waitcnt lgkmcnt(11)
    buffer_load_dwordx4 v16, s[20:23], s41 offen offset:2048 lds
    v_mfma_f32_16x16x32_bf16 v[80:83], a[132:135], v[96:99], v[80:83]
    s_waitcnt lgkmcnt(10)
    v_exp_f32 v184, v184
    v_mfma_f32_16x16x32_bf16 v[80:83], a[136:139], v[128:131], v[80:83]
    s_waitcnt lgkmcnt(9)
    ds_read_b128 a[180:183], v3 offset:61440
    v_mfma_f32_16x16x32_bf16 v[80:83], a[140:143], v[160:163], v[80:83]
    v_exp_f32 v185, v185
    v_mfma_f32_16x16x32_bf16 v[84:87], a[140:143], v[164:167], v[228:231]
    v_cvt_pk_bf16_f32 v218, v184, v185
    v_mfma_f32_16x16x32_bf16 v[84:87], a[136:139], v[132:135], v[84:87]
    v_exp_f32 v186, v186
    v_mfma_f32_16x16x32_bf16 v[84:87], a[132:135], v[100:103], v[84:87]
    ds_read_b128 a[184:187], v4 offset:61440
    v_mfma_f32_16x16x32_bf16 v[84:87], a[128:131], v[68:71], v[84:87]
    v_exp_f32 v187, v187
    v_mfma_f32_16x16x32_bf16 v[88:91], a[128:131], v[72:75], v[232:235]
    ds_read_b128 a[188:191], v5 offset:61440
    v_cvt_pk_bf16_f32 v219, v186, v187
    v_mfma_f32_16x16x32_bf16 v[88:91], a[132:135], v[104:107], v[88:91]
    v_exp_f32 v188, v188
    v_mfma_f32_16x16x32_bf16 v[88:91], a[136:139], v[136:139], v[88:91]
    v_mfma_f32_16x16x32_bf16 v[88:91], a[140:143], v[168:171], v[88:91]
    v_exp_f32 v189, v189
    v_mfma_f32_16x16x32_bf16 v[92:95], a[140:143], v[172:175], v[236:239]
    ds_read_b64_tr_b16 a[192:193], v6 offset:0
    v_cvt_pk_bf16_f32 v222, v188, v189
    v_mfma_f32_16x16x32_bf16 v[92:95], a[136:139], v[140:143], v[92:95]
    v_exp_f32 v190, v190
    v_mfma_f32_16x16x32_bf16 v[92:95], a[132:135], v[108:111], v[92:95]
    ds_read_b64_tr_b16 a[194:195], v6 offset:4096
    v_mfma_f32_16x16x32_bf16 v[92:95], a[128:131], v[76:79], v[92:95]
    s_waitcnt lgkmcnt(13)
    v_exp_f32 v191, v191
    v_mfma_f32_16x16x32_bf16 v[112:115], a[144:147], v[64:67], v[224:227]
    s_waitcnt lgkmcnt(12)
    buffer_load_dwordx4 v17, s[20:23], s41 offen offset:3072 lds
    v_cvt_pk_bf16_f32 v223, v190, v191
    v_mfma_f32_16x16x32_bf16 v[112:115], a[148:151], v[96:99], v[112:115]
    s_waitcnt lgkmcnt(11)
    s_add_u32 s41, s41, 16384
    v_exp_f32 v80, v80
    v_mfma_f32_16x16x32_bf16 v[112:115], a[152:155], v[128:131], v[112:115]
    s_waitcnt lgkmcnt(10)
    ds_read_b64_tr_b16 a[196:197], v6 offset:8192
    v_add_f32 v240, v240, v80
    v_mfma_f32_16x16x32_bf16 v[112:115], a[156:159], v[160:163], v[112:115]
    v_exp_f32 v81, v81
    v_mfma_f32_16x16x32_bf16 v[116:119], a[156:159], v[164:167], v[228:231]
    ds_read_b64_tr_b16 a[198:199], v6 offset:12288
    v_add_f32 v240, v240, v81
    v_mfma_f32_16x16x32_bf16 v[116:119], a[152:155], v[132:135], v[116:119]
    v_exp_f32 v82, v82
    v_mfma_f32_16x16x32_bf16 v[116:119], a[148:151], v[100:103], v[116:119]
    ds_read_b64_tr_b16 a[200:201], v7 offset:0
    v_cvt_pk_bf16_f32 v32, v80, v81
    v_mfma_f32_16x16x32_bf16 v[116:119], a[144:147], v[68:71], v[116:119]
    v_exp_f32 v83, v83
    v_mfma_f32_16x16x32_bf16 v[120:123], a[144:147], v[72:75], v[232:235]
    ds_read_b64_tr_b16 a[202:203], v7 offset:4096
    v_add_f32 v240, v240, v82
    v_mfma_f32_16x16x32_bf16 v[120:123], a[148:151], v[104:107], v[120:123]
    v_exp_f32 v84, v84
    v_mfma_f32_16x16x32_bf16 v[120:123], a[152:155], v[136:139], v[120:123]
    ds_read_b64_tr_b16 a[204:205], v7 offset:8192
    v_add_f32 v240, v240, v83
    v_mfma_f32_16x16x32_bf16 v[120:123], a[156:159], v[168:171], v[120:123]
    v_exp_f32 v85, v85
    v_mfma_f32_16x16x32_bf16 v[124:127], a[156:159], v[172:175], v[236:239]
    ds_read_b64_tr_b16 a[206:207], v7 offset:12288
    v_cvt_pk_bf16_f32 v33, v82, v83
    v_mfma_f32_16x16x32_bf16 v[124:127], a[152:155], v[140:143], v[124:127]
    v_exp_f32 v86, v86
    v_mfma_f32_16x16x32_bf16 v[124:127], a[148:151], v[108:111], v[124:127]
    ds_read_b64_tr_b16 a[208:209], v8 offset:0
    v_add_f32 v241, v241, v84
    v_mfma_f32_16x16x32_bf16 v[124:127], a[144:147], v[76:79], v[124:127]
    s_waitcnt lgkmcnt(15)
    s_add_u32 m0, s40, 49152
    v_exp_f32 v87, v87
    v_mfma_f32_16x16x32_bf16 v[144:147], a[160:163], v[64:67], v[224:227]
    s_waitcnt lgkmcnt(15)
    buffer_load_dwordx4 v18, s[24:27], s42 offen offset:0 lds
    v_mfma_f32_16x16x32_bf16 v[144:147], a[164:167], v[96:99], v[144:147]
    s_waitcnt lgkmcnt(14)
    v_exp_f32 v88, v88
    v_mfma_f32_16x16x32_bf16 v[144:147], a[168:171], v[128:131], v[144:147]
    s_waitcnt lgkmcnt(13)
    ds_read_b64_tr_b16 a[210:211], v8 offset:4096
    v_add_f32 v241, v241, v85
    v_mfma_f32_16x16x32_bf16 v[144:147], a[172:175], v[160:163], v[144:147]
    v_exp_f32 v89, v89
    v_mfma_f32_16x16x32_bf16 v[148:151], a[172:175], v[164:167], v[228:231]
    ds_read_b64_tr_b16 a[212:213], v8 offset:8192
    v_cvt_pk_bf16_f32 v36, v84, v85
    v_mfma_f32_16x16x32_bf16 v[148:151], a[168:171], v[132:135], v[148:151]
    v_exp_f32 v90, v90
    v_mfma_f32_16x16x32_bf16 v[148:151], a[164:167], v[100:103], v[148:151]
    ds_read_b64_tr_b16 a[214:215], v8 offset:12288
    v_add_f32 v241, v241, v86
    v_mfma_f32_16x16x32_bf16 v[148:151], a[160:163], v[68:71], v[148:151]
    v_exp_f32 v91, v91
    v_mfma_f32_16x16x32_bf16 v[152:155], a[160:163], v[72:75], v[232:235]
    ds_read_b64_tr_b16 a[216:217], v9 offset:0
    v_add_f32 v241, v241, v87
    v_mfma_f32_16x16x32_bf16 v[152:155], a[164:167], v[104:107], v[152:155]
    v_exp_f32 v92, v92
    v_mfma_f32_16x16x32_bf16 v[152:155], a[168:171], v[136:139], v[152:155]
    ds_read_b64_tr_b16 a[218:219], v9 offset:4096
    v_cvt_pk_bf16_f32 v37, v86, v87
    v_mfma_f32_16x16x32_bf16 v[152:155], a[172:175], v[168:171], v[152:155]
    v_exp_f32 v93, v93
    v_mfma_f32_16x16x32_bf16 v[156:159], a[172:175], v[172:175], v[236:239]
    ds_read_b64_tr_b16 a[220:221], v9 offset:8192
    v_cvt_pk_bf16_f32 v40, v88, v89
    v_mfma_f32_16x16x32_bf16 v[156:159], a[168:171], v[140:143], v[156:159]
    v_exp_f32 v94, v94
    v_mfma_f32_16x16x32_bf16 v[156:159], a[164:167], v[108:111], v[156:159]
    ds_read_b64_tr_b16 a[222:223], v9 offset:12288
    v_cvt_pk_bf16_f32 v41, v90, v91
    v_mfma_f32_16x16x32_bf16 v[156:159], a[160:163], v[76:79], v[156:159]
    s_waitcnt lgkmcnt(15)
    v_exp_f32 v95, v95
    v_mfma_f32_16x16x32_bf16 v[176:179], a[176:179], v[64:67], v[224:227]
    s_waitcnt lgkmcnt(15)
    buffer_load_dwordx4 v19, s[24:27], s42 offen offset:1024 lds
    v_mfma_f32_16x16x32_bf16 v[176:179], a[180:183], v[96:99], v[176:179]
    s_waitcnt lgkmcnt(15)
    v_exp_f32 v112, v112
    v_mfma_f32_16x16x32_bf16 v[176:179], a[184:187], v[128:131], v[176:179]
    s_waitcnt lgkmcnt(15)
    ds_read_b64_tr_b16 a[224:225], v10 offset:0
    v_cvt_pk_bf16_f32 v44, v92, v93
    v_mfma_f32_16x16x32_bf16 v[176:179], a[188:191], v[160:163], v[176:179]
    v_exp_f32 v113, v113
    v_mfma_f32_16x16x32_bf16 v[180:183], a[188:191], v[164:167], v[228:231]
    ds_read_b64_tr_b16 a[226:227], v10 offset:4096
    v_cvt_pk_bf16_f32 v45, v94, v95
    v_mfma_f32_16x16x32_bf16 v[180:183], a[184:187], v[132:135], v[180:183]
    v_exp_f32 v114, v114
    v_mfma_f32_16x16x32_bf16 v[180:183], a[180:183], v[100:103], v[180:183]
    ds_read_b64_tr_b16 a[228:229], v10 offset:8192
    v_add_f32 v240, v240, v112
    v_mfma_f32_16x16x32_bf16 v[180:183], a[176:179], v[68:71], v[180:183]
    v_exp_f32 v115, v115
    v_mfma_f32_16x16x32_bf16 v[184:187], a[176:179], v[72:75], v[232:235]
    ds_read_b64_tr_b16 a[230:231], v10 offset:12288
    v_add_f32 v240, v240, v113
    v_mfma_f32_16x16x32_bf16 v[184:187], a[180:183], v[104:107], v[184:187]
    v_exp_f32 v116, v116
    v_mfma_f32_16x16x32_bf16 v[184:187], a[184:187], v[136:139], v[184:187]
    ds_read_b64_tr_b16 a[232:233], v11 offset:0
    v_cvt_pk_bf16_f32 v34, v112, v113
    v_mfma_f32_16x16x32_bf16 v[184:187], a[188:191], v[168:171], v[184:187]
    v_exp_f32 v117, v117
    v_mfma_f32_16x16x32_bf16 v[188:191], a[188:191], v[172:175], v[236:239]
    ds_read_b64_tr_b16 a[234:235], v11 offset:4096
    v_add_f32 v240, v240, v114
    v_mfma_f32_16x16x32_bf16 v[188:191], a[184:187], v[140:143], v[188:191]
    v_exp_f32 v118, v118
    v_mfma_f32_16x16x32_bf16 v[188:191], a[180:183], v[108:111], v[188:191]
    ds_read_b64_tr_b16 a[236:237], v11 offset:8192
    v_add_f32 v240, v240, v115
    v_mfma_f32_16x16x32_bf16 v[188:191], a[176:179], v[76:79], v[188:191]
    s_waitcnt lgkmcnt(15)
    v_exp_f32 v119, v119
    v_mfma_f32_16x16x32_bf16 a[0:3], a[192:195], v[192:195], a[0:3]
    s_waitcnt lgkmcnt(15)
    buffer_load_dwordx4 v18, s[24:27], s42 offen offset:2048 lds
    v_mfma_f32_16x16x32_bf16 a[0:3], a[196:199], v[208:211], a[0:3]
    v_exp_f32 v120, v120
    v_mfma_f32_16x16x32_bf16 a[4:7], a[192:195], v[196:199], a[4:7]
    ds_read_b64_tr_b16 a[238:239], v11 offset:12288
    v_cvt_pk_bf16_f32 v35, v114, v115
    v_mfma_f32_16x16x32_bf16 a[4:7], a[196:199], v[212:215], a[4:7]
    v_exp_f32 v121, v121
    v_mfma_f32_16x16x32_bf16 a[8:11], a[192:195], v[200:203], a[8:11]
    ds_read_b64_tr_b16 a[240:241], v12 offset:0
    v_add_f32 v241, v241, v116
    v_mfma_f32_16x16x32_bf16 a[8:11], a[196:199], v[216:219], a[8:11]
    v_exp_f32 v122, v122
    v_mfma_f32_16x16x32_bf16 a[12:15], a[192:195], v[204:207], a[12:15]
    ds_read_b64_tr_b16 a[242:243], v12 offset:4096
    v_add_f32 v241, v241, v117
    v_mfma_f32_16x16x32_bf16 a[12:15], a[196:199], v[220:223], a[12:15]
    s_waitcnt lgkmcnt(15)
    v_exp_f32 v123, v123
    v_mfma_f32_16x16x32_bf16 a[16:19], a[200:203], v[192:195], a[16:19]
    s_waitcnt lgkmcnt(15)
    ds_read_b64_tr_b16 a[244:245], v12 offset:8192
    v_cvt_pk_bf16_f32 v38, v116, v117
    v_mfma_f32_16x16x32_bf16 a[16:19], a[204:207], v[208:211], a[16:19]
    v_exp_f32 v124, v124
    v_mfma_f32_16x16x32_bf16 a[20:23], a[200:203], v[196:199], a[20:23]
    ds_read_b64_tr_b16 a[246:247], v12 offset:12288
    v_add_f32 v241, v241, v118
    v_mfma_f32_16x16x32_bf16 a[20:23], a[204:207], v[212:215], a[20:23]
    v_exp_f32 v125, v125
    v_mfma_f32_16x16x32_bf16 a[24:27], a[200:203], v[200:203], a[24:27]
    ds_read_b64_tr_b16 a[248:249], v13 offset:0
    v_add_f32 v241, v241, v119
    v_mfma_f32_16x16x32_bf16 a[24:27], a[204:207], v[216:219], a[24:27]
    v_exp_f32 v126, v126
    v_mfma_f32_16x16x32_bf16 a[28:31], a[200:203], v[204:207], a[28:31]
    ds_read_b64_tr_b16 a[250:251], v13 offset:4096
    v_cvt_pk_bf16_f32 v39, v118, v119
    v_mfma_f32_16x16x32_bf16 a[28:31], a[204:207], v[220:223], a[28:31]
    s_waitcnt lgkmcnt(15)
    v_exp_f32 v127, v127
    v_mfma_f32_16x16x32_bf16 a[32:35], a[208:211], v[192:195], a[32:35]
    s_waitcnt lgkmcnt(15)
    buffer_load_dwordx4 v19, s[24:27], s42 offen offset:3072 lds
    v_mfma_f32_16x16x32_bf16 a[32:35], a[212:215], v[208:211], a[32:35]
    s_add_u32 s42, s42, 16384
    v_exp_f32 v144, v144
    v_mfma_f32_16x16x32_bf16 a[36:39], a[208:211], v[196:199], a[36:39]
    ds_read_b64_tr_b16 a[252:253], v13 offset:8192
    v_cvt_pk_bf16_f32 v42, v120, v121
    v_mfma_f32_16x16x32_bf16 a[36:39], a[212:215], v[212:215], a[36:39]
    v_exp_f32 v145, v145
    v_mfma_f32_16x16x32_bf16 a[40:43], a[208:211], v[200:203], a[40:43]
    ds_read_b64_tr_b16 a[254:255], v13 offset:12288
    v_cvt_pk_bf16_f32 v43, v122, v123
    v_mfma_f32_16x16x32_bf16 a[40:43], a[212:215], v[216:219], a[40:43]
    v_exp_f32 v146, v146
    v_mfma_f32_16x16x32_bf16 a[44:47], a[208:211], v[204:207], a[44:47]
    v_cvt_pk_bf16_f32 v46, v124, v125
    v_cvt_pk_bf16_f32 v47, v126, v127
    v_mfma_f32_16x16x32_bf16 a[44:47], a[212:215], v[220:223], a[44:47]
    s_waitcnt lgkmcnt(15)
    v_exp_f32 v147, v147
    v_mfma_f32_16x16x32_bf16 a[48:51], a[216:219], v[192:195], a[48:51]
    s_waitcnt lgkmcnt(15)
    v_add_f32 v240, v240, v144
    v_add_f32 v240, v240, v145
    v_mfma_f32_16x16x32_bf16 a[48:51], a[220:223], v[208:211], a[48:51]
    v_exp_f32 v148, v148
    v_mfma_f32_16x16x32_bf16 a[52:55], a[216:219], v[196:199], a[52:55]
    v_cvt_pk_bf16_f32 v48, v144, v145
    v_add_f32 v240, v240, v146
    v_mfma_f32_16x16x32_bf16 a[52:55], a[220:223], v[212:215], a[52:55]
    s_waitcnt lgkmcnt(0)
    s_waitcnt vmcnt(17)
    v_exp_f32 v149, v149
    v_mfma_f32_16x16x32_bf16 a[56:59], a[216:219], v[200:203], a[56:59]
    s_barrier
    v_add_f32 v240, v240, v147
    v_mfma_f32_16x16x32_bf16 a[56:59], a[220:223], v[216:219], a[56:59]
    v_exp_f32 v150, v150
    v_mfma_f32_16x16x32_bf16 a[60:63], a[216:219], v[204:207], a[60:63]
    ds_read_b128 a[128:131], v2 offset:32768
    v_cvt_pk_bf16_f32 v49, v146, v147
    v_mfma_f32_16x16x32_bf16 a[60:63], a[220:223], v[220:223], a[60:63]
    v_exp_f32 v151, v151
    v_mfma_f32_16x16x32_bf16 a[64:67], a[224:227], v[192:195], a[64:67]
    ds_read_b128 a[132:135], v3 offset:32768
    v_add_f32 v241, v241, v148
    v_mfma_f32_16x16x32_bf16 a[64:67], a[228:231], v[208:211], a[64:67]
    v_exp_f32 v152, v152
    v_mfma_f32_16x16x32_bf16 a[68:71], a[224:227], v[196:199], a[68:71]
    v_add_f32 v241, v241, v149
    v_cvt_pk_bf16_f32 v52, v148, v149
    v_mfma_f32_16x16x32_bf16 a[68:71], a[228:231], v[212:215], a[68:71]
    s_add_u32 m0, s40, 147456
    v_exp_f32 v153, v153
    v_mfma_f32_16x16x32_bf16 a[72:75], a[224:227], v[200:203], a[72:75]
    buffer_load_dwordx4 v14, s[20:23], s41 offen offset:0 lds
    v_mfma_f32_16x16x32_bf16 a[72:75], a[228:231], v[216:219], a[72:75]
    v_exp_f32 v154, v154
    v_mfma_f32_16x16x32_bf16 a[76:79], a[224:227], v[204:207], a[76:79]
    ds_read_b128 a[136:139], v4 offset:32768
    v_add_f32 v241, v241, v150
    v_mfma_f32_16x16x32_bf16 a[76:79], a[228:231], v[220:223], a[76:79]
    v_exp_f32 v155, v155
    v_mfma_f32_16x16x32_bf16 a[80:83], a[232:235], v[192:195], a[80:83]
    ds_read_b128 a[140:143], v5 offset:32768
    v_add_f32 v241, v241, v151
    v_mfma_f32_16x16x32_bf16 a[80:83], a[236:239], v[208:211], a[80:83]
    v_exp_f32 v156, v156
    v_mfma_f32_16x16x32_bf16 a[84:87], a[232:235], v[196:199], a[84:87]
    v_cvt_pk_bf16_f32 v53, v150, v151
    v_cvt_pk_bf16_f32 v56, v152, v153
    v_mfma_f32_16x16x32_bf16 a[84:87], a[236:239], v[212:215], a[84:87]
    v_exp_f32 v157, v157
    v_mfma_f32_16x16x32_bf16 a[88:91], a[232:235], v[200:203], a[88:91]
    ds_read_b128 a[144:147], v2 offset:36864
    v_cvt_pk_bf16_f32 v57, v154, v155
    v_mfma_f32_16x16x32_bf16 a[88:91], a[236:239], v[216:219], a[88:91]
    v_exp_f32 v158, v158
    v_mfma_f32_16x16x32_bf16 a[92:95], a[232:235], v[204:207], a[92:95]
    ds_read_b128 a[148:151], v3 offset:36864
    v_cvt_pk_bf16_f32 v60, v156, v157
    v_mfma_f32_16x16x32_bf16 a[92:95], a[236:239], v[220:223], a[92:95]
    v_exp_f32 v159, v159
    v_mfma_f32_16x16x32_bf16 a[96:99], a[240:243], v[192:195], a[96:99]
    v_cvt_pk_bf16_f32 v61, v158, v159
    v_mfma_f32_16x16x32_bf16 a[96:99], a[244:247], v[208:211], a[96:99]
    v_exp_f32 v176, v176
    v_mfma_f32_16x16x32_bf16 a[100:103], a[240:243], v[196:199], a[100:103]
    ds_read_b128 a[152:155], v4 offset:36864
    v_add_f32 v240, v240, v176
    v_mfma_f32_16x16x32_bf16 a[100:103], a[244:247], v[212:215], a[100:103]
    v_exp_f32 v177, v177
    v_mfma_f32_16x16x32_bf16 a[104:107], a[240:243], v[200:203], a[104:107]
    buffer_load_dwordx4 v15, s[20:23], s41 offen offset:1024 lds
    v_mfma_f32_16x16x32_bf16 a[104:107], a[244:247], v[216:219], a[104:107]
    v_exp_f32 v178, v178
    v_mfma_f32_16x16x32_bf16 a[108:111], a[240:243], v[204:207], a[108:111]
    ds_read_b128 a[156:159], v5 offset:36864
    v_add_f32 v240, v240, v177
    v_mfma_f32_16x16x32_bf16 a[108:111], a[244:247], v[220:223], a[108:111]
    v_exp_f32 v179, v179
    v_mfma_f32_16x16x32_bf16 a[112:115], a[248:251], v[192:195], a[112:115]
    v_cvt_pk_bf16_f32 v50, v176, v177
    v_add_f32 v240, v240, v178
    v_mfma_f32_16x16x32_bf16 a[112:115], a[252:255], v[208:211], a[112:115]
    v_exp_f32 v180, v180
    v_mfma_f32_16x16x32_bf16 a[116:119], a[248:251], v[196:199], a[116:119]
    ds_read_b128 a[160:163], v2 offset:40960
    v_add_f32 v240, v240, v179
    v_mfma_f32_16x16x32_bf16 a[116:119], a[252:255], v[212:215], a[116:119]
    v_exp_f32 v181, v181
    v_mfma_f32_16x16x32_bf16 a[120:123], a[248:251], v[200:203], a[120:123]
    ds_read_b128 a[164:167], v3 offset:40960
    v_cvt_pk_bf16_f32 v51, v178, v179
    v_mfma_f32_16x16x32_bf16 a[120:123], a[252:255], v[216:219], a[120:123]
    v_exp_f32 v182, v182
    v_mfma_f32_16x16x32_bf16 a[124:127], a[248:251], v[204:207], a[124:127]
    v_add_f32 v241, v241, v180
    v_add_f32 v241, v241, v181
    v_mfma_f32_16x16x32_bf16 a[124:127], a[252:255], v[220:223], a[124:127]
    s_add_u32 s43, s43, 1
    v_exp_f32 v183, v183
    v_mfma_f32_16x16x32_bf16 v[248:251], v[244:247], v[204:207], v[248:251]
    ds_read_b128 a[168:171], v4 offset:40960
    v_cvt_pk_bf16_f32 v54, v180, v181
    v_mfma_f32_16x16x32_bf16 v[248:251], v[244:247], v[220:223], v[248:251]
    s_cmp_lt_u32 s43, 7
    ds_read_b128 a[172:175], v5 offset:40960
    v_add_f32 v241, v241, v182
    v_mfma_f32_16x16x32_bf16 v[252:255], v[244:247], v[200:203], v[252:255]
    v_add_f32 v241, v241, v183
    v_cvt_pk_bf16_f32 v55, v182, v183
    v_mfma_f32_16x16x32_bf16 v[252:255], v[244:247], v[216:219], v[252:255]
    ds_read_b128 a[176:179], v2 offset:45056
    s_cbranch_scc1 L_at_loop
    s_waitcnt lgkmcnt(12)
    v_mfma_f32_16x16x32_bf16 v[80:83], a[128:131], v[64:67], v[224:227]
    s_waitcnt lgkmcnt(11)
    buffer_load_dwordx4 v16, s[20:23], s41 offen offset:2048 lds
    v_mfma_f32_16x16x32_bf16 v[80:83], a[132:135], v[96:99], v[80:83]
    s_waitcnt lgkmcnt(10)
    v_exp_f32 v184, v184
    v_mfma_f32_16x16x32_bf16 v[80:83], a[136:139], v[128:131], v[80:83]
    s_waitcnt lgkmcnt(9)
    ds_read_b128 a[180:183], v3 offset:45056
    v_mfma_f32_16x16x32_bf16 v[80:83], a[140:143], v[160:163], v[80:83]
    v_exp_f32 v185, v185
    v_mfma_f32_16x16x32_bf16 v[84:87], a[140:143], v[164:167], v[228:231]
    v_cvt_pk_bf16_f32 v58, v184, v185
    v_mfma_f32_16x16x32_bf16 v[84:87], a[136:139], v[132:135], v[84:87]
    s_lshl_b32 s53, s5, 11
    v_exp_f32 v186, v186
    v_mfma_f32_16x16x32_bf16 v[84:87], a[132:135], v[100:103], v[84:87]
    ds_read_b128 a[184:187], v4 offset:45056
    v_mfma_f32_16x16x32_bf16 v[84:87], a[128:131], v[68:71], v[84:87]
    s_add_u32 s53, s53, 512
    v_exp_f32 v187, v187
    v_mfma_f32_16x16x32_bf16 v[88:91], a[128:131], v[72:75], v[232:235]
    ds_read_b128 a[188:191], v5 offset:45056
    v_cvt_pk_bf16_f32 v59, v186, v187
    v_mfma_f32_16x16x32_bf16 v[88:91], a[132:135], v[104:107], v[88:91]
    v_exp_f32 v188, v188
    v_mfma_f32_16x16x32_bf16 v[88:91], a[136:139], v[136:139], v[88:91]
    v_mfma_f32_16x16x32_bf16 v[88:91], a[140:143], v[168:171], v[88:91]
    v_exp_f32 v189, v189
    v_mfma_f32_16x16x32_bf16 v[92:95], a[140:143], v[172:175], v[236:239]
    ds_read_b64_tr_b16 a[192:193], v6 offset:49152
    v_cvt_pk_bf16_f32 v62, v188, v189
    v_mfma_f32_16x16x32_bf16 v[92:95], a[136:139], v[140:143], v[92:95]
    v_exp_f32 v190, v190
    v_mfma_f32_16x16x32_bf16 v[92:95], a[132:135], v[108:111], v[92:95]
    ds_read_b64_tr_b16 a[194:195], v6 offset:53248
    v_mfma_f32_16x16x32_bf16 v[92:95], a[128:131], v[76:79], v[92:95]
    s_waitcnt lgkmcnt(13)
    v_exp_f32 v191, v191
    v_mfma_f32_16x16x32_bf16 v[112:115], a[144:147], v[64:67], v[224:227]
    s_waitcnt lgkmcnt(12)
    buffer_load_dwordx4 v17, s[20:23], s41 offen offset:3072 lds
    v_cvt_pk_bf16_f32 v63, v190, v191
    v_mfma_f32_16x16x32_bf16 v[112:115], a[148:151], v[96:99], v[112:115]
    s_waitcnt lgkmcnt(11)
    s_add_u32 s41, s41, 16384
    v_exp_f32 v80, v80
    v_mfma_f32_16x16x32_bf16 v[112:115], a[152:155], v[128:131], v[112:115]
    s_waitcnt lgkmcnt(10)
    ds_read_b64_tr_b16 a[196:197], v6 offset:57344
    v_add_f32 v240, v240, v80
    v_mfma_f32_16x16x32_bf16 v[112:115], a[156:159], v[160:163], v[112:115]
    v_exp_f32 v81, v81
    v_mfma_f32_16x16x32_bf16 v[116:119], a[156:159], v[164:167], v[228:231]
    ds_read_b64_tr_b16 a[198:199], v6 offset:61440
    v_add_f32 v240, v240, v81
    v_mfma_f32_16x16x32_bf16 v[116:119], a[152:155], v[132:135], v[116:119]
    v_exp_f32 v82, v82
    v_mfma_f32_16x16x32_bf16 v[116:119], a[148:151], v[100:103], v[116:119]
    ds_read_b64_tr_b16 a[200:201], v7 offset:49152
    v_cvt_pk_bf16_f32 v192, v80, v81
    v_mfma_f32_16x16x32_bf16 v[116:119], a[144:147], v[68:71], v[116:119]
    v_exp_f32 v83, v83
    v_mfma_f32_16x16x32_bf16 v[120:123], a[144:147], v[72:75], v[232:235]
    ds_read_b64_tr_b16 a[202:203], v7 offset:53248
    v_add_f32 v240, v240, v82
    v_mfma_f32_16x16x32_bf16 v[120:123], a[148:151], v[104:107], v[120:123]
    v_exp_f32 v84, v84
    v_mfma_f32_16x16x32_bf16 v[120:123], a[152:155], v[136:139], v[120:123]
    ds_read_b64_tr_b16 a[204:205], v7 offset:57344
    v_add_f32 v240, v240, v83
    v_mfma_f32_16x16x32_bf16 v[120:123], a[156:159], v[168:171], v[120:123]
    v_exp_f32 v85, v85
    v_mfma_f32_16x16x32_bf16 v[124:127], a[156:159], v[172:175], v[236:239]
    ds_read_b64_tr_b16 a[206:207], v7 offset:61440
    v_cvt_pk_bf16_f32 v193, v82, v83
    v_mfma_f32_16x16x32_bf16 v[124:127], a[152:155], v[140:143], v[124:127]
    v_exp_f32 v86, v86
    v_mfma_f32_16x16x32_bf16 v[124:127], a[148:151], v[108:111], v[124:127]
    ds_read_b64_tr_b16 a[208:209], v8 offset:49152
    v_add_f32 v241, v241, v84
    v_mfma_f32_16x16x32_bf16 v[124:127], a[144:147], v[76:79], v[124:127]
    s_waitcnt lgkmcnt(15)
    s_add_u32 m0, s40, 32768
    v_exp_f32 v87, v87
    v_mfma_f32_16x16x32_bf16 v[144:147], a[160:163], v[64:67], v[224:227]
    s_waitcnt lgkmcnt(15)
    buffer_load_dwordx4 v18, s[24:27], s42 offen offset:0 lds
    v_mfma_f32_16x16x32_bf16 v[144:147], a[164:167], v[96:99], v[144:147]
    s_waitcnt lgkmcnt(14)
    v_exp_f32 v88, v88
    v_mfma_f32_16x16x32_bf16 v[144:147], a[168:171], v[128:131], v[144:147]
    s_waitcnt lgkmcnt(13)
    ds_read_b64_tr_b16 a[210:211], v8 offset:53248
    v_add_f32 v241, v241, v85
    v_mfma_f32_16x16x32_bf16 v[144:147], a[172:175], v[160:163], v[144:147]
    v_exp_f32 v89, v89
    v_mfma_f32_16x16x32_bf16 v[148:151], a[172:175], v[164:167], v[228:231]
    ds_read_b64_tr_b16 a[212:213], v8 offset:57344
    v_cvt_pk_bf16_f32 v196, v84, v85
    v_mfma_f32_16x16x32_bf16 v[148:151], a[168:171], v[132:135], v[148:151]
    v_exp_f32 v90, v90
    v_mfma_f32_16x16x32_bf16 v[148:151], a[164:167], v[100:103], v[148:151]
    ds_read_b64_tr_b16 a[214:215], v8 offset:61440
    v_add_f32 v241, v241, v86
    v_mfma_f32_16x16x32_bf16 v[148:151], a[160:163], v[68:71], v[148:151]
    v_exp_f32 v91, v91
    v_mfma_f32_16x16x32_bf16 v[152:155], a[160:163], v[72:75], v[232:235]
    ds_read_b64_tr_b16 a[216:217], v9 offset:49152
    v_add_f32 v241, v241, v87
    v_mfma_f32_16x16x32_bf16 v[152:155], a[164:167], v[104:107], v[152:155]
    v_exp_f32 v92, v92
    v_mfma_f32_16x16x32_bf16 v[152:155], a[168:171], v[136:139], v[152:155]
    ds_read_b64_tr_b16 a[218:219], v9 offset:53248
    v_cvt_pk_bf16_f32 v197, v86, v87
    v_mfma_f32_16x16x32_bf16 v[152:155], a[172:175], v[168:171], v[152:155]
    v_exp_f32 v93, v93
    v_mfma_f32_16x16x32_bf16 v[156:159], a[172:175], v[172:175], v[236:239]
    ds_read_b64_tr_b16 a[220:221], v9 offset:57344
    v_cvt_pk_bf16_f32 v200, v88, v89
    v_mfma_f32_16x16x32_bf16 v[156:159], a[168:171], v[140:143], v[156:159]
    v_exp_f32 v94, v94
    v_mfma_f32_16x16x32_bf16 v[156:159], a[164:167], v[108:111], v[156:159]
    ds_read_b64_tr_b16 a[222:223], v9 offset:61440
    v_cvt_pk_bf16_f32 v201, v90, v91
    v_mfma_f32_16x16x32_bf16 v[156:159], a[160:163], v[76:79], v[156:159]
    s_waitcnt lgkmcnt(15)
    v_exp_f32 v95, v95
    v_mfma_f32_16x16x32_bf16 v[176:179], a[176:179], v[64:67], v[224:227]
    s_waitcnt lgkmcnt(15)
    buffer_load_dwordx4 v19, s[24:27], s42 offen offset:1024 lds
    v_mfma_f32_16x16x32_bf16 v[176:179], a[180:183], v[96:99], v[176:179]
    s_waitcnt lgkmcnt(15)
    v_exp_f32 v112, v112
    v_mfma_f32_16x16x32_bf16 v[176:179], a[184:187], v[128:131], v[176:179]
    s_waitcnt lgkmcnt(15)
    ds_read_b64_tr_b16 a[224:225], v10 offset:49152
    v_cvt_pk_bf16_f32 v204, v92, v93
    v_mfma_f32_16x16x32_bf16 v[176:179], a[188:191], v[160:163], v[176:179]
    v_exp_f32 v113, v113
    v_mfma_f32_16x16x32_bf16 v[180:183], a[188:191], v[164:167], v[228:231]
    ds_read_b64_tr_b16 a[226:227], v10 offset:53248
    v_cvt_pk_bf16_f32 v205, v94, v95
    v_mfma_f32_16x16x32_bf16 v[180:183], a[184:187], v[132:135], v[180:183]
    v_exp_f32 v114, v114
    v_mfma_f32_16x16x32_bf16 v[180:183], a[180:183], v[100:103], v[180:183]
    ds_read_b64_tr_b16 a[228:229], v10 offset:57344
    v_add_f32 v240, v240, v112
    v_mfma_f32_16x16x32_bf16 v[180:183], a[176:179], v[68:71], v[180:183]
    v_exp_f32 v115, v115
    v_mfma_f32_16x16x32_bf16 v[184:187], a[176:179], v[72:75], v[232:235]
    ds_read_b64_tr_b16 a[230:231], v10 offset:61440
    v_add_f32 v240, v240, v113
    v_mfma_f32_16x16x32_bf16 v[184:187], a[180:183], v[104:107], v[184:187]
    v_exp_f32 v116, v116
    v_mfma_f32_16x16x32_bf16 v[184:187], a[184:187], v[136:139], v[184:187]
    ds_read_b64_tr_b16 a[232:233], v11 offset:49152
    v_cvt_pk_bf16_f32 v194, v112, v113
    v_mfma_f32_16x16x32_bf16 v[184:187], a[188:191], v[168:171], v[184:187]
    v_exp_f32 v117, v117
    v_mfma_f32_16x16x32_bf16 v[188:191], a[188:191], v[172:175], v[236:239]
    ds_read_b64_tr_b16 a[234:235], v11 offset:53248
    v_add_f32 v240, v240, v114
    v_mfma_f32_16x16x32_bf16 v[188:191], a[184:187], v[140:143], v[188:191]
    v_exp_f32 v118, v118
    v_mfma_f32_16x16x32_bf16 v[188:191], a[180:183], v[108:111], v[188:191]
    ds_read_b64_tr_b16 a[236:237], v11 offset:57344
    v_add_f32 v240, v240, v115
    v_mfma_f32_16x16x32_bf16 v[188:191], a[176:179], v[76:79], v[188:191]
    s_waitcnt lgkmcnt(15)
    v_exp_f32 v119, v119
    v_mfma_f32_16x16x32_bf16 a[0:3], a[192:195], v[32:35], a[0:3]
    s_waitcnt lgkmcnt(15)
    buffer_load_dwordx4 v18, s[24:27], s42 offen offset:2048 lds
    v_mfma_f32_16x16x32_bf16 a[0:3], a[196:199], v[48:51], a[0:3]
    v_exp_f32 v120, v120
    v_mfma_f32_16x16x32_bf16 a[4:7], a[192:195], v[36:39], a[4:7]
    ds_read_b64_tr_b16 a[238:239], v11 offset:61440
    v_cvt_pk_bf16_f32 v195, v114, v115
    v_mfma_f32_16x16x32_bf16 a[4:7], a[196:199], v[52:55], a[4:7]
    v_exp_f32 v121, v121
    v_mfma_f32_16x16x32_bf16 a[8:11], a[192:195], v[40:43], a[8:11]
    ds_read_b64_tr_b16 a[240:241], v12 offset:49152
    v_add_f32 v241, v241, v116
    v_mfma_f32_16x16x32_bf16 a[8:11], a[196:199], v[56:59], a[8:11]
    v_exp_f32 v122, v122
    v_mfma_f32_16x16x32_bf16 a[12:15], a[192:195], v[44:47], a[12:15]
    ds_read_b64_tr_b16 a[242:243], v12 offset:53248
    v_add_f32 v241, v241, v117
    v_mfma_f32_16x16x32_bf16 a[12:15], a[196:199], v[60:63], a[12:15]
    s_waitcnt lgkmcnt(15)
    v_exp_f32 v123, v123
    v_mfma_f32_16x16x32_bf16 a[16:19], a[200:203], v[32:35], a[16:19]
    s_waitcnt lgkmcnt(15)
    ds_read_b64_tr_b16 a[244:245], v12 offset:57344
    v_cvt_pk_bf16_f32 v198, v116, v117
    v_mfma_f32_16x16x32_bf16 a[16:19], a[204:207], v[48:51], a[16:19]
    v_exp_f32 v124, v124
    v_mfma_f32_16x16x32_bf16 a[20:23], a[200:203], v[36:39], a[20:23]
    ds_read_b64_tr_b16 a[246:247], v12 offset:61440
    v_add_f32 v241, v241, v118
    v_mfma_f32_16x16x32_bf16 a[20:23], a[204:207], v[52:55], a[20:23]
    v_exp_f32 v125, v125
    v_mfma_f32_16x16x32_bf16 a[24:27], a[200:203], v[40:43], a[24:27]
    ds_read_b64_tr_b16 a[248:249], v13 offset:49152
    v_add_f32 v241, v241, v119
    v_mfma_f32_16x16x32_bf16 a[24:27], a[204:207], v[56:59], a[24:27]
    v_exp_f32 v126, v126
    v_mfma_f32_16x16x32_bf16 a[28:31], a[200:203], v[44:47], a[28:31]
    ds_read_b64_tr_b16 a[250:251], v13 offset:53248
    v_cvt_pk_bf16_f32 v199, v118, v119
    v_mfma_f32_16x16x32_bf16 a[28:31], a[204:207], v[60:63], a[28:31]
    s_waitcnt lgkmcnt(15)
    v_exp_f32 v127, v127
    v_mfma_f32_16x16x32_bf16 a[32:35], a[208:211], v[32:35], a[32:35]
    s_waitcnt lgkmcnt(15)
    buffer_load_dwordx4 v19, s[24:27], s42 offen offset:3072 lds
    v_mfma_f32_16x16x32_bf16 a[32:35], a[212:215], v[48:51], a[32:35]
    s_add_u32 s42, s42, 16384
    v_exp_f32 v144, v144
    v_mfma_f32_16x16x32_bf16 a[36:39], a[208:211], v[36:39], a[36:39]
    ds_read_b64_tr_b16 a[252:253], v13 offset:57344
    v_cvt_pk_bf16_f32 v202, v120, v121
    v_mfma_f32_16x16x32_bf16 a[36:39], a[212:215], v[52:55], a[36:39]
    v_exp_f32 v145, v145
    v_mfma_f32_16x16x32_bf16 a[40:43], a[208:211], v[40:43], a[40:43]
    ds_read_b64_tr_b16 a[254:255], v13 offset:61440
    v_cvt_pk_bf16_f32 v203, v122, v123
    v_mfma_f32_16x16x32_bf16 a[40:43], a[212:215], v[56:59], a[40:43]
    v_exp_f32 v146, v146
    v_mfma_f32_16x16x32_bf16 a[44:47], a[208:211], v[44:47], a[44:47]
    v_cvt_pk_bf16_f32 v206, v124, v125
    v_cvt_pk_bf16_f32 v207, v126, v127
    v_mfma_f32_16x16x32_bf16 a[44:47], a[212:215], v[60:63], a[44:47]
    s_waitcnt lgkmcnt(15)
    v_exp_f32 v147, v147
    v_mfma_f32_16x16x32_bf16 a[48:51], a[216:219], v[32:35], a[48:51]
    s_waitcnt lgkmcnt(15)
    v_add_f32 v240, v240, v144
    v_add_f32 v240, v240, v145
    v_mfma_f32_16x16x32_bf16 a[48:51], a[220:223], v[48:51], a[48:51]
    v_exp_f32 v148, v148
    v_mfma_f32_16x16x32_bf16 a[52:55], a[216:219], v[36:39], a[52:55]
    v_cvt_pk_bf16_f32 v208, v144, v145
    v_add_f32 v240, v240, v146
    v_mfma_f32_16x16x32_bf16 a[52:55], a[220:223], v[52:55], a[52:55]
    s_waitcnt lgkmcnt(0)
    s_waitcnt vmcnt(16)
    v_exp_f32 v149, v149
    v_mfma_f32_16x16x32_bf16 a[56:59], a[216:219], v[40:43], a[56:59]
    s_barrier
    v_add_f32 v240, v240, v147
    s_or_b32 s52, s3, s60
    s_cbranch_scc1 L_skip_h
    v_mov_b32 v243, 1
    s_mov_b64 exec, 1
    buffer_atomic_add v243, off, s[72:75], s53 sc1
    s_mov_b64 exec, -1
L_skip_h:
    v_mfma_f32_16x16x32_bf16 a[56:59], a[220:223], v[56:59], a[56:59]
    v_exp_f32 v150, v150
    v_mfma_f32_16x16x32_bf16 a[60:63], a[216:219], v[44:47], a[60:63]
    ds_read_b128 a[128:131], v2 offset:16384
    v_cvt_pk_bf16_f32 v209, v146, v147
    v_mfma_f32_16x16x32_bf16 a[60:63], a[220:223], v[60:63], a[60:63]
    v_exp_f32 v151, v151
    v_mfma_f32_16x16x32_bf16 a[64:67], a[224:227], v[32:35], a[64:67]
    ds_read_b128 a[132:135], v3 offset:16384
    v_add_f32 v241, v241, v148
    v_mfma_f32_16x16x32_bf16 a[64:67], a[228:231], v[48:51], a[64:67]
    v_exp_f32 v152, v152
    v_mfma_f32_16x16x32_bf16 a[68:71], a[224:227], v[36:39], a[68:71]
    v_add_f32 v241, v241, v149
    v_cvt_pk_bf16_f32 v212, v148, v149
    v_mfma_f32_16x16x32_bf16 a[68:71], a[228:231], v[52:55], a[68:71]
    v_exp_f32 v153, v153
    v_mfma_f32_16x16x32_bf16 a[72:75], a[224:227], v[40:43], a[72:75]
    v_mfma_f32_16x16x32_bf16 a[72:75], a[228:231], v[56:59], a[72:75]
    v_exp_f32 v154, v154
    v_mfma_f32_16x16x32_bf16 a[76:79], a[224:227], v[44:47], a[76:79]
    ds_read_b128 a[136:139], v4 offset:16384
    v_add_f32 v241, v241, v150
    v_mfma_f32_16x16x32_bf16 a[76:79], a[228:231], v[60:63], a[76:79]
    v_exp_f32 v155, v155
    v_mfma_f32_16x16x32_bf16 a[80:83], a[232:235], v[32:35], a[80:83]
    ds_read_b128 a[140:143], v5 offset:16384
    v_add_f32 v241, v241, v151
    v_mfma_f32_16x16x32_bf16 a[80:83], a[236:239], v[48:51], a[80:83]
    v_exp_f32 v156, v156
    v_mfma_f32_16x16x32_bf16 a[84:87], a[232:235], v[36:39], a[84:87]
    v_cvt_pk_bf16_f32 v213, v150, v151
    v_cvt_pk_bf16_f32 v216, v152, v153
    v_mfma_f32_16x16x32_bf16 a[84:87], a[236:239], v[52:55], a[84:87]
    v_exp_f32 v157, v157
    v_mfma_f32_16x16x32_bf16 a[88:91], a[232:235], v[40:43], a[88:91]
    ds_read_b128 a[144:147], v2 offset:20480
    v_cvt_pk_bf16_f32 v217, v154, v155
    v_mfma_f32_16x16x32_bf16 a[88:91], a[236:239], v[56:59], a[88:91]
    v_exp_f32 v158, v158
    v_mfma_f32_16x16x32_bf16 a[92:95], a[232:235], v[44:47], a[92:95]
    ds_read_b128 a[148:151], v3 offset:20480
    v_cvt_pk_bf16_f32 v220, v156, v157
    v_mfma_f32_16x16x32_bf16 a[92:95], a[236:239], v[60:63], a[92:95]
    v_exp_f32 v159, v159
    v_mfma_f32_16x16x32_bf16 a[96:99], a[240:243], v[32:35], a[96:99]
    v_cvt_pk_bf16_f32 v221, v158, v159
    v_mfma_f32_16x16x32_bf16 a[96:99], a[244:247], v[48:51], a[96:99]
    v_exp_f32 v176, v176
    v_mfma_f32_16x16x32_bf16 a[100:103], a[240:243], v[36:39], a[100:103]
    ds_read_b128 a[152:155], v4 offset:20480
    v_add_f32 v240, v240, v176
    v_mfma_f32_16x16x32_bf16 a[100:103], a[244:247], v[52:55], a[100:103]
    v_exp_f32 v177, v177
    v_mfma_f32_16x16x32_bf16 a[104:107], a[240:243], v[40:43], a[104:107]
    v_mfma_f32_16x16x32_bf16 a[104:107], a[244:247], v[56:59], a[104:107]
    v_exp_f32 v178, v178
    v_mfma_f32_16x16x32_bf16 a[108:111], a[240:243], v[44:47], a[108:111]
    ds_read_b128 a[156:159], v5 offset:20480
    v_add_f32 v240, v240, v177
    v_mfma_f32_16x16x32_bf16 a[108:111], a[244:247], v[60:63], a[108:111]
    v_exp_f32 v179, v179
    v_mfma_f32_16x16x32_bf16 a[112:115], a[248:251], v[32:35], a[112:115]
    v_cvt_pk_bf16_f32 v210, v176, v177
    v_add_f32 v240, v240, v178
    v_mfma_f32_16x16x32_bf16 a[112:115], a[252:255], v[48:51], a[112:115]
    v_exp_f32 v180, v180
    v_mfma_f32_16x16x32_bf16 a[116:119], a[248:251], v[36:39], a[116:119]
    ds_read_b128 a[160:163], v2 offset:24576
    v_add_f32 v240, v240, v179
    v_mfma_f32_16x16x32_bf16 a[116:119], a[252:255], v[52:55], a[116:119]
    v_exp_f32 v181, v181
    v_mfma_f32_16x16x32_bf16 a[120:123], a[248:251], v[40:43], a[120:123]
    ds_read_b128 a[164:167], v3 offset:24576
    v_cvt_pk_bf16_f32 v211, v178, v179
    v_mfma_f32_16x16x32_bf16 a[120:123], a[252:255], v[56:59], a[120:123]
    v_exp_f32 v182, v182
    v_mfma_f32_16x16x32_bf16 a[124:127], a[248:251], v[44:47], a[124:127]
    v_add_f32 v241, v241, v180
    v_add_f32 v241, v241, v181
    v_mfma_f32_16x16x32_bf16 a[124:127], a[252:255], v[60:63], a[124:127]
    v_exp_f32 v183, v183
    v_mfma_f32_16x16x32_bf16 v[248:251], v[244:247], v[44:47], v[248:251]
    ds_read_b128 a[168:171], v4 offset:24576
    v_cvt_pk_bf16_f32 v214, v180, v181
    v_mfma_f32_16x16x32_bf16 v[248:251], v[244:247], v[60:63], v[248:251]
    ds_read_b128 a[172:175], v5 offset:24576
    v_add_f32 v241, v241, v182
    v_mfma_f32_16x16x32_bf16 v[252:255], v[244:247], v[40:43], v[252:255]
    v_add_f32 v241, v241, v183
    v_cvt_pk_bf16_f32 v215, v182, v183
    v_mfma_f32_16x16x32_bf16 v[252:255], v[244:247], v[56:59], v[252:255]
    s_waitcnt lgkmcnt(11)
    ds_read_b128 a[176:179], v2 offset:28672
    v_mfma_f32_16x16x32_bf16 v[80:83], a[128:131], v[64:67], v[224:227]
    s_waitcnt lgkmcnt(11)
    v_mfma_f32_16x16x32_bf16 v[80:83], a[132:135], v[96:99], v[80:83]
    s_waitcnt lgkmcnt(10)
    v_exp_f32 v184, v184
    v_mfma_f32_16x16x32_bf16 v[80:83], a[136:139], v[128:131], v[80:83]
    s_waitcnt lgkmcnt(9)
    ds_read_b128 a[180:183], v3 offset:28672
    v_mfma_f32_16x16x32_bf16 v[80:83], a[140:143], v[160:163], v[80:83]
    v_exp_f32 v185, v185
    v_mfma_f32_16x16x32_bf16 v[84:87], a[140:143], v[164:167], v[228:231]
    v_cvt_pk_bf16_f32 v218, v184, v185
    v_mfma_f32_16x16x32_bf16 v[84:87], a[136:139], v[132:135], v[84:87]
    v_exp_f32 v186, v186
    v_mfma_f32_16x16x32_bf16 v[84:87], a[132:135], v[100:103], v[84:87]
    ds_read_b128 a[184:187], v4 offset:28672
    v_mfma_f32_16x16x32_bf16 v[84:87], a[128:131], v[68:71], v[84:87]
    v_exp_f32 v187, v187
    v_mfma_f32_16x16x32_bf16 v[88:91], a[128:131], v[72:75], v[232:235]
    ds_read_b128 a[188:191], v5 offset:28672
    v_cvt_pk_bf16_f32 v219, v186, v187
    v_mfma_f32_16x16x32_bf16 v[88:91], a[132:135], v[104:107], v[88:91]
    v_exp_f32 v188, v188
    v_mfma_f32_16x16x32_bf16 v[88:91], a[136:139], v[136:139], v[88:91]
    v_mfma_f32_16x16x32_bf16 v[88:91], a[140:143], v[168:171], v[88:91]
    v_exp_f32 v189, v189
    v_mfma_f32_16x16x32_bf16 v[92:95], a[140:143], v[172:175], v[236:239]
    ds_read_b64_tr_b16 a[192:193], v6 offset:32768
    v_cvt_pk_bf16_f32 v222, v188, v189
    v_mfma_f32_16x16x32_bf16 v[92:95], a[136:139], v[140:143], v[92:95]
    v_exp_f32 v190, v190
    v_mfma_f32_16x16x32_bf16 v[92:95], a[132:135], v[108:111], v[92:95]
    ds_read_b64_tr_b16 a[194:195], v6 offset:36864
    v_mfma_f32_16x16x32_bf16 v[92:95], a[128:131], v[76:79], v[92:95]
    s_waitcnt lgkmcnt(13)
    v_exp_f32 v191, v191
    v_mfma_f32_16x16x32_bf16 v[112:115], a[144:147], v[64:67], v[224:227]
    s_waitcnt lgkmcnt(12)
    v_cvt_pk_bf16_f32 v223, v190, v191
    v_mfma_f32_16x16x32_bf16 v[112:115], a[148:151], v[96:99], v[112:115]
    s_waitcnt lgkmcnt(11)
    v_exp_f32 v80, v80
    v_mfma_f32_16x16x32_bf16 v[112:115], a[152:155], v[128:131], v[112:115]
    s_waitcnt lgkmcnt(10)
    ds_read_b64_tr_b16 a[196:197], v6 offset:40960
    v_add_f32 v240, v240, v80
    v_mfma_f32_16x16x32_bf16 v[112:115], a[156:159], v[160:163], v[112:115]
    v_exp_f32 v81, v81
    v_mfma_f32_16x16x32_bf16 v[116:119], a[156:159], v[164:167], v[228:231]
    ds_read_b64_tr_b16 a[198:199], v6 offset:45056
    v_add_f32 v240, v240, v81
    v_mfma_f32_16x16x32_bf16 v[116:119], a[152:155], v[132:135], v[116:119]
    v_exp_f32 v82, v82
    v_mfma_f32_16x16x32_bf16 v[116:119], a[148:151], v[100:103], v[116:119]
    ds_read_b64_tr_b16 a[200:201], v7 offset:32768
    v_cvt_pk_bf16_f32 v32, v80, v81
    v_mfma_f32_16x16x32_bf16 v[116:119], a[144:147], v[68:71], v[116:119]
    v_exp_f32 v83, v83
    v_mfma_f32_16x16x32_bf16 v[120:123], a[144:147], v[72:75], v[232:235]
    ds_read_b64_tr_b16 a[202:203], v7 offset:36864
    v_add_f32 v240, v240, v82
    v_mfma_f32_16x16x32_bf16 v[120:123], a[148:151], v[104:107], v[120:123]
    v_exp_f32 v84, v84
    v_mfma_f32_16x16x32_bf16 v[120:123], a[152:155], v[136:139], v[120:123]
    ds_read_b64_tr_b16 a[204:205], v7 offset:40960
    v_add_f32 v240, v240, v83
    v_mfma_f32_16x16x32_bf16 v[120:123], a[156:159], v[168:171], v[120:123]
    v_exp_f32 v85, v85
    v_mfma_f32_16x16x32_bf16 v[124:127], a[156:159], v[172:175], v[236:239]
    ds_read_b64_tr_b16 a[206:207], v7 offset:45056
    v_cvt_pk_bf16_f32 v33, v82, v83
    v_mfma_f32_16x16x32_bf16 v[124:127], a[152:155], v[140:143], v[124:127]
    v_exp_f32 v86, v86
    v_mfma_f32_16x16x32_bf16 v[124:127], a[148:151], v[108:111], v[124:127]
    ds_read_b64_tr_b16 a[208:209], v8 offset:32768
    v_add_f32 v241, v241, v84
    v_mfma_f32_16x16x32_bf16 v[124:127], a[144:147], v[76:79], v[124:127]
    s_waitcnt lgkmcnt(15)
    v_exp_f32 v87, v87
    v_mfma_f32_16x16x32_bf16 v[144:147], a[160:163], v[64:67], v[224:227]
    s_waitcnt lgkmcnt(15)
    v_mfma_f32_16x16x32_bf16 v[144:147], a[164:167], v[96:99], v[144:147]
    s_waitcnt lgkmcnt(14)
    v_exp_f32 v88, v88
    v_mfma_f32_16x16x32_bf16 v[144:147], a[168:171], v[128:131], v[144:147]
    s_waitcnt lgkmcnt(13)
    ds_read_b64_tr_b16 a[210:211], v8 offset:36864
    v_add_f32 v241, v241, v85
    v_mfma_f32_16x16x32_bf16 v[144:147], a[172:175], v[160:163], v[144:147]
    v_exp_f32 v89, v89
    v_mfma_f32_16x16x32_bf16 v[148:151], a[172:175], v[164:167], v[228:231]
    ds_read_b64_tr_b16 a[212:213], v8 offset:40960
    v_cvt_pk_bf16_f32 v36, v84, v85
    v_mfma_f32_16x16x32_bf16 v[148:151], a[168:171], v[132:135], v[148:151]
    v_exp_f32 v90, v90
    v_mfma_f32_16x16x32_bf16 v[148:151], a[164:167], v[100:103], v[148:151]
    ds_read_b64_tr_b16 a[214:215], v8 offset:45056
    v_add_f32 v241, v241, v86
    v_mfma_f32_16x16x32_bf16 v[148:151], a[160:163], v[68:71], v[148:151]
    v_exp_f32 v91, v91
    v_mfma_f32_16x16x32_bf16 v[152:155], a[160:163], v[72:75], v[232:235]
    ds_read_b64_tr_b16 a[216:217], v9 offset:32768
    v_add_f32 v241, v241, v87
    v_mfma_f32_16x16x32_bf16 v[152:155], a[164:167], v[104:107], v[152:155]
    v_exp_f32 v92, v92
    v_mfma_f32_16x16x32_bf16 v[152:155], a[168:171], v[136:139], v[152:155]
    ds_read_b64_tr_b16 a[218:219], v9 offset:36864
    v_cvt_pk_bf16_f32 v37, v86, v87
    v_mfma_f32_16x16x32_bf16 v[152:155], a[172:175], v[168:171], v[152:155]
    v_exp_f32 v93, v93
    v_mfma_f32_16x16x32_bf16 v[156:159], a[172:175], v[172:175], v[236:239]
    ds_read_b64_tr_b16 a[220:221], v9 offset:40960
    v_cvt_pk_bf16_f32 v40, v88, v89
    v_mfma_f32_16x16x32_bf16 v[156:159], a[168:171], v[140:143], v[156:159]
    v_exp_f32 v94, v94
    v_mfma_f32_16x16x32_bf16 v[156:159], a[164:167], v[108:111], v[156:159]
    ds_read_b64_tr_b16 a[222:223], v9 offset:45056
    v_cvt_pk_bf16_f32 v41, v90, v91
    v_mfma_f32_16x16x32_bf16 v[156:159], a[160:163], v[76:79], v[156:159]
    s_waitcnt lgkmcnt(15)
    v_exp_f32 v95, v95
    v_mfma_f32_16x16x32_bf16 v[176:179], a[176:179], v[64:67], v[224:227]
    s_waitcnt lgkmcnt(15)
    v_mfma_f32_16x16x32_bf16 v[176:179], a[180:183], v[96:99], v[176:179]
    s_waitcnt lgkmcnt(15)
    v_exp_f32 v112, v112
    v_mfma_f32_16x16x32_bf16 v[176:179], a[184:187], v[128:131], v[176:179]
    s_waitcnt lgkmcnt(15)
    ds_read_b64_tr_b16 a[224:225], v10 offset:32768
    v_cvt_pk_bf16_f32 v44, v92, v93
    v_mfma_f32_16x16x32_bf16 v[176:179], a[188:191], v[160:163], v[176:179]
    v_exp_f32 v113, v113
    v_mfma_f32_16x16x32_bf16 v[180:183], a[188:191], v[164:167], v[228:231]
    ds_read_b64_tr_b16 a[226:227], v10 offset:36864
    v_cvt_pk_bf16_f32 v45, v94, v95
    v_mfma_f32_16x16x32_bf16 v[180:183], a[184:187], v[132:135], v[180:183]
    v_exp_f32 v114, v114
    v_mfma_f32_16x16x32_bf16 v[180:183], a[180:183], v[100:103], v[180:183]
    ds_read_b64_tr_b16 a[228:229], v10 offset:40960
    v_add_f32 v240, v240, v112
    v_mfma_f32_16x16x32_bf16 v[180:183], a[176:179], v[68:71], v[180:183]
    v_exp_f32 v115, v115
    v_mfma_f32_16x16x32_bf16 v[184:187], a[176:179], v[72:75], v[232:235]
    ds_read_b64_tr_b16 a[230:231], v10 offset:45056
    v_add_f32 v240, v240, v113
    v_mfma_f32_16x16x32_bf16 v[184:187], a[180:183], v[104:107], v[184:187]
    v_exp_f32 v116, v116
    v_mfma_f32_16x16x32_bf16 v[184:187], a[184:187], v[136:139], v[184:187]
    ds_read_b64_tr_b16 a[232:233], v11 offset:32768
    v_cvt_pk_bf16_f32 v34, v112, v113
    v_mfma_f32_16x16x32_bf16 v[184:187], a[188:191], v[168:171], v[184:187]
    v_exp_f32 v117, v117
    v_mfma_f32_16x16x32_bf16 v[188:191], a[188:191], v[172:175], v[236:239]
    ds_read_b64_tr_b16 a[234:235], v11 offset:36864
    v_add_f32 v240, v240, v114
    v_mfma_f32_16x16x32_bf16 v[188:191], a[184:187], v[140:143], v[188:191]
    v_exp_f32 v118, v118
    v_mfma_f32_16x16x32_bf16 v[188:191], a[180:183], v[108:111], v[188:191]
    ds_read_b64_tr_b16 a[236:237], v11 offset:40960
    v_add_f32 v240, v240, v115
    v_mfma_f32_16x16x32_bf16 v[188:191], a[176:179], v[76:79], v[188:191]
    s_waitcnt lgkmcnt(15)
    v_exp_f32 v119, v119
    v_mfma_f32_16x16x32_bf16 a[0:3], a[192:195], v[192:195], a[0:3]
    s_waitcnt lgkmcnt(15)
    v_mfma_f32_16x16x32_bf16 a[0:3], a[196:199], v[208:211], a[0:3]
    v_exp_f32 v120, v120
    v_mfma_f32_16x16x32_bf16 a[4:7], a[192:195], v[196:199], a[4:7]
    ds_read_b64_tr_b16 a[238:239], v11 offset:45056
    v_cvt_pk_bf16_f32 v35, v114, v115
    v_mfma_f32_16x16x32_bf16 a[4:7], a[196:199], v[212:215], a[4:7]
    v_exp_f32 v121, v121
    v_mfma_f32_16x16x32_bf16 a[8:11], a[192:195], v[200:203], a[8:11]
    ds_read_b64_tr_b16 a[240:241], v12 offset:32768
    v_add_f32 v241, v241, v116
    v_mfma_f32_16x16x32_bf16 a[8:11], a[196:199], v[216:219], a[8:11]
    v_exp_f32 v122, v122
    v_mfma_f32_16x16x32_bf16 a[12:15], a[192:195], v[204:207], a[12:15]
    ds_read_b64_tr_b16 a[242:243], v12 offset:36864
    v_add_f32 v241, v241, v117
    v_mfma_f32_16x16x32_bf16 a[12:15], a[196:199], v[220:223], a[12:15]
    s_waitcnt lgkmcnt(15)
    v_exp_f32 v123, v123
    v_mfma_f32_16x16x32_bf16 a[16:19], a[200:203], v[192:195], a[16:19]
    s_waitcnt lgkmcnt(15)
    ds_read_b64_tr_b16 a[244:245], v12 offset:40960
    v_cvt_pk_bf16_f32 v38, v116, v117
    v_mfma_f32_16x16x32_bf16 a[16:19], a[204:207], v[208:211], a[16:19]
    v_exp_f32 v124, v124
    v_mfma_f32_16x16x32_bf16 a[20:23], a[200:203], v[196:199], a[20:23]
    ds_read_b64_tr_b16 a[246:247], v12 offset:45056
    v_add_f32 v241, v241, v118
    v_mfma_f32_16x16x32_bf16 a[20:23], a[204:207], v[212:215], a[20:23]
    v_exp_f32 v125, v125
    v_mfma_f32_16x16x32_bf16 a[24:27], a[200:203], v[200:203], a[24:27]
    ds_read_b64_tr_b16 a[248:249], v13 offset:32768
    v_add_f32 v241, v241, v119
    v_mfma_f32_16x16x32_bf16 a[24:27], a[204:207], v[216:219], a[24:27]
    v_exp_f32 v126, v126
    v_mfma_f32_16x16x32_bf16 a[28:31], a[200:203], v[204:207], a[28:31]
    ds_read_b64_tr_b16 a[250:251], v13 offset:36864
    v_cvt_pk_bf16_f32 v39, v118, v119
    v_mfma_f32_16x16x32_bf16 a[28:31], a[204:207], v[220:223], a[28:31]
    s_waitcnt lgkmcnt(15)
    v_exp_f32 v127, v127
    v_mfma_f32_16x16x32_bf16 a[32:35], a[208:211], v[192:195], a[32:35]
    s_waitcnt lgkmcnt(15)
    v_mfma_f32_16x16x32_bf16 a[32:35], a[212:215], v[208:211], a[32:35]
    v_exp_f32 v144, v144
    v_mfma_f32_16x16x32_bf16 a[36:39], a[208:211], v[196:199], a[36:39]
    ds_read_b64_tr_b16 a[252:253], v13 offset:40960
    v_cvt_pk_bf16_f32 v42, v120, v121
    v_mfma_f32_16x16x32_bf16 a[36:39], a[212:215], v[212:215], a[36:39]
    v_exp_f32 v145, v145
    v_mfma_f32_16x16x32_bf16 a[40:43], a[208:211], v[200:203], a[40:43]
    ds_read_b64_tr_b16 a[254:255], v13 offset:45056
    v_cvt_pk_bf16_f32 v43, v122, v123
    v_mfma_f32_16x16x32_bf16 a[40:43], a[212:215], v[216:219], a[40:43]
    v_exp_f32 v146, v146
    v_mfma_f32_16x16x32_bf16 a[44:47], a[208:211], v[204:207], a[44:47]
    v_cvt_pk_bf16_f32 v46, v124, v125
    v_cvt_pk_bf16_f32 v47, v126, v127
    v_mfma_f32_16x16x32_bf16 a[44:47], a[212:215], v[220:223], a[44:47]
    s_waitcnt lgkmcnt(15)
    v_exp_f32 v147, v147
    v_mfma_f32_16x16x32_bf16 a[48:51], a[216:219], v[192:195], a[48:51]
    s_waitcnt lgkmcnt(15)
    v_add_f32 v240, v240, v144
    v_add_f32 v240, v240, v145
    v_mfma_f32_16x16x32_bf16 a[48:51], a[220:223], v[208:211], a[48:51]
    v_exp_f32 v148, v148
    v_mfma_f32_16x16x32_bf16 a[52:55], a[216:219], v[196:199], a[52:55]
    v_cvt_pk_bf16_f32 v48, v144, v145
    v_add_f32 v240, v240, v146
    v_mfma_f32_16x16x32_bf16 a[52:55], a[220:223], v[212:215], a[52:55]
    s_waitcnt lgkmcnt(0)
    s_waitcnt vmcnt(8)
    s_waitcnt vmcnt(0)
    v_exp_f32 v149, v149
    v_mfma_f32_16x16x32_bf16 a[56:59], a[216:219], v[200:203], a[56:59]
    s_barrier
    v_add_f32 v240, v240, v147
    v_mfma_f32_16x16x32_bf16 a[56:59], a[220:223], v[216:219], a[56:59]
    v_exp_f32 v150, v150
    v_mfma_f32_16x16x32_bf16 a[60:63], a[216:219], v[204:207], a[60:63]
    ds_read_b128 a[128:131], v2 offset:0
    v_cvt_pk_bf16_f32 v49, v146, v147
    v_mfma_f32_16x16x32_bf16 a[60:63], a[220:223], v[220:223], a[60:63]
    v_exp_f32 v151, v151
    v_mfma_f32_16x16x32_bf16 a[64:67], a[224:227], v[192:195], a[64:67]
    ds_read_b128 a[132:135], v3 offset:0
    v_add_f32 v241, v241, v148
    v_mfma_f32_16x16x32_bf16 a[64:67], a[228:231], v[208:211], a[64:67]
    v_exp_f32 v152, v152
    v_mfma_f32_16x16x32_bf16 a[68:71], a[224:227], v[196:199], a[68:71]
    v_add_f32 v241, v241, v149
    v_cvt_pk_bf16_f32 v52, v148, v149
    v_mfma_f32_16x16x32_bf16 a[68:71], a[228:231], v[212:215], a[68:71]
    s_add_u32 m0, s79, 73728
    v_exp_f32 v153, v153
    v_mfma_f32_16x16x32_bf16 a[72:75], a[224:227], v[200:203], a[72:75]
    buffer_load_dwordx4 v20, s[8:11], s78 offen offset:0 lds
    v_mfma_f32_16x16x32_bf16 a[72:75], a[228:231], v[216:219], a[72:75]
    v_exp_f32 v154, v154
    v_mfma_f32_16x16x32_bf16 a[76:79], a[224:227], v[204:207], a[76:79]
    ds_read_b128 a[136:139], v4 offset:0
    v_add_f32 v241, v241, v150
    v_mfma_f32_16x16x32_bf16 a[76:79], a[228:231], v[220:223], a[76:79]
    v_exp_f32 v155, v155
    v_mfma_f32_16x16x32_bf16 a[80:83], a[232:235], v[192:195], a[80:83]
    ds_read_b128 a[140:143], v5 offset:0
    v_add_f32 v241, v241, v151
    v_mfma_f32_16x16x32_bf16 a[80:83], a[236:239], v[208:211], a[80:83]
    v_exp_f32 v156, v156
    v_mfma_f32_16x16x32_bf16 a[84:87], a[232:235], v[196:199], a[84:87]
    v_cvt_pk_bf16_f32 v53, v150, v151
    v_cvt_pk_bf16_f32 v56, v152, v153
    v_mfma_f32_16x16x32_bf16 a[84:87], a[236:239], v[212:215], a[84:87]
    v_exp_f32 v157, v157
    v_mfma_f32_16x16x32_bf16 a[88:91], a[232:235], v[200:203], a[88:91]
    ds_read_b128 a[144:147], v2 offset:4096
    v_cvt_pk_bf16_f32 v57, v154, v155
    v_mfma_f32_16x16x32_bf16 a[88:91], a[236:239], v[216:219], a[88:91]
    v_exp_f32 v158, v158
    v_mfma_f32_16x16x32_bf16 a[92:95], a[232:235], v[204:207], a[92:95]
    ds_read_b128 a[148:151], v3 offset:4096
    v_cvt_pk_bf16_f32 v60, v156, v157
    v_mfma_f32_16x16x32_bf16 a[92:95], a[236:239], v[220:223], a[92:95]
    v_exp_f32 v159, v159
    v_mfma_f32_16x16x32_bf16 a[96:99], a[240:243], v[192:195], a[96:99]
    v_cvt_pk_bf16_f32 v61, v158, v159
    v_mfma_f32_16x16x32_bf16 a[96:99], a[244:247], v[208:211], a[96:99]
    v_exp_f32 v176, v176
    v_mfma_f32_16x16x32_bf16 a[100:103], a[240:243], v[196:199], a[100:103]
    ds_read_b128 a[152:155], v4 offset:4096
    v_add_f32 v240, v240, v176
    v_mfma_f32_16x16x32_bf16 a[100:103], a[244:247], v[212:215], a[100:103]
    v_exp_f32 v177, v177
    v_mfma_f32_16x16x32_bf16 a[104:107], a[240:243], v[200:203], a[104:107]
    buffer_load_dwordx4 v21, s[8:11], s78 offen offset:1024 lds
    v_mfma_f32_16x16x32_bf16 a[104:107], a[244:247], v[216:219], a[104:107]
    v_exp_f32 v178, v178
    v_mfma_f32_16x16x32_bf16 a[108:111], a[240:243], v[204:207], a[108:111]
    ds_read_b128 a[156:159], v5 offset:4096
    v_add_f32 v240, v240, v177
    v_mfma_f32_16x16x32_bf16 a[108:111], a[244:247], v[220:223], a[108:111]
    v_exp_f32 v179, v179
    v_mfma_f32_16x16x32_bf16 a[112:115], a[248:251], v[192:195], a[112:115]
    v_cvt_pk_bf16_f32 v50, v176, v177
    v_add_f32 v240, v240, v178
    v_mfma_f32_16x16x32_bf16 a[112:115], a[252:255], v[208:211], a[112:115]
    v_exp_f32 v180, v180
    v_mfma_f32_16x16x32_bf16 a[116:119], a[248:251], v[196:199], a[116:119]
    ds_read_b128 a[160:163], v2 offset:8192
    v_add_f32 v240, v240, v179
    v_mfma_f32_16x16x32_bf16 a[116:119], a[252:255], v[212:215], a[116:119]
    v_exp_f32 v181, v181
    v_mfma_f32_16x16x32_bf16 a[120:123], a[248:251], v[200:203], a[120:123]
    ds_read_b128 a[164:167], v3 offset:8192
    v_cvt_pk_bf16_f32 v51, v178, v179
    v_mfma_f32_16x16x32_bf16 a[120:123], a[252:255], v[216:219], a[120:123]
    v_exp_f32 v182, v182
    v_mfma_f32_16x16x32_bf16 a[124:127], a[248:251], v[204:207], a[124:127]
    v_add_f32 v241, v241, v180
    v_add_f32 v241, v241, v181
    v_mfma_f32_16x16x32_bf16 a[124:127], a[252:255], v[220:223], a[124:127]
    v_exp_f32 v183, v183
    v_mfma_f32_16x16x32_bf16 v[248:251], v[244:247], v[204:207], v[248:251]
    ds_read_b128 a[168:171], v4 offset:8192
    v_cvt_pk_bf16_f32 v54, v180, v181
    v_mfma_f32_16x16x32_bf16 v[248:251], v[244:247], v[220:223], v[248:251]
    ds_read_b128 a[172:175], v5 offset:8192
    v_add_f32 v241, v241, v182
    v_mfma_f32_16x16x32_bf16 v[252:255], v[244:247], v[200:203], v[252:255]
    v_add_f32 v241, v241, v183
    v_cvt_pk_bf16_f32 v55, v182, v183
    v_mfma_f32_16x16x32_bf16 v[252:255], v[244:247], v[216:219], v[252:255]
    s_waitcnt lgkmcnt(11)
    ds_read_b128 a[176:179], v2 offset:12288
    v_mfma_f32_16x16x32_bf16 v[80:83], a[128:131], v[64:67], v[224:227]
    s_waitcnt lgkmcnt(11)
    v_mfma_f32_16x16x32_bf16 v[80:83], a[132:135], v[96:99], v[80:83]
    s_waitcnt lgkmcnt(10)
    v_exp_f32 v184, v184
    v_mfma_f32_16x16x32_bf16 v[80:83], a[136:139], v[128:131], v[80:83]
    s_waitcnt lgkmcnt(9)
    ds_read_b128 a[180:183], v3 offset:12288
    buffer_load_dwordx4 v22, s[8:11], s78 offen offset:2048 lds
    v_mfma_f32_16x16x32_bf16 v[80:83], a[140:143], v[160:163], v[80:83]
    v_exp_f32 v185, v185
    v_mfma_f32_16x16x32_bf16 v[84:87], a[140:143], v[164:167], v[228:231]
    v_cvt_pk_bf16_f32 v58, v184, v185
    v_mfma_f32_16x16x32_bf16 v[84:87], a[136:139], v[132:135], v[84:87]
    v_exp_f32 v186, v186
    v_mfma_f32_16x16x32_bf16 v[84:87], a[132:135], v[100:103], v[84:87]
    ds_read_b128 a[184:187], v4 offset:12288
    v_mfma_f32_16x16x32_bf16 v[84:87], a[128:131], v[68:71], v[84:87]
    v_exp_f32 v187, v187
    v_mfma_f32_16x16x32_bf16 v[88:91], a[128:131], v[72:75], v[232:235]
    ds_read_b128 a[188:191], v5 offset:12288
    v_cvt_pk_bf16_f32 v59, v186, v187
    v_mfma_f32_16x16x32_bf16 v[88:91], a[132:135], v[104:107], v[88:91]
    v_exp_f32 v188, v188
    v_mfma_f32_16x16x32_bf16 v[88:91], a[136:139], v[136:139], v[88:91]
    v_mfma_f32_16x16x32_bf16 v[88:91], a[140:143], v[168:171], v[88:91]
    v_exp_f32 v189, v189
    v_mfma_f32_16x16x32_bf16 v[92:95], a[140:143], v[172:175], v[236:239]
    ds_read_b64_tr_b16 a[192:193], v6 offset:16384
    v_cvt_pk_bf16_f32 v62, v188, v189
    v_mfma_f32_16x16x32_bf16 v[92:95], a[136:139], v[140:143], v[92:95]
    v_exp_f32 v190, v190
    v_mfma_f32_16x16x32_bf16 v[92:95], a[132:135], v[108:111], v[92:95]
    ds_read_b64_tr_b16 a[194:195], v6 offset:20480
    buffer_load_dwordx4 v23, s[8:11], s78 offen offset:3072 lds
    v_mfma_f32_16x16x32_bf16 v[92:95], a[128:131], v[76:79], v[92:95]
    s_waitcnt lgkmcnt(13)
    v_exp_f32 v191, v191
    v_mfma_f32_16x16x32_bf16 v[112:115], a[144:147], v[64:67], v[224:227]
    s_waitcnt lgkmcnt(12)
    v_cvt_pk_bf16_f32 v63, v190, v191
    v_mfma_f32_16x16x32_bf16 v[112:115], a[148:151], v[96:99], v[112:115]
    s_waitcnt lgkmcnt(11)
    v_exp_f32 v80, v80
    v_mfma_f32_16x16x32_bf16 v[112:115], a[152:155], v[128:131], v[112:115]
    s_waitcnt lgkmcnt(10)
    ds_read_b64_tr_b16 a[196:197], v6 offset:24576
    v_add_f32 v240, v240, v80
    v_mfma_f32_16x16x32_bf16 v[112:115], a[156:159], v[160:163], v[112:115]
    v_exp_f32 v81, v81
    v_mfma_f32_16x16x32_bf16 v[116:119], a[156:159], v[164:167], v[228:231]
    ds_read_b64_tr_b16 a[198:199], v6 offset:28672
    v_add_f32 v240, v240, v81
    v_mfma_f32_16x16x32_bf16 v[116:119], a[152:155], v[132:135], v[116:119]
    v_exp_f32 v82, v82
    v_mfma_f32_16x16x32_bf16 v[116:119], a[148:151], v[100:103], v[116:119]
    ds_read_b64_tr_b16 a[200:201], v7 offset:16384
    v_cvt_pk_bf16_f32 v192, v80, v81
    v_mfma_f32_16x16x32_bf16 v[116:119], a[144:147], v[68:71], v[116:119]
    v_exp_f32 v83, v83
    v_mfma_f32_16x16x32_bf16 v[120:123], a[144:147], v[72:75], v[232:235]
    ds_read_b64_tr_b16 a[202:203], v7 offset:20480
    v_add_f32 v240, v240, v82
    v_mfma_f32_16x16x32_bf16 v[120:123], a[148:151], v[104:107], v[120:123]
    s_add_u32 m0, s79, 77824
    v_exp_f32 v84, v84
    v_mfma_f32_16x16x32_bf16 v[120:123], a[152:155], v[136:139], v[120:123]
    ds_read_b64_tr_b16 a[204:205], v7 offset:24576
    buffer_load_dwordx4 v24, s[8:11], s78 offen offset:0 lds
    v_add_f32 v240, v240, v83
    v_mfma_f32_16x16x32_bf16 v[120:123], a[156:159], v[168:171], v[120:123]
    v_exp_f32 v85, v85
    v_mfma_f32_16x16x32_bf16 v[124:127], a[156:159], v[172:175], v[236:239]
    ds_read_b64_tr_b16 a[206:207], v7 offset:28672
    v_cvt_pk_bf16_f32 v193, v82, v83
    v_mfma_f32_16x16x32_bf16 v[124:127], a[152:155], v[140:143], v[124:127]
    v_exp_f32 v86, v86
    v_mfma_f32_16x16x32_bf16 v[124:127], a[148:151], v[108:111], v[124:127]
    ds_read_b64_tr_b16 a[208:209], v8 offset:16384
    v_add_f32 v241, v241, v84
    v_mfma_f32_16x16x32_bf16 v[124:127], a[144:147], v[76:79], v[124:127]
    s_waitcnt lgkmcnt(15)
    v_exp_f32 v87, v87
    v_mfma_f32_16x16x32_bf16 v[144:147], a[160:163], v[64:67], v[224:227]
    s_waitcnt lgkmcnt(15)
    v_mfma_f32_16x16x32_bf16 v[144:147], a[164:167], v[96:99], v[144:147]
    s_waitcnt lgkmcnt(14)
    v_exp_f32 v88, v88
    v_mfma_f32_16x16x32_bf16 v[144:147], a[168:171], v[128:131], v[144:147]
    s_waitcnt lgkmcnt(13)
    ds_read_b64_tr_b16 a[210:211], v8 offset:20480
    v_add_f32 v241, v241, v85
    v_mfma_f32_16x16x32_bf16 v[144:147], a[172:175], v[160:163], v[144:147]
    v_exp_f32 v89, v89
    v_mfma_f32_16x16x32_bf16 v[148:151], a[172:175], v[164:167], v[228:231]
    ds_read_b64_tr_b16 a[212:213], v8 offset:24576
    v_cvt_pk_bf16_f32 v196, v84, v85
    v_mfma_f32_16x16x32_bf16 v[148:151], a[168:171], v[132:135], v[148:151]
    v_exp_f32 v90, v90
    v_mfma_f32_16x16x32_bf16 v[148:151], a[164:167], v[100:103], v[148:151]
    ds_read_b64_tr_b16 a[214:215], v8 offset:28672
    buffer_load_dwordx4 v25, s[8:11], s78 offen offset:1024 lds
    v_add_f32 v241, v241, v86
    v_mfma_f32_16x16x32_bf16 v[148:151], a[160:163], v[68:71], v[148:151]
    v_exp_f32 v91, v91
    v_mfma_f32_16x16x32_bf16 v[152:155], a[160:163], v[72:75], v[232:235]
    ds_read_b64_tr_b16 a[216:217], v9 offset:16384
    v_add_f32 v241, v241, v87
    v_mfma_f32_16x16x32_bf16 v[152:155], a[164:167], v[104:107], v[152:155]
    v_exp_f32 v92, v92
    v_mfma_f32_16x16x32_bf16 v[152:155], a[168:171], v[136:139], v[152:155]
    ds_read_b64_tr_b16 a[218:219], v9 offset:20480
    v_cvt_pk_bf16_f32 v197, v86, v87
    v_mfma_f32_16x16x32_bf16 v[152:155], a[172:175], v[168:171], v[152:155]
    v_exp_f32 v93, v93
    v_mfma_f32_16x16x32_bf16 v[156:159], a[172:175], v[172:175], v[236:239]
    ds_read_b64_tr_b16 a[220:221], v9 offset:24576
    v_cvt_pk_bf16_f32 v200, v88, v89
    v_mfma_f32_16x16x32_bf16 v[156:159], a[168:171], v[140:143], v[156:159]
    v_exp_f32 v94, v94
    v_mfma_f32_16x16x32_bf16 v[156:159], a[164:167], v[108:111], v[156:159]
    ds_read_b64_tr_b16 a[222:223], v9 offset:28672
    v_cvt_pk_bf16_f32 v201, v90, v91
    v_mfma_f32_16x16x32_bf16 v[156:159], a[160:163], v[76:79], v[156:159]
    s_waitcnt lgkmcnt(15)
    v_exp_f32 v95, v95
    v_mfma_f32_16x16x32_bf16 v[176:179], a[176:179], v[64:67], v[224:227]
    s_waitcnt lgkmcnt(15)
    v_mfma_f32_16x16x32_bf16 v[176:179], a[180:183], v[96:99], v[176:179]
    s_waitcnt lgkmcnt(15)
    v_exp_f32 v112, v112
    v_mfma_f32_16x16x32_bf16 v[176:179], a[184:187], v[128:131], v[176:179]
    s_waitcnt lgkmcnt(15)
    ds_read_b64_tr_b16 a[224:225], v10 offset:16384
    buffer_load_dwordx4 v26, s[8:11], s78 offen offset:2048 lds
    v_cvt_pk_bf16_f32 v204, v92, v93
    v_mfma_f32_16x16x32_bf16 v[176:179], a[188:191], v[160:163], v[176:179]
    v_exp_f32 v113, v113
    v_mfma_f32_16x16x32_bf16 v[180:183], a[188:191], v[164:167], v[228:231]
    ds_read_b64_tr_b16 a[226:227], v10 offset:20480
    v_cvt_pk_bf16_f32 v205, v94, v95
    v_mfma_f32_16x16x32_bf16 v[180:183], a[184:187], v[132:135], v[180:183]
    v_exp_f32 v114, v114
    v_mfma_f32_16x16x32_bf16 v[180:183], a[180:183], v[100:103], v[180:183]
    ds_read_b64_tr_b16 a[228:229], v10 offset:24576
    v_add_f32 v240, v240, v112
    v_mfma_f32_16x16x32_bf16 v[180:183], a[176:179], v[68:71], v[180:183]
    v_exp_f32 v115, v115
    v_mfma_f32_16x16x32_bf16 v[184:187], a[176:179], v[72:75], v[232:235]
    ds_read_b64_tr_b16 a[230:231], v10 offset:28672
    v_add_f32 v240, v240, v113
    v_mfma_f32_16x16x32_bf16 v[184:187], a[180:183], v[104:107], v[184:187]
    v_exp_f32 v116, v116
    v_mfma_f32_16x16x32_bf16 v[184:187], a[184:187], v[136:139], v[184:187]
    ds_read_b64_tr_b16 a[232:233], v11 offset:16384
    v_cvt_pk_bf16_f32 v194, v112, v113
    v_mfma_f32_16x16x32_bf16 v[184:187], a[188:191], v[168:171], v[184:187]
    v_exp_f32 v117, v117
    v_mfma_f32_16x16x32_bf16 v[188:191], a[188:191], v[172:175], v[236:239]
    ds_read_b64_tr_b16 a[234:235], v11 offset:20480
    v_add_f32 v240, v240, v114
    v_mfma_f32_16x16x32_bf16 v[188:191], a[184:187], v[140:143], v[188:191]
    v_exp_f32 v118, v118
    v_mfma_f32_16x16x32_bf16 v[188:191], a[180:183], v[108:111], v[188:191]
    ds_read_b64_tr_b16 a[236:237], v11 offset:24576
    buffer_load_dwordx4 v27, s[8:11], s78 offen offset:3072 lds
    v_add_f32 v240, v240, v115
    v_mfma_f32_16x16x32_bf16 v[188:191], a[176:179], v[76:79], v[188:191]
    s_waitcnt lgkmcnt(15)
    v_exp_f32 v119, v119
    v_mfma_f32_16x16x32_bf16 a[0:3], a[192:195], v[32:35], a[0:3]
    s_waitcnt lgkmcnt(15)
    v_mfma_f32_16x16x32_bf16 a[0:3], a[196:199], v[48:51], a[0:3]
    v_exp_f32 v120, v120
    v_mfma_f32_16x16x32_bf16 a[4:7], a[192:195], v[36:39], a[4:7]
    ds_read_b64_tr_b16 a[238:239], v11 offset:28672
    v_cvt_pk_bf16_f32 v195, v114, v115
    v_mfma_f32_16x16x32_bf16 a[4:7], a[196:199], v[52:55], a[4:7]
    v_exp_f32 v121, v121
    v_mfma_f32_16x16x32_bf16 a[8:11], a[192:195], v[40:43], a[8:11]
    ds_read_b64_tr_b16 a[240:241], v12 offset:16384
    v_add_f32 v241, v241, v116
    v_mfma_f32_16x16x32_bf16 a[8:11], a[196:199], v[56:59], a[8:11]
    v_exp_f32 v122, v122
    v_mfma_f32_16x16x32_bf16 a[12:15], a[192:195], v[44:47], a[12:15]
    ds_read_b64_tr_b16 a[242:243], v12 offset:20480
    v_add_f32 v241, v241, v117
    v_mfma_f32_16x16x32_bf16 a[12:15], a[196:199], v[60:63], a[12:15]
    s_waitcnt lgkmcnt(15)
    v_exp_f32 v123, v123
    v_mfma_f32_16x16x32_bf16 a[16:19], a[200:203], v[32:35], a[16:19]
    s_waitcnt lgkmcnt(15)
    ds_read_b64_tr_b16 a[244:245], v12 offset:24576
    v_cvt_pk_bf16_f32 v198, v116, v117
    v_mfma_f32_16x16x32_bf16 a[16:19], a[204:207], v[48:51], a[16:19]
    s_add_u32 m0, s79, 81920
    v_exp_f32 v124, v124
    v_mfma_f32_16x16x32_bf16 a[20:23], a[200:203], v[36:39], a[20:23]
    ds_read_b64_tr_b16 a[246:247], v12 offset:28672
    buffer_load_dwordx4 v28, s[8:11], s78 offen offset:0 lds
    v_add_f32 v241, v241, v118
    v_mfma_f32_16x16x32_bf16 a[20:23], a[204:207], v[52:55], a[20:23]
    v_exp_f32 v125, v125
    v_mfma_f32_16x16x32_bf16 a[24:27], a[200:203], v[40:43], a[24:27]
    ds_read_b64_tr_b16 a[248:249], v13 offset:16384
    v_add_f32 v241, v241, v119
    v_mfma_f32_16x16x32_bf16 a[24:27], a[204:207], v[56:59], a[24:27]
    v_exp_f32 v126, v126
    v_mfma_f32_16x16x32_bf16 a[28:31], a[200:203], v[44:47], a[28:31]
    ds_read_b64_tr_b16 a[250:251], v13 offset:20480
    v_cvt_pk_bf16_f32 v199, v118, v119
    v_mfma_f32_16x16x32_bf16 a[28:31], a[204:207], v[60:63], a[28:31]
    s_waitcnt lgkmcnt(15)
    v_exp_f32 v127, v127
    v_mfma_f32_16x16x32_bf16 a[32:35], a[208:211], v[32:35], a[32:35]
    s_waitcnt lgkmcnt(15)
    v_mfma_f32_16x16x32_bf16 a[32:35], a[212:215], v[48:51], a[32:35]
    v_exp_f32 v144, v144
    v_mfma_f32_16x16x32_bf16 a[36:39], a[208:211], v[36:39], a[36:39]
    ds_read_b64_tr_b16 a[252:253], v13 offset:24576
    v_cvt_pk_bf16_f32 v202, v120, v121
    v_mfma_f32_16x16x32_bf16 a[36:39], a[212:215], v[52:55], a[36:39]
    v_exp_f32 v145, v145
    v_mfma_f32_16x16x32_bf16 a[40:43], a[208:211], v[40:43], a[40:43]
    ds_read_b64_tr_b16 a[254:255], v13 offset:28672
    v_cvt_pk_bf16_f32 v203, v122, v123
    v_mfma_f32_16x16x32_bf16 a[40:43], a[212:215], v[56:59], a[40:43]
    v_exp_f32 v146, v146
    v_mfma_f32_16x16x32_bf16 a[44:47], a[208:211], v[44:47], a[44:47]
    v_cvt_pk_bf16_f32 v206, v124, v125
    v_cvt_pk_bf16_f32 v207, v126, v127
    v_mfma_f32_16x16x32_bf16 a[44:47], a[212:215], v[60:63], a[44:47]
    s_waitcnt lgkmcnt(15)
    v_exp_f32 v147, v147
    v_mfma_f32_16x16x32_bf16 a[48:51], a[216:219], v[32:35], a[48:51]
    s_waitcnt lgkmcnt(15)
    v_add_f32 v240, v240, v144
    v_add_f32 v240, v240, v145
    v_mfma_f32_16x16x32_bf16 a[48:51], a[220:223], v[48:51], a[48:51]
    v_exp_f32 v148, v148
    v_mfma_f32_16x16x32_bf16 a[52:55], a[216:219], v[36:39], a[52:55]
    v_cvt_pk_bf16_f32 v208, v144, v145
    v_add_f32 v240, v240, v146
    v_mfma_f32_16x16x32_bf16 a[52:55], a[220:223], v[52:55], a[52:55]
    s_waitcnt lgkmcnt(0)
    s_waitcnt vmcnt(9)
    v_exp_f32 v149, v149
    v_mfma_f32_16x16x32_bf16 a[56:59], a[216:219], v[40:43], a[56:59]
    s_barrier
    v_add_f32 v240, v240, v147
    v_mfma_f32_16x16x32_bf16 a[56:59], a[220:223], v[56:59], a[56:59]
    s_add_u32 s54, s78, 147456
    s_add_u32 m0, s79, 36864
    v_exp_f32 v150, v150
    v_mfma_f32_16x16x32_bf16 a[60:63], a[216:219], v[44:47], a[60:63]
    buffer_load_dwordx4 v20, s[8:11], s54 offen offset:0 lds
    v_cvt_pk_bf16_f32 v209, v146, v147
    v_mfma_f32_16x16x32_bf16 a[60:63], a[220:223], v[60:63], a[60:63]
    v_exp_f32 v151, v151
    v_mfma_f32_16x16x32_bf16 a[64:67], a[224:227], v[32:35], a[64:67]
    v_add_f32 v241, v241, v148
    v_mfma_f32_16x16x32_bf16 a[64:67], a[228:231], v[48:51], a[64:67]
    v_exp_f32 v152, v152
    v_mfma_f32_16x16x32_bf16 a[68:71], a[224:227], v[36:39], a[68:71]
    v_add_f32 v241, v241, v149
    v_cvt_pk_bf16_f32 v212, v148, v149
    v_mfma_f32_16x16x32_bf16 a[68:71], a[228:231], v[52:55], a[68:71]
    v_exp_f32 v153, v153
    v_mfma_f32_16x16x32_bf16 a[72:75], a[224:227], v[40:43], a[72:75]
    buffer_load_dwordx4 v21, s[8:11], s54 offen offset:1024 lds
    v_mfma_f32_16x16x32_bf16 a[72:75], a[228:231], v[56:59], a[72:75]
    v_exp_f32 v154, v154
    v_mfma_f32_16x16x32_bf16 a[76:79], a[224:227], v[44:47], a[76:79]
    v_add_f32 v241, v241, v150
    v_mfma_f32_16x16x32_bf16 a[76:79], a[228:231], v[60:63], a[76:79]
    v_exp_f32 v155, v155
    v_mfma_f32_16x16x32_bf16 a[80:83], a[232:235], v[32:35], a[80:83]
    v_add_f32 v241, v241, v151
    v_mfma_f32_16x16x32_bf16 a[80:83], a[236:239], v[48:51], a[80:83]
    v_exp_f32 v156, v156
    v_mfma_f32_16x16x32_bf16 a[84:87], a[232:235], v[36:39], a[84:87]
    buffer_load_dwordx4 v22, s[8:11], s54 offen offset:2048 lds
    v_cvt_pk_bf16_f32 v213, v150, v151
    v_cvt_pk_bf16_f32 v216, v152, v153
    v_mfma_f32_16x16x32_bf16 a[84:87], a[236:239], v[52:55], a[84:87]
    v_exp_f32 v157, v157
    v_mfma_f32_16x16x32_bf16 a[88:91], a[232:235], v[40:43], a[88:91]
    v_cvt_pk_bf16_f32 v217, v154, v155
    v_mfma_f32_16x16x32_bf16 a[88:91], a[236:239], v[56:59], a[88:91]
    v_exp_f32 v158, v158
    v_mfma_f32_16x16x32_bf16 a[92:95], a[232:235], v[44:47], a[92:95]
    v_cvt_pk_bf16_f32 v220, v156, v157
    v_mfma_f32_16x16x32_bf16 a[92:95], a[236:239], v[60:63], a[92:95]
    v_exp_f32 v159, v159
    v_mfma_f32_16x16x32_bf16 a[96:99], a[240:243], v[32:35], a[96:99]
    buffer_load_dwordx4 v23, s[8:11], s54 offen offset:3072 lds
    v_cvt_pk_bf16_f32 v221, v158, v159
    v_mfma_f32_16x16x32_bf16 a[96:99], a[244:247], v[48:51], a[96:99]
    v_exp_f32 v176, v176
    v_mfma_f32_16x16x32_bf16 a[100:103], a[240:243], v[36:39], a[100:103]
    v_add_f32 v240, v240, v176
    v_mfma_f32_16x16x32_bf16 a[100:103], a[244:247], v[52:55], a[100:103]
    v_exp_f32 v177, v177
    v_mfma_f32_16x16x32_bf16 a[104:107], a[240:243], v[40:43], a[104:107]
    v_mfma_f32_16x16x32_bf16 a[104:107], a[244:247], v[56:59], a[104:107]
    s_add_u32 m0, s79, 40960
    v_exp_f32 v178, v178
    v_mfma_f32_16x16x32_bf16 a[108:111], a[240:243], v[44:47], a[108:111]
    buffer_load_dwordx4 v24, s[8:11], s54 offen offset:0 lds
    v_add_f32 v240, v240, v177
    v_mfma_f32_16x16x32_bf16 a[108:111], a[244:247], v[60:63], a[108:111]
    v_exp_f32 v179, v179
    v_mfma_f32_16x16x32_bf16 a[112:115], a[248:251], v[32:35], a[112:115]
    v_cvt_pk_bf16_f32 v210, v176, v177
    v_add_f32 v240, v240, v178
    v_mfma_f32_16x16x32_bf16 a[112:115], a[252:255], v[48:51], a[112:115]
    v_exp_f32 v180, v180
    v_mfma_f32_16x16x32_bf16 a[116:119], a[248:251], v[36:39], a[116:119]
    v_add_f32 v240, v240, v179
    v_mfma_f32_16x16x32_bf16 a[116:119], a[252:255], v[52:55], a[116:119]
    v_exp_f32 v181, v181
    v_mfma_f32_16x16x32_bf16 a[120:123], a[248:251], v[40:43], a[120:123]
    buffer_load_dwordx4 v25, s[8:11], s54 offen offset:1024 lds
    v_cvt_pk_bf16_f32 v211, v178, v179
    v_mfma_f32_16x16x32_bf16 a[120:123], a[252:255], v[56:59], a[120:123]
    v_exp_f32 v182, v182
    v_mfma_f32_16x16x32_bf16 a[124:127], a[248:251], v[44:47], a[124:127]
    v_add_f32 v241, v241, v180
    v_add_f32 v241, v241, v181
    v_mfma_f32_16x16x32_bf16 a[124:127], a[252:255], v[60:63], a[124:127]
    v_exp_f32 v183, v183
    v_mfma_f32_16x16x32_bf16 v[248:251], v[244:247], v[44:47], v[248:251]
    v_cvt_pk_bf16_f32 v214, v180, v181
    v_mfma_f32_16x16x32_bf16 v[248:251], v[244:247], v[60:63], v[248:251]
    v_add_f32 v241, v241, v182
    v_mfma_f32_16x16x32_bf16 v[252:255], v[244:247], v[40:43], v[252:255]
    buffer_load_dwordx4 v26, s[8:11], s54 offen offset:2048 lds
    v_add_f32 v241, v241, v183
    v_cvt_pk_bf16_f32 v215, v182, v183
    v_mfma_f32_16x16x32_bf16 v[252:255], v[244:247], v[56:59], v[252:255]
    v_exp_f32 v184, v184
    v_exp_f32 v185, v185
    s_nop 0
    v_cvt_pk_bf16_f32 v218, v184, v185
    v_exp_f32 v186, v186
    v_exp_f32 v187, v187
    s_nop 0
    v_cvt_pk_bf16_f32 v219, v186, v187
    v_exp_f32 v188, v188
    v_exp_f32 v189, v189
    ds_read_b64_tr_b16 a[192:193], v6 offset:0
    buffer_load_dwordx4 v27, s[8:11], s54 offen offset:3072 lds
    v_cvt_pk_bf16_f32 v222, v188, v189
    v_exp_f32 v190, v190
    ds_read_b64_tr_b16 a[194:195], v6 offset:4096
    v_exp_f32 v191, v191
    s_nop 0
    v_cvt_pk_bf16_f32 v223, v190, v191
    ds_read_b64_tr_b16 a[196:197], v6 offset:8192
    ds_read_b64_tr_b16 a[198:199], v6 offset:12288
    ds_read_b64_tr_b16 a[200:201], v7 offset:0
    s_add_u32 m0, s79, 45056
    ds_read_b64_tr_b16 a[202:203], v7 offset:4096
    buffer_load_dwordx4 v28, s[8:11], s54 offen offset:0 lds
    ds_read_b64_tr_b16 a[204:205], v7 offset:8192
    ds_read_b64_tr_b16 a[206:207], v7 offset:12288
    ds_read_b64_tr_b16 a[208:209], v8 offset:0
    ds_read_b64_tr_b16 a[210:211], v8 offset:4096
    s_add_u32 s54, s78, 294912
    s_add_u32 m0, s79, 0
    ds_read_b64_tr_b16 a[212:213], v8 offset:8192
    buffer_load_dwordx4 v20, s[8:11], s54 offen offset:0 lds
    ds_read_b64_tr_b16 a[214:215], v8 offset:12288
    ds_read_b64_tr_b16 a[216:217], v9 offset:0
    ds_read_b64_tr_b16 a[218:219], v9 offset:4096
    ds_read_b64_tr_b16 a[220:221], v9 offset:8192
    ds_read_b64_tr_b16 a[222:223], v9 offset:12288
    buffer_load_dwordx4 v21, s[8:11], s54 offen offset:1024 lds
    ds_read_b64_tr_b16 a[224:225], v10 offset:0
    ds_read_b64_tr_b16 a[226:227], v10 offset:4096
    ds_read_b64_tr_b16 a[228:229], v10 offset:8192
    ds_read_b64_tr_b16 a[230:231], v10 offset:12288
    ds_read_b64_tr_b16 a[232:233], v11 offset:0
    v_mfma_f32_16x16x32_bf16 v[248:251], v[244:247], v[204:207], v[248:251]
    ds_read_b64_tr_b16 a[234:235], v11 offset:4096
    v_mov_b32 v228, v240
    v_mfma_f32_16x16x32_bf16 v[248:251], v[244:247], v[220:223], v[248:251]
    v_mov_b32 v229, v241
    v_mfma_f32_16x16x32_bf16 v[252:255], v[244:247], v[200:203], v[252:255]
    ds_read_b64_tr_b16 a[236:237], v11 offset:8192
    v_mfma_f32_16x16x32_bf16 v[252:255], v[244:247], v[216:219], v[252:255]
    s_waitcnt lgkmcnt(15)
    buffer_load_dwordx4 v22, s[8:11], s54 offen offset:2048 lds
    v_mfma_f32_16x16x32_bf16 a[0:3], a[192:195], v[192:195], a[0:3]
    s_waitcnt lgkmcnt(15)
    v_permlane16_swap_b32 v240, v228
    v_mfma_f32_16x16x32_bf16 a[0:3], a[196:199], v[208:211], a[0:3]
    v_permlane16_swap_b32 v241, v229
    v_mfma_f32_16x16x32_bf16 a[4:7], a[192:195], v[196:199], a[4:7]
    ds_read_b64_tr_b16 a[238:239], v11 offset:12288
    v_add_f32 v240, v240, v228
    v_mfma_f32_16x16x32_bf16 a[4:7], a[196:199], v[212:215], a[4:7]
    v_add_f32 v241, v241, v229
    v_mov_b32 v228, v240
    v_mfma_f32_16x16x32_bf16 a[8:11], a[192:195], v[200:203], a[8:11]
    ds_read_b64_tr_b16 a[240:241], v12 offset:0
    v_mov_b32 v229, v241
    v_mfma_f32_16x16x32_bf16 a[8:11], a[196:199], v[216:219], a[8:11]
    buffer_load_dwordx4 v23, s[8:11], s54 offen offset:3072 lds
    v_mfma_f32_16x16x32_bf16 a[12:15], a[192:195], v[204:207], a[12:15]
    ds_read_b64_tr_b16 a[242:243], v12 offset:4096
    v_mfma_f32_16x16x32_bf16 a[12:15], a[196:199], v[220:223], a[12:15]
    s_waitcnt lgkmcnt(15)
    v_permlane32_swap_b32 v240, v228
    v_mfma_f32_16x16x32_bf16 a[16:19], a[200:203], v[192:195], a[16:19]
    s_waitcnt lgkmcnt(15)
    ds_read_b64_tr_b16 a[244:245], v12 offset:8192
    v_mfma_f32_16x16x32_bf16 a[16:19], a[204:207], v[208:211], a[16:19]
    v_permlane32_swap_b32 v241, v229
    v_mfma_f32_16x16x32_bf16 a[20:23], a[200:203], v[196:199], a[20:23]
    s_add_u32 m0, s79, 4096
    ds_read_b64_tr_b16 a[246:247], v12 offset:12288
    v_add_f32 v240, v240, v228
    v_mfma_f32_16x16x32_bf16 a[20:23], a[204:207], v[212:215], a[20:23]
    buffer_load_dwordx4 v24, s[8:11], s54 offen offset:0 lds
    v_mfma_f32_16x16x32_bf16 a[24:27], a[200:203], v[200:203], a[24:27]
    ds_read_b64_tr_b16 a[248:249], v13 offset:0
    v_add_f32 v241, v241, v229
    v_mfma_f32_16x16x32_bf16 a[24:27], a[204:207], v[216:219], a[24:27]
    v_mov_b32 v243, v248
    v_mov_b32 v242, v252
    v_mfma_f32_16x16x32_bf16 a[28:31], a[200:203], v[204:207], a[28:31]
    ds_read_b64_tr_b16 a[250:251], v13 offset:4096
    v_mov_b32 v229, v243
    v_mfma_f32_16x16x32_bf16 a[28:31], a[204:207], v[220:223], a[28:31]
    s_waitcnt lgkmcnt(15)
    v_mov_b32 v228, v242
    v_mfma_f32_16x16x32_bf16 a[32:35], a[208:211], v[192:195], a[32:35]
    s_waitcnt lgkmcnt(15)
    v_permlane16_swap_b32 v243, v229
    v_mfma_f32_16x16x32_bf16 a[32:35], a[212:215], v[208:211], a[32:35]
    buffer_load_dwordx4 v25, s[8:11], s54 offen offset:1024 lds
    v_mfma_f32_16x16x32_bf16 a[36:39], a[208:211], v[196:199], a[36:39]
    ds_read_b64_tr_b16 a[252:253], v13 offset:8192
    v_mfma_f32_16x16x32_bf16 a[36:39], a[212:215], v[212:215], a[36:39]
    v_permlane16_swap_b32 v242, v228
    v_mfma_f32_16x16x32_bf16 a[40:43], a[208:211], v[200:203], a[40:43]
    ds_read_b64_tr_b16 a[254:255], v13 offset:12288
    v_add_f32 v243, v243, v229
    v_mfma_f32_16x16x32_bf16 a[40:43], a[212:215], v[216:219], a[40:43]
    v_add_f32 v242, v242, v228
    v_mov_b32 v229, v243
    v_mfma_f32_16x16x32_bf16 a[44:47], a[208:211], v[204:207], a[44:47]
    v_mov_b32 v228, v242
    v_mfma_f32_16x16x32_bf16 a[44:47], a[212:215], v[220:223], a[44:47]
    s_waitcnt lgkmcnt(15)
    buffer_load_dwordx4 v26, s[8:11], s54 offen offset:2048 lds
    v_mfma_f32_16x16x32_bf16 a[48:51], a[216:219], v[192:195], a[48:51]
    s_waitcnt lgkmcnt(15)
    v_permlane32_swap_b32 v243, v229
    v_mfma_f32_16x16x32_bf16 a[48:51], a[220:223], v[208:211], a[48:51]
    v_permlane32_swap_b32 v242, v228
    v_mfma_f32_16x16x32_bf16 a[52:55], a[216:219], v[196:199], a[52:55]
    v_add_f32 v243, v243, v229
    v_add_f32 v242, v242, v228
    v_mfma_f32_16x16x32_bf16 a[52:55], a[220:223], v[212:215], a[52:55]
    v_rcp_f32 v224, v240
    v_mfma_f32_16x16x32_bf16 a[56:59], a[216:219], v[200:203], a[56:59]
    v_rcp_f32 v225, v241
    v_mfma_f32_16x16x32_bf16 a[56:59], a[220:223], v[216:219], a[56:59]
    buffer_load_dwordx4 v27, s[8:11], s54 offen offset:3072 lds
    v_mfma_f32_16x16x32_bf16 a[60:63], a[216:219], v[204:207], a[60:63]
    v_rcp_f32 v226, v242
    v_mfma_f32_16x16x32_bf16 a[60:63], a[220:223], v[220:223], a[60:63]
    s_waitcnt lgkmcnt(14)
    v_rcp_f32 v227, v243
    v_mfma_f32_16x16x32_bf16 a[64:67], a[224:227], v[192:195], a[64:67]
    s_waitcnt lgkmcnt(12)
    v_accvgpr_read_b32 v80, a0
    v_accvgpr_read_b32 v81, a1
    v_mfma_f32_16x16x32_bf16 a[64:67], a[228:231], v[208:211], a[64:67]
    v_accvgpr_read_b32 v82, a2
    v_accvgpr_read_b32 v83, a3
    v_mfma_f32_16x16x32_bf16 a[68:71], a[224:227], v[196:199], a[68:71]
    s_add_u32 m0, s79, 8192
    v_accvgpr_read_b32 v84, a16
    v_accvgpr_read_b32 v85, a17
    v_mfma_f32_16x16x32_bf16 a[68:71], a[228:231], v[212:215], a[68:71]
    buffer_load_dwordx4 v28, s[8:11], s54 offen offset:0 lds
    v_mfma_f32_16x16x32_bf16 a[72:75], a[224:227], v[200:203], a[72:75]
    v_accvgpr_read_b32 v86, a18
    v_accvgpr_read_b32 v87, a19
    v_mfma_f32_16x16x32_bf16 a[72:75], a[228:231], v[216:219], a[72:75]
    v_mul_f32 v80, v80, v224
    v_mul_f32 v81, v81, v224
    v_mfma_f32_16x16x32_bf16 a[76:79], a[224:227], v[204:207], a[76:79]
    v_mul_f32 v82, v82, v224
    v_mul_f32 v83, v83, v224
    v_mfma_f32_16x16x32_bf16 a[76:79], a[228:231], v[220:223], a[76:79]
    s_waitcnt lgkmcnt(10)
    v_mul_f32 v84, v84, v224
    v_mul_f32 v85, v85, v224
    v_mfma_f32_16x16x32_bf16 a[80:83], a[232:235], v[192:195], a[80:83]
    s_waitcnt lgkmcnt(8)
    v_mul_f32 v86, v86, v224
    v_mul_f32 v87, v87, v224
    v_mfma_f32_16x16x32_bf16 a[80:83], a[236:239], v[208:211], a[80:83]
    v_cvt_pk_bf16_f32 v32, v80, v81
    v_cvt_pk_bf16_f32 v33, v82, v83
    v_mfma_f32_16x16x32_bf16 a[84:87], a[232:235], v[196:199], a[84:87]
    s_add_u32 s52, s45, 0
    v_cvt_pk_bf16_f32 v34, v84, v85
    v_cvt_pk_bf16_f32 v35, v86, v87
    v_mfma_f32_16x16x32_bf16 a[84:87], a[236:239], v[212:215], a[84:87]
    buffer_store_dwordx4 v[32:35], v1, s[28:31], s52 offen offset:0 sc1
    v_mfma_f32_16x16x32_bf16 a[88:91], a[232:235], v[200:203], a[88:91]
    v_accvgpr_read_b32 v88, a4
    v_accvgpr_read_b32 v89, a5
    v_mfma_f32_16x16x32_bf16 a[88:91], a[236:239], v[216:219], a[88:91]
    v_accvgpr_read_b32 v90, a6
    v_accvgpr_read_b32 v91, a7
    v_mfma_f32_16x16x32_bf16 a[92:95], a[232:235], v[204:207], a[92:95]
    v_accvgpr_read_b32 v92, a20
    v_accvgpr_read_b32 v93, a21
    v_mfma_f32_16x16x32_bf16 a[92:95], a[236:239], v[220:223], a[92:95]
    s_waitcnt lgkmcnt(6)
    v_accvgpr_read_b32 v94, a22
    v_accvgpr_read_b32 v95, a23
    v_mfma_f32_16x16x32_bf16 a[96:99], a[240:243], v[192:195], a[96:99]
    s_waitcnt lgkmcnt(4)
    v_mul_f32 v88, v88, v225
    v_mul_f32 v89, v89, v225
    v_mfma_f32_16x16x32_bf16 a[96:99], a[244:247], v[208:211], a[96:99]
    v_mul_f32 v90, v90, v225
    v_mul_f32 v91, v91, v225
    v_mfma_f32_16x16x32_bf16 a[100:103], a[240:243], v[196:199], a[100:103]
    v_mul_f32 v92, v92, v225
    v_mul_f32 v93, v93, v225
    v_mfma_f32_16x16x32_bf16 a[100:103], a[244:247], v[212:215], a[100:103]
    v_mul_f32 v94, v94, v225
    v_mul_f32 v95, v95, v225
    v_mfma_f32_16x16x32_bf16 a[104:107], a[240:243], v[200:203], a[104:107]
    v_cvt_pk_bf16_f32 v36, v88, v89
    v_cvt_pk_bf16_f32 v37, v90, v91
    v_mfma_f32_16x16x32_bf16 a[104:107], a[244:247], v[216:219], a[104:107]
    s_add_u32 s52, s45, 131072
    v_cvt_pk_bf16_f32 v38, v92, v93
    v_cvt_pk_bf16_f32 v39, v94, v95
    v_mfma_f32_16x16x32_bf16 a[108:111], a[240:243], v[204:207], a[108:111]
    buffer_store_dwordx4 v[36:39], v1, s[28:31], s52 offen offset:0 sc1
    v_mfma_f32_16x16x32_bf16 a[108:111], a[244:247], v[220:223], a[108:111]
    s_waitcnt lgkmcnt(2)
    v_accvgpr_read_b32 v112, a8
    v_accvgpr_read_b32 v113, a9
    v_mfma_f32_16x16x32_bf16 a[112:115], a[248:251], v[192:195], a[112:115]
    s_waitcnt lgkmcnt(0)
    v_accvgpr_read_b32 v114, a10
    v_accvgpr_read_b32 v115, a11
    v_mfma_f32_16x16x32_bf16 a[112:115], a[252:255], v[208:211], a[112:115]
    v_accvgpr_read_b32 v116, a24
    v_accvgpr_read_b32 v117, a25
    v_mfma_f32_16x16x32_bf16 a[116:119], a[248:251], v[196:199], a[116:119]
    v_accvgpr_read_b32 v118, a26
    v_accvgpr_read_b32 v119, a27
    v_mfma_f32_16x16x32_bf16 a[116:119], a[252:255], v[212:215], a[116:119]
    v_mul_f32 v112, v112, v226
    v_mul_f32 v113, v113, v226
    v_mfma_f32_16x16x32_bf16 a[120:123], a[248:251], v[200:203], a[120:123]
    v_mul_f32 v114, v114, v226
    v_mul_f32 v115, v115, v226
    v_mfma_f32_16x16x32_bf16 a[120:123], a[252:255], v[216:219], a[120:123]
    v_mul_f32 v116, v116, v226
    v_mul_f32 v117, v117, v226
    v_mfma_f32_16x16x32_bf16 a[124:127], a[248:251], v[204:207], a[124:127]
    buffer_load_dword v231, off, s[72:75], s39 sc1
    v_mfma_f32_16x16x32_bf16 a[124:127], a[252:255], v[220:223], a[124:127]
    v_mul_f32 v118, v118, v226
    v_mul_f32 v119, v119, v226
    v_cvt_pk_bf16_f32 v40, v112, v113
    v_cvt_pk_bf16_f32 v41, v114, v115
    s_add_u32 s52, s45, 262144
    v_cvt_pk_bf16_f32 v42, v116, v117
    v_cvt_pk_bf16_f32 v43, v118, v119
    buffer_store_dwordx4 v[40:43], v1, s[28:31], s52 offen offset:0 sc1
    v_accvgpr_read_b32 v120, a12
    v_accvgpr_read_b32 v121, a13
    v_accvgpr_read_b32 v122, a14
    v_accvgpr_read_b32 v123, a15
    v_accvgpr_read_b32 v124, a28
    v_accvgpr_read_b32 v125, a29
    v_accvgpr_read_b32 v126, a30
    v_accvgpr_read_b32 v127, a31
    v_mul_f32 v120, v120, v227
    v_mul_f32 v121, v121, v227
    v_mul_f32 v122, v122, v227
    v_mul_f32 v123, v123, v227
    v_mul_f32 v124, v124, v227
    v_mul_f32 v125, v125, v227
    v_mul_f32 v126, v126, v227
    v_mul_f32 v127, v127, v227
    v_cvt_pk_bf16_f32 v44, v120, v121
    v_cvt_pk_bf16_f32 v45, v122, v123
    s_add_u32 s52, s45, 393216
    v_cvt_pk_bf16_f32 v46, v124, v125
    v_cvt_pk_bf16_f32 v47, v126, v127
    buffer_store_dwordx4 v[44:47], v1, s[28:31], s52 offen offset:0 sc1
    v_accvgpr_read_b32 v144, a32
    v_accvgpr_read_b32 v145, a33
    v_accvgpr_read_b32 v146, a34
    v_accvgpr_read_b32 v147, a35
    v_accvgpr_read_b32 v148, a48
    v_accvgpr_read_b32 v149, a49
    v_accvgpr_read_b32 v150, a50
    v_accvgpr_read_b32 v151, a51
    v_mul_f32 v144, v144, v224
    v_mul_f32 v145, v145, v224
    v_mul_f32 v146, v146, v224
    v_mul_f32 v147, v147, v224
    v_mul_f32 v148, v148, v224
    v_mul_f32 v149, v149, v224
    v_mul_f32 v150, v150, v224
    v_mul_f32 v151, v151, v224
    v_cvt_pk_bf16_f32 v48, v144, v145
    v_cvt_pk_bf16_f32 v49, v146, v147
    s_add_u32 s52, s45, 0
    v_cvt_pk_bf16_f32 v50, v148, v149
    v_cvt_pk_bf16_f32 v51, v150, v151
    buffer_store_dwordx4 v[48:51], v1, s[28:31], s52 offen offset:1024 sc1
    v_accvgpr_read_b32 v152, a36
    v_accvgpr_read_b32 v153, a37
    v_accvgpr_read_b32 v154, a38
    v_accvgpr_read_b32 v155, a39
    v_accvgpr_read_b32 v156, a52
    v_accvgpr_read_b32 v157, a53
    v_accvgpr_read_b32 v158, a54
    v_accvgpr_read_b32 v159, a55
    v_mul_f32 v152, v152, v225
    v_mul_f32 v153, v153, v225
    v_mul_f32 v154, v154, v225
    v_mul_f32 v155, v155, v225
    v_mul_f32 v156, v156, v225
    v_mul_f32 v157, v157, v225
    v_mul_f32 v158, v158, v225
    v_mul_f32 v159, v159, v225
    v_cvt_pk_bf16_f32 v52, v152, v153
    v_cvt_pk_bf16_f32 v53, v154, v155
    s_add_u32 s52, s45, 131072
    v_cvt_pk_bf16_f32 v54, v156, v157
    v_cvt_pk_bf16_f32 v55, v158, v159
    buffer_store_dwordx4 v[52:55], v1, s[28:31], s52 offen offset:1024 sc1
    v_accvgpr_read_b32 v176, a40
    v_accvgpr_read_b32 v177, a41
    v_accvgpr_read_b32 v178, a42
    v_accvgpr_read_b32 v179, a43
    v_accvgpr_read_b32 v180, a56
    v_accvgpr_read_b32 v181, a57
    v_accvgpr_read_b32 v182, a58
    v_accvgpr_read_b32 v183, a59
    v_mul_f32 v176, v176, v226
    v_mul_f32 v177, v177, v226
    v_mul_f32 v178, v178, v226
    v_mul_f32 v179, v179, v226
    v_mul_f32 v180, v180, v226
    v_mul_f32 v181, v181, v226
    v_mul_f32 v182, v182, v226
    v_mul_f32 v183, v183, v226
    v_cvt_pk_bf16_f32 v56, v176, v177
    v_cvt_pk_bf16_f32 v57, v178, v179
    s_add_u32 s52, s45, 262144
    v_cvt_pk_bf16_f32 v58, v180, v181
    v_cvt_pk_bf16_f32 v59, v182, v183
    buffer_store_dwordx4 v[56:59], v1, s[28:31], s52 offen offset:1024 sc1
    v_accvgpr_read_b32 v184, a44
    v_accvgpr_read_b32 v185, a45
    v_accvgpr_read_b32 v186, a46
    v_accvgpr_read_b32 v187, a47
    v_accvgpr_read_b32 v188, a60
    v_accvgpr_read_b32 v189, a61
    v_accvgpr_read_b32 v190, a62
    v_accvgpr_read_b32 v191, a63
    v_mul_f32 v184, v184, v227
    v_mul_f32 v185, v185, v227
    v_mul_f32 v186, v186, v227
    v_mul_f32 v187, v187, v227
    v_mul_f32 v188, v188, v227
    v_mul_f32 v189, v189, v227
    v_mul_f32 v190, v190, v227
    v_mul_f32 v191, v191, v227
    v_cvt_pk_bf16_f32 v60, v184, v185
    v_cvt_pk_bf16_f32 v61, v186, v187
    s_add_u32 s52, s45, 393216
    v_cvt_pk_bf16_f32 v62, v188, v189
    v_cvt_pk_bf16_f32 v63, v190, v191
    buffer_store_dwordx4 v[60:63], v1, s[28:31], s52 offen offset:1024 sc1
    v_accvgpr_read_b32 v80, a64
    v_accvgpr_read_b32 v81, a65
    v_accvgpr_read_b32 v82, a66
    v_accvgpr_read_b32 v83, a67
    v_accvgpr_read_b32 v84, a80
    v_accvgpr_read_b32 v85, a81
    v_accvgpr_read_b32 v86, a82
    v_accvgpr_read_b32 v87, a83
    v_mul_f32 v80, v80, v224
    v_mul_f32 v81, v81, v224
    v_mul_f32 v82, v82, v224
    v_mul_f32 v83, v83, v224
    v_mul_f32 v84, v84, v224
    v_mul_f32 v85, v85, v224
    v_mul_f32 v86, v86, v224
    v_mul_f32 v87, v87, v224
    v_cvt_pk_bf16_f32 v32, v80, v81
    v_cvt_pk_bf16_f32 v33, v82, v83
    s_add_u32 s52, s45, 0
    v_cvt_pk_bf16_f32 v34, v84, v85
    v_cvt_pk_bf16_f32 v35, v86, v87
    buffer_store_dwordx4 v[32:35], v1, s[28:31], s52 offen offset:2048 sc1
    v_accvgpr_read_b32 v88, a68
    v_accvgpr_read_b32 v89, a69
    v_accvgpr_read_b32 v90, a70
    v_accvgpr_read_b32 v91, a71
    v_accvgpr_read_b32 v92, a84
    v_accvgpr_read_b32 v93, a85
    v_accvgpr_read_b32 v94, a86
    v_accvgpr_read_b32 v95, a87
    v_mul_f32 v88, v88, v225
    v_mul_f32 v89, v89, v225
    v_mul_f32 v90, v90, v225
    v_mul_f32 v91, v91, v225
    v_mul_f32 v92, v92, v225
    v_mul_f32 v93, v93, v225
    v_mul_f32 v94, v94, v225
    v_mul_f32 v95, v95, v225
    v_cvt_pk_bf16_f32 v36, v88, v89
    v_cvt_pk_bf16_f32 v37, v90, v91
    s_add_u32 s52, s45, 131072
    v_cvt_pk_bf16_f32 v38, v92, v93
    v_cvt_pk_bf16_f32 v39, v94, v95
    buffer_store_dwordx4 v[36:39], v1, s[28:31], s52 offen offset:2048 sc1
    v_accvgpr_read_b32 v112, a72
    v_accvgpr_read_b32 v113, a73
    v_accvgpr_read_b32 v114, a74
    v_accvgpr_read_b32 v115, a75
    v_accvgpr_read_b32 v116, a88
    v_accvgpr_read_b32 v117, a89
    v_accvgpr_read_b32 v118, a90
    v_accvgpr_read_b32 v119, a91
    v_mul_f32 v112, v112, v226
    v_mul_f32 v113, v113, v226
    v_mul_f32 v114, v114, v226
    v_mul_f32 v115, v115, v226
    v_mul_f32 v116, v116, v226
    v_mul_f32 v117, v117, v226
    v_mul_f32 v118, v118, v226
    v_mul_f32 v119, v119, v226
    v_cvt_pk_bf16_f32 v40, v112, v113
    v_cvt_pk_bf16_f32 v41, v114, v115
    s_add_u32 s52, s45, 262144
    v_cvt_pk_bf16_f32 v42, v116, v117
    v_cvt_pk_bf16_f32 v43, v118, v119
    buffer_store_dwordx4 v[40:43], v1, s[28:31], s52 offen offset:2048 sc1
    v_accvgpr_read_b32 v120, a76
    v_accvgpr_read_b32 v121, a77
    v_accvgpr_read_b32 v122, a78
    v_accvgpr_read_b32 v123, a79
    v_accvgpr_read_b32 v124, a92
    v_accvgpr_read_b32 v125, a93
    v_accvgpr_read_b32 v126, a94
    v_accvgpr_read_b32 v127, a95
    v_mul_f32 v120, v120, v227
    v_mul_f32 v121, v121, v227
    v_mul_f32 v122, v122, v227
    v_mul_f32 v123, v123, v227
    v_mul_f32 v124, v124, v227
    v_mul_f32 v125, v125, v227
    v_mul_f32 v126, v126, v227
    v_mul_f32 v127, v127, v227
    v_cvt_pk_bf16_f32 v44, v120, v121
    v_cvt_pk_bf16_f32 v45, v122, v123
    s_add_u32 s52, s45, 393216
    v_cvt_pk_bf16_f32 v46, v124, v125
    v_cvt_pk_bf16_f32 v47, v126, v127
    buffer_store_dwordx4 v[44:47], v1, s[28:31], s52 offen offset:2048 sc1
    v_accvgpr_read_b32 v144, a96
    v_accvgpr_read_b32 v145, a97
    v_accvgpr_read_b32 v146, a98
    v_accvgpr_read_b32 v147, a99
    v_accvgpr_read_b32 v148, a112
    v_accvgpr_read_b32 v149, a113
    v_accvgpr_read_b32 v150, a114
    v_accvgpr_read_b32 v151, a115
    v_mul_f32 v144, v144, v224
    v_mul_f32 v145, v145, v224
    v_mul_f32 v146, v146, v224
    v_mul_f32 v147, v147, v224
    v_mul_f32 v148, v148, v224
    v_mul_f32 v149, v149, v224
    v_mul_f32 v150, v150, v224
    v_mul_f32 v151, v151, v224
    v_cvt_pk_bf16_f32 v48, v144, v145
    v_cvt_pk_bf16_f32 v49, v146, v147
    s_add_u32 s52, s45, 0
    v_cvt_pk_bf16_f32 v50, v148, v149
    v_cvt_pk_bf16_f32 v51, v150, v151
    buffer_store_dwordx4 v[48:51], v1, s[28:31], s52 offen offset:3072 sc1
    v_accvgpr_read_b32 v152, a100
    v_accvgpr_read_b32 v153, a101
    v_accvgpr_read_b32 v154, a102
    v_accvgpr_read_b32 v155, a103
    v_accvgpr_read_b32 v156, a116
    v_accvgpr_read_b32 v157, a117
    v_accvgpr_read_b32 v158, a118
    v_accvgpr_read_b32 v159, a119
    v_mul_f32 v152, v152, v225
    v_mul_f32 v153, v153, v225
    v_mul_f32 v154, v154, v225
    v_mul_f32 v155, v155, v225
    v_mul_f32 v156, v156, v225
    v_mul_f32 v157, v157, v225
    v_mul_f32 v158, v158, v225
    v_mul_f32 v159, v159, v225
    v_cvt_pk_bf16_f32 v52, v152, v153
    v_cvt_pk_bf16_f32 v53, v154, v155
    s_add_u32 s52, s45, 131072
    v_cvt_pk_bf16_f32 v54, v156, v157
    v_cvt_pk_bf16_f32 v55, v158, v159
    buffer_store_dwordx4 v[52:55], v1, s[28:31], s52 offen offset:3072 sc1
    v_accvgpr_read_b32 v176, a104
    v_accvgpr_read_b32 v177, a105
    v_accvgpr_read_b32 v178, a106
    v_accvgpr_read_b32 v179, a107
    v_accvgpr_read_b32 v180, a120
    v_accvgpr_read_b32 v181, a121
    v_accvgpr_read_b32 v182, a122
    v_accvgpr_read_b32 v183, a123
    v_mul_f32 v176, v176, v226
    v_mul_f32 v177, v177, v226
    v_mul_f32 v178, v178, v226
    v_mul_f32 v179, v179, v226
    v_mul_f32 v180, v180, v226
    v_mul_f32 v181, v181, v226
    v_mul_f32 v182, v182, v226
    v_mul_f32 v183, v183, v226
    v_cvt_pk_bf16_f32 v56, v176, v177
    v_cvt_pk_bf16_f32 v57, v178, v179
    s_add_u32 s52, s45, 262144
    v_cvt_pk_bf16_f32 v58, v180, v181
    v_cvt_pk_bf16_f32 v59, v182, v183
    buffer_store_dwordx4 v[56:59], v1, s[28:31], s52 offen offset:3072 sc1
    v_accvgpr_read_b32 v184, a108
    v_accvgpr_read_b32 v185, a109
    v_accvgpr_read_b32 v186, a110
    v_accvgpr_read_b32 v187, a111
    v_accvgpr_read_b32 v188, a124
    v_accvgpr_read_b32 v189, a125
    v_accvgpr_read_b32 v190, a126
    v_accvgpr_read_b32 v191, a127
    v_mul_f32 v184, v184, v227
    v_mul_f32 v185, v185, v227
    v_mul_f32 v186, v186, v227
    v_mul_f32 v187, v187, v227
    v_mul_f32 v188, v188, v227
    v_mul_f32 v189, v189, v227
    v_mul_f32 v190, v190, v227
    v_mul_f32 v191, v191, v227
    v_cvt_pk_bf16_f32 v60, v184, v185
    v_cvt_pk_bf16_f32 v61, v186, v187
    s_add_u32 s52, s45, 393216
    v_cvt_pk_bf16_f32 v62, v188, v189
    v_cvt_pk_bf16_f32 v63, v190, v191
    buffer_store_dwordx4 v[60:63], v1, s[28:31], s52 offen offset:3072 sc1
    v_add_f32 v228, v240, v241
    v_add_f32 v229, v242, v243
    v_add_f32 v228, v228, v229
    s_mov_b32 s52, 0x53800000
    v_cmp_nge_f32 vcc, s52, v228
    s_nop 0
    s_cmp_lg_u64 vcc, 0
    s_cselect_b32 s52, 1, 0
    s_andn2_b32 s52, s52, s60
    s_lshl_b32 s53, s3, 2
    v_mov_b32 v230, s53
    s_lshl_b32 s55, s5, 4
    s_lshr_b32 s53, s4, 3
    s_add_u32 s55, s55, s53
    s_lshl_b32 s55, s55, 7
    s_waitcnt vmcnt(0)
    v_readfirstlane_b32 s53, v231
    s_nop 0
    s_cmp_ge_u32 s53, s38
    s_cselect_b32 s53, 0, 2
    s_or_b32 s52, s52, s53
    v_mov_b32 v229, s52
    ds_write_b32 v230, v229
    v_mov_b32 v230, 0
    s_waitcnt lgkmcnt(0)
    s_barrier
    ds_read_b128 v[232:235], v230
    s_waitcnt lgkmcnt(0)
    v_or_b32 v232, v232, v233
    v_or3_b32 v232, v232, v234, v235
    s_nop 0
    v_readfirstlane_b32 s43, v232
    s_nop 0
    s_bitcmp1_b32 s43, 0
    s_cbranch_scc1 L_at_fallback
    s_cmp_lg_u32 s3, 0
    s_cbranch_scc1 L_skip_o
    v_mov_b32 v243, 1
    s_mov_b64 exec, 1
    buffer_atomic_add v243, off, s[72:75], s55 sc1
    s_mov_b64 exec, -1
L_skip_o:
    s_cmp_eq_u32 s43, 0
    s_cbranch_scc1 L_skip_o2
    s_cmp_lg_u32 s3, 1
    s_cbranch_scc1 L_skip_o2
    s_mov_b32 s53, 0x10000
L_poll_o2:
    buffer_load_dword v253, off, s[72:75], s39 sc1
    s_waitcnt vmcnt(0)
    v_readfirstlane_b32 s52, v253
    s_sub_u32 s53, s53, 1
    s_cbranch_scc1 L_skip_o2
    s_cmp_ge_u32 s52, s38
    s_cbranch_scc1 L_skip_o2
    s_sleep 1
    s_branch L_poll_o2
L_skip_o2:
    s_mov_b32 s52, 4194304
    s_cmp_lt_u32 s7, 4
    s_cselect_b32 s52, s52, 20971520
    s_lshl_b32 s53, s36, 12
    s_lshl_b32 s54, s5, 4
    s_lshl_b32 s55, s3, 2
    s_add_u32 s54, s54, s55
    s_mul_i32 s54, s54, s53
    s_lshl_b32 s55, s37, 10
    s_add_u32 s54, s54, s55
    s_add_u32 s54, s54, s52
    s_add_u32 s12, s76, s54
    s_addc_u32 s13, s77, 0
    s_lshl_b32 s14, s36, 10
    s_mov_b32 s15, 0x00020000
    s_add_u32 s54, s54, s53
    s_add_u32 s16, s76, s54
    s_addc_u32 s17, s77, 0
    s_lshl_b32 s18, s36, 10
    s_mov_b32 s19, 0x00020000
    s_add_u32 s54, s54, s53
    s_add_u32 s20, s76, s54
    s_addc_u32 s21, s77, 0
    s_lshl_b32 s22, s36, 10
    s_mov_b32 s23, 0x00020000
    s_add_u32 s54, s54, s53
    s_add_u32 s24, s76, s54
    s_addc_u32 s25, s77, 0
    s_lshl_b32 s26, s36, 10
    s_mov_b32 s27, 0x00020000
    s_add_u32 s44, s78, 442368
    s_mov_b32 s46, 0
    s_lshr_b32 s47, s36, 2
    s_sub_u32 s47, s47, 2
    s_cmp_eq_u32 s43, 0
    s_cbranch_scc1 L_op_go
    s_barrier
L_op_go:
    buffer_load_dwordx4 a[0:3], v1, s[12:15], s46 offen offset:0 sc1
    buffer_load_dwordx4 a[16:19], v1, s[12:15], s46 offen offset:1024 sc1
    buffer_load_dwordx4 a[4:7], v1, s[16:19], s46 offen offset:0 sc1
    buffer_load_dwordx4 a[20:23], v1, s[16:19], s46 offen offset:1024 sc1
    buffer_load_dwordx4 a[8:11], v1, s[20:23], s46 offen offset:0 sc1
    buffer_load_dwordx4 a[24:27], v1, s[20:23], s46 offen offset:1024 sc1
    buffer_load_dwordx4 a[12:15], v1, s[24:27], s46 offen offset:0 sc1
    buffer_load_dwordx4 a[28:31], v1, s[24:27], s46 offen offset:1024 sc1
    buffer_load_dwordx4 a[32:35], v1, s[12:15], s46 offen offset:2048 sc1
    buffer_load_dwordx4 a[48:51], v1, s[12:15], s46 offen offset:3072 sc1
    buffer_load_dwordx4 a[36:39], v1, s[16:19], s46 offen offset:2048 sc1
    buffer_load_dwordx4 a[52:55], v1, s[16:19], s46 offen offset:3072 sc1
    buffer_load_dwordx4 a[40:43], v1, s[20:23], s46 offen offset:2048 sc1
    buffer_load_dwordx4 a[56:59], v1, s[20:23], s46 offen offset:3072 sc1
    buffer_load_dwordx4 a[44:47], v1, s[24:27], s46 offen offset:2048 sc1
    buffer_load_dwordx4 a[60:63], v1, s[24:27], s46 offen offset:3072 sc1
    s_add_u32 s46, s46, 4096
    ds_read_b64_tr_b16 v[208:209], v29 offset:0
    ds_read_b64_tr_b16 v[210:211], v29 offset:4608
    ds_read_b64_tr_b16 v[212:213], v29 offset:9216
    ds_read_b64_tr_b16 v[214:215], v29 offset:13824
    ds_read_b64_tr_b16 v[216:217], v29 offset:32
    ds_read_b64_tr_b16 v[218:219], v29 offset:4640
    ds_read_b64_tr_b16 v[220:221], v29 offset:9248
    ds_read_b64_tr_b16 v[222:223], v29 offset:13856
    s_add_u32 s28, s76, 41943040
    s_addc_u32 s29, s77, 0
    s_mov_b32 s30, 18874368
    s_mov_b32 s31, 0x00020000
    s_lshl_b32 s48, s5, 2
    s_add_u32 s48, s48, s6
    s_lshl_b32 s55, s5, 4
    s_add_u32 s55, s55, s6
    s_add_u32 s55, s55, 8
    s_lshl_b32 s55, s55, 7
    s_mul_i32 s48, s48, 73728
    s_mul_i32 s49, s7, 9216
    s_add_u32 s49, s49, s48
    s_mul_i32 s52, s7, 2359296
    s_add_u32 s48, s48, s52
    s_mul_i32 s52, s3, 18432
    s_add_u32 s48, s48, s52
    s_load_dwordx2 s[56:57], s[0:1], 0
    s_load_dwordx2 s[58:59], s[0:1], 72
    s_lshl_b32 s60, s5, 3
    s_add_u32 s60, s60, s7
    s_mul_i32 s60, s60, 36864
    s_mul_i32 s52, s6, 288
    s_add_u32 s60, s60, s52
    s_lshr_b32 s63, s3, 1
    s_mul_i32 s63, s63, 18432
    s_add_u32 s63, s63, s60
    s_and_b32 s52, s3, 1
    s_lshl_b32 s52, s52, 2
    s_add_u32 s63, s63, s52
    s_add_u32 s63, s63, 256
    s_lshl_b32 s52, s3, 5
    s_add_u32 s60, s60, s52
    s_add_u32 s61, s60, 18432
    s_lshl_b32 s50, s3, 2
    s_add_u32 s50, s50, s49
    s_add_u32 s50, s50, 8192
    s_lshl_b32 s52, s3, 10
    s_add_u32 s49, s49, s52
    v_and_b32 v2, 15, v0
    v_lshrrev_b32 v3, 4, v0
    v_mul_u32_u24 v2, 1152, v2
    v_lshl_add_u32 v2, v3, 3, v2
    s_mov_b32 s62, 0xc2b17218
    s_waitcnt lgkmcnt(0)
    s_mov_b32 s64, s56
    s_mov_b32 s65, s57
    s_mov_b32 s66, 2359296
    s_mov_b32 s67, 0x00020000
    s_mov_b32 s68, s58
    s_mov_b32 s69, s59
    s_mov_b32 s70, 2359296
    s_mov_b32 s71, 0x00020000
    s_waitcnt vmcnt(15)
    v_mfma_f32_16x16x32_bf16 v[64:67], v[208:211], a[0:3], 0
    s_waitcnt vmcnt(14)
    ds_read_b64_tr_b16 v[224:225], v29 offset:64
    v_mfma_f32_16x16x32_bf16 v[64:67], v[212:215], a[16:19], v[64:67]
    s_waitcnt vmcnt(13)
    v_mfma_f32_16x16x32_bf16 v[68:71], v[208:211], a[4:7], 0
    s_waitcnt vmcnt(12)
    ds_read_b64_tr_b16 v[226:227], v29 offset:4672
    v_mfma_f32_16x16x32_bf16 v[68:71], v[212:215], a[20:23], v[68:71]
    s_waitcnt vmcnt(11)
    v_mfma_f32_16x16x32_bf16 v[72:75], v[208:211], a[8:11], 0
    s_waitcnt vmcnt(10)
    ds_read_b64_tr_b16 v[228:229], v29 offset:9280
    v_mfma_f32_16x16x32_bf16 v[72:75], v[212:215], a[24:27], v[72:75]
    s_waitcnt vmcnt(9)
    buffer_load_dwordx4 a[64:67], v1, s[12:15], s46 offen offset:0 sc1
    v_mfma_f32_16x16x32_bf16 v[76:79], v[208:211], a[12:15], 0
    s_waitcnt vmcnt(9)
    ds_read_b64_tr_b16 v[230:231], v29 offset:13888
    v_mfma_f32_16x16x32_bf16 v[76:79], v[212:215], a[28:31], v[76:79]
    v_mfma_f32_16x16x32_bf16 v[80:83], v[216:219], a[0:3], 0
    ds_read_b64_tr_b16 v[208:209], v29 offset:96
    v_mfma_f32_16x16x32_bf16 v[80:83], v[220:223], a[16:19], v[80:83]
    buffer_load_dwordx4 a[80:83], v1, s[12:15], s46 offen offset:1024 sc1
    v_mfma_f32_16x16x32_bf16 v[84:87], v[216:219], a[4:7], 0
    ds_read_b64_tr_b16 v[210:211], v29 offset:4704
    v_mfma_f32_16x16x32_bf16 v[84:87], v[220:223], a[20:23], v[84:87]
    v_mfma_f32_16x16x32_bf16 v[88:91], v[216:219], a[8:11], 0
    ds_read_b64_tr_b16 v[212:213], v29 offset:9312
    v_mfma_f32_16x16x32_bf16 v[88:91], v[220:223], a[24:27], v[88:91]
    buffer_load_dwordx4 a[68:71], v1, s[16:19], s46 offen offset:0 sc1
    v_mfma_f32_16x16x32_bf16 v[92:95], v[216:219], a[12:15], 0
    ds_read_b64_tr_b16 v[214:215], v29 offset:13920
    v_mfma_f32_16x16x32_bf16 v[92:95], v[220:223], a[28:31], v[92:95]
    s_waitcnt lgkmcnt(6)
    v_mfma_f32_16x16x32_bf16 v[96:99], v[224:227], a[0:3], 0
    s_waitcnt lgkmcnt(4)
    ds_read_b64_tr_b16 v[216:217], v29 offset:128
    v_mfma_f32_16x16x32_bf16 v[96:99], v[228:231], a[16:19], v[96:99]
    buffer_load_dwordx4 a[84:87], v1, s[16:19], s46 offen offset:1024 sc1
    v_mfma_f32_16x16x32_bf16 v[100:103], v[224:227], a[4:7], 0
    ds_read_b64_tr_b16 v[218:219], v29 offset:4736
    v_mfma_f32_16x16x32_bf16 v[100:103], v[228:231], a[20:23], v[100:103]
    v_mfma_f32_16x16x32_bf16 v[104:107], v[224:227], a[8:11], 0
    ds_read_b64_tr_b16 v[220:221], v29 offset:9344
    v_mfma_f32_16x16x32_bf16 v[104:107], v[228:231], a[24:27], v[104:107]
    buffer_load_dwordx4 a[72:75], v1, s[20:23], s46 offen offset:0 sc1
    v_mfma_f32_16x16x32_bf16 v[108:111], v[224:227], a[12:15], 0
    ds_read_b64_tr_b16 v[222:223], v29 offset:13952
    v_mfma_f32_16x16x32_bf16 v[108:111], v[228:231], a[28:31], v[108:111]
    s_waitcnt lgkmcnt(6)
    v_mfma_f32_16x16x32_bf16 v[112:115], v[208:211], a[0:3], 0
    s_waitcnt lgkmcnt(4)
    ds_read_b64_tr_b16 v[224:225], v29 offset:160
    v_mfma_f32_16x16x32_bf16 v[112:115], v[212:215], a[16:19], v[112:115]
    buffer_load_dwordx4 a[88:91], v1, s[20:23], s46 offen offset:1024 sc1
    v_mfma_f32_16x16x32_bf16 v[116:119], v[208:211], a[4:7], 0
    ds_read_b64_tr_b16 v[226:227], v29 offset:4768
    v_mfma_f32_16x16x32_bf16 v[116:119], v[212:215], a[20:23], v[116:119]
    v_mfma_f32_16x16x32_bf16 v[120:123], v[208:211], a[8:11], 0
    ds_read_b64_tr_b16 v[228:229], v29 offset:9376
    v_mfma_f32_16x16x32_bf16 v[120:123], v[212:215], a[24:27], v[120:123]
    buffer_load_dwordx4 a[76:79], v1, s[24:27], s46 offen offset:0 sc1
    v_mfma_f32_16x16x32_bf16 v[124:127], v[208:211], a[12:15], 0
    ds_read_b64_tr_b16 v[230:231], v29 offset:13984
    v_mfma_f32_16x16x32_bf16 v[124:127], v[212:215], a[28:31], v[124:127]
    s_waitcnt lgkmcnt(6)
    v_mfma_f32_16x16x32_bf16 v[128:131], v[216:219], a[0:3], 0
    s_waitcnt lgkmcnt(4)
    ds_read_b64_tr_b16 v[208:209], v29 offset:192
    v_mfma_f32_16x16x32_bf16 v[128:131], v[220:223], a[16:19], v[128:131]
    buffer_load_dwordx4 a[92:95], v1, s[24:27], s46 offen offset:1024 sc1
    v_mfma_f32_16x16x32_bf16 v[132:135], v[216:219], a[4:7], 0
    ds_read_b64_tr_b16 v[210:211], v29 offset:4800
    v_mfma_f32_16x16x32_bf16 v[132:135], v[220:223], a[20:23], v[132:135]
    v_mfma_f32_16x16x32_bf16 v[136:139], v[216:219], a[8:11], 0
    ds_read_b64_tr_b16 v[212:213], v29 offset:9408
    v_mfma_f32_16x16x32_bf16 v[136:139], v[220:223], a[24:27], v[136:139]
    buffer_load_dwordx4 a[96:99], v1, s[12:15], s46 offen offset:2048 sc1
    v_mfma_f32_16x16x32_bf16 v[140:143], v[216:219], a[12:15], 0
    ds_read_b64_tr_b16 v[214:215], v29 offset:14016
    v_mfma_f32_16x16x32_bf16 v[140:143], v[220:223], a[28:31], v[140:143]
    s_waitcnt lgkmcnt(6)
    v_mfma_f32_16x16x32_bf16 v[144:147], v[224:227], a[0:3], 0
    s_waitcnt lgkmcnt(4)
    ds_read_b64_tr_b16 v[216:217], v29 offset:224
    v_mfma_f32_16x16x32_bf16 v[144:147], v[228:231], a[16:19], v[144:147]
    buffer_load_dwordx4 a[112:115], v1, s[12:15], s46 offen offset:3072 sc1
    v_mfma_f32_16x16x32_bf16 v[148:151], v[224:227], a[4:7], 0
    ds_read_b64_tr_b16 v[218:219], v29 offset:4832
    v_mfma_f32_16x16x32_bf16 v[148:151], v[228:231], a[20:23], v[148:151]
    v_mfma_f32_16x16x32_bf16 v[152:155], v[224:227], a[8:11], 0
    ds_read_b64_tr_b16 v[220:221], v29 offset:9440
    v_mfma_f32_16x16x32_bf16 v[152:155], v[228:231], a[24:27], v[152:155]
    buffer_load_dwordx4 a[100:103], v1, s[16:19], s46 offen offset:2048 sc1
    v_mfma_f32_16x16x32_bf16 v[156:159], v[224:227], a[12:15], 0
    ds_read_b64_tr_b16 v[222:223], v29 offset:14048
    v_mfma_f32_16x16x32_bf16 v[156:159], v[228:231], a[28:31], v[156:159]
    s_waitcnt lgkmcnt(6)
    v_mfma_f32_16x16x32_bf16 v[160:163], v[208:211], a[0:3], 0
    s_waitcnt lgkmcnt(4)
    ds_read_b64_tr_b16 v[224:225], v29 offset:256
    v_mfma_f32_16x16x32_bf16 v[160:163], v[212:215], a[16:19], v[160:163]
    buffer_load_dwordx4 a[116:119], v1, s[16:19], s46 offen offset:3072 sc1
    v_mfma_f32_16x16x32_bf16 v[164:167], v[208:211], a[4:7], 0
    ds_read_b64_tr_b16 v[226:227], v29 offset:4864
    v_mfma_f32_16x16x32_bf16 v[164:167], v[212:215], a[20:23], v[164:167]
    v_mfma_f32_16x16x32_bf16 v[168:171], v[208:211], a[8:11], 0
    ds_read_b64_tr_b16 v[228:229], v29 offset:9472
    v_mfma_f32_16x16x32_bf16 v[168:171], v[212:215], a[24:27], v[168:171]
    buffer_load_dwordx4 a[104:107], v1, s[20:23], s46 offen offset:2048 sc1
    v_mfma_f32_16x16x32_bf16 v[172:175], v[208:211], a[12:15], 0
    ds_read_b64_tr_b16 v[230:231], v29 offset:14080
    v_mfma_f32_16x16x32_bf16 v[172:175], v[212:215], a[28:31], v[172:175]
    s_waitcnt lgkmcnt(6)
    v_mfma_f32_16x16x32_bf16 v[176:179], v[216:219], a[0:3], 0
    s_waitcnt lgkmcnt(4)
    ds_read_b64_tr_b16 v[208:209], v29 offset:18432
    v_mfma_f32_16x16x32_bf16 v[176:179], v[220:223], a[16:19], v[176:179]
    buffer_load_dwordx4 a[120:123], v1, s[20:23], s46 offen offset:3072 sc1
    v_mfma_f32_16x16x32_bf16 v[180:183], v[216:219], a[4:7], 0
    ds_read_b64_tr_b16 v[210:211], v29 offset:23040
    v_mfma_f32_16x16x32_bf16 v[180:183], v[220:223], a[20:23], v[180:183]
    v_mfma_f32_16x16x32_bf16 v[184:187], v[216:219], a[8:11], 0
    ds_read_b64_tr_b16 v[212:213], v29 offset:27648
    v_mfma_f32_16x16x32_bf16 v[184:187], v[220:223], a[24:27], v[184:187]
    buffer_load_dwordx4 a[108:111], v1, s[24:27], s46 offen offset:2048 sc1
    v_mfma_f32_16x16x32_bf16 v[188:191], v[216:219], a[12:15], 0
    ds_read_b64_tr_b16 v[214:215], v29 offset:32256
    v_mfma_f32_16x16x32_bf16 v[188:191], v[220:223], a[28:31], v[188:191]
    s_waitcnt lgkmcnt(6)
    v_mfma_f32_16x16x32_bf16 v[192:195], v[224:227], a[0:3], 0
    s_waitcnt lgkmcnt(4)
    ds_read_b64_tr_b16 v[216:217], v29 offset:18464
    v_mfma_f32_16x16x32_bf16 v[192:195], v[228:231], a[16:19], v[192:195]
    buffer_load_dwordx4 a[124:127], v1, s[24:27], s46 offen offset:3072 sc1
    v_mfma_f32_16x16x32_bf16 v[196:199], v[224:227], a[4:7], 0
    s_add_u32 s46, s46, 4096
    ds_read_b64_tr_b16 v[218:219], v29 offset:23072
    v_mfma_f32_16x16x32_bf16 v[196:199], v[228:231], a[20:23], v[196:199]
    v_mfma_f32_16x16x32_bf16 v[200:203], v[224:227], a[8:11], 0
    ds_read_b64_tr_b16 v[220:221], v29 offset:27680
    v_mfma_f32_16x16x32_bf16 v[200:203], v[228:231], a[24:27], v[200:203]
    v_mfma_f32_16x16x32_bf16 v[204:207], v[224:227], a[12:15], 0
    ds_read_b64_tr_b16 v[222:223], v29 offset:32288
    v_mfma_f32_16x16x32_bf16 v[204:207], v[228:231], a[28:31], v[204:207]
    s_waitcnt vmcnt(23) lgkmcnt(6)
    buffer_load_dwordx4 a[128:131], v1, s[12:15], s46 offen offset:0 sc1
    v_mfma_f32_16x16x32_bf16 v[64:67], v[208:211], a[32:35], v[64:67]
    s_waitcnt vmcnt(23) lgkmcnt(4)
    ds_read_b64_tr_b16 v[224:225], v29 offset:18496
    v_mfma_f32_16x16x32_bf16 v[64:67], v[212:215], a[48:51], v[64:67]
    s_waitcnt vmcnt(22)
    v_mfma_f32_16x16x32_bf16 v[68:71], v[208:211], a[36:39], v[68:71]
    s_waitcnt vmcnt(21)
    ds_read_b64_tr_b16 v[226:227], v29 offset:23104
    v_mfma_f32_16x16x32_bf16 v[68:71], v[212:215], a[52:55], v[68:71]
    s_waitcnt vmcnt(20)
    buffer_load_dwordx4 a[144:147], v1, s[12:15], s46 offen offset:1024 sc1
    v_mfma_f32_16x16x32_bf16 v[72:75], v[208:211], a[40:43], v[72:75]
    s_waitcnt vmcnt(20)
    ds_read_b64_tr_b16 v[228:229], v29 offset:27712
    v_mfma_f32_16x16x32_bf16 v[72:75], v[212:215], a[56:59], v[72:75]
    s_waitcnt vmcnt(19)
    v_mfma_f32_16x16x32_bf16 v[76:79], v[208:211], a[44:47], v[76:79]
    s_waitcnt vmcnt(18)
    ds_read_b64_tr_b16 v[230:231], v29 offset:32320
    v_mfma_f32_16x16x32_bf16 v[76:79], v[212:215], a[60:63], v[76:79]
    s_waitcnt lgkmcnt(6)
    buffer_load_dwordx4 a[132:135], v1, s[16:19], s46 offen offset:0 sc1
    v_mfma_f32_16x16x32_bf16 v[80:83], v[216:219], a[32:35], v[80:83]
    s_waitcnt lgkmcnt(4)
    ds_read_b64_tr_b16 v[208:209], v29 offset:18528
    v_mfma_f32_16x16x32_bf16 v[80:83], v[220:223], a[48:51], v[80:83]
    v_mfma_f32_16x16x32_bf16 v[84:87], v[216:219], a[36:39], v[84:87]
    ds_read_b64_tr_b16 v[210:211], v29 offset:23136
    v_mfma_f32_16x16x32_bf16 v[84:87], v[220:223], a[52:55], v[84:87]
    buffer_load_dwordx4 a[148:151], v1, s[16:19], s46 offen offset:1024 sc1
    v_mfma_f32_16x16x32_bf16 v[88:91], v[216:219], a[40:43], v[88:91]
    ds_read_b64_tr_b16 v[212:213], v29 offset:27744
    v_mfma_f32_16x16x32_bf16 v[88:91], v[220:223], a[56:59], v[88:91]
    v_mfma_f32_16x16x32_bf16 v[92:95], v[216:219], a[44:47], v[92:95]
    ds_read_b64_tr_b16 v[214:215], v29 offset:32352
    v_mfma_f32_16x16x32_bf16 v[92:95], v[220:223], a[60:63], v[92:95]
    s_waitcnt lgkmcnt(6)
    buffer_load_dwordx4 a[136:139], v1, s[20:23], s46 offen offset:0 sc1
    v_mfma_f32_16x16x32_bf16 v[96:99], v[224:227], a[32:35], v[96:99]
    s_waitcnt lgkmcnt(4)
    ds_read_b64_tr_b16 v[216:217], v29 offset:18560
    v_mfma_f32_16x16x32_bf16 v[96:99], v[228:231], a[48:51], v[96:99]
    v_mfma_f32_16x16x32_bf16 v[100:103], v[224:227], a[36:39], v[100:103]
    ds_read_b64_tr_b16 v[218:219], v29 offset:23168
    v_mfma_f32_16x16x32_bf16 v[100:103], v[228:231], a[52:55], v[100:103]
    buffer_load_dwordx4 a[152:155], v1, s[20:23], s46 offen offset:1024 sc1
    v_mfma_f32_16x16x32_bf16 v[104:107], v[224:227], a[40:43], v[104:107]
    ds_read_b64_tr_b16 v[220:221], v29 offset:27776
    v_mfma_f32_16x16x32_bf16 v[104:107], v[228:231], a[56:59], v[104:107]
    v_mfma_f32_16x16x32_bf16 v[108:111], v[224:227], a[44:47], v[108:111]
    ds_read_b64_tr_b16 v[222:223], v29 offset:32384
    v_mfma_f32_16x16x32_bf16 v[108:111], v[228:231], a[60:63], v[108:111]
    s_waitcnt lgkmcnt(6)
    buffer_load_dwordx4 a[140:143], v1, s[24:27], s46 offen offset:0 sc1
    v_mfma_f32_16x16x32_bf16 v[112:115], v[208:211], a[32:35], v[112:115]
    s_waitcnt lgkmcnt(4)
    ds_read_b64_tr_b16 v[224:225], v29 offset:18592
    v_mfma_f32_16x16x32_bf16 v[112:115], v[212:215], a[48:51], v[112:115]
    v_mfma_f32_16x16x32_bf16 v[116:119], v[208:211], a[36:39], v[116:119]
    ds_read_b64_tr_b16 v[226:227], v29 offset:23200
    v_mfma_f32_16x16x32_bf16 v[116:119], v[212:215], a[52:55], v[116:119]
    buffer_load_dwordx4 a[156:159], v1, s[24:27], s46 offen offset:1024 sc1
    v_mfma_f32_16x16x32_bf16 v[120:123], v[208:211], a[40:43], v[120:123]
    ds_read_b64_tr_b16 v[228:229], v29 offset:27808
    v_mfma_f32_16x16x32_bf16 v[120:123], v[212:215], a[56:59], v[120:123]
    v_mfma_f32_16x16x32_bf16 v[124:127], v[208:211], a[44:47], v[124:127]
    ds_read_b64_tr_b16 v[230:231], v29 offset:32416
    v_mfma_f32_16x16x32_bf16 v[124:127], v[212:215], a[60:63], v[124:127]
    s_waitcnt lgkmcnt(6)
    buffer_load_dwordx4 a[160:163], v1, s[12:15], s46 offen offset:2048 sc1
    v_mfma_f32_16x16x32_bf16 v[128:131], v[216:219], a[32:35], v[128:131]
    s_waitcnt lgkmcnt(4)
    ds_read_b64_tr_b16 v[208:209], v29 offset:18624
    v_mfma_f32_16x16x32_bf16 v[128:131], v[220:223], a[48:51], v[128:131]
    v_mfma_f32_16x16x32_bf16 v[132:135], v[216:219], a[36:39], v[132:135]
    ds_read_b64_tr_b16 v[210:211], v29 offset:23232
    v_mfma_f32_16x16x32_bf16 v[132:135], v[220:223], a[52:55], v[132:135]
    buffer_load_dwordx4 a[176:179], v1, s[12:15], s46 offen offset:3072 sc1
    v_mfma_f32_16x16x32_bf16 v[136:139], v[216:219], a[40:43], v[136:139]
    ds_read_b64_tr_b16 v[212:213], v29 offset:27840
    v_mfma_f32_16x16x32_bf16 v[136:139], v[220:223], a[56:59], v[136:139]
    v_mfma_f32_16x16x32_bf16 v[140:143], v[216:219], a[44:47], v[140:143]
    ds_read_b64_tr_b16 v[214:215], v29 offset:32448
    v_mfma_f32_16x16x32_bf16 v[140:143], v[220:223], a[60:63], v[140:143]
    s_waitcnt lgkmcnt(6)
    buffer_load_dwordx4 a[164:167], v1, s[16:19], s46 offen offset:2048 sc1
    v_mfma_f32_16x16x32_bf16 v[144:147], v[224:227], a[32:35], v[144:147]
    s_waitcnt lgkmcnt(4)
    ds_read_b64_tr_b16 v[216:217], v29 offset:18656
    v_mfma_f32_16x16x32_bf16 v[144:147], v[228:231], a[48:51], v[144:147]
    v_mfma_f32_16x16x32_bf16 v[148:151], v[224:227], a[36:39], v[148:151]
    ds_read_b64_tr_b16 v[218:219], v29 offset:23264
    v_mfma_f32_16x16x32_bf16 v[148:151], v[228:231], a[52:55], v[148:151]
    buffer_load_dwordx4 a[180:183], v1, s[16:19], s46 offen offset:3072 sc1
    v_mfma_f32_16x16x32_bf16 v[152:155], v[224:227], a[40:43], v[152:155]
    ds_read_b64_tr_b16 v[220:221], v29 offset:27872
    v_mfma_f32_16x16x32_bf16 v[152:155], v[228:231], a[56:59], v[152:155]
    v_mfma_f32_16x16x32_bf16 v[156:159], v[224:227], a[44:47], v[156:159]
    ds_read_b64_tr_b16 v[222:223], v29 offset:32480
    v_mfma_f32_16x16x32_bf16 v[156:159], v[228:231], a[60:63], v[156:159]
    s_waitcnt lgkmcnt(6)
    buffer_load_dwordx4 a[168:171], v1, s[20:23], s46 offen offset:2048 sc1
    v_mfma_f32_16x16x32_bf16 v[160:163], v[208:211], a[32:35], v[160:163]
    s_waitcnt lgkmcnt(4)
    ds_read_b64_tr_b16 v[224:225], v29 offset:18688
    v_mfma_f32_16x16x32_bf16 v[160:163], v[212:215], a[48:51], v[160:163]
    ds_read_b64_tr_b16 v[226:227], v29 offset:23296
    v_mfma_f32_16x16x32_bf16 v[164:167], v[208:211], a[36:39], v[164:167]
    ds_read_b64_tr_b16 v[228:229], v29 offset:27904
    v_mfma_f32_16x16x32_bf16 v[164:167], v[212:215], a[52:55], v[164:167]
    ds_read_b64_tr_b16 v[230:231], v29 offset:32512
    v_mfma_f32_16x16x32_bf16 v[168:171], v[208:211], a[40:43], v[168:171]
    buffer_load_dwordx4 a[184:187], v1, s[20:23], s46 offen offset:3072 sc1
    v_mfma_f32_16x16x32_bf16 v[168:171], v[212:215], a[56:59], v[168:171]
    v_mfma_f32_16x16x32_bf16 v[172:175], v[208:211], a[44:47], v[172:175]
    v_mfma_f32_16x16x32_bf16 v[172:175], v[212:215], a[60:63], v[172:175]
    s_waitcnt lgkmcnt(0)
    buffer_load_dwordx4 a[172:175], v1, s[24:27], s46 offen offset:2048 sc1
    v_mfma_f32_16x16x32_bf16 v[176:179], v[216:219], a[32:35], v[176:179]
    s_waitcnt vmcnt(63)
    s_barrier
    ds_read_b64_tr_b16 v[208:209], v30 offset:0
    v_mfma_f32_16x16x32_bf16 v[176:179], v[220:223], a[48:51], v[176:179]
    v_mfma_f32_16x16x32_bf16 v[180:183], v[216:219], a[36:39], v[180:183]
    ds_read_b64_tr_b16 v[210:211], v30 offset:4608
    v_mfma_f32_16x16x32_bf16 v[180:183], v[220:223], a[52:55], v[180:183]
    buffer_load_dwordx4 a[188:191], v1, s[24:27], s46 offen offset:3072 sc1
    v_mfma_f32_16x16x32_bf16 v[184:187], v[216:219], a[40:43], v[184:187]
    s_add_u32 s46, s46, 4096
    ds_read_b64_tr_b16 v[212:213], v30 offset:9216
    v_mfma_f32_16x16x32_bf16 v[184:187], v[220:223], a[56:59], v[184:187]
    v_mfma_f32_16x16x32_bf16 v[188:191], v[216:219], a[44:47], v[188:191]
    ds_read_b64_tr_b16 v[214:215], v30 offset:13824
    v_mfma_f32_16x16x32_bf16 v[188:191], v[220:223], a[60:63], v[188:191]
    v_mfma_f32_16x16x32_bf16 v[192:195], v[224:227], a[32:35], v[192:195]
    ds_read_b64_tr_b16 v[216:217], v30 offset:32
    v_mfma_f32_16x16x32_bf16 v[192:195], v[228:231], a[48:51], v[192:195]
    v_mfma_f32_16x16x32_bf16 v[196:199], v[224:227], a[36:39], v[196:199]
    ds_read_b64_tr_b16 v[218:219], v30 offset:4640
    v_mfma_f32_16x16x32_bf16 v[196:199], v[228:231], a[52:55], v[196:199]
    v_mfma_f32_16x16x32_bf16 v[200:203], v[224:227], a[40:43], v[200:203]
    ds_read_b64_tr_b16 v[220:221], v30 offset:9248
    v_mfma_f32_16x16x32_bf16 v[200:203], v[228:231], a[56:59], v[200:203]
    v_mfma_f32_16x16x32_bf16 v[204:207], v[224:227], a[44:47], v[204:207]
    ds_read_b64_tr_b16 v[222:223], v30 offset:13856
    v_mfma_f32_16x16x32_bf16 v[204:207], v[228:231], a[60:63], v[204:207]
L_op_loop:
    s_waitcnt vmcnt(31) lgkmcnt(6)
    v_mfma_f32_16x16x32_bf16 v[64:67], v[208:211], a[64:67], v[64:67]
    s_waitcnt vmcnt(30) lgkmcnt(4)
    ds_read_b64_tr_b16 v[224:225], v30 offset:64
    v_mfma_f32_16x16x32_bf16 v[64:67], v[212:215], a[80:83], v[64:67]
    s_waitcnt vmcnt(29)
    v_mfma_f32_16x16x32_bf16 v[68:71], v[208:211], a[68:71], v[68:71]
    s_waitcnt vmcnt(28)
    ds_read_b64_tr_b16 v[226:227], v30 offset:4672
    v_mfma_f32_16x16x32_bf16 v[68:71], v[212:215], a[84:87], v[68:71]
    s_waitcnt vmcnt(27)
    s_add_u32 m0, s79, 73728
    v_mfma_f32_16x16x32_bf16 v[72:75], v[208:211], a[72:75], v[72:75]
    s_waitcnt vmcnt(26)
    ds_read_b64_tr_b16 v[228:229], v30 offset:9280
    v_mfma_f32_16x16x32_bf16 v[72:75], v[212:215], a[88:91], v[72:75]
    s_waitcnt vmcnt(25)
    buffer_load_dwordx4 v20, s[8:11], s44 offen offset:0 lds
    v_mfma_f32_16x16x32_bf16 v[76:79], v[208:211], a[76:79], v[76:79]
    s_waitcnt vmcnt(25)
    ds_read_b64_tr_b16 v[230:231], v30 offset:13888
    v_mfma_f32_16x16x32_bf16 v[76:79], v[212:215], a[92:95], v[76:79]
    s_waitcnt lgkmcnt(6)
    v_mfma_f32_16x16x32_bf16 v[80:83], v[216:219], a[64:67], v[80:83]
    s_waitcnt lgkmcnt(4)
    ds_read_b64_tr_b16 v[208:209], v30 offset:96
    v_mfma_f32_16x16x32_bf16 v[80:83], v[220:223], a[80:83], v[80:83]
    buffer_load_dwordx4 v21, s[8:11], s44 offen offset:1024 lds
    v_mfma_f32_16x16x32_bf16 v[84:87], v[216:219], a[68:71], v[84:87]
    ds_read_b64_tr_b16 v[210:211], v30 offset:4704
    v_mfma_f32_16x16x32_bf16 v[84:87], v[220:223], a[84:87], v[84:87]
    v_mfma_f32_16x16x32_bf16 v[88:91], v[216:219], a[72:75], v[88:91]
    ds_read_b64_tr_b16 v[212:213], v30 offset:9312
    v_mfma_f32_16x16x32_bf16 v[88:91], v[220:223], a[88:91], v[88:91]
    v_mfma_f32_16x16x32_bf16 v[92:95], v[216:219], a[76:79], v[92:95]
    ds_read_b64_tr_b16 v[214:215], v30 offset:13920
    v_mfma_f32_16x16x32_bf16 v[92:95], v[220:223], a[92:95], v[92:95]
    s_waitcnt lgkmcnt(6)
    buffer_load_dwordx4 v22, s[8:11], s44 offen offset:2048 lds
    v_mfma_f32_16x16x32_bf16 v[96:99], v[224:227], a[64:67], v[96:99]
    s_waitcnt lgkmcnt(4)
    ds_read_b64_tr_b16 v[216:217], v30 offset:128
    v_mfma_f32_16x16x32_bf16 v[96:99], v[228:231], a[80:83], v[96:99]
    v_mfma_f32_16x16x32_bf16 v[100:103], v[224:227], a[68:71], v[100:103]
    ds_read_b64_tr_b16 v[218:219], v30 offset:4736
    v_mfma_f32_16x16x32_bf16 v[100:103], v[228:231], a[84:87], v[100:103]
    buffer_load_dwordx4 v23, s[8:11], s44 offen offset:3072 lds
    v_mfma_f32_16x16x32_bf16 v[104:107], v[224:227], a[72:75], v[104:107]
    s_add_u32 m0, s79, 77824
    ds_read_b64_tr_b16 v[220:221], v30 offset:9344
    v_mfma_f32_16x16x32_bf16 v[104:107], v[228:231], a[88:91], v[104:107]
    v_mfma_f32_16x16x32_bf16 v[108:111], v[224:227], a[76:79], v[108:111]
    ds_read_b64_tr_b16 v[222:223], v30 offset:13952
    v_mfma_f32_16x16x32_bf16 v[108:111], v[228:231], a[92:95], v[108:111]
    s_waitcnt lgkmcnt(6)
    v_mfma_f32_16x16x32_bf16 v[112:115], v[208:211], a[64:67], v[112:115]
    s_waitcnt lgkmcnt(4)
    ds_read_b64_tr_b16 v[224:225], v30 offset:160
    v_mfma_f32_16x16x32_bf16 v[112:115], v[212:215], a[80:83], v[112:115]
    buffer_load_dwordx4 v24, s[8:11], s44 offen offset:0 lds
    v_mfma_f32_16x16x32_bf16 v[116:119], v[208:211], a[68:71], v[116:119]
    ds_read_b64_tr_b16 v[226:227], v30 offset:4768
    v_mfma_f32_16x16x32_bf16 v[116:119], v[212:215], a[84:87], v[116:119]
    v_mfma_f32_16x16x32_bf16 v[120:123], v[208:211], a[72:75], v[120:123]
    ds_read_b64_tr_b16 v[228:229], v30 offset:9376
    v_mfma_f32_16x16x32_bf16 v[120:123], v[212:215], a[88:91], v[120:123]
    v_mfma_f32_16x16x32_bf16 v[124:127], v[208:211], a[76:79], v[124:127]
    ds_read_b64_tr_b16 v[230:231], v30 offset:13984
    v_mfma_f32_16x16x32_bf16 v[124:127], v[212:215], a[92:95], v[124:127]
    s_waitcnt lgkmcnt(6)
    buffer_load_dwordx4 v25, s[8:11], s44 offen offset:1024 lds
    v_mfma_f32_16x16x32_bf16 v[128:131], v[216:219], a[64:67], v[128:131]
    s_waitcnt lgkmcnt(4)
    ds_read_b64_tr_b16 v[208:209], v30 offset:192
    v_mfma_f32_16x16x32_bf16 v[128:131], v[220:223], a[80:83], v[128:131]
    v_mfma_f32_16x16x32_bf16 v[132:135], v[216:219], a[68:71], v[132:135]
    ds_read_b64_tr_b16 v[210:211], v30 offset:4800
    v_mfma_f32_16x16x32_bf16 v[132:135], v[220:223], a[84:87], v[132:135]
    buffer_load_dwordx4 v26, s[8:11], s44 offen offset:2048 lds
    v_mfma_f32_16x16x32_bf16 v[136:139], v[216:219], a[72:75], v[136:139]
    ds_read_b64_tr_b16 v[212:213], v30 offset:9408
    v_mfma_f32_16x16x32_bf16 v[136:139], v[220:223], a[88:91], v[136:139]
    v_mfma_f32_16x16x32_bf16 v[140:143], v[216:219], a[76:79], v[140:143]
    ds_read_b64_tr_b16 v[214:215], v30 offset:14016
    v_mfma_f32_16x16x32_bf16 v[140:143], v[220:223], a[92:95], v[140:143]
    s_waitcnt lgkmcnt(6)
    v_mfma_f32_16x16x32_bf16 v[144:147], v[224:227], a[64:67], v[144:147]
    s_waitcnt lgkmcnt(4)
    ds_read_b64_tr_b16 v[216:217], v30 offset:224
    v_mfma_f32_16x16x32_bf16 v[144:147], v[228:231], a[80:83], v[144:147]
    buffer_load_dwordx4 v27, s[8:11], s44 offen offset:3072 lds
    v_mfma_f32_16x16x32_bf16 v[148:151], v[224:227], a[68:71], v[148:151]
    s_add_u32 m0, s79, 81920
    ds_read_b64_tr_b16 v[218:219], v30 offset:4832
    v_mfma_f32_16x16x32_bf16 v[148:151], v[228:231], a[84:87], v[148:151]
    v_mfma_f32_16x16x32_bf16 v[152:155], v[224:227], a[72:75], v[152:155]
    ds_read_b64_tr_b16 v[220:221], v30 offset:9440
    v_mfma_f32_16x16x32_bf16 v[152:155], v[228:231], a[88:91], v[152:155]
    v_mfma_f32_16x16x32_bf16 v[156:159], v[224:227], a[76:79], v[156:159]
    ds_read_b64_tr_b16 v[222:223], v30 offset:14048
    v_mfma_f32_16x16x32_bf16 v[156:159], v[228:231], a[92:95], v[156:159]
    s_waitcnt lgkmcnt(6)
    buffer_load_dwordx4 v28, s[8:11], s44 offen offset:0 lds
    v_mfma_f32_16x16x32_bf16 v[160:163], v[208:211], a[64:67], v[160:163]
    s_waitcnt lgkmcnt(4)
    s_add_u32 s44, s44, 147456
    ds_read_b64_tr_b16 v[224:225], v30 offset:256
    v_mfma_f32_16x16x32_bf16 v[160:163], v[212:215], a[80:83], v[160:163]
    v_mfma_f32_16x16x32_bf16 v[164:167], v[208:211], a[68:71], v[164:167]
    ds_read_b64_tr_b16 v[226:227], v30 offset:4864
    v_mfma_f32_16x16x32_bf16 v[164:167], v[212:215], a[84:87], v[164:167]
    buffer_load_dwordx4 a[0:3], v1, s[12:15], s46 offen offset:0 sc1
    v_mfma_f32_16x16x32_bf16 v[168:171], v[208:211], a[72:75], v[168:171]
    ds_read_b64_tr_b16 v[228:229], v30 offset:9472
    v_mfma_f32_16x16x32_bf16 v[168:171], v[212:215], a[88:91], v[168:171]
    v_mfma_f32_16x16x32_bf16 v[172:175], v[208:211], a[76:79], v[172:175]
    ds_read_b64_tr_b16 v[230:231], v30 offset:14080
    v_mfma_f32_16x16x32_bf16 v[172:175], v[212:215], a[92:95], v[172:175]
    s_waitcnt lgkmcnt(6)
    v_mfma_f32_16x16x32_bf16 v[176:179], v[216:219], a[64:67], v[176:179]
    s_waitcnt lgkmcnt(4)
    ds_read_b64_tr_b16 v[208:209], v30 offset:18432
    v_mfma_f32_16x16x32_bf16 v[176:179], v[220:223], a[80:83], v[176:179]
    buffer_load_dwordx4 a[16:19], v1, s[12:15], s46 offen offset:1024 sc1
    v_mfma_f32_16x16x32_bf16 v[180:183], v[216:219], a[68:71], v[180:183]
    ds_read_b64_tr_b16 v[210:211], v30 offset:23040
    v_mfma_f32_16x16x32_bf16 v[180:183], v[220:223], a[84:87], v[180:183]
    v_mfma_f32_16x16x32_bf16 v[184:187], v[216:219], a[72:75], v[184:187]
    ds_read_b64_tr_b16 v[212:213], v30 offset:27648
    v_mfma_f32_16x16x32_bf16 v[184:187], v[220:223], a[88:91], v[184:187]
    v_mfma_f32_16x16x32_bf16 v[188:191], v[216:219], a[76:79], v[188:191]
    ds_read_b64_tr_b16 v[214:215], v30 offset:32256
    v_mfma_f32_16x16x32_bf16 v[188:191], v[220:223], a[92:95], v[188:191]
    s_waitcnt lgkmcnt(6)
    buffer_load_dwordx4 a[4:7], v1, s[16:19], s46 offen offset:0 sc1
    v_mfma_f32_16x16x32_bf16 v[192:195], v[224:227], a[64:67], v[192:195]
    s_waitcnt lgkmcnt(4)
    ds_read_b64_tr_b16 v[216:217], v30 offset:18464
    v_mfma_f32_16x16x32_bf16 v[192:195], v[228:231], a[80:83], v[192:195]
    v_mfma_f32_16x16x32_bf16 v[196:199], v[224:227], a[68:71], v[196:199]
    ds_read_b64_tr_b16 v[218:219], v30 offset:23072
    v_mfma_f32_16x16x32_bf16 v[196:199], v[228:231], a[84:87], v[196:199]
    buffer_load_dwordx4 a[20:23], v1, s[16:19], s46 offen offset:1024 sc1
    v_mfma_f32_16x16x32_bf16 v[200:203], v[224:227], a[72:75], v[200:203]
    ds_read_b64_tr_b16 v[220:221], v30 offset:27680
    v_mfma_f32_16x16x32_bf16 v[200:203], v[228:231], a[88:91], v[200:203]
    v_mfma_f32_16x16x32_bf16 v[204:207], v[224:227], a[76:79], v[204:207]
    ds_read_b64_tr_b16 v[222:223], v30 offset:32288
    v_mfma_f32_16x16x32_bf16 v[204:207], v[228:231], a[92:95], v[204:207]
    s_waitcnt vmcnt(36) lgkmcnt(6)
    v_mfma_f32_16x16x32_bf16 v[64:67], v[208:211], a[96:99], v[64:67]
    s_waitcnt vmcnt(35) lgkmcnt(4)
    ds_read_b64_tr_b16 v[224:225], v30 offset:18496
    v_mfma_f32_16x16x32_bf16 v[64:67], v[212:215], a[112:115], v[64:67]
    s_waitcnt vmcnt(34)
    buffer_load_dwordx4 a[8:11], v1, s[20:23], s46 offen offset:0 sc1
    v_mfma_f32_16x16x32_bf16 v[68:71], v[208:211], a[100:103], v[68:71]
    s_waitcnt vmcnt(34)
    ds_read_b64_tr_b16 v[226:227], v30 offset:23104
    v_mfma_f32_16x16x32_bf16 v[68:71], v[212:215], a[116:119], v[68:71]
    s_waitcnt vmcnt(33)
    v_mfma_f32_16x16x32_bf16 v[72:75], v[208:211], a[104:107], v[72:75]
    s_waitcnt vmcnt(32)
    ds_read_b64_tr_b16 v[228:229], v30 offset:27712
    v_mfma_f32_16x16x32_bf16 v[72:75], v[212:215], a[120:123], v[72:75]
    s_waitcnt vmcnt(31)
    buffer_load_dwordx4 a[24:27], v1, s[20:23], s46 offen offset:1024 sc1
    v_mfma_f32_16x16x32_bf16 v[76:79], v[208:211], a[108:111], v[76:79]
    s_waitcnt vmcnt(31)
    ds_read_b64_tr_b16 v[230:231], v30 offset:32320
    v_mfma_f32_16x16x32_bf16 v[76:79], v[212:215], a[124:127], v[76:79]
    s_waitcnt lgkmcnt(6)
    v_mfma_f32_16x16x32_bf16 v[80:83], v[216:219], a[96:99], v[80:83]
    s_waitcnt lgkmcnt(4)
    ds_read_b64_tr_b16 v[208:209], v30 offset:18528
    v_mfma_f32_16x16x32_bf16 v[80:83], v[220:223], a[112:115], v[80:83]
    v_mfma_f32_16x16x32_bf16 v[84:87], v[216:219], a[100:103], v[84:87]
    ds_read_b64_tr_b16 v[210:211], v30 offset:23136
    v_mfma_f32_16x16x32_bf16 v[84:87], v[220:223], a[116:119], v[84:87]
    buffer_load_dwordx4 a[12:15], v1, s[24:27], s46 offen offset:0 sc1
    v_mfma_f32_16x16x32_bf16 v[88:91], v[216:219], a[104:107], v[88:91]
    ds_read_b64_tr_b16 v[212:213], v30 offset:27744
    v_mfma_f32_16x16x32_bf16 v[88:91], v[220:223], a[120:123], v[88:91]
    v_mfma_f32_16x16x32_bf16 v[92:95], v[216:219], a[108:111], v[92:95]
    ds_read_b64_tr_b16 v[214:215], v30 offset:32352
    v_mfma_f32_16x16x32_bf16 v[92:95], v[220:223], a[124:127], v[92:95]
    s_waitcnt lgkmcnt(6)
    v_mfma_f32_16x16x32_bf16 v[96:99], v[224:227], a[96:99], v[96:99]
    s_waitcnt lgkmcnt(4)
    ds_read_b64_tr_b16 v[216:217], v30 offset:18560
    v_mfma_f32_16x16x32_bf16 v[96:99], v[228:231], a[112:115], v[96:99]
    buffer_load_dwordx4 a[28:31], v1, s[24:27], s46 offen offset:1024 sc1
    v_mfma_f32_16x16x32_bf16 v[100:103], v[224:227], a[100:103], v[100:103]
    ds_read_b64_tr_b16 v[218:219], v30 offset:23168
    v_mfma_f32_16x16x32_bf16 v[100:103], v[228:231], a[116:119], v[100:103]
    v_mfma_f32_16x16x32_bf16 v[104:107], v[224:227], a[104:107], v[104:107]
    ds_read_b64_tr_b16 v[220:221], v30 offset:27776
    v_mfma_f32_16x16x32_bf16 v[104:107], v[228:231], a[120:123], v[104:107]
    buffer_load_dwordx4 a[32:35], v1, s[12:15], s46 offen offset:2048 sc1
    v_mfma_f32_16x16x32_bf16 v[108:111], v[224:227], a[108:111], v[108:111]
    ds_read_b64_tr_b16 v[222:223], v30 offset:32384
    v_mfma_f32_16x16x32_bf16 v[108:111], v[228:231], a[124:127], v[108:111]
    s_waitcnt lgkmcnt(6)
    v_mfma_f32_16x16x32_bf16 v[112:115], v[208:211], a[96:99], v[112:115]
    s_waitcnt lgkmcnt(4)
    ds_read_b64_tr_b16 v[224:225], v30 offset:18592
    v_mfma_f32_16x16x32_bf16 v[112:115], v[212:215], a[112:115], v[112:115]
    v_mfma_f32_16x16x32_bf16 v[116:119], v[208:211], a[100:103], v[116:119]
    ds_read_b64_tr_b16 v[226:227], v30 offset:23200
    v_mfma_f32_16x16x32_bf16 v[116:119], v[212:215], a[116:119], v[116:119]
    buffer_load_dwordx4 a[48:51], v1, s[12:15], s46 offen offset:3072 sc1
    v_mfma_f32_16x16x32_bf16 v[120:123], v[208:211], a[104:107], v[120:123]
    ds_read_b64_tr_b16 v[228:229], v30 offset:27808
    v_mfma_f32_16x16x32_bf16 v[120:123], v[212:215], a[120:123], v[120:123]
    v_mfma_f32_16x16x32_bf16 v[124:127], v[208:211], a[108:111], v[124:127]
    ds_read_b64_tr_b16 v[230:231], v30 offset:32416
    v_mfma_f32_16x16x32_bf16 v[124:127], v[212:215], a[124:127], v[124:127]
    s_waitcnt lgkmcnt(6)
    v_mfma_f32_16x16x32_bf16 v[128:131], v[216:219], a[96:99], v[128:131]
    s_waitcnt lgkmcnt(4)
    ds_read_b64_tr_b16 v[208:209], v30 offset:18624
    v_mfma_f32_16x16x32_bf16 v[128:131], v[220:223], a[112:115], v[128:131]
    buffer_load_dwordx4 a[36:39], v1, s[16:19], s46 offen offset:2048 sc1
    v_mfma_f32_16x16x32_bf16 v[132:135], v[216:219], a[100:103], v[132:135]
    ds_read_b64_tr_b16 v[210:211], v30 offset:23232
    v_mfma_f32_16x16x32_bf16 v[132:135], v[220:223], a[116:119], v[132:135]
    v_mfma_f32_16x16x32_bf16 v[136:139], v[216:219], a[104:107], v[136:139]
    ds_read_b64_tr_b16 v[212:213], v30 offset:27840
    v_mfma_f32_16x16x32_bf16 v[136:139], v[220:223], a[120:123], v[136:139]
    buffer_load_dwordx4 a[52:55], v1, s[16:19], s46 offen offset:3072 sc1
    v_mfma_f32_16x16x32_bf16 v[140:143], v[216:219], a[108:111], v[140:143]
    ds_read_b64_tr_b16 v[214:215], v30 offset:32448
    v_mfma_f32_16x16x32_bf16 v[140:143], v[220:223], a[124:127], v[140:143]
    s_waitcnt lgkmcnt(6)
    v_mfma_f32_16x16x32_bf16 v[144:147], v[224:227], a[96:99], v[144:147]
    s_waitcnt lgkmcnt(4)
    ds_read_b64_tr_b16 v[216:217], v30 offset:18656
    v_mfma_f32_16x16x32_bf16 v[144:147], v[228:231], a[112:115], v[144:147]
    v_mfma_f32_16x16x32_bf16 v[148:151], v[224:227], a[100:103], v[148:151]
    ds_read_b64_tr_b16 v[218:219], v30 offset:23264
    v_mfma_f32_16x16x32_bf16 v[148:151], v[228:231], a[116:119], v[148:151]
    buffer_load_dwordx4 a[40:43], v1, s[20:23], s46 offen offset:2048 sc1
    v_mfma_f32_16x16x32_bf16 v[152:155], v[224:227], a[104:107], v[152:155]
    ds_read_b64_tr_b16 v[220:221], v30 offset:27872
    v_mfma_f32_16x16x32_bf16 v[152:155], v[228:231], a[120:123], v[152:155]
    v_mfma_f32_16x16x32_bf16 v[156:159], v[224:227], a[108:111], v[156:159]
    ds_read_b64_tr_b16 v[222:223], v30 offset:32480
    v_mfma_f32_16x16x32_bf16 v[156:159], v[228:231], a[124:127], v[156:159]
    s_waitcnt lgkmcnt(6)
    v_mfma_f32_16x16x32_bf16 v[160:163], v[208:211], a[96:99], v[160:163]
    s_waitcnt lgkmcnt(4)
    ds_read_b64_tr_b16 v[224:225], v30 offset:18688
    v_mfma_f32_16x16x32_bf16 v[160:163], v[212:215], a[112:115], v[160:163]
    ds_read_b64_tr_b16 v[226:227], v30 offset:23296
    v_mfma_f32_16x16x32_bf16 v[164:167], v[208:211], a[100:103], v[164:167]
    ds_read_b64_tr_b16 v[228:229], v30 offset:27904
    v_mfma_f32_16x16x32_bf16 v[164:167], v[212:215], a[116:119], v[164:167]
    ds_read_b64_tr_b16 v[230:231], v30 offset:32512
    v_mfma_f32_16x16x32_bf16 v[168:171], v[208:211], a[104:107], v[168:171]
    buffer_load_dwordx4 a[56:59], v1, s[20:23], s46 offen offset:3072 sc1
    v_mfma_f32_16x16x32_bf16 v[168:171], v[212:215], a[120:123], v[168:171]
    buffer_load_dwordx4 a[44:47], v1, s[24:27], s46 offen offset:2048 sc1
    v_mfma_f32_16x16x32_bf16 v[172:175], v[208:211], a[108:111], v[172:175]
    v_mfma_f32_16x16x32_bf16 v[172:175], v[212:215], a[124:127], v[172:175]
    s_waitcnt lgkmcnt(0)
    v_mfma_f32_16x16x32_bf16 v[176:179], v[216:219], a[96:99], v[176:179]
    s_waitcnt vmcnt(40)
    s_barrier
    ds_read_b64_tr_b16 v[208:209], v31 offset:0
    v_mfma_f32_16x16x32_bf16 v[176:179], v[220:223], a[112:115], v[176:179]
    v_mfma_f32_16x16x32_bf16 v[180:183], v[216:219], a[100:103], v[180:183]
    ds_read_b64_tr_b16 v[210:211], v31 offset:4608
    v_mfma_f32_16x16x32_bf16 v[180:183], v[220:223], a[116:119], v[180:183]
    buffer_load_dwordx4 a[60:63], v1, s[24:27], s46 offen offset:3072 sc1
    v_mfma_f32_16x16x32_bf16 v[184:187], v[216:219], a[104:107], v[184:187]
    s_add_u32 s46, s46, 4096
    ds_read_b64_tr_b16 v[212:213], v31 offset:9216
    v_mfma_f32_16x16x32_bf16 v[184:187], v[220:223], a[120:123], v[184:187]
    v_mfma_f32_16x16x32_bf16 v[188:191], v[216:219], a[108:111], v[188:191]
    ds_read_b64_tr_b16 v[214:215], v31 offset:13824
    v_mfma_f32_16x16x32_bf16 v[188:191], v[220:223], a[124:127], v[188:191]
    v_mfma_f32_16x16x32_bf16 v[192:195], v[224:227], a[96:99], v[192:195]
    ds_read_b64_tr_b16 v[216:217], v31 offset:32
    v_mfma_f32_16x16x32_bf16 v[192:195], v[228:231], a[112:115], v[192:195]
    v_mfma_f32_16x16x32_bf16 v[196:199], v[224:227], a[100:103], v[196:199]
    ds_read_b64_tr_b16 v[218:219], v31 offset:4640
    v_mfma_f32_16x16x32_bf16 v[196:199], v[228:231], a[116:119], v[196:199]
    v_mfma_f32_16x16x32_bf16 v[200:203], v[224:227], a[104:107], v[200:203]
    ds_read_b64_tr_b16 v[220:221], v31 offset:9248
    v_mfma_f32_16x16x32_bf16 v[200:203], v[228:231], a[120:123], v[200:203]
    s_sub_u32 s47, s47, 1
    v_mfma_f32_16x16x32_bf16 v[204:207], v[224:227], a[108:111], v[204:207]
    s_cmp_eq_u32 s47, 0
    ds_read_b64_tr_b16 v[222:223], v31 offset:13856
    v_mfma_f32_16x16x32_bf16 v[204:207], v[228:231], a[124:127], v[204:207]
    s_cbranch_scc1 L_op_last2
    s_waitcnt vmcnt(40) lgkmcnt(6)
    v_mfma_f32_16x16x32_bf16 v[64:67], v[208:211], a[128:131], v[64:67]
    s_waitcnt vmcnt(39) lgkmcnt(4)
    ds_read_b64_tr_b16 v[224:225], v31 offset:64
    v_mfma_f32_16x16x32_bf16 v[64:67], v[212:215], a[144:147], v[64:67]
    s_waitcnt vmcnt(38)
    v_mfma_f32_16x16x32_bf16 v[68:71], v[208:211], a[132:135], v[68:71]
    s_waitcnt vmcnt(37)
    ds_read_b64_tr_b16 v[226:227], v31 offset:4672
    v_mfma_f32_16x16x32_bf16 v[68:71], v[212:215], a[148:151], v[68:71]
    s_waitcnt vmcnt(36)
    s_add_u32 m0, s79, 36864
    v_mfma_f32_16x16x32_bf16 v[72:75], v[208:211], a[136:139], v[72:75]
    s_waitcnt vmcnt(35)
    ds_read_b64_tr_b16 v[228:229], v31 offset:9280
    v_mfma_f32_16x16x32_bf16 v[72:75], v[212:215], a[152:155], v[72:75]
    s_waitcnt vmcnt(34)
    buffer_load_dwordx4 v20, s[8:11], s44 offen offset:0 lds
    v_mfma_f32_16x16x32_bf16 v[76:79], v[208:211], a[140:143], v[76:79]
    s_waitcnt vmcnt(34)
    ds_read_b64_tr_b16 v[230:231], v31 offset:13888
    v_mfma_f32_16x16x32_bf16 v[76:79], v[212:215], a[156:159], v[76:79]
    s_waitcnt lgkmcnt(6)
    v_mfma_f32_16x16x32_bf16 v[80:83], v[216:219], a[128:131], v[80:83]
    s_waitcnt lgkmcnt(4)
    ds_read_b64_tr_b16 v[208:209], v31 offset:96
    v_mfma_f32_16x16x32_bf16 v[80:83], v[220:223], a[144:147], v[80:83]
    buffer_load_dwordx4 v21, s[8:11], s44 offen offset:1024 lds
    v_mfma_f32_16x16x32_bf16 v[84:87], v[216:219], a[132:135], v[84:87]
    ds_read_b64_tr_b16 v[210:211], v31 offset:4704
    v_mfma_f32_16x16x32_bf16 v[84:87], v[220:223], a[148:151], v[84:87]
    v_mfma_f32_16x16x32_bf16 v[88:91], v[216:219], a[136:139], v[88:91]
    ds_read_b64_tr_b16 v[212:213], v31 offset:9312
    v_mfma_f32_16x16x32_bf16 v[88:91], v[220:223], a[152:155], v[88:91]
    v_mfma_f32_16x16x32_bf16 v[92:95], v[216:219], a[140:143], v[92:95]
    ds_read_b64_tr_b16 v[214:215], v31 offset:13920
    v_mfma_f32_16x16x32_bf16 v[92:95], v[220:223], a[156:159], v[92:95]
    s_waitcnt lgkmcnt(6)
    buffer_load_dwordx4 v22, s[8:11], s44 offen offset:2048 lds
    v_mfma_f32_16x16x32_bf16 v[96:99], v[224:227], a[128:131], v[96:99]
    s_waitcnt lgkmcnt(4)
    ds_read_b64_tr_b16 v[216:217], v31 offset:128
    v_mfma_f32_16x16x32_bf16 v[96:99], v[228:231], a[144:147], v[96:99]
    v_mfma_f32_16x16x32_bf16 v[100:103], v[224:227], a[132:135], v[100:103]
    ds_read_b64_tr_b16 v[218:219], v31 offset:4736
    v_mfma_f32_16x16x32_bf16 v[100:103], v[228:231], a[148:151], v[100:103]
    buffer_load_dwordx4 v23, s[8:11], s44 offen offset:3072 lds
    v_mfma_f32_16x16x32_bf16 v[104:107], v[224:227], a[136:139], v[104:107]
    s_add_u32 m0, s79, 40960
    ds_read_b64_tr_b16 v[220:221], v31 offset:9344
    v_mfma_f32_16x16x32_bf16 v[104:107], v[228:231], a[152:155], v[104:107]
    v_mfma_f32_16x16x32_bf16 v[108:111], v[224:227], a[140:143], v[108:111]
    ds_read_b64_tr_b16 v[222:223], v31 offset:13952
    v_mfma_f32_16x16x32_bf16 v[108:111], v[228:231], a[156:159], v[108:111]
    s_waitcnt lgkmcnt(6)
    v_mfma_f32_16x16x32_bf16 v[112:115], v[208:211], a[128:131], v[112:115]
    s_waitcnt lgkmcnt(4)
    ds_read_b64_tr_b16 v[224:225], v31 offset:160
    v_mfma_f32_16x16x32_bf16 v[112:115], v[212:215], a[144:147], v[112:115]
    buffer_load_dwordx4 v24, s[8:11], s44 offen offset:0 lds
    v_mfma_f32_16x16x32_bf16 v[116:119], v[208:211], a[132:135], v[116:119]
    ds_read_b64_tr_b16 v[226:227], v31 offset:4768
    v_mfma_f32_16x16x32_bf16 v[116:119], v[212:215], a[148:151], v[116:119]
    v_mfma_f32_16x16x32_bf16 v[120:123], v[208:211], a[136:139], v[120:123]
    ds_read_b64_tr_b16 v[228:229], v31 offset:9376
    v_mfma_f32_16x16x32_bf16 v[120:123], v[212:215], a[152:155], v[120:123]
    v_mfma_f32_16x16x32_bf16 v[124:127], v[208:211], a[140:143], v[124:127]
    ds_read_b64_tr_b16 v[230:231], v31 offset:13984
    v_mfma_f32_16x16x32_bf16 v[124:127], v[212:215], a[156:159], v[124:127]
    s_waitcnt lgkmcnt(6)
    buffer_load_dwordx4 v25, s[8:11], s44 offen offset:1024 lds
    v_mfma_f32_16x16x32_bf16 v[128:131], v[216:219], a[128:131], v[128:131]
    s_waitcnt lgkmcnt(4)
    ds_read_b64_tr_b16 v[208:209], v31 offset:192
    v_mfma_f32_16x16x32_bf16 v[128:131], v[220:223], a[144:147], v[128:131]
    v_mfma_f32_16x16x32_bf16 v[132:135], v[216:219], a[132:135], v[132:135]
    ds_read_b64_tr_b16 v[210:211], v31 offset:4800
    v_mfma_f32_16x16x32_bf16 v[132:135], v[220:223], a[148:151], v[132:135]
    buffer_load_dwordx4 v26, s[8:11], s44 offen offset:2048 lds
    v_mfma_f32_16x16x32_bf16 v[136:139], v[216:219], a[136:139], v[136:139]
    ds_read_b64_tr_b16 v[212:213], v31 offset:9408
    v_mfma_f32_16x16x32_bf16 v[136:139], v[220:223], a[152:155], v[136:139]
    v_mfma_f32_16x16x32_bf16 v[140:143], v[216:219], a[140:143], v[140:143]
    ds_read_b64_tr_b16 v[214:215], v31 offset:14016
    v_mfma_f32_16x16x32_bf16 v[140:143], v[220:223], a[156:159], v[140:143]
    s_waitcnt lgkmcnt(6)
    v_mfma_f32_16x16x32_bf16 v[144:147], v[224:227], a[128:131], v[144:147]
    s_waitcnt lgkmcnt(4)
    ds_read_b64_tr_b16 v[216:217], v31 offset:224
    v_mfma_f32_16x16x32_bf16 v[144:147], v[228:231], a[144:147], v[144:147]
    buffer_load_dwordx4 v27, s[8:11], s44 offen offset:3072 lds
    v_mfma_f32_16x16x32_bf16 v[148:151], v[224:227], a[132:135], v[148:151]
    s_add_u32 m0, s79, 45056
    ds_read_b64_tr_b16 v[218:219], v31 offset:4832
    v_mfma_f32_16x16x32_bf16 v[148:151], v[228:231], a[148:151], v[148:151]
    v_mfma_f32_16x16x32_bf16 v[152:155], v[224:227], a[136:139], v[152:155]
    ds_read_b64_tr_b16 v[220:221], v31 offset:9440
    v_mfma_f32_16x16x32_bf16 v[152:155], v[228:231], a[152:155], v[152:155]
    v_mfma_f32_16x16x32_bf16 v[156:159], v[224:227], a[140:143], v[156:159]
    ds_read_b64_tr_b16 v[222:223], v31 offset:14048
    v_mfma_f32_16x16x32_bf16 v[156:159], v[228:231], a[156:159], v[156:159]
    s_waitcnt lgkmcnt(6)
    buffer_load_dwordx4 v28, s[8:11], s44 offen offset:0 lds
    v_mfma_f32_16x16x32_bf16 v[160:163], v[208:211], a[128:131], v[160:163]
    s_waitcnt lgkmcnt(4)
    s_add_u32 s44, s44, 147456
    ds_read_b64_tr_b16 v[224:225], v31 offset:256
    v_mfma_f32_16x16x32_bf16 v[160:163], v[212:215], a[144:147], v[160:163]
    v_mfma_f32_16x16x32_bf16 v[164:167], v[208:211], a[132:135], v[164:167]
    ds_read_b64_tr_b16 v[226:227], v31 offset:4864
    v_mfma_f32_16x16x32_bf16 v[164:167], v[212:215], a[148:151], v[164:167]
    buffer_load_dwordx4 a[64:67], v1, s[12:15], s46 offen offset:0 sc1
    v_mfma_f32_16x16x32_bf16 v[168:171], v[208:211], a[136:139], v[168:171]
    ds_read_b64_tr_b16 v[228:229], v31 offset:9472
    v_mfma_f32_16x16x32_bf16 v[168:171], v[212:215], a[152:155], v[168:171]
    v_mfma_f32_16x16x32_bf16 v[172:175], v[208:211], a[140:143], v[172:175]
    ds_read_b64_tr_b16 v[230:231], v31 offset:14080
    v_mfma_f32_16x16x32_bf16 v[172:175], v[212:215], a[156:159], v[172:175]
    s_waitcnt lgkmcnt(6)
    v_mfma_f32_16x16x32_bf16 v[176:179], v[216:219], a[128:131], v[176:179]
    s_waitcnt lgkmcnt(4)
    ds_read_b64_tr_b16 v[208:209], v31 offset:18432
    v_mfma_f32_16x16x32_bf16 v[176:179], v[220:223], a[144:147], v[176:179]
    buffer_load_dwordx4 a[80:83], v1, s[12:15], s46 offen offset:1024 sc1
    v_mfma_f32_16x16x32_bf16 v[180:183], v[216:219], a[132:135], v[180:183]
    ds_read_b64_tr_b16 v[210:211], v31 offset:23040
    v_mfma_f32_16x16x32_bf16 v[180:183], v[220:223], a[148:151], v[180:183]
    v_mfma_f32_16x16x32_bf16 v[184:187], v[216:219], a[136:139], v[184:187]
    ds_read_b64_tr_b16 v[212:213], v31 offset:27648
    v_mfma_f32_16x16x32_bf16 v[184:187], v[220:223], a[152:155], v[184:187]
    v_mfma_f32_16x16x32_bf16 v[188:191], v[216:219], a[140:143], v[188:191]
    ds_read_b64_tr_b16 v[214:215], v31 offset:32256
    v_mfma_f32_16x16x32_bf16 v[188:191], v[220:223], a[156:159], v[188:191]
    s_waitcnt lgkmcnt(6)
    buffer_load_dwordx4 a[68:71], v1, s[16:19], s46 offen offset:0 sc1
    v_mfma_f32_16x16x32_bf16 v[192:195], v[224:227], a[128:131], v[192:195]
    s_waitcnt lgkmcnt(4)
    ds_read_b64_tr_b16 v[216:217], v31 offset:18464
    v_mfma_f32_16x16x32_bf16 v[192:195], v[228:231], a[144:147], v[192:195]
    v_mfma_f32_16x16x32_bf16 v[196:199], v[224:227], a[132:135], v[196:199]
    ds_read_b64_tr_b16 v[218:219], v31 offset:23072
    v_mfma_f32_16x16x32_bf16 v[196:199], v[228:231], a[148:151], v[196:199]
    buffer_load_dwordx4 a[84:87], v1, s[16:19], s46 offen offset:1024 sc1
    v_mfma_f32_16x16x32_bf16 v[200:203], v[224:227], a[136:139], v[200:203]
    ds_read_b64_tr_b16 v[220:221], v31 offset:27680
    v_mfma_f32_16x16x32_bf16 v[200:203], v[228:231], a[152:155], v[200:203]
    v_mfma_f32_16x16x32_bf16 v[204:207], v[224:227], a[140:143], v[204:207]
    ds_read_b64_tr_b16 v[222:223], v31 offset:32288
    v_mfma_f32_16x16x32_bf16 v[204:207], v[228:231], a[156:159], v[204:207]
    s_waitcnt vmcnt(45) lgkmcnt(6)
    v_mfma_f32_16x16x32_bf16 v[64:67], v[208:211], a[160:163], v[64:67]
    s_waitcnt vmcnt(44) lgkmcnt(4)
    ds_read_b64_tr_b16 v[224:225], v31 offset:18496
    v_mfma_f32_16x16x32_bf16 v[64:67], v[212:215], a[176:179], v[64:67]
    s_waitcnt vmcnt(43)
    buffer_load_dwordx4 a[72:75], v1, s[20:23], s46 offen offset:0 sc1
    v_mfma_f32_16x16x32_bf16 v[68:71], v[208:211], a[164:167], v[68:71]
    s_waitcnt vmcnt(43)
    ds_read_b64_tr_b16 v[226:227], v31 offset:23104
    v_mfma_f32_16x16x32_bf16 v[68:71], v[212:215], a[180:183], v[68:71]
    s_waitcnt vmcnt(42)
    v_mfma_f32_16x16x32_bf16 v[72:75], v[208:211], a[168:171], v[72:75]
    s_waitcnt vmcnt(41)
    ds_read_b64_tr_b16 v[228:229], v31 offset:27712
    v_mfma_f32_16x16x32_bf16 v[72:75], v[212:215], a[184:187], v[72:75]
    s_waitcnt vmcnt(40)
    buffer_load_dwordx4 a[88:91], v1, s[20:23], s46 offen offset:1024 sc1
    v_mfma_f32_16x16x32_bf16 v[76:79], v[208:211], a[172:175], v[76:79]
    s_waitcnt vmcnt(40)
    ds_read_b64_tr_b16 v[230:231], v31 offset:32320
    v_mfma_f32_16x16x32_bf16 v[76:79], v[212:215], a[188:191], v[76:79]
    s_waitcnt lgkmcnt(6)
    v_mfma_f32_16x16x32_bf16 v[80:83], v[216:219], a[160:163], v[80:83]
    s_waitcnt lgkmcnt(4)
    ds_read_b64_tr_b16 v[208:209], v31 offset:18528
    v_mfma_f32_16x16x32_bf16 v[80:83], v[220:223], a[176:179], v[80:83]
    v_mfma_f32_16x16x32_bf16 v[84:87], v[216:219], a[164:167], v[84:87]
    ds_read_b64_tr_b16 v[210:211], v31 offset:23136
    v_mfma_f32_16x16x32_bf16 v[84:87], v[220:223], a[180:183], v[84:87]
    buffer_load_dwordx4 a[76:79], v1, s[24:27], s46 offen offset:0 sc1
    v_mfma_f32_16x16x32_bf16 v[88:91], v[216:219], a[168:171], v[88:91]
    ds_read_b64_tr_b16 v[212:213], v31 offset:27744
    v_mfma_f32_16x16x32_bf16 v[88:91], v[220:223], a[184:187], v[88:91]
    v_mfma_f32_16x16x32_bf16 v[92:95], v[216:219], a[172:175], v[92:95]
    ds_read_b64_tr_b16 v[214:215], v31 offset:32352
    v_mfma_f32_16x16x32_bf16 v[92:95], v[220:223], a[188:191], v[92:95]
    s_waitcnt lgkmcnt(6)
    v_mfma_f32_16x16x32_bf16 v[96:99], v[224:227], a[160:163], v[96:99]
    s_waitcnt lgkmcnt(4)
    ds_read_b64_tr_b16 v[216:217], v31 offset:18560
    v_mfma_f32_16x16x32_bf16 v[96:99], v[228:231], a[176:179], v[96:99]
    buffer_load_dwordx4 a[92:95], v1, s[24:27], s46 offen offset:1024 sc1
    v_mfma_f32_16x16x32_bf16 v[100:103], v[224:227], a[164:167], v[100:103]
    ds_read_b64_tr_b16 v[218:219], v31 offset:23168
    v_mfma_f32_16x16x32_bf16 v[100:103], v[228:231], a[180:183], v[100:103]
    v_mfma_f32_16x16x32_bf16 v[104:107], v[224:227], a[168:171], v[104:107]
    ds_read_b64_tr_b16 v[220:221], v31 offset:27776
    v_mfma_f32_16x16x32_bf16 v[104:107], v[228:231], a[184:187], v[104:107]
    buffer_load_dwordx4 a[96:99], v1, s[12:15], s46 offen offset:2048 sc1
    v_mfma_f32_16x16x32_bf16 v[108:111], v[224:227], a[172:175], v[108:111]
    ds_read_b64_tr_b16 v[222:223], v31 offset:32384
    v_mfma_f32_16x16x32_bf16 v[108:111], v[228:231], a[188:191], v[108:111]
    s_waitcnt lgkmcnt(6)
    v_mfma_f32_16x16x32_bf16 v[112:115], v[208:211], a[160:163], v[112:115]
    s_waitcnt lgkmcnt(4)
    ds_read_b64_tr_b16 v[224:225], v31 offset:18592
    v_mfma_f32_16x16x32_bf16 v[112:115], v[212:215], a[176:179], v[112:115]
    v_mfma_f32_16x16x32_bf16 v[116:119], v[208:211], a[164:167], v[116:119]
    ds_read_b64_tr_b16 v[226:227], v31 offset:23200
    v_mfma_f32_16x16x32_bf16 v[116:119], v[212:215], a[180:183], v[116:119]
    buffer_load_dwordx4 a[112:115], v1, s[12:15], s46 offen offset:3072 sc1
    v_mfma_f32_16x16x32_bf16 v[120:123], v[208:211], a[168:171], v[120:123]
    ds_read_b64_tr_b16 v[228:229], v31 offset:27808
    v_mfma_f32_16x16x32_bf16 v[120:123], v[212:215], a[184:187], v[120:123]
    v_mfma_f32_16x16x32_bf16 v[124:127], v[208:211], a[172:175], v[124:127]
    ds_read_b64_tr_b16 v[230:231], v31 offset:32416
    v_mfma_f32_16x16x32_bf16 v[124:127], v[212:215], a[188:191], v[124:127]
    s_waitcnt lgkmcnt(6)
    v_mfma_f32_16x16x32_bf16 v[128:131], v[216:219], a[160:163], v[128:131]
    s_waitcnt lgkmcnt(4)
    ds_read_b64_tr_b16 v[208:209], v31 offset:18624
    v_mfma_f32_16x16x32_bf16 v[128:131], v[220:223], a[176:179], v[128:131]
    buffer_load_dwordx4 a[100:103], v1, s[16:19], s46 offen offset:2048 sc1
    v_mfma_f32_16x16x32_bf16 v[132:135], v[216:219], a[164:167], v[132:135]
    ds_read_b64_tr_b16 v[210:211], v31 offset:23232
    v_mfma_f32_16x16x32_bf16 v[132:135], v[220:223], a[180:183], v[132:135]
    v_mfma_f32_16x16x32_bf16 v[136:139], v[216:219], a[168:171], v[136:139]
    ds_read_b64_tr_b16 v[212:213], v31 offset:27840
    v_mfma_f32_16x16x32_bf16 v[136:139], v[220:223], a[184:187], v[136:139]
    buffer_load_dwordx4 a[116:119], v1, s[16:19], s46 offen offset:3072 sc1
    v_mfma_f32_16x16x32_bf16 v[140:143], v[216:219], a[172:175], v[140:143]
    ds_read_b64_tr_b16 v[214:215], v31 offset:32448
    v_mfma_f32_16x16x32_bf16 v[140:143], v[220:223], a[188:191], v[140:143]
    s_waitcnt lgkmcnt(6)
    v_mfma_f32_16x16x32_bf16 v[144:147], v[224:227], a[160:163], v[144:147]
    s_waitcnt lgkmcnt(4)
    ds_read_b64_tr_b16 v[216:217], v31 offset:18656
    v_mfma_f32_16x16x32_bf16 v[144:147], v[228:231], a[176:179], v[144:147]
    v_mfma_f32_16x16x32_bf16 v[148:151], v[224:227], a[164:167], v[148:151]
    ds_read_b64_tr_b16 v[218:219], v31 offset:23264
    v_mfma_f32_16x16x32_bf16 v[148:151], v[228:231], a[180:183], v[148:151]
    buffer_load_dwordx4 a[104:107], v1, s[20:23], s46 offen offset:2048 sc1
    v_mfma_f32_16x16x32_bf16 v[152:155], v[224:227], a[168:171], v[152:155]
    ds_read_b64_tr_b16 v[220:221], v31 offset:27872
    v_mfma_f32_16x16x32_bf16 v[152:155], v[228:231], a[184:187], v[152:155]
    v_mfma_f32_16x16x32_bf16 v[156:159], v[224:227], a[172:175], v[156:159]
    ds_read_b64_tr_b16 v[222:223], v31 offset:32480
    v_mfma_f32_16x16x32_bf16 v[156:159], v[228:231], a[188:191], v[156:159]
    s_waitcnt lgkmcnt(6)
    v_mfma_f32_16x16x32_bf16 v[160:163], v[208:211], a[160:163], v[160:163]
    s_waitcnt lgkmcnt(4)
    ds_read_b64_tr_b16 v[224:225], v31 offset:18688
    v_mfma_f32_16x16x32_bf16 v[160:163], v[212:215], a[176:179], v[160:163]
    ds_read_b64_tr_b16 v[226:227], v31 offset:23296
    v_mfma_f32_16x16x32_bf16 v[164:167], v[208:211], a[164:167], v[164:167]
    ds_read_b64_tr_b16 v[228:229], v31 offset:27904
    v_mfma_f32_16x16x32_bf16 v[164:167], v[212:215], a[180:183], v[164:167]
    ds_read_b64_tr_b16 v[230:231], v31 offset:32512
    v_mfma_f32_16x16x32_bf16 v[168:171], v[208:211], a[168:171], v[168:171]
    buffer_load_dwordx4 a[120:123], v1, s[20:23], s46 offen offset:3072 sc1
    v_mfma_f32_16x16x32_bf16 v[168:171], v[212:215], a[184:187], v[168:171]
    buffer_load_dwordx4 a[108:111], v1, s[24:27], s46 offen offset:2048 sc1
    v_mfma_f32_16x16x32_bf16 v[172:175], v[208:211], a[172:175], v[172:175]
    v_mfma_f32_16x16x32_bf16 v[172:175], v[212:215], a[188:191], v[172:175]
    s_waitcnt lgkmcnt(0)
    v_mfma_f32_16x16x32_bf16 v[176:179], v[216:219], a[160:163], v[176:179]
    s_waitcnt vmcnt(40)
    s_barrier
    ds_read_b64_tr_b16 v[208:209], v29 offset:0
    v_mfma_f32_16x16x32_bf16 v[176:179], v[220:223], a[176:179], v[176:179]
    v_mfma_f32_16x16x32_bf16 v[180:183], v[216:219], a[164:167], v[180:183]
    ds_read_b64_tr_b16 v[210:211], v29 offset:4608
    v_mfma_f32_16x16x32_bf16 v[180:183], v[220:223], a[180:183], v[180:183]
    buffer_load_dwordx4 a[124:127], v1, s[24:27], s46 offen offset:3072 sc1
    v_mfma_f32_16x16x32_bf16 v[184:187], v[216:219], a[168:171], v[184:187]
    s_add_u32 s46, s46, 4096
    ds_read_b64_tr_b16 v[212:213], v29 offset:9216
    v_mfma_f32_16x16x32_bf16 v[184:187], v[220:223], a[184:187], v[184:187]
    v_mfma_f32_16x16x32_bf16 v[188:191], v[216:219], a[172:175], v[188:191]
    ds_read_b64_tr_b16 v[214:215], v29 offset:13824
    v_mfma_f32_16x16x32_bf16 v[188:191], v[220:223], a[188:191], v[188:191]
    v_mfma_f32_16x16x32_bf16 v[192:195], v[224:227], a[160:163], v[192:195]
    ds_read_b64_tr_b16 v[216:217], v29 offset:32
    v_mfma_f32_16x16x32_bf16 v[192:195], v[228:231], a[176:179], v[192:195]
    v_mfma_f32_16x16x32_bf16 v[196:199], v[224:227], a[164:167], v[196:199]
    ds_read_b64_tr_b16 v[218:219], v29 offset:4640
    v_mfma_f32_16x16x32_bf16 v[196:199], v[228:231], a[180:183], v[196:199]
    v_mfma_f32_16x16x32_bf16 v[200:203], v[224:227], a[168:171], v[200:203]
    ds_read_b64_tr_b16 v[220:221], v29 offset:9248
    v_mfma_f32_16x16x32_bf16 v[200:203], v[228:231], a[184:187], v[200:203]
    s_sub_u32 s47, s47, 1
    v_mfma_f32_16x16x32_bf16 v[204:207], v[224:227], a[172:175], v[204:207]
    ds_read_b64_tr_b16 v[222:223], v29 offset:13856
    v_mfma_f32_16x16x32_bf16 v[204:207], v[228:231], a[188:191], v[204:207]
    s_waitcnt vmcnt(40) lgkmcnt(6)
    v_mfma_f32_16x16x32_bf16 v[64:67], v[208:211], a[0:3], v[64:67]
    s_waitcnt vmcnt(39) lgkmcnt(4)
    ds_read_b64_tr_b16 v[224:225], v29 offset:64
    v_mfma_f32_16x16x32_bf16 v[64:67], v[212:215], a[16:19], v[64:67]
    s_waitcnt vmcnt(38)
    v_mfma_f32_16x16x32_bf16 v[68:71], v[208:211], a[4:7], v[68:71]
    s_waitcnt vmcnt(37)
    ds_read_b64_tr_b16 v[226:227], v29 offset:4672
    v_mfma_f32_16x16x32_bf16 v[68:71], v[212:215], a[20:23], v[68:71]
    s_waitcnt vmcnt(36)
    s_add_u32 m0, s79, 0
    v_mfma_f32_16x16x32_bf16 v[72:75], v[208:211], a[8:11], v[72:75]
    s_waitcnt vmcnt(35)
    ds_read_b64_tr_b16 v[228:229], v29 offset:9280
    v_mfma_f32_16x16x32_bf16 v[72:75], v[212:215], a[24:27], v[72:75]
    s_waitcnt vmcnt(34)
    buffer_load_dwordx4 v20, s[8:11], s44 offen offset:0 lds
    v_mfma_f32_16x16x32_bf16 v[76:79], v[208:211], a[12:15], v[76:79]
    s_waitcnt vmcnt(34)
    ds_read_b64_tr_b16 v[230:231], v29 offset:13888
    v_mfma_f32_16x16x32_bf16 v[76:79], v[212:215], a[28:31], v[76:79]
    s_waitcnt lgkmcnt(6)
    v_mfma_f32_16x16x32_bf16 v[80:83], v[216:219], a[0:3], v[80:83]
    s_waitcnt lgkmcnt(4)
    ds_read_b64_tr_b16 v[208:209], v29 offset:96
    v_mfma_f32_16x16x32_bf16 v[80:83], v[220:223], a[16:19], v[80:83]
    buffer_load_dwordx4 v21, s[8:11], s44 offen offset:1024 lds
    v_mfma_f32_16x16x32_bf16 v[84:87], v[216:219], a[4:7], v[84:87]
    ds_read_b64_tr_b16 v[210:211], v29 offset:4704
    v_mfma_f32_16x16x32_bf16 v[84:87], v[220:223], a[20:23], v[84:87]
    v_mfma_f32_16x16x32_bf16 v[88:91], v[216:219], a[8:11], v[88:91]
    ds_read_b64_tr_b16 v[212:213], v29 offset:9312
    v_mfma_f32_16x16x32_bf16 v[88:91], v[220:223], a[24:27], v[88:91]
    v_mfma_f32_16x16x32_bf16 v[92:95], v[216:219], a[12:15], v[92:95]
    ds_read_b64_tr_b16 v[214:215], v29 offset:13920
    v_mfma_f32_16x16x32_bf16 v[92:95], v[220:223], a[28:31], v[92:95]
    s_waitcnt lgkmcnt(6)
    buffer_load_dwordx4 v22, s[8:11], s44 offen offset:2048 lds
    v_mfma_f32_16x16x32_bf16 v[96:99], v[224:227], a[0:3], v[96:99]
    s_waitcnt lgkmcnt(4)
    ds_read_b64_tr_b16 v[216:217], v29 offset:128
    v_mfma_f32_16x16x32_bf16 v[96:99], v[228:231], a[16:19], v[96:99]
    v_mfma_f32_16x16x32_bf16 v[100:103], v[224:227], a[4:7], v[100:103]
    ds_read_b64_tr_b16 v[218:219], v29 offset:4736
    v_mfma_f32_16x16x32_bf16 v[100:103], v[228:231], a[20:23], v[100:103]
    buffer_load_dwordx4 v23, s[8:11], s44 offen offset:3072 lds
    v_mfma_f32_16x16x32_bf16 v[104:107], v[224:227], a[8:11], v[104:107]
    s_add_u32 m0, s79, 4096
    ds_read_b64_tr_b16 v[220:221], v29 offset:9344
    v_mfma_f32_16x16x32_bf16 v[104:107], v[228:231], a[24:27], v[104:107]
    v_mfma_f32_16x16x32_bf16 v[108:111], v[224:227], a[12:15], v[108:111]
    ds_read_b64_tr_b16 v[222:223], v29 offset:13952
    v_mfma_f32_16x16x32_bf16 v[108:111], v[228:231], a[28:31], v[108:111]
    s_waitcnt lgkmcnt(6)
    v_mfma_f32_16x16x32_bf16 v[112:115], v[208:211], a[0:3], v[112:115]
    s_waitcnt lgkmcnt(4)
    ds_read_b64_tr_b16 v[224:225], v29 offset:160
    v_mfma_f32_16x16x32_bf16 v[112:115], v[212:215], a[16:19], v[112:115]
    buffer_load_dwordx4 v24, s[8:11], s44 offen offset:0 lds
    v_mfma_f32_16x16x32_bf16 v[116:119], v[208:211], a[4:7], v[116:119]
    ds_read_b64_tr_b16 v[226:227], v29 offset:4768
    v_mfma_f32_16x16x32_bf16 v[116:119], v[212:215], a[20:23], v[116:119]
    v_mfma_f32_16x16x32_bf16 v[120:123], v[208:211], a[8:11], v[120:123]
    ds_read_b64_tr_b16 v[228:229], v29 offset:9376
    v_mfma_f32_16x16x32_bf16 v[120:123], v[212:215], a[24:27], v[120:123]
    v_mfma_f32_16x16x32_bf16 v[124:127], v[208:211], a[12:15], v[124:127]
    ds_read_b64_tr_b16 v[230:231], v29 offset:13984
    v_mfma_f32_16x16x32_bf16 v[124:127], v[212:215], a[28:31], v[124:127]
    s_waitcnt lgkmcnt(6)
    buffer_load_dwordx4 v25, s[8:11], s44 offen offset:1024 lds
    v_mfma_f32_16x16x32_bf16 v[128:131], v[216:219], a[0:3], v[128:131]
    s_waitcnt lgkmcnt(4)
    ds_read_b64_tr_b16 v[208:209], v29 offset:192
    v_mfma_f32_16x16x32_bf16 v[128:131], v[220:223], a[16:19], v[128:131]
    v_mfma_f32_16x16x32_bf16 v[132:135], v[216:219], a[4:7], v[132:135]
    ds_read_b64_tr_b16 v[210:211], v29 offset:4800
    v_mfma_f32_16x16x32_bf16 v[132:135], v[220:223], a[20:23], v[132:135]
    buffer_load_dwordx4 v26, s[8:11], s44 offen offset:2048 lds
    v_mfma_f32_16x16x32_bf16 v[136:139], v[216:219], a[8:11], v[136:139]
    ds_read_b64_tr_b16 v[212:213], v29 offset:9408
    v_mfma_f32_16x16x32_bf16 v[136:139], v[220:223], a[24:27], v[136:139]
    v_mfma_f32_16x16x32_bf16 v[140:143], v[216:219], a[12:15], v[140:143]
    ds_read_b64_tr_b16 v[214:215], v29 offset:14016
    v_mfma_f32_16x16x32_bf16 v[140:143], v[220:223], a[28:31], v[140:143]
    s_waitcnt lgkmcnt(6)
    v_mfma_f32_16x16x32_bf16 v[144:147], v[224:227], a[0:3], v[144:147]
    s_waitcnt lgkmcnt(4)
    ds_read_b64_tr_b16 v[216:217], v29 offset:224
    v_mfma_f32_16x16x32_bf16 v[144:147], v[228:231], a[16:19], v[144:147]
    buffer_load_dwordx4 v27, s[8:11], s44 offen offset:3072 lds
    v_mfma_f32_16x16x32_bf16 v[148:151], v[224:227], a[4:7], v[148:151]
    s_add_u32 m0, s79, 8192
    ds_read_b64_tr_b16 v[218:219], v29 offset:4832
    v_mfma_f32_16x16x32_bf16 v[148:151], v[228:231], a[20:23], v[148:151]
    v_mfma_f32_16x16x32_bf16 v[152:155], v[224:227], a[8:11], v[152:155]
    ds_read_b64_tr_b16 v[220:221], v29 offset:9440
    v_mfma_f32_16x16x32_bf16 v[152:155], v[228:231], a[24:27], v[152:155]
    v_mfma_f32_16x16x32_bf16 v[156:159], v[224:227], a[12:15], v[156:159]
    ds_read_b64_tr_b16 v[222:223], v29 offset:14048
    v_mfma_f32_16x16x32_bf16 v[156:159], v[228:231], a[28:31], v[156:159]
    s_waitcnt lgkmcnt(6)
    buffer_load_dwordx4 v28, s[8:11], s44 offen offset:0 lds
    v_mfma_f32_16x16x32_bf16 v[160:163], v[208:211], a[0:3], v[160:163]
    s_waitcnt lgkmcnt(4)
    s_add_u32 s44, s44, 147456
    ds_read_b64_tr_b16 v[224:225], v29 offset:256
    v_mfma_f32_16x16x32_bf16 v[160:163], v[212:215], a[16:19], v[160:163]
    v_mfma_f32_16x16x32_bf16 v[164:167], v[208:211], a[4:7], v[164:167]
    ds_read_b64_tr_b16 v[226:227], v29 offset:4864
    v_mfma_f32_16x16x32_bf16 v[164:167], v[212:215], a[20:23], v[164:167]
    buffer_load_dwordx4 a[128:131], v1, s[12:15], s46 offen offset:0 sc1
    v_mfma_f32_16x16x32_bf16 v[168:171], v[208:211], a[8:11], v[168:171]
    ds_read_b64_tr_b16 v[228:229], v29 offset:9472
    v_mfma_f32_16x16x32_bf16 v[168:171], v[212:215], a[24:27], v[168:171]
    v_mfma_f32_16x16x32_bf16 v[172:175], v[208:211], a[12:15], v[172:175]
    ds_read_b64_tr_b16 v[230:231], v29 offset:14080
    v_mfma_f32_16x16x32_bf16 v[172:175], v[212:215], a[28:31], v[172:175]
    s_waitcnt lgkmcnt(6)
    v_mfma_f32_16x16x32_bf16 v[176:179], v[216:219], a[0:3], v[176:179]
    s_waitcnt lgkmcnt(4)
    ds_read_b64_tr_b16 v[208:209], v29 offset:18432
    v_mfma_f32_16x16x32_bf16 v[176:179], v[220:223], a[16:19], v[176:179]
    buffer_load_dwordx4 a[144:147], v1, s[12:15], s46 offen offset:1024 sc1
    v_mfma_f32_16x16x32_bf16 v[180:183], v[216:219], a[4:7], v[180:183]
    ds_read_b64_tr_b16 v[210:211], v29 offset:23040
    v_mfma_f32_16x16x32_bf16 v[180:183], v[220:223], a[20:23], v[180:183]
    v_mfma_f32_16x16x32_bf16 v[184:187], v[216:219], a[8:11], v[184:187]
    ds_read_b64_tr_b16 v[212:213], v29 offset:27648
    v_mfma_f32_16x16x32_bf16 v[184:187], v[220:223], a[24:27], v[184:187]
    v_mfma_f32_16x16x32_bf16 v[188:191], v[216:219], a[12:15], v[188:191]
    ds_read_b64_tr_b16 v[214:215], v29 offset:32256
    v_mfma_f32_16x16x32_bf16 v[188:191], v[220:223], a[28:31], v[188:191]
    s_waitcnt lgkmcnt(6)
    buffer_load_dwordx4 a[132:135], v1, s[16:19], s46 offen offset:0 sc1
    v_mfma_f32_16x16x32_bf16 v[192:195], v[224:227], a[0:3], v[192:195]
    s_waitcnt lgkmcnt(4)
    ds_read_b64_tr_b16 v[216:217], v29 offset:18464
    v_mfma_f32_16x16x32_bf16 v[192:195], v[228:231], a[16:19], v[192:195]
    v_mfma_f32_16x16x32_bf16 v[196:199], v[224:227], a[4:7], v[196:199]
    ds_read_b64_tr_b16 v[218:219], v29 offset:23072
    v_mfma_f32_16x16x32_bf16 v[196:199], v[228:231], a[20:23], v[196:199]
    buffer_load_dwordx4 a[148:151], v1, s[16:19], s46 offen offset:1024 sc1
    v_mfma_f32_16x16x32_bf16 v[200:203], v[224:227], a[8:11], v[200:203]
    ds_read_b64_tr_b16 v[220:221], v29 offset:27680
    v_mfma_f32_16x16x32_bf16 v[200:203], v[228:231], a[24:27], v[200:203]
    v_mfma_f32_16x16x32_bf16 v[204:207], v[224:227], a[12:15], v[204:207]
    ds_read_b64_tr_b16 v[222:223], v29 offset:32288
    v_mfma_f32_16x16x32_bf16 v[204:207], v[228:231], a[28:31], v[204:207]
    s_waitcnt vmcnt(45) lgkmcnt(6)
    v_mfma_f32_16x16x32_bf16 v[64:67], v[208:211], a[32:35], v[64:67]
    s_waitcnt vmcnt(44) lgkmcnt(4)
    ds_read_b64_tr_b16 v[224:225], v29 offset:18496
    v_mfma_f32_16x16x32_bf16 v[64:67], v[212:215], a[48:51], v[64:67]
    s_waitcnt vmcnt(43)
    buffer_load_dwordx4 a[136:139], v1, s[20:23], s46 offen offset:0 sc1
    v_mfma_f32_16x16x32_bf16 v[68:71], v[208:211], a[36:39], v[68:71]
    s_waitcnt vmcnt(43)
    ds_read_b64_tr_b16 v[226:227], v29 offset:23104
    v_mfma_f32_16x16x32_bf16 v[68:71], v[212:215], a[52:55], v[68:71]
    s_waitcnt vmcnt(42)
    v_mfma_f32_16x16x32_bf16 v[72:75], v[208:211], a[40:43], v[72:75]
    s_waitcnt vmcnt(41)
    ds_read_b64_tr_b16 v[228:229], v29 offset:27712
    v_mfma_f32_16x16x32_bf16 v[72:75], v[212:215], a[56:59], v[72:75]
    s_waitcnt vmcnt(40)
    buffer_load_dwordx4 a[152:155], v1, s[20:23], s46 offen offset:1024 sc1
    v_mfma_f32_16x16x32_bf16 v[76:79], v[208:211], a[44:47], v[76:79]
    s_waitcnt vmcnt(40)
    ds_read_b64_tr_b16 v[230:231], v29 offset:32320
    v_mfma_f32_16x16x32_bf16 v[76:79], v[212:215], a[60:63], v[76:79]
    s_waitcnt lgkmcnt(6)
    v_mfma_f32_16x16x32_bf16 v[80:83], v[216:219], a[32:35], v[80:83]
    s_waitcnt lgkmcnt(4)
    ds_read_b64_tr_b16 v[208:209], v29 offset:18528
    v_mfma_f32_16x16x32_bf16 v[80:83], v[220:223], a[48:51], v[80:83]
    v_mfma_f32_16x16x32_bf16 v[84:87], v[216:219], a[36:39], v[84:87]
    ds_read_b64_tr_b16 v[210:211], v29 offset:23136
    v_mfma_f32_16x16x32_bf16 v[84:87], v[220:223], a[52:55], v[84:87]
    buffer_load_dwordx4 a[140:143], v1, s[24:27], s46 offen offset:0 sc1
    v_mfma_f32_16x16x32_bf16 v[88:91], v[216:219], a[40:43], v[88:91]
    ds_read_b64_tr_b16 v[212:213], v29 offset:27744
    v_mfma_f32_16x16x32_bf16 v[88:91], v[220:223], a[56:59], v[88:91]
    v_mfma_f32_16x16x32_bf16 v[92:95], v[216:219], a[44:47], v[92:95]
    ds_read_b64_tr_b16 v[214:215], v29 offset:32352
    v_mfma_f32_16x16x32_bf16 v[92:95], v[220:223], a[60:63], v[92:95]
    s_waitcnt lgkmcnt(6)
    v_mfma_f32_16x16x32_bf16 v[96:99], v[224:227], a[32:35], v[96:99]
    s_waitcnt lgkmcnt(4)
    ds_read_b64_tr_b16 v[216:217], v29 offset:18560
    v_mfma_f32_16x16x32_bf16 v[96:99], v[228:231], a[48:51], v[96:99]
    buffer_load_dwordx4 a[156:159], v1, s[24:27], s46 offen offset:1024 sc1
    v_mfma_f32_16x16x32_bf16 v[100:103], v[224:227], a[36:39], v[100:103]
    ds_read_b64_tr_b16 v[218:219], v29 offset:23168
    v_mfma_f32_16x16x32_bf16 v[100:103], v[228:231], a[52:55], v[100:103]
    v_mfma_f32_16x16x32_bf16 v[104:107], v[224:227], a[40:43], v[104:107]
    ds_read_b64_tr_b16 v[220:221], v29 offset:27776
    v_mfma_f32_16x16x32_bf16 v[104:107], v[228:231], a[56:59], v[104:107]
    buffer_load_dwordx4 a[160:163], v1, s[12:15], s46 offen offset:2048 sc1
    v_mfma_f32_16x16x32_bf16 v[108:111], v[224:227], a[44:47], v[108:111]
    ds_read_b64_tr_b16 v[222:223], v29 offset:32384
    v_mfma_f32_16x16x32_bf16 v[108:111], v[228:231], a[60:63], v[108:111]
    s_waitcnt lgkmcnt(6)
    v_mfma_f32_16x16x32_bf16 v[112:115], v[208:211], a[32:35], v[112:115]
    s_waitcnt lgkmcnt(4)
    ds_read_b64_tr_b16 v[224:225], v29 offset:18592
    v_mfma_f32_16x16x32_bf16 v[112:115], v[212:215], a[48:51], v[112:115]
    v_mfma_f32_16x16x32_bf16 v[116:119], v[208:211], a[36:39], v[116:119]
    ds_read_b64_tr_b16 v[226:227], v29 offset:23200
    v_mfma_f32_16x16x32_bf16 v[116:119], v[212:215], a[52:55], v[116:119]
    buffer_load_dwordx4 a[176:179], v1, s[12:15], s46 offen offset:3072 sc1
    v_mfma_f32_16x16x32_bf16 v[120:123], v[208:211], a[40:43], v[120:123]
    ds_read_b64_tr_b16 v[228:229], v29 offset:27808
    v_mfma_f32_16x16x32_bf16 v[120:123], v[212:215], a[56:59], v[120:123]
    v_mfma_f32_16x16x32_bf16 v[124:127], v[208:211], a[44:47], v[124:127]
    ds_read_b64_tr_b16 v[230:231], v29 offset:32416
    v_mfma_f32_16x16x32_bf16 v[124:127], v[212:215], a[60:63], v[124:127]
    s_waitcnt lgkmcnt(6)
    v_mfma_f32_16x16x32_bf16 v[128:131], v[216:219], a[32:35], v[128:131]
    s_waitcnt lgkmcnt(4)
    ds_read_b64_tr_b16 v[208:209], v29 offset:18624
    v_mfma_f32_16x16x32_bf16 v[128:131], v[220:223], a[48:51], v[128:131]
    buffer_load_dwordx4 a[164:167], v1, s[16:19], s46 offen offset:2048 sc1
    v_mfma_f32_16x16x32_bf16 v[132:135], v[216:219], a[36:39], v[132:135]
    ds_read_b64_tr_b16 v[210:211], v29 offset:23232
    v_mfma_f32_16x16x32_bf16 v[132:135], v[220:223], a[52:55], v[132:135]
    v_mfma_f32_16x16x32_bf16 v[136:139], v[216:219], a[40:43], v[136:139]
    ds_read_b64_tr_b16 v[212:213], v29 offset:27840
    v_mfma_f32_16x16x32_bf16 v[136:139], v[220:223], a[56:59], v[136:139]
    buffer_load_dwordx4 a[180:183], v1, s[16:19], s46 offen offset:3072 sc1
    v_mfma_f32_16x16x32_bf16 v[140:143], v[216:219], a[44:47], v[140:143]
    ds_read_b64_tr_b16 v[214:215], v29 offset:32448
    v_mfma_f32_16x16x32_bf16 v[140:143], v[220:223], a[60:63], v[140:143]
    s_waitcnt lgkmcnt(6)
    v_mfma_f32_16x16x32_bf16 v[144:147], v[224:227], a[32:35], v[144:147]
    s_waitcnt lgkmcnt(4)
    ds_read_b64_tr_b16 v[216:217], v29 offset:18656
    v_mfma_f32_16x16x32_bf16 v[144:147], v[228:231], a[48:51], v[144:147]
    v_mfma_f32_16x16x32_bf16 v[148:151], v[224:227], a[36:39], v[148:151]
    ds_read_b64_tr_b16 v[218:219], v29 offset:23264
    v_mfma_f32_16x16x32_bf16 v[148:151], v[228:231], a[52:55], v[148:151]
    buffer_load_dwordx4 a[168:171], v1, s[20:23], s46 offen offset:2048 sc1
    v_mfma_f32_16x16x32_bf16 v[152:155], v[224:227], a[40:43], v[152:155]
    ds_read_b64_tr_b16 v[220:221], v29 offset:27872
    v_mfma_f32_16x16x32_bf16 v[152:155], v[228:231], a[56:59], v[152:155]
    v_mfma_f32_16x16x32_bf16 v[156:159], v[224:227], a[44:47], v[156:159]
    ds_read_b64_tr_b16 v[222:223], v29 offset:32480
    v_mfma_f32_16x16x32_bf16 v[156:159], v[228:231], a[60:63], v[156:159]
    s_waitcnt lgkmcnt(6)
    v_mfma_f32_16x16x32_bf16 v[160:163], v[208:211], a[32:35], v[160:163]
    s_waitcnt lgkmcnt(4)
    ds_read_b64_tr_b16 v[224:225], v29 offset:18688
    v_mfma_f32_16x16x32_bf16 v[160:163], v[212:215], a[48:51], v[160:163]
    ds_read_b64_tr_b16 v[226:227], v29 offset:23296
    v_mfma_f32_16x16x32_bf16 v[164:167], v[208:211], a[36:39], v[164:167]
    ds_read_b64_tr_b16 v[228:229], v29 offset:27904
    v_mfma_f32_16x16x32_bf16 v[164:167], v[212:215], a[52:55], v[164:167]
    ds_read_b64_tr_b16 v[230:231], v29 offset:32512
    v_mfma_f32_16x16x32_bf16 v[168:171], v[208:211], a[40:43], v[168:171]
    buffer_load_dwordx4 a[184:187], v1, s[20:23], s46 offen offset:3072 sc1
    v_mfma_f32_16x16x32_bf16 v[168:171], v[212:215], a[56:59], v[168:171]
    buffer_load_dwordx4 a[172:175], v1, s[24:27], s46 offen offset:2048 sc1
    v_mfma_f32_16x16x32_bf16 v[172:175], v[208:211], a[44:47], v[172:175]
    v_mfma_f32_16x16x32_bf16 v[172:175], v[212:215], a[60:63], v[172:175]
    s_waitcnt lgkmcnt(0)
    v_mfma_f32_16x16x32_bf16 v[176:179], v[216:219], a[32:35], v[176:179]
    s_waitcnt vmcnt(40)
    s_barrier
    ds_read_b64_tr_b16 v[208:209], v30 offset:0
    v_mfma_f32_16x16x32_bf16 v[176:179], v[220:223], a[48:51], v[176:179]
    v_mfma_f32_16x16x32_bf16 v[180:183], v[216:219], a[36:39], v[180:183]
    ds_read_b64_tr_b16 v[210:211], v30 offset:4608
    v_mfma_f32_16x16x32_bf16 v[180:183], v[220:223], a[52:55], v[180:183]
    buffer_load_dwordx4 a[188:191], v1, s[24:27], s46 offen offset:3072 sc1
    v_mfma_f32_16x16x32_bf16 v[184:187], v[216:219], a[40:43], v[184:187]
    s_add_u32 s46, s46, 4096
    ds_read_b64_tr_b16 v[212:213], v30 offset:9216
    v_mfma_f32_16x16x32_bf16 v[184:187], v[220:223], a[56:59], v[184:187]
    v_mfma_f32_16x16x32_bf16 v[188:191], v[216:219], a[44:47], v[188:191]
    ds_read_b64_tr_b16 v[214:215], v30 offset:13824
    v_mfma_f32_16x16x32_bf16 v[188:191], v[220:223], a[60:63], v[188:191]
    v_mfma_f32_16x16x32_bf16 v[192:195], v[224:227], a[32:35], v[192:195]
    ds_read_b64_tr_b16 v[216:217], v30 offset:32
    v_mfma_f32_16x16x32_bf16 v[192:195], v[228:231], a[48:51], v[192:195]
    v_mfma_f32_16x16x32_bf16 v[196:199], v[224:227], a[36:39], v[196:199]
    ds_read_b64_tr_b16 v[218:219], v30 offset:4640
    v_mfma_f32_16x16x32_bf16 v[196:199], v[228:231], a[52:55], v[196:199]
    v_mfma_f32_16x16x32_bf16 v[200:203], v[224:227], a[40:43], v[200:203]
    ds_read_b64_tr_b16 v[220:221], v30 offset:9248
    v_mfma_f32_16x16x32_bf16 v[200:203], v[228:231], a[56:59], v[200:203]
    s_sub_u32 s47, s47, 1
    v_mfma_f32_16x16x32_bf16 v[204:207], v[224:227], a[44:47], v[204:207]
    s_cmp_eq_u32 s47, 0
    ds_read_b64_tr_b16 v[222:223], v30 offset:13856
    v_mfma_f32_16x16x32_bf16 v[204:207], v[228:231], a[60:63], v[204:207]
    s_cbranch_scc1 L_op_last1
    s_branch L_op_loop
L_op_last1:
    s_waitcnt vmcnt(40) lgkmcnt(6)
    v_mfma_f32_16x16x32_bf16 v[64:67], v[208:211], a[64:67], v[64:67]
    s_waitcnt vmcnt(39) lgkmcnt(4)
    ds_read_b64_tr_b16 v[224:225], v30 offset:18432
    v_mfma_f32_16x16x32_bf16 v[64:67], v[212:215], a[80:83], v[64:67]
    s_waitcnt vmcnt(38)
    buffer_load_dwordx2 v[8:9], v2, s[64:67], s60 offen offset:0
    v_mfma_f32_16x16x32_bf16 v[68:71], v[208:211], a[68:71], v[68:71]
    s_waitcnt vmcnt(38)
    ds_read_b64_tr_b16 v[226:227], v30 offset:23040
    v_mfma_f32_16x16x32_bf16 v[68:71], v[212:215], a[84:87], v[68:71]
    s_waitcnt vmcnt(37)
    v_mfma_f32_16x16x32_bf16 v[72:75], v[208:211], a[72:75], v[72:75]
    s_waitcnt vmcnt(36)
    ds_read_b64_tr_b16 v[228:229], v30 offset:27648
    v_mfma_f32_16x16x32_bf16 v[72:75], v[212:215], a[88:91], v[72:75]
    s_waitcnt vmcnt(35)
    buffer_load_dwordx2 v[10:11], v2, s[64:67], s61 offen offset:0
    v_mfma_f32_16x16x32_bf16 v[76:79], v[208:211], a[76:79], v[76:79]
    s_waitcnt vmcnt(35)
    ds_read_b64_tr_b16 v[230:231], v30 offset:32256
    v_mfma_f32_16x16x32_bf16 v[76:79], v[212:215], a[92:95], v[76:79]
    s_waitcnt lgkmcnt(6)
    v_mfma_f32_16x16x32_bf16 v[80:83], v[216:219], a[64:67], v[80:83]
    s_waitcnt lgkmcnt(4)
    ds_read_b64_tr_b16 v[208:209], v30 offset:18464
    v_mfma_f32_16x16x32_bf16 v[80:83], v[220:223], a[80:83], v[80:83]
    buffer_load_dwordx2 v[12:13], v2, s[64:67], s60 offen offset:128
    v_mfma_f32_16x16x32_bf16 v[84:87], v[216:219], a[68:71], v[84:87]
    ds_read_b64_tr_b16 v[210:211], v30 offset:23072
    v_mfma_f32_16x16x32_bf16 v[84:87], v[220:223], a[84:87], v[84:87]
    v_mfma_f32_16x16x32_bf16 v[88:91], v[216:219], a[72:75], v[88:91]
    ds_read_b64_tr_b16 v[212:213], v30 offset:27680
    v_mfma_f32_16x16x32_bf16 v[88:91], v[220:223], a[88:91], v[88:91]
    buffer_load_dwordx2 v[14:15], v2, s[64:67], s61 offen offset:128
    v_mfma_f32_16x16x32_bf16 v[92:95], v[216:219], a[76:79], v[92:95]
    ds_read_b64_tr_b16 v[214:215], v30 offset:32288
    v_mfma_f32_16x16x32_bf16 v[92:95], v[220:223], a[92:95], v[92:95]
    s_waitcnt vmcnt(36) lgkmcnt(6)
    v_mfma_f32_16x16x32_bf16 v[64:67], v[224:227], a[96:99], v[64:67]
    s_waitcnt vmcnt(35) lgkmcnt(4)
    ds_read_b64_tr_b16 v[216:217], v30 offset:64
    v_mfma_f32_16x16x32_bf16 v[64:67], v[228:231], a[112:115], v[64:67]
    s_waitcnt vmcnt(34)
    buffer_load_dword v16, v2, s[64:67], s63 offen
    v_mfma_f32_16x16x32_bf16 v[68:71], v[224:227], a[100:103], v[68:71]
    s_waitcnt vmcnt(34)
    ds_read_b64_tr_b16 v[218:219], v30 offset:4672
    v_mfma_f32_16x16x32_bf16 v[68:71], v[228:231], a[116:119], v[68:71]
    s_waitcnt vmcnt(33)
    v_mfma_f32_16x16x32_bf16 v[72:75], v[224:227], a[104:107], v[72:75]
    s_waitcnt vmcnt(32)
    ds_read_b64_tr_b16 v[220:221], v30 offset:9280
    v_mfma_f32_16x16x32_bf16 v[72:75], v[228:231], a[120:123], v[72:75]
    s_waitcnt vmcnt(31)
    v_mfma_f32_16x16x32_bf16 v[76:79], v[224:227], a[108:111], v[76:79]
    s_waitcnt vmcnt(30)
    ds_read_b64_tr_b16 v[222:223], v30 offset:13888
    v_mfma_f32_16x16x32_bf16 v[76:79], v[228:231], a[124:127], v[76:79]
    s_waitcnt lgkmcnt(6)
    v_mfma_f32_16x16x32_bf16 v[80:83], v[208:211], a[96:99], v[80:83]
    s_waitcnt lgkmcnt(4)
    ds_read_b64_tr_b16 v[224:225], v30 offset:18496
    v_cvt_pk_bf16_f32 v64, v64, v65
    v_mfma_f32_16x16x32_bf16 v[80:83], v[212:215], a[112:115], v[80:83]
    v_cvt_pk_bf16_f32 v65, v66, v67
    v_cvt_pk_bf16_f32 v66, v68, v69
    v_mfma_f32_16x16x32_bf16 v[84:87], v[208:211], a[100:103], v[84:87]
    s_add_u32 s52, s48, 0
    ds_read_b64_tr_b16 v[226:227], v30 offset:23104
    v_cvt_pk_bf16_f32 v67, v70, v71
    v_mfma_f32_16x16x32_bf16 v[84:87], v[212:215], a[116:119], v[84:87]
    buffer_store_dwordx4 v[64:67], v1, s[28:31], s52 offen sc1
    v_mfma_f32_16x16x32_bf16 v[88:91], v[208:211], a[104:107], v[88:91]
    ds_read_b64_tr_b16 v[228:229], v30 offset:27712
    v_mfma_f32_16x16x32_bf16 v[88:91], v[212:215], a[120:123], v[88:91]
    v_mfma_f32_16x16x32_bf16 v[92:95], v[208:211], a[108:111], v[92:95]
    ds_read_b64_tr_b16 v[230:231], v30 offset:32320
    v_mfma_f32_16x16x32_bf16 v[92:95], v[212:215], a[124:127], v[92:95]
    s_waitcnt lgkmcnt(6)
    v_cvt_pk_bf16_f32 v72, v72, v73
    v_cvt_pk_bf16_f32 v73, v74, v75
    v_mfma_f32_16x16x32_bf16 v[96:99], v[216:219], a[64:67], v[96:99]
    s_waitcnt lgkmcnt(4)
    ds_read_b64_tr_b16 v[208:209], v30 offset:96
    v_cvt_pk_bf16_f32 v74, v76, v77
    v_mfma_f32_16x16x32_bf16 v[96:99], v[220:223], a[80:83], v[96:99]
    s_add_u32 s52, s48, 9216
    v_cvt_pk_bf16_f32 v75, v78, v79
    v_mfma_f32_16x16x32_bf16 v[100:103], v[216:219], a[68:71], v[100:103]
    ds_read_b64_tr_b16 v[210:211], v30 offset:4704
    v_mfma_f32_16x16x32_bf16 v[100:103], v[220:223], a[84:87], v[100:103]
    buffer_store_dwordx4 v[72:75], v1, s[28:31], s52 offen sc1
    v_mfma_f32_16x16x32_bf16 v[104:107], v[216:219], a[72:75], v[104:107]
    ds_read_b64_tr_b16 v[212:213], v30 offset:9312
    v_mfma_f32_16x16x32_bf16 v[104:107], v[220:223], a[88:91], v[104:107]
    v_mfma_f32_16x16x32_bf16 v[108:111], v[216:219], a[76:79], v[108:111]
    ds_read_b64_tr_b16 v[214:215], v30 offset:13920
    v_mfma_f32_16x16x32_bf16 v[108:111], v[220:223], a[92:95], v[108:111]
    s_waitcnt lgkmcnt(6)
    v_cvt_pk_bf16_f32 v80, v80, v81
    v_cvt_pk_bf16_f32 v81, v82, v83
    v_mfma_f32_16x16x32_bf16 v[96:99], v[224:227], a[96:99], v[96:99]
    s_waitcnt lgkmcnt(4)
    ds_read_b64_tr_b16 v[216:217], v30 offset:18528
    v_cvt_pk_bf16_f32 v82, v84, v85
    v_mfma_f32_16x16x32_bf16 v[96:99], v[228:231], a[112:115], v[96:99]
    s_add_u32 s52, s48, 1024
    v_cvt_pk_bf16_f32 v83, v86, v87
    v_mfma_f32_16x16x32_bf16 v[100:103], v[224:227], a[100:103], v[100:103]
    ds_read_b64_tr_b16 v[218:219], v30 offset:23136
    v_mfma_f32_16x16x32_bf16 v[100:103], v[228:231], a[116:119], v[100:103]
    buffer_store_dwordx4 v[80:83], v1, s[28:31], s52 offen sc1
    v_mfma_f32_16x16x32_bf16 v[104:107], v[224:227], a[104:107], v[104:107]
    ds_read_b64_tr_b16 v[220:221], v30 offset:27744
    v_mfma_f32_16x16x32_bf16 v[104:107], v[228:231], a[120:123], v[104:107]
    v_mfma_f32_16x16x32_bf16 v[108:111], v[224:227], a[108:111], v[108:111]
    ds_read_b64_tr_b16 v[222:223], v30 offset:32352
    v_mfma_f32_16x16x32_bf16 v[108:111], v[228:231], a[124:127], v[108:111]
    s_waitcnt lgkmcnt(6)
    v_cvt_pk_bf16_f32 v88, v88, v89
    v_cvt_pk_bf16_f32 v89, v90, v91
    v_mfma_f32_16x16x32_bf16 v[112:115], v[208:211], a[64:67], v[112:115]
    s_waitcnt lgkmcnt(4)
    ds_read_b64_tr_b16 v[224:225], v30 offset:128
    v_cvt_pk_bf16_f32 v90, v92, v93
    v_mfma_f32_16x16x32_bf16 v[112:115], v[212:215], a[80:83], v[112:115]
    s_add_u32 s52, s48, 10240
    v_cvt_pk_bf16_f32 v91, v94, v95
    v_mfma_f32_16x16x32_bf16 v[116:119], v[208:211], a[68:71], v[116:119]
    ds_read_b64_tr_b16 v[226:227], v30 offset:4736
    v_mfma_f32_16x16x32_bf16 v[116:119], v[212:215], a[84:87], v[116:119]
    buffer_store_dwordx4 v[88:91], v1, s[28:31], s52 offen sc1
    v_mfma_f32_16x16x32_bf16 v[120:123], v[208:211], a[72:75], v[120:123]
    ds_read_b64_tr_b16 v[228:229], v30 offset:9344
    v_mfma_f32_16x16x32_bf16 v[120:123], v[212:215], a[88:91], v[120:123]
    v_mfma_f32_16x16x32_bf16 v[124:127], v[208:211], a[76:79], v[124:127]
    ds_read_b64_tr_b16 v[230:231], v30 offset:13952
    v_mfma_f32_16x16x32_bf16 v[124:127], v[212:215], a[92:95], v[124:127]
    s_waitcnt lgkmcnt(6)
    v_cvt_pk_bf16_f32 v96, v96, v97
    v_cvt_pk_bf16_f32 v97, v98, v99
    v_mfma_f32_16x16x32_bf16 v[112:115], v[216:219], a[96:99], v[112:115]
    s_waitcnt lgkmcnt(4)
    ds_read_b64_tr_b16 v[208:209], v30 offset:18560
    v_cvt_pk_bf16_f32 v98, v100, v101
    v_mfma_f32_16x16x32_bf16 v[112:115], v[220:223], a[112:115], v[112:115]
    s_add_u32 s52, s48, 2048
    v_cvt_pk_bf16_f32 v99, v102, v103
    v_mfma_f32_16x16x32_bf16 v[116:119], v[216:219], a[100:103], v[116:119]
    ds_read_b64_tr_b16 v[210:211], v30 offset:23168
    v_mfma_f32_16x16x32_bf16 v[116:119], v[220:223], a[116:119], v[116:119]
    buffer_store_dwordx4 v[96:99], v1, s[28:31], s52 offen sc1
    v_mfma_f32_16x16x32_bf16 v[120:123], v[216:219], a[104:107], v[120:123]
    ds_read_b64_tr_b16 v[212:213], v30 offset:27776
    v_mfma_f32_16x16x32_bf16 v[120:123], v[220:223], a[120:123], v[120:123]
    v_mfma_f32_16x16x32_bf16 v[124:127], v[216:219], a[108:111], v[124:127]
    ds_read_b64_tr_b16 v[214:215], v30 offset:32384
    v_mfma_f32_16x16x32_bf16 v[124:127], v[220:223], a[124:127], v[124:127]
    s_waitcnt lgkmcnt(6)
    v_cvt_pk_bf16_f32 v104, v104, v105
    v_cvt_pk_bf16_f32 v105, v106, v107
    v_mfma_f32_16x16x32_bf16 v[128:131], v[224:227], a[64:67], v[128:131]
    s_waitcnt lgkmcnt(4)
    ds_read_b64_tr_b16 v[216:217], v30 offset:160
    v_cvt_pk_bf16_f32 v106, v108, v109
    v_mfma_f32_16x16x32_bf16 v[128:131], v[228:231], a[80:83], v[128:131]
    s_add_u32 s52, s48, 11264
    v_cvt_pk_bf16_f32 v107, v110, v111
    v_mfma_f32_16x16x32_bf16 v[132:135], v[224:227], a[68:71], v[132:135]
    ds_read_b64_tr_b16 v[218:219], v30 offset:4768
    v_mfma_f32_16x16x32_bf16 v[132:135], v[228:231], a[84:87], v[132:135]
    buffer_store_dwordx4 v[104:107], v1, s[28:31], s52 offen sc1
    v_mfma_f32_16x16x32_bf16 v[136:139], v[224:227], a[72:75], v[136:139]
    ds_read_b64_tr_b16 v[220:221], v30 offset:9376
    v_mfma_f32_16x16x32_bf16 v[136:139], v[228:231], a[88:91], v[136:139]
    v_mfma_f32_16x16x32_bf16 v[140:143], v[224:227], a[76:79], v[140:143]
    ds_read_b64_tr_b16 v[222:223], v30 offset:13984
    v_mfma_f32_16x16x32_bf16 v[140:143], v[228:231], a[92:95], v[140:143]
    s_waitcnt lgkmcnt(6)
    v_cvt_pk_bf16_f32 v112, v112, v113
    v_cvt_pk_bf16_f32 v113, v114, v115
    v_mfma_f32_16x16x32_bf16 v[128:131], v[208:211], a[96:99], v[128:131]
    s_waitcnt lgkmcnt(4)
    ds_read_b64_tr_b16 v[224:225], v30 offset:18592
    v_cvt_pk_bf16_f32 v114, v116, v117
    v_mfma_f32_16x16x32_bf16 v[128:131], v[212:215], a[112:115], v[128:131]
    s_add_u32 s52, s48, 3072
    v_cvt_pk_bf16_f32 v115, v118, v119
    v_mfma_f32_16x16x32_bf16 v[132:135], v[208:211], a[100:103], v[132:135]
    ds_read_b64_tr_b16 v[226:227], v30 offset:23200
    v_mfma_f32_16x16x32_bf16 v[132:135], v[212:215], a[116:119], v[132:135]
    buffer_store_dwordx4 v[112:115], v1, s[28:31], s52 offen sc1
    v_mfma_f32_16x16x32_bf16 v[136:139], v[208:211], a[104:107], v[136:139]
    ds_read_b64_tr_b16 v[228:229], v30 offset:27808
    v_mfma_f32_16x16x32_bf16 v[136:139], v[212:215], a[120:123], v[136:139]
    v_mfma_f32_16x16x32_bf16 v[140:143], v[208:211], a[108:111], v[140:143]
    ds_read_b64_tr_b16 v[230:231], v30 offset:32416
    v_mfma_f32_16x16x32_bf16 v[140:143], v[212:215], a[124:127], v[140:143]
    s_waitcnt lgkmcnt(6)
    v_cvt_pk_bf16_f32 v120, v120, v121
    v_cvt_pk_bf16_f32 v121, v122, v123
    v_mfma_f32_16x16x32_bf16 v[144:147], v[216:219], a[64:67], v[144:147]
    s_waitcnt lgkmcnt(4)
    ds_read_b64_tr_b16 v[208:209], v30 offset:192
    v_cvt_pk_bf16_f32 v122, v124, v125
    v_mfma_f32_16x16x32_bf16 v[144:147], v[220:223], a[80:83], v[144:147]
    s_add_u32 s52, s48, 12288
    v_cvt_pk_bf16_f32 v123, v126, v127
    v_mfma_f32_16x16x32_bf16 v[148:151], v[216:219], a[68:71], v[148:151]
    ds_read_b64_tr_b16 v[210:211], v30 offset:4800
    v_mfma_f32_16x16x32_bf16 v[148:151], v[220:223], a[84:87], v[148:151]
    buffer_store_dwordx4 v[120:123], v1, s[28:31], s52 offen sc1
    v_mfma_f32_16x16x32_bf16 v[152:155], v[216:219], a[72:75], v[152:155]
    ds_read_b64_tr_b16 v[212:213], v30 offset:9408
    v_mfma_f32_16x16x32_bf16 v[152:155], v[220:223], a[88:91], v[152:155]
    v_mfma_f32_16x16x32_bf16 v[156:159], v[216:219], a[76:79], v[156:159]
    ds_read_b64_tr_b16 v[214:215], v30 offset:14016
    v_mfma_f32_16x16x32_bf16 v[156:159], v[220:223], a[92:95], v[156:159]
    s_waitcnt lgkmcnt(6)
    v_cvt_pk_bf16_f32 v128, v128, v129
    v_cvt_pk_bf16_f32 v129, v130, v131
    v_mfma_f32_16x16x32_bf16 v[144:147], v[224:227], a[96:99], v[144:147]
    s_waitcnt lgkmcnt(4)
    ds_read_b64_tr_b16 v[216:217], v30 offset:18624
    v_cvt_pk_bf16_f32 v130, v132, v133
    v_mfma_f32_16x16x32_bf16 v[144:147], v[228:231], a[112:115], v[144:147]
    s_add_u32 s52, s48, 4096
    v_cvt_pk_bf16_f32 v131, v134, v135
    v_mfma_f32_16x16x32_bf16 v[148:151], v[224:227], a[100:103], v[148:151]
    ds_read_b64_tr_b16 v[218:219], v30 offset:23232
    v_mfma_f32_16x16x32_bf16 v[148:151], v[228:231], a[116:119], v[148:151]
    buffer_store_dwordx4 v[128:131], v1, s[28:31], s52 offen sc1
    v_mfma_f32_16x16x32_bf16 v[152:155], v[224:227], a[104:107], v[152:155]
    ds_read_b64_tr_b16 v[220:221], v30 offset:27840
    v_mfma_f32_16x16x32_bf16 v[152:155], v[228:231], a[120:123], v[152:155]
    v_mfma_f32_16x16x32_bf16 v[156:159], v[224:227], a[108:111], v[156:159]
    ds_read_b64_tr_b16 v[222:223], v30 offset:32448
    v_mfma_f32_16x16x32_bf16 v[156:159], v[228:231], a[124:127], v[156:159]
    s_waitcnt lgkmcnt(6)
    v_cvt_pk_bf16_f32 v136, v136, v137
    v_cvt_pk_bf16_f32 v137, v138, v139
    v_mfma_f32_16x16x32_bf16 v[160:163], v[208:211], a[64:67], v[160:163]
    s_waitcnt lgkmcnt(4)
    ds_read_b64_tr_b16 v[224:225], v30 offset:224
    v_cvt_pk_bf16_f32 v138, v140, v141
    v_mfma_f32_16x16x32_bf16 v[160:163], v[212:215], a[80:83], v[160:163]
    s_add_u32 s52, s48, 13312
    v_cvt_pk_bf16_f32 v139, v142, v143
    v_mfma_f32_16x16x32_bf16 v[164:167], v[208:211], a[68:71], v[164:167]
    ds_read_b64_tr_b16 v[226:227], v30 offset:4832
    v_mfma_f32_16x16x32_bf16 v[164:167], v[212:215], a[84:87], v[164:167]
    buffer_store_dwordx4 v[136:139], v1, s[28:31], s52 offen sc1
    v_mfma_f32_16x16x32_bf16 v[168:171], v[208:211], a[72:75], v[168:171]
    ds_read_b64_tr_b16 v[228:229], v30 offset:9440
    v_mfma_f32_16x16x32_bf16 v[168:171], v[212:215], a[88:91], v[168:171]
    v_mfma_f32_16x16x32_bf16 v[172:175], v[208:211], a[76:79], v[172:175]
    ds_read_b64_tr_b16 v[230:231], v30 offset:14048
    v_mfma_f32_16x16x32_bf16 v[172:175], v[212:215], a[92:95], v[172:175]
    s_waitcnt lgkmcnt(6)
    v_cvt_pk_bf16_f32 v144, v144, v145
    v_cvt_pk_bf16_f32 v145, v146, v147
    v_mfma_f32_16x16x32_bf16 v[160:163], v[216:219], a[96:99], v[160:163]
    s_waitcnt lgkmcnt(4)
    ds_read_b64_tr_b16 v[208:209], v30 offset:18656
    v_cvt_pk_bf16_f32 v146, v148, v149
    v_mfma_f32_16x16x32_bf16 v[160:163], v[220:223], a[112:115], v[160:163]
    s_add_u32 s52, s48, 5120
    v_cvt_pk_bf16_f32 v147, v150, v151
    v_mfma_f32_16x16x32_bf16 v[164:167], v[216:219], a[100:103], v[164:167]
    ds_read_b64_tr_b16 v[210:211], v30 offset:23264
    v_mfma_f32_16x16x32_bf16 v[164:167], v[220:223], a[116:119], v[164:167]
    buffer_store_dwordx4 v[144:147], v1, s[28:31], s52 offen sc1
    v_mfma_f32_16x16x32_bf16 v[168:171], v[216:219], a[104:107], v[168:171]
    ds_read_b64_tr_b16 v[212:213], v30 offset:27872
    v_mfma_f32_16x16x32_bf16 v[168:171], v[220:223], a[120:123], v[168:171]
    v_mfma_f32_16x16x32_bf16 v[172:175], v[216:219], a[108:111], v[172:175]
    s_waitcnt vmcnt(15)
    ds_read_b64_tr_b16 v[214:215], v30 offset:32480
    v_lshlrev_b32 v232, 16, v8
    v_mfma_f32_16x16x32_bf16 v[172:175], v[220:223], a[124:127], v[172:175]
    s_waitcnt lgkmcnt(6)
    v_and_b32 v233, 0xffff0000, v8
    v_lshlrev_b32 v234, 16, v9
    v_mfma_f32_16x16x32_bf16 v[176:179], v[224:227], a[64:67], v[176:179]
    s_waitcnt lgkmcnt(4)
    ds_read_b64_tr_b16 v[216:217], v30 offset:256
    v_and_b32 v235, 0xffff0000, v9
    v_mfma_f32_16x16x32_bf16 v[176:179], v[228:231], a[80:83], v[176:179]
    s_waitcnt vmcnt(14)
    v_lshlrev_b32 v236, 16, v10
    v_and_b32 v237, 0xffff0000, v10
    v_mfma_f32_16x16x32_bf16 v[180:183], v[224:227], a[68:71], v[180:183]
    ds_read_b64_tr_b16 v[218:219], v30 offset:4864
    v_lshlrev_b32 v238, 16, v11
    v_mfma_f32_16x16x32_bf16 v[180:183], v[228:231], a[84:87], v[180:183]
    s_waitcnt vmcnt(13)
    v_and_b32 v239, 0xffff0000, v11
    v_lshlrev_b32 v240, 16, v12
    v_mfma_f32_16x16x32_bf16 v[184:187], v[224:227], a[72:75], v[184:187]
    ds_read_b64_tr_b16 v[220:221], v30 offset:9472
    v_and_b32 v241, 0xffff0000, v12
    v_mfma_f32_16x16x32_bf16 v[184:187], v[228:231], a[88:91], v[184:187]
    v_lshlrev_b32 v242, 16, v13
    v_and_b32 v243, 0xffff0000, v13
    v_mfma_f32_16x16x32_bf16 v[188:191], v[224:227], a[76:79], v[188:191]
    s_waitcnt vmcnt(12)
    ds_read_b64_tr_b16 v[222:223], v30 offset:14080
    v_lshlrev_b32 v244, 16, v14
    v_mfma_f32_16x16x32_bf16 v[188:191], v[228:231], a[92:95], v[188:191]
    s_waitcnt lgkmcnt(6)
    v_and_b32 v245, 0xffff0000, v14
    v_lshlrev_b32 v246, 16, v15
    v_mfma_f32_16x16x32_bf16 v[176:179], v[208:211], a[96:99], v[176:179]
    s_waitcnt lgkmcnt(4)
    ds_read_b64_tr_b16 v[224:225], v30 offset:18688
    v_and_b32 v247, 0xffff0000, v15
    v_mfma_f32_16x16x32_bf16 v[176:179], v[212:215], a[112:115], v[176:179]
    s_waitcnt vmcnt(11)
    ds_read_b64_tr_b16 v[226:227], v30 offset:23296
    v_lshlrev_b32 v248, 16, v16
    v_mfma_f32_16x16x32_bf16 v[180:183], v[208:211], a[100:103], v[180:183]
    ds_read_b64_tr_b16 v[228:229], v30 offset:27904
    v_and_b32 v249, 0xffff0000, v16
    v_mfma_f32_16x16x32_bf16 v[180:183], v[212:215], a[116:119], v[180:183]
    ds_read_b64_tr_b16 v[230:231], v30 offset:32512
    v_cvt_pk_bf16_f32 v152, v152, v153
    v_mfma_f32_16x16x32_bf16 v[184:187], v[208:211], a[104:107], v[184:187]
    v_cvt_pk_bf16_f32 v153, v154, v155
    v_cvt_pk_bf16_f32 v154, v156, v157
    v_mfma_f32_16x16x32_bf16 v[184:187], v[212:215], a[120:123], v[184:187]
    s_add_u32 s52, s48, 14336
    v_cvt_pk_bf16_f32 v155, v158, v159
    v_mfma_f32_16x16x32_bf16 v[188:191], v[208:211], a[108:111], v[188:191]
    buffer_store_dwordx4 v[152:155], v1, s[28:31], s52 offen sc1
    v_mfma_f32_16x16x32_bf16 v[188:191], v[212:215], a[124:127], v[188:191]
    s_waitcnt lgkmcnt(6)
    v_mfma_f32_16x16x32_bf16 v[192:195], v[216:219], a[64:67], v[192:195]
    s_waitcnt lgkmcnt(4)
    v_mfma_f32_16x16x32_bf16 v[192:195], v[220:223], a[80:83], v[192:195]
    buffer_load_dword v253, off, s[72:75], s55 sc1
    v_mfma_f32_16x16x32_bf16 v[196:199], v[216:219], a[68:71], v[196:199]
    v_cvt_pk_bf16_f32 v160, v160, v161
    v_cvt_pk_bf16_f32 v161, v162, v163
    v_mfma_f32_16x16x32_bf16 v[196:199], v[220:223], a[84:87], v[196:199]
    s_add_u32 s52, s48, 6144
    v_cvt_pk_bf16_f32 v162, v164, v165
    v_cvt_pk_bf16_f32 v163, v166, v167
    v_mfma_f32_16x16x32_bf16 v[200:203], v[216:219], a[72:75], v[200:203]
    buffer_store_dwordx4 v[160:163], v1, s[28:31], s52 offen sc1
    v_mfma_f32_16x16x32_bf16 v[200:203], v[220:223], a[88:91], v[200:203]
    v_mfma_f32_16x16x32_bf16 v[204:207], v[216:219], a[76:79], v[204:207]
    v_mfma_f32_16x16x32_bf16 v[204:207], v[220:223], a[92:95], v[204:207]
    s_waitcnt lgkmcnt(2)
    v_mfma_f32_16x16x32_bf16 v[192:195], v[224:227], a[96:99], v[192:195]
    s_waitcnt lgkmcnt(0)
    v_cvt_pk_bf16_f32 v168, v168, v169
    v_cvt_pk_bf16_f32 v169, v170, v171
    v_mfma_f32_16x16x32_bf16 v[192:195], v[228:231], a[112:115], v[192:195]
    s_add_u32 s52, s48, 15360
    v_cvt_pk_bf16_f32 v170, v172, v173
    v_cvt_pk_bf16_f32 v171, v174, v175
    v_mfma_f32_16x16x32_bf16 v[196:199], v[224:227], a[100:103], v[196:199]
    buffer_store_dwordx4 v[168:171], v1, s[28:31], s52 offen sc1
    v_mfma_f32_16x16x32_bf16 v[196:199], v[228:231], a[116:119], v[196:199]
    v_mfma_f32_16x16x32_bf16 v[200:203], v[224:227], a[104:107], v[200:203]
    v_mfma_f32_16x16x32_bf16 v[200:203], v[228:231], a[120:123], v[200:203]
    v_mfma_f32_16x16x32_bf16 v[204:207], v[224:227], a[108:111], v[204:207]
    v_cvt_pk_bf16_f32 v176, v176, v177
    v_cvt_pk_bf16_f32 v177, v178, v179
    v_mfma_f32_16x16x32_bf16 v[204:207], v[228:231], a[124:127], v[204:207]
    s_add_u32 s52, s48, 7168
    v_cvt_pk_bf16_f32 v178, v180, v181
    v_cvt_pk_bf16_f32 v179, v182, v183
    buffer_store_dwordx4 v[176:179], v1, s[28:31], s52 offen sc1
    v_cvt_pk_bf16_f32 v184, v184, v185
    v_cvt_pk_bf16_f32 v185, v186, v187
    s_add_u32 s52, s48, 16384
    v_cvt_pk_bf16_f32 v186, v188, v189
    v_cvt_pk_bf16_f32 v187, v190, v191
    buffer_store_dwordx4 v[184:187], v1, s[28:31], s52 offen sc1
    v_cvt_pk_bf16_f32 v192, v192, v193
    v_cvt_pk_bf16_f32 v193, v194, v195
    s_add_u32 s52, s48, 8192
    v_cvt_pk_bf16_f32 v194, v196, v197
    v_cvt_pk_bf16_f32 v195, v198, v199
    buffer_store_dwordx4 v[192:195], v1, s[28:31], s52 offen sc1
    v_cvt_pk_bf16_f32 v200, v200, v201
    v_cvt_pk_bf16_f32 v201, v202, v203
    s_add_u32 s52, s48, 17408
    v_cvt_pk_bf16_f32 v202, v204, v205
    v_cvt_pk_bf16_f32 v203, v206, v207
    buffer_store_dwordx4 v[200:203], v1, s[28:31], s52 offen sc1
    s_branch L_op_done
L_op_last2:
    s_waitcnt vmcnt(40) lgkmcnt(6)
    v_mfma_f32_16x16x32_bf16 v[64:67], v[208:211], a[128:131], v[64:67]
    s_waitcnt vmcnt(39) lgkmcnt(4)
    ds_read_b64_tr_b16 v[224:225], v31 offset:18432
    v_mfma_f32_16x16x32_bf16 v[64:67], v[212:215], a[144:147], v[64:67]
    s_waitcnt vmcnt(38)
    buffer_load_dwordx2 v[8:9], v2, s[64:67], s60 offen offset:0
    v_mfma_f32_16x16x32_bf16 v[68:71], v[208:211], a[132:135], v[68:71]
    s_waitcnt vmcnt(38)
    ds_read_b64_tr_b16 v[226:227], v31 offset:23040
    v_mfma_f32_16x16x32_bf16 v[68:71], v[212:215], a[148:151], v[68:71]
    s_waitcnt vmcnt(37)
    v_mfma_f32_16x16x32_bf16 v[72:75], v[208:211], a[136:139], v[72:75]
    s_waitcnt vmcnt(36)
    ds_read_b64_tr_b16 v[228:229], v31 offset:27648
    v_mfma_f32_16x16x32_bf16 v[72:75], v[212:215], a[152:155], v[72:75]
    s_waitcnt vmcnt(35)
    buffer_load_dwordx2 v[10:11], v2, s[64:67], s61 offen offset:0
    v_mfma_f32_16x16x32_bf16 v[76:79], v[208:211], a[140:143], v[76:79]
    s_waitcnt vmcnt(35)
    ds_read_b64_tr_b16 v[230:231], v31 offset:32256
    v_mfma_f32_16x16x32_bf16 v[76:79], v[212:215], a[156:159], v[76:79]
    s_waitcnt lgkmcnt(6)
    v_mfma_f32_16x16x32_bf16 v[80:83], v[216:219], a[128:131], v[80:83]
    s_waitcnt lgkmcnt(4)
    ds_read_b64_tr_b16 v[208:209], v31 offset:18464
    v_mfma_f32_16x16x32_bf16 v[80:83], v[220:223], a[144:147], v[80:83]
    buffer_load_dwordx2 v[12:13], v2, s[64:67], s60 offen offset:128
    v_mfma_f32_16x16x32_bf16 v[84:87], v[216:219], a[132:135], v[84:87]
    ds_read_b64_tr_b16 v[210:211], v31 offset:23072
    v_mfma_f32_16x16x32_bf16 v[84:87], v[220:223], a[148:151], v[84:87]
    v_mfma_f32_16x16x32_bf16 v[88:91], v[216:219], a[136:139], v[88:91]
    ds_read_b64_tr_b16 v[212:213], v31 offset:27680
    v_mfma_f32_16x16x32_bf16 v[88:91], v[220:223], a[152:155], v[88:91]
    buffer_load_dwordx2 v[14:15], v2, s[64:67], s61 offen offset:128
    v_mfma_f32_16x16x32_bf16 v[92:95], v[216:219], a[140:143], v[92:95]
    ds_read_b64_tr_b16 v[214:215], v31 offset:32288
    v_mfma_f32_16x16x32_bf16 v[92:95], v[220:223], a[156:159], v[92:95]
    s_waitcnt vmcnt(36) lgkmcnt(6)
    v_mfma_f32_16x16x32_bf16 v[64:67], v[224:227], a[160:163], v[64:67]
    s_waitcnt vmcnt(35) lgkmcnt(4)
    ds_read_b64_tr_b16 v[216:217], v31 offset:64
    v_mfma_f32_16x16x32_bf16 v[64:67], v[228:231], a[176:179], v[64:67]
    s_waitcnt vmcnt(34)
    buffer_load_dword v16, v2, s[64:67], s63 offen
    v_mfma_f32_16x16x32_bf16 v[68:71], v[224:227], a[164:167], v[68:71]
    s_waitcnt vmcnt(34)
    ds_read_b64_tr_b16 v[218:219], v31 offset:4672
    v_mfma_f32_16x16x32_bf16 v[68:71], v[228:231], a[180:183], v[68:71]
    s_waitcnt vmcnt(33)
    v_mfma_f32_16x16x32_bf16 v[72:75], v[224:227], a[168:171], v[72:75]
    s_waitcnt vmcnt(32)
    ds_read_b64_tr_b16 v[220:221], v31 offset:9280
    v_mfma_f32_16x16x32_bf16 v[72:75], v[228:231], a[184:187], v[72:75]
    s_waitcnt vmcnt(31)
    v_mfma_f32_16x16x32_bf16 v[76:79], v[224:227], a[172:175], v[76:79]
    s_waitcnt vmcnt(30)
    ds_read_b64_tr_b16 v[222:223], v31 offset:13888
    v_mfma_f32_16x16x32_bf16 v[76:79], v[228:231], a[188:191], v[76:79]
    s_waitcnt lgkmcnt(6)
    v_mfma_f32_16x16x32_bf16 v[80:83], v[208:211], a[160:163], v[80:83]
    s_waitcnt lgkmcnt(4)
    ds_read_b64_tr_b16 v[224:225], v31 offset:18496
    v_cvt_pk_bf16_f32 v64, v64, v65
    v_mfma_f32_16x16x32_bf16 v[80:83], v[212:215], a[176:179], v[80:83]
    v_cvt_pk_bf16_f32 v65, v66, v67
    v_cvt_pk_bf16_f32 v66, v68, v69
    v_mfma_f32_16x16x32_bf16 v[84:87], v[208:211], a[164:167], v[84:87]
    s_add_u32 s52, s48, 0
    ds_read_b64_tr_b16 v[226:227], v31 offset:23104
    v_cvt_pk_bf16_f32 v67, v70, v71
    v_mfma_f32_16x16x32_bf16 v[84:87], v[212:215], a[180:183], v[84:87]
    buffer_store_dwordx4 v[64:67], v1, s[28:31], s52 offen sc1
    v_mfma_f32_16x16x32_bf16 v[88:91], v[208:211], a[168:171], v[88:91]
    ds_read_b64_tr_b16 v[228:229], v31 offset:27712
    v_mfma_f32_16x16x32_bf16 v[88:91], v[212:215], a[184:187], v[88:91]
    v_mfma_f32_16x16x32_bf16 v[92:95], v[208:211], a[172:175], v[92:95]
    ds_read_b64_tr_b16 v[230:231], v31 offset:32320
    v_mfma_f32_16x16x32_bf16 v[92:95], v[212:215], a[188:191], v[92:95]
    s_waitcnt lgkmcnt(6)
    v_cvt_pk_bf16_f32 v72, v72, v73
    v_cvt_pk_bf16_f32 v73, v74, v75
    v_mfma_f32_16x16x32_bf16 v[96:99], v[216:219], a[128:131], v[96:99]
    s_waitcnt lgkmcnt(4)
    ds_read_b64_tr_b16 v[208:209], v31 offset:96
    v_cvt_pk_bf16_f32 v74, v76, v77
    v_mfma_f32_16x16x32_bf16 v[96:99], v[220:223], a[144:147], v[96:99]
    s_add_u32 s52, s48, 9216
    v_cvt_pk_bf16_f32 v75, v78, v79
    v_mfma_f32_16x16x32_bf16 v[100:103], v[216:219], a[132:135], v[100:103]
    ds_read_b64_tr_b16 v[210:211], v31 offset:4704
    v_mfma_f32_16x16x32_bf16 v[100:103], v[220:223], a[148:151], v[100:103]
    buffer_store_dwordx4 v[72:75], v1, s[28:31], s52 offen sc1
    v_mfma_f32_16x16x32_bf16 v[104:107], v[216:219], a[136:139], v[104:107]
    ds_read_b64_tr_b16 v[212:213], v31 offset:9312
    v_mfma_f32_16x16x32_bf16 v[104:107], v[220:223], a[152:155], v[104:107]
    v_mfma_f32_16x16x32_bf16 v[108:111], v[216:219], a[140:143], v[108:111]
    ds_read_b64_tr_b16 v[214:215], v31 offset:13920
    v_mfma_f32_16x16x32_bf16 v[108:111], v[220:223], a[156:159], v[108:111]
    s_waitcnt lgkmcnt(6)
    v_cvt_pk_bf16_f32 v80, v80, v81
    v_cvt_pk_bf16_f32 v81, v82, v83
    v_mfma_f32_16x16x32_bf16 v[96:99], v[224:227], a[160:163], v[96:99]
    s_waitcnt lgkmcnt(4)
    ds_read_b64_tr_b16 v[216:217], v31 offset:18528
    v_cvt_pk_bf16_f32 v82, v84, v85
    v_mfma_f32_16x16x32_bf16 v[96:99], v[228:231], a[176:179], v[96:99]
    s_add_u32 s52, s48, 1024
    v_cvt_pk_bf16_f32 v83, v86, v87
    v_mfma_f32_16x16x32_bf16 v[100:103], v[224:227], a[164:167], v[100:103]
    ds_read_b64_tr_b16 v[218:219], v31 offset:23136
    v_mfma_f32_16x16x32_bf16 v[100:103], v[228:231], a[180:183], v[100:103]
    buffer_store_dwordx4 v[80:83], v1, s[28:31], s52 offen sc1
    v_mfma_f32_16x16x32_bf16 v[104:107], v[224:227], a[168:171], v[104:107]
    ds_read_b64_tr_b16 v[220:221], v31 offset:27744
    v_mfma_f32_16x16x32_bf16 v[104:107], v[228:231], a[184:187], v[104:107]
    v_mfma_f32_16x16x32_bf16 v[108:111], v[224:227], a[172:175], v[108:111]
    ds_read_b64_tr_b16 v[222:223], v31 offset:32352
    v_mfma_f32_16x16x32_bf16 v[108:111], v[228:231], a[188:191], v[108:111]
    s_waitcnt lgkmcnt(6)
    v_cvt_pk_bf16_f32 v88, v88, v89
    v_cvt_pk_bf16_f32 v89, v90, v91
    v_mfma_f32_16x16x32_bf16 v[112:115], v[208:211], a[128:131], v[112:115]
    s_waitcnt lgkmcnt(4)
    ds_read_b64_tr_b16 v[224:225], v31 offset:128
    v_cvt_pk_bf16_f32 v90, v92, v93
    v_mfma_f32_16x16x32_bf16 v[112:115], v[212:215], a[144:147], v[112:115]
    s_add_u32 s52, s48, 10240
    v_cvt_pk_bf16_f32 v91, v94, v95
    v_mfma_f32_16x16x32_bf16 v[116:119], v[208:211], a[132:135], v[116:119]
    ds_read_b64_tr_b16 v[226:227], v31 offset:4736
    v_mfma_f32_16x16x32_bf16 v[116:119], v[212:215], a[148:151], v[116:119]
    buffer_store_dwordx4 v[88:91], v1, s[28:31], s52 offen sc1
    v_mfma_f32_16x16x32_bf16 v[120:123], v[208:211], a[136:139], v[120:123]
    ds_read_b64_tr_b16 v[228:229], v31 offset:9344
    v_mfma_f32_16x16x32_bf16 v[120:123], v[212:215], a[152:155], v[120:123]
    v_mfma_f32_16x16x32_bf16 v[124:127], v[208:211], a[140:143], v[124:127]
    ds_read_b64_tr_b16 v[230:231], v31 offset:13952
    v_mfma_f32_16x16x32_bf16 v[124:127], v[212:215], a[156:159], v[124:127]
    s_waitcnt lgkmcnt(6)
    v_cvt_pk_bf16_f32 v96, v96, v97
    v_cvt_pk_bf16_f32 v97, v98, v99
    v_mfma_f32_16x16x32_bf16 v[112:115], v[216:219], a[160:163], v[112:115]
    s_waitcnt lgkmcnt(4)
    ds_read_b64_tr_b16 v[208:209], v31 offset:18560
    v_cvt_pk_bf16_f32 v98, v100, v101
    v_mfma_f32_16x16x32_bf16 v[112:115], v[220:223], a[176:179], v[112:115]
    s_add_u32 s52, s48, 2048
    v_cvt_pk_bf16_f32 v99, v102, v103
    v_mfma_f32_16x16x32_bf16 v[116:119], v[216:219], a[164:167], v[116:119]
    ds_read_b64_tr_b16 v[210:211], v31 offset:23168
    v_mfma_f32_16x16x32_bf16 v[116:119], v[220:223], a[180:183], v[116:119]
    buffer_store_dwordx4 v[96:99], v1, s[28:31], s52 offen sc1
    v_mfma_f32_16x16x32_bf16 v[120:123], v[216:219], a[168:171], v[120:123]
    ds_read_b64_tr_b16 v[212:213], v31 offset:27776
    v_mfma_f32_16x16x32_bf16 v[120:123], v[220:223], a[184:187], v[120:123]
    v_mfma_f32_16x16x32_bf16 v[124:127], v[216:219], a[172:175], v[124:127]
    ds_read_b64_tr_b16 v[214:215], v31 offset:32384
    v_mfma_f32_16x16x32_bf16 v[124:127], v[220:223], a[188:191], v[124:127]
    s_waitcnt lgkmcnt(6)
    v_cvt_pk_bf16_f32 v104, v104, v105
    v_cvt_pk_bf16_f32 v105, v106, v107
    v_mfma_f32_16x16x32_bf16 v[128:131], v[224:227], a[128:131], v[128:131]
    s_waitcnt lgkmcnt(4)
    ds_read_b64_tr_b16 v[216:217], v31 offset:160
    v_cvt_pk_bf16_f32 v106, v108, v109
    v_mfma_f32_16x16x32_bf16 v[128:131], v[228:231], a[144:147], v[128:131]
    s_add_u32 s52, s48, 11264
    v_cvt_pk_bf16_f32 v107, v110, v111
    v_mfma_f32_16x16x32_bf16 v[132:135], v[224:227], a[132:135], v[132:135]
    ds_read_b64_tr_b16 v[218:219], v31 offset:4768
    v_mfma_f32_16x16x32_bf16 v[132:135], v[228:231], a[148:151], v[132:135]
    buffer_store_dwordx4 v[104:107], v1, s[28:31], s52 offen sc1
    v_mfma_f32_16x16x32_bf16 v[136:139], v[224:227], a[136:139], v[136:139]
    ds_read_b64_tr_b16 v[220:221], v31 offset:9376
    v_mfma_f32_16x16x32_bf16 v[136:139], v[228:231], a[152:155], v[136:139]
    v_mfma_f32_16x16x32_bf16 v[140:143], v[224:227], a[140:143], v[140:143]
    ds_read_b64_tr_b16 v[222:223], v31 offset:13984
    v_mfma_f32_16x16x32_bf16 v[140:143], v[228:231], a[156:159], v[140:143]
    s_waitcnt lgkmcnt(6)
    v_cvt_pk_bf16_f32 v112, v112, v113
    v_cvt_pk_bf16_f32 v113, v114, v115
    v_mfma_f32_16x16x32_bf16 v[128:131], v[208:211], a[160:163], v[128:131]
    s_waitcnt lgkmcnt(4)
    ds_read_b64_tr_b16 v[224:225], v31 offset:18592
    v_cvt_pk_bf16_f32 v114, v116, v117
    v_mfma_f32_16x16x32_bf16 v[128:131], v[212:215], a[176:179], v[128:131]
    s_add_u32 s52, s48, 3072
    v_cvt_pk_bf16_f32 v115, v118, v119
    v_mfma_f32_16x16x32_bf16 v[132:135], v[208:211], a[164:167], v[132:135]
    ds_read_b64_tr_b16 v[226:227], v31 offset:23200
    v_mfma_f32_16x16x32_bf16 v[132:135], v[212:215], a[180:183], v[132:135]
    buffer_store_dwordx4 v[112:115], v1, s[28:31], s52 offen sc1
    v_mfma_f32_16x16x32_bf16 v[136:139], v[208:211], a[168:171], v[136:139]
    ds_read_b64_tr_b16 v[228:229], v31 offset:27808
    v_mfma_f32_16x16x32_bf16 v[136:139], v[212:215], a[184:187], v[136:139]
    v_mfma_f32_16x16x32_bf16 v[140:143], v[208:211], a[172:175], v[140:143]
    ds_read_b64_tr_b16 v[230:231], v31 offset:32416
    v_mfma_f32_16x16x32_bf16 v[140:143], v[212:215], a[188:191], v[140:143]
    s_waitcnt lgkmcnt(6)
    v_cvt_pk_bf16_f32 v120, v120, v121
    v_cvt_pk_bf16_f32 v121, v122, v123
    v_mfma_f32_16x16x32_bf16 v[144:147], v[216:219], a[128:131], v[144:147]
    s_waitcnt lgkmcnt(4)
    ds_read_b64_tr_b16 v[208:209], v31 offset:192
    v_cvt_pk_bf16_f32 v122, v124, v125
    v_mfma_f32_16x16x32_bf16 v[144:147], v[220:223], a[144:147], v[144:147]
    s_add_u32 s52, s48, 12288
    v_cvt_pk_bf16_f32 v123, v126, v127
    v_mfma_f32_16x16x32_bf16 v[148:151], v[216:219], a[132:135], v[148:151]
    ds_read_b64_tr_b16 v[210:211], v31 offset:4800
    v_mfma_f32_16x16x32_bf16 v[148:151], v[220:223], a[148:151], v[148:151]
    buffer_store_dwordx4 v[120:123], v1, s[28:31], s52 offen sc1
    v_mfma_f32_16x16x32_bf16 v[152:155], v[216:219], a[136:139], v[152:155]
    ds_read_b64_tr_b16 v[212:213], v31 offset:9408
    v_mfma_f32_16x16x32_bf16 v[152:155], v[220:223], a[152:155], v[152:155]
    v_mfma_f32_16x16x32_bf16 v[156:159], v[216:219], a[140:143], v[156:159]
    ds_read_b64_tr_b16 v[214:215], v31 offset:14016
    v_mfma_f32_16x16x32_bf16 v[156:159], v[220:223], a[156:159], v[156:159]
    s_waitcnt lgkmcnt(6)
    v_cvt_pk_bf16_f32 v128, v128, v129
    v_cvt_pk_bf16_f32 v129, v130, v131
    v_mfma_f32_16x16x32_bf16 v[144:147], v[224:227], a[160:163], v[144:147]
    s_waitcnt lgkmcnt(4)
    ds_read_b64_tr_b16 v[216:217], v31 offset:18624
    v_cvt_pk_bf16_f32 v130, v132, v133
    v_mfma_f32_16x16x32_bf16 v[144:147], v[228:231], a[176:179], v[144:147]
    s_add_u32 s52, s48, 4096
    v_cvt_pk_bf16_f32 v131, v134, v135
    v_mfma_f32_16x16x32_bf16 v[148:151], v[224:227], a[164:167], v[148:151]
    ds_read_b64_tr_b16 v[218:219], v31 offset:23232
    v_mfma_f32_16x16x32_bf16 v[148:151], v[228:231], a[180:183], v[148:151]
    buffer_store_dwordx4 v[128:131], v1, s[28:31], s52 offen sc1
    v_mfma_f32_16x16x32_bf16 v[152:155], v[224:227], a[168:171], v[152:155]
    ds_read_b64_tr_b16 v[220:221], v31 offset:27840
    v_mfma_f32_16x16x32_bf16 v[152:155], v[228:231], a[184:187], v[152:155]
    v_mfma_f32_16x16x32_bf16 v[156:159], v[224:227], a[172:175], v[156:159]
    ds_read_b64_tr_b16 v[222:223], v31 offset:32448
    v_mfma_f32_16x16x32_bf16 v[156:159], v[228:231], a[188:191], v[156:159]
    s_waitcnt lgkmcnt(6)
    v_cvt_pk_bf16_f32 v136, v136, v137
    v_cvt_pk_bf16_f32 v137, v138, v139
    v_mfma_f32_16x16x32_bf16 v[160:163], v[208:211], a[128:131], v[160:163]
    s_waitcnt lgkmcnt(4)
    ds_read_b64_tr_b16 v[224:225], v31 offset:224
    v_cvt_pk_bf16_f32 v138, v140, v141
    v_mfma_f32_16x16x32_bf16 v[160:163], v[212:215], a[144:147], v[160:163]
    s_add_u32 s52, s48, 13312
    v_cvt_pk_bf16_f32 v139, v142, v143
    v_mfma_f32_16x16x32_bf16 v[164:167], v[208:211], a[132:135], v[164:167]
    ds_read_b64_tr_b16 v[226:227], v31 offset:4832
    v_mfma_f32_16x16x32_bf16 v[164:167], v[212:215], a[148:151], v[164:167]
    buffer_store_dwordx4 v[136:139], v1, s[28:31], s52 offen sc1
    v_mfma_f32_16x16x32_bf16 v[168:171], v[208:211], a[136:139], v[168:171]
    ds_read_b64_tr_b16 v[228:229], v31 offset:9440
    v_mfma_f32_16x16x32_bf16 v[168:171], v[212:215], a[152:155], v[168:171]
    v_mfma_f32_16x16x32_bf16 v[172:175], v[208:211], a[140:143], v[172:175]
    ds_read_b64_tr_b16 v[230:231], v31 offset:14048
    v_mfma_f32_16x16x32_bf16 v[172:175], v[212:215], a[156:159], v[172:175]
    s_waitcnt lgkmcnt(6)
    v_cvt_pk_bf16_f32 v144, v144, v145
    v_cvt_pk_bf16_f32 v145, v146, v147
    v_mfma_f32_16x16x32_bf16 v[160:163], v[216:219], a[160:163], v[160:163]
    s_waitcnt lgkmcnt(4)
    ds_read_b64_tr_b16 v[208:209], v31 offset:18656
    v_cvt_pk_bf16_f32 v146, v148, v149
    v_mfma_f32_16x16x32_bf16 v[160:163], v[220:223], a[176:179], v[160:163]
    s_add_u32 s52, s48, 5120
    v_cvt_pk_bf16_f32 v147, v150, v151
    v_mfma_f32_16x16x32_bf16 v[164:167], v[216:219], a[164:167], v[164:167]
    ds_read_b64_tr_b16 v[210:211], v31 offset:23264
    v_mfma_f32_16x16x32_bf16 v[164:167], v[220:223], a[180:183], v[164:167]
    buffer_store_dwordx4 v[144:147], v1, s[28:31], s52 offen sc1
    v_mfma_f32_16x16x32_bf16 v[168:171], v[216:219], a[168:171], v[168:171]
    ds_read_b64_tr_b16 v[212:213], v31 offset:27872
    v_mfma_f32_16x16x32_bf16 v[168:171], v[220:223], a[184:187], v[168:171]
    v_mfma_f32_16x16x32_bf16 v[172:175], v[216:219], a[172:175], v[172:175]
    s_waitcnt vmcnt(15)
    ds_read_b64_tr_b16 v[214:215], v31 offset:32480
    v_lshlrev_b32 v232, 16, v8
    v_mfma_f32_16x16x32_bf16 v[172:175], v[220:223], a[188:191], v[172:175]
    s_waitcnt lgkmcnt(6)
    v_and_b32 v233, 0xffff0000, v8
    v_lshlrev_b32 v234, 16, v9
    v_mfma_f32_16x16x32_bf16 v[176:179], v[224:227], a[128:131], v[176:179]
    s_waitcnt lgkmcnt(4)
    ds_read_b64_tr_b16 v[216:217], v31 offset:256
    v_and_b32 v235, 0xffff0000, v9
    v_mfma_f32_16x16x32_bf16 v[176:179], v[228:231], a[144:147], v[176:179]
    s_waitcnt vmcnt(14)
    v_lshlrev_b32 v236, 16, v10
    v_and_b32 v237, 0xffff0000, v10
    v_mfma_f32_16x16x32_bf16 v[180:183], v[224:227], a[132:135], v[180:183]
    ds_read_b64_tr_b16 v[218:219], v31 offset:4864
    v_lshlrev_b32 v238, 16, v11
    v_mfma_f32_16x16x32_bf16 v[180:183], v[228:231], a[148:151], v[180:183]
    s_waitcnt vmcnt(13)
    v_and_b32 v239, 0xffff0000, v11
    v_lshlrev_b32 v240, 16, v12
    v_mfma_f32_16x16x32_bf16 v[184:187], v[224:227], a[136:139], v[184:187]
    ds_read_b64_tr_b16 v[220:221], v31 offset:9472
    v_and_b32 v241, 0xffff0000, v12
    v_mfma_f32_16x16x32_bf16 v[184:187], v[228:231], a[152:155], v[184:187]
    v_lshlrev_b32 v242, 16, v13
    v_and_b32 v243, 0xffff0000, v13
    v_mfma_f32_16x16x32_bf16 v[188:191], v[224:227], a[140:143], v[188:191]
    s_waitcnt vmcnt(12)
    ds_read_b64_tr_b16 v[222:223], v31 offset:14080
    v_lshlrev_b32 v244, 16, v14
    v_mfma_f32_16x16x32_bf16 v[188:191], v[228:231], a[156:159], v[188:191]
    s_waitcnt lgkmcnt(6)
    v_and_b32 v245, 0xffff0000, v14
    v_lshlrev_b32 v246, 16, v15
    v_mfma_f32_16x16x32_bf16 v[176:179], v[208:211], a[160:163], v[176:179]
    s_waitcnt lgkmcnt(4)
    ds_read_b64_tr_b16 v[224:225], v31 offset:18688
    v_and_b32 v247, 0xffff0000, v15
    v_mfma_f32_16x16x32_bf16 v[176:179], v[212:215], a[176:179], v[176:179]
    s_waitcnt vmcnt(11)
    ds_read_b64_tr_b16 v[226:227], v31 offset:23296
    v_lshlrev_b32 v248, 16, v16
    v_mfma_f32_16x16x32_bf16 v[180:183], v[208:211], a[164:167], v[180:183]
    ds_read_b64_tr_b16 v[228:229], v31 offset:27904
    v_and_b32 v249, 0xffff0000, v16
    v_mfma_f32_16x16x32_bf16 v[180:183], v[212:215], a[180:183], v[180:183]
    ds_read_b64_tr_b16 v[230:231], v31 offset:32512
    v_cvt_pk_bf16_f32 v152, v152, v153
    v_mfma_f32_16x16x32_bf16 v[184:187], v[208:211], a[168:171], v[184:187]
    v_cvt_pk_bf16_f32 v153, v154, v155
    v_cvt_pk_bf16_f32 v154, v156, v157
    v_mfma_f32_16x16x32_bf16 v[184:187], v[212:215], a[184:187], v[184:187]
    s_add_u32 s52, s48, 14336
    v_cvt_pk_bf16_f32 v155, v158, v159
    v_mfma_f32_16x16x32_bf16 v[188:191], v[208:211], a[172:175], v[188:191]
    buffer_store_dwordx4 v[152:155], v1, s[28:31], s52 offen sc1
    v_mfma_f32_16x16x32_bf16 v[188:191], v[212:215], a[188:191], v[188:191]
    s_waitcnt lgkmcnt(6)
    v_mfma_f32_16x16x32_bf16 v[192:195], v[216:219], a[128:131], v[192:195]
    s_waitcnt lgkmcnt(4)
    v_mfma_f32_16x16x32_bf16 v[192:195], v[220:223], a[144:147], v[192:195]
    buffer_load_dword v253, off, s[72:75], s55 sc1
    v_mfma_f32_16x16x32_bf16 v[196:199], v[216:219], a[132:135], v[196:199]
    v_cvt_pk_bf16_f32 v160, v160, v161
    v_cvt_pk_bf16_f32 v161, v162, v163
    v_mfma_f32_16x16x32_bf16 v[196:199], v[220:223], a[148:151], v[196:199]
    s_add_u32 s52, s48, 6144
    v_cvt_pk_bf16_f32 v162, v164, v165
    v_cvt_pk_bf16_f32 v163, v166, v167
    v_mfma_f32_16x16x32_bf16 v[200:203], v[216:219], a[136:139], v[200:203]
    buffer_store_dwordx4 v[160:163], v1, s[28:31], s52 offen sc1
    v_mfma_f32_16x16x32_bf16 v[200:203], v[220:223], a[152:155], v[200:203]
    v_mfma_f32_16x16x32_bf16 v[204:207], v[216:219], a[140:143], v[204:207]
    v_mfma_f32_16x16x32_bf16 v[204:207], v[220:223], a[156:159], v[204:207]
    s_waitcnt lgkmcnt(2)
    v_mfma_f32_16x16x32_bf16 v[192:195], v[224:227], a[160:163], v[192:195]
    s_waitcnt lgkmcnt(0)
    v_cvt_pk_bf16_f32 v168, v168, v169
    v_cvt_pk_bf16_f32 v169, v170, v171
    v_mfma_f32_16x16x32_bf16 v[192:195], v[228:231], a[176:179], v[192:195]
    s_add_u32 s52, s48, 15360
    v_cvt_pk_bf16_f32 v170, v172, v173
    v_cvt_pk_bf16_f32 v171, v174, v175
    v_mfma_f32_16x16x32_bf16 v[196:199], v[224:227], a[164:167], v[196:199]
    buffer_store_dwordx4 v[168:171], v1, s[28:31], s52 offen sc1
    v_mfma_f32_16x16x32_bf16 v[196:199], v[228:231], a[180:183], v[196:199]
    v_mfma_f32_16x16x32_bf16 v[200:203], v[224:227], a[168:171], v[200:203]
    v_mfma_f32_16x16x32_bf16 v[200:203], v[228:231], a[184:187], v[200:203]
    v_mfma_f32_16x16x32_bf16 v[204:207], v[224:227], a[172:175], v[204:207]
    v_cvt_pk_bf16_f32 v176, v176, v177
    v_cvt_pk_bf16_f32 v177, v178, v179
    v_mfma_f32_16x16x32_bf16 v[204:207], v[228:231], a[188:191], v[204:207]
    s_add_u32 s52, s48, 7168
    v_cvt_pk_bf16_f32 v178, v180, v181
    v_cvt_pk_bf16_f32 v179, v182, v183
    buffer_store_dwordx4 v[176:179], v1, s[28:31], s52 offen sc1
    v_cvt_pk_bf16_f32 v184, v184, v185
    v_cvt_pk_bf16_f32 v185, v186, v187
    s_add_u32 s52, s48, 16384
    v_cvt_pk_bf16_f32 v186, v188, v189
    v_cvt_pk_bf16_f32 v187, v190, v191
    buffer_store_dwordx4 v[184:187], v1, s[28:31], s52 offen sc1
    v_cvt_pk_bf16_f32 v192, v192, v193
    v_cvt_pk_bf16_f32 v193, v194, v195
    s_add_u32 s52, s48, 8192
    v_cvt_pk_bf16_f32 v194, v196, v197
    v_cvt_pk_bf16_f32 v195, v198, v199
    buffer_store_dwordx4 v[192:195], v1, s[28:31], s52 offen sc1
    v_cvt_pk_bf16_f32 v200, v200, v201
    v_cvt_pk_bf16_f32 v201, v202, v203
    s_add_u32 s52, s48, 17408
    v_cvt_pk_bf16_f32 v202, v204, v205
    v_cvt_pk_bf16_f32 v203, v206, v207
    buffer_store_dwordx4 v[200:203], v1, s[28:31], s52 offen sc1
L_op_done:
    v_mov_b32 v32, 0
    v_mov_b32 v33, 0
    v_mov_b32 v34, 0
    v_mov_b32 v35, 0
    v_mov_b32 v36, 0
    v_mov_b32 v37, 0
    v_mov_b32 v38, 0
    v_mov_b32 v39, 0
    v_mov_b32 v40, 0
    v_mov_b32 v41, 0
    v_mov_b32 v42, 0
    v_mov_b32 v43, 0
    v_mov_b32 v44, 0
    v_mov_b32 v45, 0
    v_mov_b32 v46, 0
    v_mov_b32 v47, 0
    v_mov_b32 v48, 0
    v_mov_b32 v49, 0
    v_mov_b32 v208, 0
    v_mov_b32 v209, 0
    v_mov_b32 v210, 0
    v_mov_b32 v211, 0
    v_mov_b32 v212, 0
    v_mov_b32 v213, 0
    v_mov_b32 v214, 0
    v_mov_b32 v215, 0
    v_mov_b32 v216, 0
    v_mov_b32 v217, 0
    v_mov_b32 v218, 0
    v_mov_b32 v219, 0
    v_mov_b32 v220, 0
    v_mov_b32 v221, 0
    v_mov_b32 v222, 0
    v_mov_b32 v223, 0
    v_mov_b32 v224, 0
    v_mov_b32 v225, 0
    v_mov_b32 v4, 0x00003f80
    v_mov_b32 v5, 0x3f800000
    s_mov_b32 s46, 0
    s_mov_b32 s47, 0
    s_mov_b32 s53, 0x10000
    s_lshl_b32 s52, 1, s7
    v_mov_b32 v252, s52
    s_cmp_eq_u32 s3, 0
    s_cselect_b32 s52, 0, 0x40000000
    s_or_b32 s52, s52, s55
    s_waitcnt vmcnt(0)
    s_barrier
    s_mov_b64 exec, 1
    buffer_atomic_or v252, off, s[72:75], s52 sc1
    s_mov_b64 exec, -1
    v_or_b32 v253, v253, v252
    s_branch L_cb_first
L_cb_loop:
    buffer_load_dword v253, off, s[72:75], s55 sc1
L_cb_last:
    s_waitcnt vmcnt(0)
L_cb_first:
    v_readfirstlane_b32 s54, v253
    s_sub_u32 s53, s53, 1
    s_cselect_b32 s54, 0xff, s54
    s_andn2_b32 s54, s54, s46
    s_bitcmp1_b32 s54, 0
    s_cbranch_scc0 L_cb_n0
    s_add_u32 s52, s49, 0
    s_add_u32 s44, s49, 4096
    s_add_u32 s43, s50, 0
    buffer_load_dwordx4 v[64:67], v1, s[28:31], s52 offen sc1
    buffer_load_dwordx4 v[68:71], v1, s[28:31], s44 offen sc1
    buffer_load_dword v72, v1, s[28:31], s43 offen sc1
L_cb_n0:
    s_bitcmp1_b32 s54, 1
    s_cbranch_scc0 L_cb_n1
    s_add_u32 s52, s49, 2359296
    s_add_u32 s44, s49, 2363392
    s_add_u32 s43, s50, 2359296
    buffer_load_dwordx4 v[76:79], v1, s[28:31], s52 offen sc1
    buffer_load_dwordx4 v[80:83], v1, s[28:31], s44 offen sc1
    buffer_load_dword v84, v1, s[28:31], s43 offen sc1
L_cb_n1:
    s_bitcmp1_b32 s54, 2
    s_cbranch_scc0 L_cb_n2
    s_add_u32 s52, s49, 4718592
    s_add_u32 s44, s49, 4722688
    s_add_u32 s43, s50, 4718592
    buffer_load_dwordx4 v[88:91], v1, s[28:31], s52 offen sc1
    buffer_load_dwordx4 v[92:95], v1, s[28:31], s44 offen sc1
    buffer_load_dword v96, v1, s[28:31], s43 offen sc1
L_cb_n2:
    s_bitcmp1_b32 s54, 3
    s_cbranch_scc0 L_cb_n3
    s_add_u32 s52, s49, 7077888
    s_add_u32 s44, s49, 7081984
    s_add_u32 s43, s50, 7077888
    buffer_load_dwordx4 v[100:103], v1, s[28:31], s52 offen sc1
    buffer_load_dwordx4 v[104:107], v1, s[28:31], s44 offen sc1
    buffer_load_dword v108, v1, s[28:31], s43 offen sc1
L_cb_n3:
    s_bitcmp1_b32 s54, 4
    s_cbranch_scc0 L_cb_n4
    s_add_u32 s52, s49, 9437184
    s_add_u32 s44, s49, 9441280
    s_add_u32 s43, s50, 9437184
    buffer_load_dwordx4 v[112:115], v1, s[28:31], s52 offen sc1
    buffer_load_dwordx4 v[116:119], v1, s[28:31], s44 offen sc1
    buffer_load_dword v120, v1, s[28:31], s43 offen sc1
L_cb_n4:
    s_bitcmp1_b32 s54, 5
    s_cbranch_scc0 L_cb_n5
    s_add_u32 s52, s49, 11796480
    s_add_u32 s44, s49, 11800576
    s_add_u32 s43, s50, 11796480
    buffer_load_dwordx4 v[124:127], v1, s[28:31], s52 offen sc1
    buffer_load_dwordx4 v[128:131], v1, s[28:31], s44 offen sc1
    buffer_load_dword v132, v1, s[28:31], s43 offen sc1
L_cb_n5:
    s_bitcmp1_b32 s54, 6
    s_cbranch_scc0 L_cb_n6
    s_add_u32 s52, s49, 14155776
    s_add_u32 s44, s49, 14159872
    s_add_u32 s43, s50, 14155776
    buffer_load_dwordx4 v[136:139], v1, s[28:31], s52 offen sc1
    buffer_load_dwordx4 v[140:143], v1, s[28:31], s44 offen sc1
    buffer_load_dword v144, v1, s[28:31], s43 offen sc1
L_cb_n6:
    s_bitcmp1_b32 s54, 7
    s_cbranch_scc0 L_cb_n7
    s_add_u32 s52, s49, 16515072
    s_add_u32 s44, s49, 16519168
    s_add_u32 s43, s50, 16515072
    buffer_load_dwordx4 v[148:151], v1, s[28:31], s52 offen sc1
    buffer_load_dwordx4 v[152:155], v1, s[28:31], s44 offen sc1
    buffer_load_dword v156, v1, s[28:31], s43 offen sc1
L_cb_n7:
    s_bitcmp1_b32 s47, 0
    s_cbranch_scc0 L_cb_a0
    v_dot2c_f32_bf16 v208, v64, v4
    v_dot2c_f32_bf16 v209, v64, v5
    v_dot2c_f32_bf16 v210, v65, v4
    v_dot2c_f32_bf16 v211, v65, v5
    v_dot2c_f32_bf16 v212, v66, v4
    v_dot2c_f32_bf16 v213, v66, v5
    v_dot2c_f32_bf16 v214, v67, v4
    v_dot2c_f32_bf16 v215, v67, v5
    v_dot2c_f32_bf16 v216, v68, v4
    v_dot2c_f32_bf16 v217, v68, v5
    v_dot2c_f32_bf16 v218, v69, v4
    v_dot2c_f32_bf16 v219, v69, v5
    v_dot2c_f32_bf16 v220, v70, v4
    v_dot2c_f32_bf16 v221, v70, v5
    v_dot2c_f32_bf16 v222, v71, v4
    v_dot2c_f32_bf16 v223, v71, v5
    v_dot2c_f32_bf16 v224, v72, v4
    v_dot2c_f32_bf16 v225, v72, v5
L_cb_a0:
    s_bitcmp1_b32 s47, 1
    s_cbranch_scc0 L_cb_a1
    v_dot2c_f32_bf16 v208, v76, v4
    v_dot2c_f32_bf16 v209, v76, v5
    v_dot2c_f32_bf16 v210, v77, v4
    v_dot2c_f32_bf16 v211, v77, v5
    v_dot2c_f32_bf16 v212, v78, v4
    v_dot2c_f32_bf16 v213, v78, v5
    v_dot2c_f32_bf16 v214, v79, v4
    v_dot2c_f32_bf16 v215, v79, v5
    v_dot2c_f32_bf16 v216, v80, v4
    v_dot2c_f32_bf16 v217, v80, v5
    v_dot2c_f32_bf16 v218, v81, v4
    v_dot2c_f32_bf16 v219, v81, v5
    v_dot2c_f32_bf16 v220, v82, v4
    v_dot2c_f32_bf16 v221, v82, v5
    v_dot2c_f32_bf16 v222, v83, v4
    v_dot2c_f32_bf16 v223, v83, v5
    v_dot2c_f32_bf16 v224, v84, v4
    v_dot2c_f32_bf16 v225, v84, v5
L_cb_a1:
    s_bitcmp1_b32 s47, 2
    s_cbranch_scc0 L_cb_a2
    v_dot2c_f32_bf16 v208, v88, v4
    v_dot2c_f32_bf16 v209, v88, v5
    v_dot2c_f32_bf16 v210, v89, v4
    v_dot2c_f32_bf16 v211, v89, v5
    v_dot2c_f32_bf16 v212, v90, v4
    v_dot2c_f32_bf16 v213, v90, v5
    v_dot2c_f32_bf16 v214, v91, v4
    v_dot2c_f32_bf16 v215, v91, v5
    v_dot2c_f32_bf16 v216, v92, v4
    v_dot2c_f32_bf16 v217, v92, v5
    v_dot2c_f32_bf16 v218, v93, v4
    v_dot2c_f32_bf16 v219, v93, v5
    v_dot2c_f32_bf16 v220, v94, v4
    v_dot2c_f32_bf16 v221, v94, v5
    v_dot2c_f32_bf16 v222, v95, v4
    v_dot2c_f32_bf16 v223, v95, v5
    v_dot2c_f32_bf16 v224, v96, v4
    v_dot2c_f32_bf16 v225, v96, v5
L_cb_a2:
    s_bitcmp1_b32 s47, 3
    s_cbranch_scc0 L_cb_a3
    v_dot2c_f32_bf16 v208, v100, v4
    v_dot2c_f32_bf16 v209, v100, v5
    v_dot2c_f32_bf16 v210, v101, v4
    v_dot2c_f32_bf16 v211, v101, v5
    v_dot2c_f32_bf16 v212, v102, v4
    v_dot2c_f32_bf16 v213, v102, v5
    v_dot2c_f32_bf16 v214, v103, v4
    v_dot2c_f32_bf16 v215, v103, v5
    v_dot2c_f32_bf16 v216, v104, v4
    v_dot2c_f32_bf16 v217, v104, v5
    v_dot2c_f32_bf16 v218, v105, v4
    v_dot2c_f32_bf16 v219, v105, v5
    v_dot2c_f32_bf16 v220, v106, v4
    v_dot2c_f32_bf16 v221, v106, v5
    v_dot2c_f32_bf16 v222, v107, v4
    v_dot2c_f32_bf16 v223, v107, v5
    v_dot2c_f32_bf16 v224, v108, v4
    v_dot2c_f32_bf16 v225, v108, v5
L_cb_a3:
    s_bitcmp1_b32 s47, 4
    s_cbranch_scc0 L_cb_a4
    v_dot2c_f32_bf16 v32, v112, v4
    v_dot2c_f32_bf16 v33, v112, v5
    v_dot2c_f32_bf16 v34, v113, v4
    v_dot2c_f32_bf16 v35, v113, v5
    v_dot2c_f32_bf16 v36, v114, v4
    v_dot2c_f32_bf16 v37, v114, v5
    v_dot2c_f32_bf16 v38, v115, v4
    v_dot2c_f32_bf16 v39, v115, v5
    v_dot2c_f32_bf16 v40, v116, v4
    v_dot2c_f32_bf16 v41, v116, v5
    v_dot2c_f32_bf16 v42, v117, v4
    v_dot2c_f32_bf16 v43, v117, v5
    v_dot2c_f32_bf16 v44, v118, v4
    v_dot2c_f32_bf16 v45, v118, v5
    v_dot2c_f32_bf16 v46, v119, v4
    v_dot2c_f32_bf16 v47, v119, v5
    v_dot2c_f32_bf16 v48, v120, v4
    v_dot2c_f32_bf16 v49, v120, v5
L_cb_a4:
    s_bitcmp1_b32 s47, 5
    s_cbranch_scc0 L_cb_a5
    v_dot2c_f32_bf16 v32, v124, v4
    v_dot2c_f32_bf16 v33, v124, v5
    v_dot2c_f32_bf16 v34, v125, v4
    v_dot2c_f32_bf16 v35, v125, v5
    v_dot2c_f32_bf16 v36, v126, v4
    v_dot2c_f32_bf16 v37, v126, v5
    v_dot2c_f32_bf16 v38, v127, v4
    v_dot2c_f32_bf16 v39, v127, v5
    v_dot2c_f32_bf16 v40, v128, v4
    v_dot2c_f32_bf16 v41, v128, v5
    v_dot2c_f32_bf16 v42, v129, v4
    v_dot2c_f32_bf16 v43, v129, v5
    v_dot2c_f32_bf16 v44, v130, v4
    v_dot2c_f32_bf16 v45, v130, v5
    v_dot2c_f32_bf16 v46, v131, v4
    v_dot2c_f32_bf16 v47, v131, v5
    v_dot2c_f32_bf16 v48, v132, v4
    v_dot2c_f32_bf16 v49, v132, v5
L_cb_a5:
    s_bitcmp1_b32 s47, 6
    s_cbranch_scc0 L_cb_a6
    v_dot2c_f32_bf16 v32, v136, v4
    v_dot2c_f32_bf16 v33, v136, v5
    v_dot2c_f32_bf16 v34, v137, v4
    v_dot2c_f32_bf16 v35, v137, v5
    v_dot2c_f32_bf16 v36, v138, v4
    v_dot2c_f32_bf16 v37, v138, v5
    v_dot2c_f32_bf16 v38, v139, v4
    v_dot2c_f32_bf16 v39, v139, v5
    v_dot2c_f32_bf16 v40, v140, v4
    v_dot2c_f32_bf16 v41, v140, v5
    v_dot2c_f32_bf16 v42, v141, v4
    v_dot2c_f32_bf16 v43, v141, v5
    v_dot2c_f32_bf16 v44, v142, v4
    v_dot2c_f32_bf16 v45, v142, v5
    v_dot2c_f32_bf16 v46, v143, v4
    v_dot2c_f32_bf16 v47, v143, v5
    v_dot2c_f32_bf16 v48, v144, v4
    v_dot2c_f32_bf16 v49, v144, v5
L_cb_a6:
    s_bitcmp1_b32 s47, 7
    s_cbranch_scc0 L_cb_a7
    v_dot2c_f32_bf16 v32, v148, v4
    v_dot2c_f32_bf16 v33, v148, v5
    v_dot2c_f32_bf16 v34, v149, v4
    v_dot2c_f32_bf16 v35, v149, v5
    v_dot2c_f32_bf16 v36, v150, v4
    v_dot2c_f32_bf16 v37, v150, v5
    v_dot2c_f32_bf16 v38, v151, v4
    v_dot2c_f32_bf16 v39, v151, v5
    v_dot2c_f32_bf16 v40, v152, v4
    v_dot2c_f32_bf16 v41, v152, v5
    v_dot2c_f32_bf16 v42, v153, v4
    v_dot2c_f32_bf16 v43, v153, v5
    v_dot2c_f32_bf16 v44, v154, v4
    v_dot2c_f32_bf16 v45, v154, v5
    v_dot2c_f32_bf16 v46, v155, v4
    v_dot2c_f32_bf16 v47, v155, v5
    v_dot2c_f32_bf16 v48, v156, v4
    v_dot2c_f32_bf16 v49, v156, v5
L_cb_a7:
    s_mov_b32 s47, s54
    s_or_b32 s46, s46, s54
    s_cmp_eq_u32 s46, 0xff
    s_cbranch_scc0 L_cb_more
    s_cmp_lg_u32 s47, 0
    s_cbranch_scc1 L_cb_last
    s_branch L_cb_done
L_cb_more:
    s_sleep 1
    s_branch L_cb_loop
L_cb_done:
    s_nop 3
    v_mul_f32 v180, s62, v32
    v_mul_f32 v181, s62, v33
    v_mul_f32 v182, s62, v34
    v_mul_f32 v183, s62, v35
    v_mul_f32 v184, s62, v36
    v_mul_f32 v185, s62, v37
    v_mul_f32 v186, s62, v38
    v_mul_f32 v187, s62, v39
    v_mul_f32 v188, s62, v40
    v_mul_f32 v189, s62, v41
    v_mul_f32 v190, s62, v42
    v_mul_f32 v191, s62, v43
    v_mul_f32 v192, s62, v44
    v_mul_f32 v193, s62, v45
    v_mul_f32 v194, s62, v46
    v_mul_f32 v195, s62, v47
    v_mul_f32 v196, s62, v48
    v_mul_f32 v197, s62, v49
    v_exp_f32 v180, v180
    v_exp_f32 v181, v181
    v_exp_f32 v182, v182
    v_exp_f32 v183, v183
    v_exp_f32 v184, v184
    v_exp_f32 v185, v185
    v_exp_f32 v186, v186
    v_exp_f32 v187, v187
    v_exp_f32 v188, v188
    v_exp_f32 v189, v189
    v_exp_f32 v190, v190
    v_exp_f32 v191, v191
    v_exp_f32 v192, v192
    v_exp_f32 v193, v193
    v_exp_f32 v194, v194
    v_exp_f32 v195, v195
    v_exp_f32 v196, v196
    v_exp_f32 v197, v197
    v_fma_f32 v180, v180, s51, s51
    v_fma_f32 v181, v181, s51, s51
    v_fma_f32 v182, v182, s51, s51
    v_fma_f32 v183, v183, s51, s51
    v_fma_f32 v184, v184, s51, s51
    v_fma_f32 v185, v185, s51, s51
    v_fma_f32 v186, v186, s51, s51
    v_fma_f32 v187, v187, s51, s51
    v_fma_f32 v188, v188, s51, s51
    v_fma_f32 v189, v189, s51, s51
    v_fma_f32 v190, v190, s51, s51
    v_fma_f32 v191, v191, s51, s51
    v_fma_f32 v192, v192, s51, s51
    v_fma_f32 v193, v193, s51, s51
    v_fma_f32 v194, v194, s51, s51
    v_fma_f32 v195, v195, s51, s51
    v_fma_f32 v196, v196, s51, s51
    v_fma_f32 v197, v197, s51, s51
    v_rcp_f32 v180, v180
    v_rcp_f32 v181, v181
    v_rcp_f32 v182, v182
    v_rcp_f32 v183, v183
    v_rcp_f32 v184, v184
    v_rcp_f32 v185, v185
    v_rcp_f32 v186, v186
    v_rcp_f32 v187, v187
    v_rcp_f32 v188, v188
    v_rcp_f32 v189, v189
    v_rcp_f32 v190, v190
    v_rcp_f32 v191, v191
    v_rcp_f32 v192, v192
    v_rcp_f32 v193, v193
    v_rcp_f32 v194, v194
    v_rcp_f32 v195, v195
    v_rcp_f32 v196, v196
    v_rcp_f32 v197, v197
    v_mul_f32 v32, v32, v208
    v_mul_f32 v33, v33, v209
    v_mul_f32 v34, v34, v210
    v_mul_f32 v35, v35, v211
    v_mul_f32 v36, v36, v212
    v_mul_f32 v37, v37, v213
    v_mul_f32 v38, v38, v214
    v_mul_f32 v39, v39, v215
    v_mul_f32 v40, v40, v216
    v_mul_f32 v41, v41, v217
    v_mul_f32 v42, v42, v218
    v_mul_f32 v43, v43, v219
    v_mul_f32 v44, v44, v220
    v_mul_f32 v45, v45, v221
    v_mul_f32 v46, v46, v222
    v_mul_f32 v47, v47, v223
    v_mul_f32 v48, v48, v224
    v_mul_f32 v49, v49, v225
    v_fma_f32 v32, v32, v180, v232
    v_fma_f32 v33, v33, v181, v233
    v_cvt_pk_bf16_f32 v8, v32, v33
    v_fma_f32 v34, v34, v182, v234
    v_fma_f32 v35, v35, v183, v235
    v_cvt_pk_bf16_f32 v9, v34, v35
    buffer_store_dwordx2 v[8:9], v2, s[68:71], s60 offen offset:0
    v_fma_f32 v36, v36, v184, v236
    v_fma_f32 v37, v37, v185, v237
    v_cvt_pk_bf16_f32 v10, v36, v37
    v_fma_f32 v38, v38, v186, v238
    v_fma_f32 v39, v39, v187, v239
    v_cvt_pk_bf16_f32 v11, v38, v39
    buffer_store_dwordx2 v[10:11], v2, s[68:71], s61 offen offset:0
    v_fma_f32 v40, v40, v188, v240
    v_fma_f32 v41, v41, v189, v241
    v_cvt_pk_bf16_f32 v12, v40, v41
    v_fma_f32 v42, v42, v190, v242
    v_fma_f32 v43, v43, v191, v243
    v_cvt_pk_bf16_f32 v13, v42, v43
    buffer_store_dwordx2 v[12:13], v2, s[68:71], s60 offen offset:128
    v_fma_f32 v44, v44, v192, v244
    v_fma_f32 v45, v45, v193, v245
    v_cvt_pk_bf16_f32 v14, v44, v45
    v_fma_f32 v46, v46, v194, v246
    v_fma_f32 v47, v47, v195, v247
    v_cvt_pk_bf16_f32 v15, v46, v47
    buffer_store_dwordx2 v[14:15], v2, s[68:71], s61 offen offset:128
    v_fma_f32 v48, v48, v196, v248
    v_fma_f32 v49, v49, v197, v249
    v_cvt_pk_bf16_f32 v16, v48, v49
    buffer_store_dword v16, v2, s[68:71], s63 offen
L_comb_done:
L_at_end:
    s_endpgm
L_at_fallback:
    s_waitcnt vmcnt(0)
    s_mov_b32 s60, 1
    s_mov_b32 s41, s40
    s_mov_b32 s43, 0
    v_mov_b32 v32, 0xff800000
    v_mov_b32 v33, 0xff800000
    v_mov_b32 v34, 0xff800000
    v_mov_b32 v35, 0xff800000
L_at_fb:
    s_barrier
    s_add_u32 m0, s40, 147456
    s_nop 0
    buffer_load_dwordx4 v14, s[20:23], s41 offen offset:0 lds
    buffer_load_dwordx4 v15, s[20:23], s41 offen offset:1024 lds
    buffer_load_dwordx4 v16, s[20:23], s41 offen offset:2048 lds
    buffer_load_dwordx4 v17, s[20:23], s41 offen offset:3072 lds
    s_add_u32 s41, s41, 16384
    s_waitcnt vmcnt(0)
    s_barrier
    ds_read_b128 a[128:131], v2 offset:49152
    ds_read_b128 a[132:135], v3 offset:49152
    ds_read_b128 a[136:139], v4 offset:49152
    ds_read_b128 a[140:143], v5 offset:49152
    ds_read_b128 a[144:147], v2 offset:53248
    ds_read_b128 a[148:151], v3 offset:53248
    ds_read_b128 a[152:155], v4 offset:53248
    ds_read_b128 a[156:159], v5 offset:53248
    ds_read_b128 a[160:163], v2 offset:57344
    ds_read_b128 a[164:167], v3 offset:57344
    ds_read_b128 a[168:171], v4 offset:57344
    ds_read_b128 a[172:175], v5 offset:57344
    ds_read_b128 a[176:179], v2 offset:61440
    ds_read_b128 a[180:183], v3 offset:61440
    ds_read_b128 a[184:187], v4 offset:61440
    ds_read_b128 a[188:191], v5 offset:61440
    s_waitcnt lgkmcnt(15)
    v_mfma_f32_16x16x32_bf16 v[80:83], a[128:131], v[64:67], 0
    s_waitcnt lgkmcnt(14)
    v_mfma_f32_16x16x32_bf16 v[80:83], a[132:135], v[96:99], v[80:83]
    s_waitcnt lgkmcnt(13)
    v_mfma_f32_16x16x32_bf16 v[80:83], a[136:139], v[128:131], v[80:83]
    s_waitcnt lgkmcnt(12)
    v_mfma_f32_16x16x32_bf16 v[80:83], a[140:143], v[160:163], v[80:83]
    v_mfma_f32_16x16x32_bf16 v[84:87], a[128:131], v[68:71], 0
    v_mfma_f32_16x16x32_bf16 v[84:87], a[132:135], v[100:103], v[84:87]
    v_mfma_f32_16x16x32_bf16 v[84:87], a[136:139], v[132:135], v[84:87]
    v_mfma_f32_16x16x32_bf16 v[84:87], a[140:143], v[164:167], v[84:87]
    v_mfma_f32_16x16x32_bf16 v[88:91], a[128:131], v[72:75], 0
    v_mfma_f32_16x16x32_bf16 v[88:91], a[132:135], v[104:107], v[88:91]
    v_mfma_f32_16x16x32_bf16 v[88:91], a[136:139], v[136:139], v[88:91]
    v_mfma_f32_16x16x32_bf16 v[88:91], a[140:143], v[168:171], v[88:91]
    v_mfma_f32_16x16x32_bf16 v[92:95], a[128:131], v[76:79], 0
    v_mfma_f32_16x16x32_bf16 v[92:95], a[132:135], v[108:111], v[92:95]
    v_mfma_f32_16x16x32_bf16 v[92:95], a[136:139], v[140:143], v[92:95]
    v_mfma_f32_16x16x32_bf16 v[92:95], a[140:143], v[172:175], v[92:95]
    s_waitcnt lgkmcnt(11)
    v_mfma_f32_16x16x32_bf16 v[112:115], a[144:147], v[64:67], 0
    s_waitcnt lgkmcnt(10)
    v_mfma_f32_16x16x32_bf16 v[112:115], a[148:151], v[96:99], v[112:115]
    s_waitcnt lgkmcnt(9)
    v_mfma_f32_16x16x32_bf16 v[112:115], a[152:155], v[128:131], v[112:115]
    s_waitcnt lgkmcnt(8)
    v_mfma_f32_16x16x32_bf16 v[112:115], a[156:159], v[160:163], v[112:115]
    v_mfma_f32_16x16x32_bf16 v[116:119], a[144:147], v[68:71], 0
    v_mfma_f32_16x16x32_bf16 v[116:119], a[148:151], v[100:103], v[116:119]
    v_mfma_f32_16x16x32_bf16 v[116:119], a[152:155], v[132:135], v[116:119]
    v_mfma_f32_16x16x32_bf16 v[116:119], a[156:159], v[164:167], v[116:119]
    v_mfma_f32_16x16x32_bf16 v[120:123], a[144:147], v[72:75], 0
    v_mfma_f32_16x16x32_bf16 v[120:123], a[148:151], v[104:107], v[120:123]
    v_mfma_f32_16x16x32_bf16 v[120:123], a[152:155], v[136:139], v[120:123]
    v_mfma_f32_16x16x32_bf16 v[120:123], a[156:159], v[168:171], v[120:123]
    v_mfma_f32_16x16x32_bf16 v[124:127], a[144:147], v[76:79], 0
    v_mfma_f32_16x16x32_bf16 v[124:127], a[148:151], v[108:111], v[124:127]
    v_mfma_f32_16x16x32_bf16 v[124:127], a[152:155], v[140:143], v[124:127]
    v_mfma_f32_16x16x32_bf16 v[124:127], a[156:159], v[172:175], v[124:127]
    s_waitcnt lgkmcnt(7)
    v_mfma_f32_16x16x32_bf16 v[144:147], a[160:163], v[64:67], 0
    s_waitcnt lgkmcnt(6)
    v_mfma_f32_16x16x32_bf16 v[144:147], a[164:167], v[96:99], v[144:147]
    s_waitcnt lgkmcnt(5)
    v_mfma_f32_16x16x32_bf16 v[144:147], a[168:171], v[128:131], v[144:147]
    s_waitcnt lgkmcnt(4)
    v_mfma_f32_16x16x32_bf16 v[144:147], a[172:175], v[160:163], v[144:147]
    v_mfma_f32_16x16x32_bf16 v[148:151], a[160:163], v[68:71], 0
    v_mfma_f32_16x16x32_bf16 v[148:151], a[164:167], v[100:103], v[148:151]
    v_mfma_f32_16x16x32_bf16 v[148:151], a[168:171], v[132:135], v[148:151]
    v_mfma_f32_16x16x32_bf16 v[148:151], a[172:175], v[164:167], v[148:151]
    v_mfma_f32_16x16x32_bf16 v[152:155], a[160:163], v[72:75], 0
    v_mfma_f32_16x16x32_bf16 v[152:155], a[164:167], v[104:107], v[152:155]
    v_mfma_f32_16x16x32_bf16 v[152:155], a[168:171], v[136:139], v[152:155]
    v_mfma_f32_16x16x32_bf16 v[152:155], a[172:175], v[168:171], v[152:155]
    v_mfma_f32_16x16x32_bf16 v[156:159], a[160:163], v[76:79], 0
    v_mfma_f32_16x16x32_bf16 v[156:159], a[164:167], v[108:111], v[156:159]
    v_mfma_f32_16x16x32_bf16 v[156:159], a[168:171], v[140:143], v[156:159]
    v_mfma_f32_16x16x32_bf16 v[156:159], a[172:175], v[172:175], v[156:159]
    s_waitcnt lgkmcnt(3)
    v_mfma_f32_16x16x32_bf16 v[176:179], a[176:179], v[64:67], 0
    s_waitcnt lgkmcnt(2)
    v_mfma_f32_16x16x32_bf16 v[176:179], a[180:183], v[96:99], v[176:179]
    s_waitcnt lgkmcnt(1)
    v_mfma_f32_16x16x32_bf16 v[176:179], a[184:187], v[128:131], v[176:179]
    s_waitcnt lgkmcnt(0)
    v_mfma_f32_16x16x32_bf16 v[176:179], a[188:191], v[160:163], v[176:179]
    v_mfma_f32_16x16x32_bf16 v[180:183], a[176:179], v[68:71], 0
    v_mfma_f32_16x16x32_bf16 v[180:183], a[180:183], v[100:103], v[180:183]
    v_mfma_f32_16x16x32_bf16 v[180:183], a[184:187], v[132:135], v[180:183]
    v_mfma_f32_16x16x32_bf16 v[180:183], a[188:191], v[164:167], v[180:183]
    v_mfma_f32_16x16x32_bf16 v[184:187], a[176:179], v[72:75], 0
    v_mfma_f32_16x16x32_bf16 v[184:187], a[180:183], v[104:107], v[184:187]
    v_mfma_f32_16x16x32_bf16 v[184:187], a[184:187], v[136:139], v[184:187]
    v_mfma_f32_16x16x32_bf16 v[184:187], a[188:191], v[168:171], v[184:187]
    v_mfma_f32_16x16x32_bf16 v[188:191], a[176:179], v[76:79], 0
    v_mfma_f32_16x16x32_bf16 v[188:191], a[180:183], v[108:111], v[188:191]
    v_mfma_f32_16x16x32_bf16 v[188:191], a[184:187], v[140:143], v[188:191]
    v_mfma_f32_16x16x32_bf16 v[188:191], a[188:191], v[172:175], v[188:191]
    v_max3_f32 v32, v32, v80, v81
    v_max3_f32 v32, v32, v82, v83
    v_max3_f32 v33, v33, v84, v85
    v_max3_f32 v33, v33, v86, v87
    v_max3_f32 v34, v34, v88, v89
    v_max3_f32 v34, v34, v90, v91
    v_max3_f32 v35, v35, v92, v93
    v_max3_f32 v35, v35, v94, v95
    v_max3_f32 v32, v32, v112, v113
    v_max3_f32 v32, v32, v114, v115
    v_max3_f32 v33, v33, v116, v117
    v_max3_f32 v33, v33, v118, v119
    v_max3_f32 v34, v34, v120, v121
    v_max3_f32 v34, v34, v122, v123
    v_max3_f32 v35, v35, v124, v125
    v_max3_f32 v35, v35, v126, v127
    v_max3_f32 v32, v32, v144, v145
    v_max3_f32 v32, v32, v146, v147
    v_max3_f32 v33, v33, v148, v149
    v_max3_f32 v33, v33, v150, v151
    v_max3_f32 v34, v34, v152, v153
    v_max3_f32 v34, v34, v154, v155
    v_max3_f32 v35, v35, v156, v157
    v_max3_f32 v35, v35, v158, v159
    v_max3_f32 v32, v32, v176, v177
    v_max3_f32 v32, v32, v178, v179
    v_max3_f32 v33, v33, v180, v181
    v_max3_f32 v33, v33, v182, v183
    v_max3_f32 v34, v34, v184, v185
    v_max3_f32 v34, v34, v186, v187
    v_max3_f32 v35, v35, v188, v189
    v_max3_f32 v35, v35, v190, v191
    s_add_u32 s43, s43, 1
    s_cmp_lt_u32 s43, 32
    s_cbranch_scc1 L_at_fb
    s_barrier
    s_add_u32 m0, s40, 147456
    s_nop 0
    buffer_load_dwordx4 v14, s[20:23], s40 offen offset:0 lds
    buffer_load_dwordx4 v15, s[20:23], s40 offen offset:1024 lds
    buffer_load_dwordx4 v16, s[20:23], s40 offen offset:2048 lds
    buffer_load_dwordx4 v17, s[20:23], s40 offen offset:3072 lds
    s_add_u32 s52, s40, 16384
    s_add_u32 m0, s40, 131072
    s_nop 0
    buffer_load_dwordx4 v14, s[20:23], s52 offen offset:0 lds
    buffer_load_dwordx4 v15, s[20:23], s52 offen offset:1024 lds
    buffer_load_dwordx4 v16, s[20:23], s52 offen offset:2048 lds
    buffer_load_dwordx4 v17, s[20:23], s52 offen offset:3072 lds
    s_add_u32 s52, s40, 0
    s_add_u32 m0, s40, 81920
    s_nop 0
    buffer_load_dwordx4 v18, s[24:27], s52 offen offset:0 lds
    buffer_load_dwordx4 v19, s[24:27], s52 offen offset:1024 lds
    buffer_load_dwordx4 v18, s[24:27], s52 offen offset:2048 lds
    buffer_load_dwordx4 v19, s[24:27], s52 offen offset:3072 lds
    s_add_u32 s52, s40, 32768
    s_add_u32 m0, s40, 114688
    s_nop 0
    buffer_load_dwordx4 v14, s[20:23], s52 offen offset:0 lds
    buffer_load_dwordx4 v15, s[20:23], s52 offen offset:1024 lds
    buffer_load_dwordx4 v16, s[20:23], s52 offen offset:2048 lds
    buffer_load_dwordx4 v17, s[20:23], s52 offen offset:3072 lds
    s_add_u32 s52, s40, 16384
    s_add_u32 m0, s40, 65536
    s_nop 0
    buffer_load_dwordx4 v18, s[24:27], s52 offen offset:0 lds
    buffer_load_dwordx4 v19, s[24:27], s52 offen offset:1024 lds
    buffer_load_dwordx4 v18, s[24:27], s52 offen offset:2048 lds
    buffer_load_dwordx4 v19, s[24:27], s52 offen offset:3072 lds
    s_add_u32 s52, s40, 49152
    s_add_u32 m0, s40, 98304
    s_nop 0
    buffer_load_dwordx4 v14, s[20:23], s52 offen offset:0 lds
    buffer_load_dwordx4 v15, s[20:23], s52 offen offset:1024 lds
    buffer_load_dwordx4 v16, s[20:23], s52 offen offset:2048 lds
    buffer_load_dwordx4 v17, s[20:23], s52 offen offset:3072 lds
    s_add_u32 s52, s40, 32768
    s_add_u32 m0, s40, 49152
    s_nop 0
    buffer_load_dwordx4 v18, s[24:27], s52 offen offset:0 lds
    buffer_load_dwordx4 v19, s[24:27], s52 offen offset:1024 lds
    buffer_load_dwordx4 v18, s[24:27], s52 offen offset:2048 lds
    buffer_load_dwordx4 v19, s[24:27], s52 offen offset:3072 lds
    s_add_u32 s41, s40, 65536
    s_add_u32 s42, s40, 49152
    v_accvgpr_write_b32 a0, 0
    v_accvgpr_write_b32 a1, 0
    v_accvgpr_write_b32 a2, 0
    v_accvgpr_write_b32 a3, 0
    v_accvgpr_write_b32 a4, 0
    v_accvgpr_write_b32 a5, 0
    v_accvgpr_write_b32 a6, 0
    v_accvgpr_write_b32 a7, 0
    v_accvgpr_write_b32 a8, 0
    v_accvgpr_write_b32 a9, 0
    v_accvgpr_write_b32 a10, 0
    v_accvgpr_write_b32 a11, 0
    v_accvgpr_write_b32 a12, 0
    v_accvgpr_write_b32 a13, 0
    v_accvgpr_write_b32 a14, 0
    v_accvgpr_write_b32 a15, 0
    v_accvgpr_write_b32 a16, 0
    v_accvgpr_write_b32 a17, 0
    v_accvgpr_write_b32 a18, 0
    v_accvgpr_write_b32 a19, 0
    v_accvgpr_write_b32 a20, 0
    v_accvgpr_write_b32 a21, 0
    v_accvgpr_write_b32 a22, 0
    v_accvgpr_write_b32 a23, 0
    v_accvgpr_write_b32 a24, 0
    v_accvgpr_write_b32 a25, 0
    v_accvgpr_write_b32 a26, 0
    v_accvgpr_write_b32 a27, 0
    v_accvgpr_write_b32 a28, 0
    v_accvgpr_write_b32 a29, 0
    v_accvgpr_write_b32 a30, 0
    v_accvgpr_write_b32 a31, 0
    v_accvgpr_write_b32 a32, 0
    v_accvgpr_write_b32 a33, 0
    v_accvgpr_write_b32 a34, 0
    v_accvgpr_write_b32 a35, 0
    v_accvgpr_write_b32 a36, 0
    v_accvgpr_write_b32 a37, 0
    v_accvgpr_write_b32 a38, 0
    v_accvgpr_write_b32 a39, 0
    v_accvgpr_write_b32 a40, 0
    v_accvgpr_write_b32 a41, 0
    v_accvgpr_write_b32 a42, 0
    v_accvgpr_write_b32 a43, 0
    v_accvgpr_write_b32 a44, 0
    v_accvgpr_write_b32 a45, 0
    v_accvgpr_write_b32 a46, 0
    v_accvgpr_write_b32 a47, 0
    v_accvgpr_write_b32 a48, 0
    v_accvgpr_write_b32 a49, 0
    v_accvgpr_write_b32 a50, 0
    v_accvgpr_write_b32 a51, 0
    v_accvgpr_write_b32 a52, 0
    v_accvgpr_write_b32 a53, 0
    v_accvgpr_write_b32 a54, 0
    v_accvgpr_write_b32 a55, 0
    v_accvgpr_write_b32 a56, 0
    v_accvgpr_write_b32 a57, 0
    v_accvgpr_write_b32 a58, 0
    v_accvgpr_write_b32 a59, 0
    v_accvgpr_write_b32 a60, 0
    v_accvgpr_write_b32 a61, 0
    v_accvgpr_write_b32 a62, 0
    v_accvgpr_write_b32 a63, 0
    v_accvgpr_write_b32 a64, 0
    v_accvgpr_write_b32 a65, 0
    v_accvgpr_write_b32 a66, 0
    v_accvgpr_write_b32 a67, 0
    v_accvgpr_write_b32 a68, 0
    v_accvgpr_write_b32 a69, 0
    v_accvgpr_write_b32 a70, 0
    v_accvgpr_write_b32 a71, 0
    v_accvgpr_write_b32 a72, 0
    v_accvgpr_write_b32 a73, 0
    v_accvgpr_write_b32 a74, 0
    v_accvgpr_write_b32 a75, 0
    v_accvgpr_write_b32 a76, 0
    v_accvgpr_write_b32 a77, 0
    v_accvgpr_write_b32 a78, 0
    v_accvgpr_write_b32 a79, 0
    v_accvgpr_write_b32 a80, 0
    v_accvgpr_write_b32 a81, 0
    v_accvgpr_write_b32 a82, 0
    v_accvgpr_write_b32 a83, 0
    v_accvgpr_write_b32 a84, 0
    v_accvgpr_write_b32 a85, 0
    v_accvgpr_write_b32 a86, 0
    v_accvgpr_write_b32 a87, 0
    v_accvgpr_write_b32 a88, 0
    v_accvgpr_write_b32 a89, 0
    v_accvgpr_write_b32 a90, 0
    v_accvgpr_write_b32 a91, 0
    v_accvgpr_write_b32 a92, 0
    v_accvgpr_write_b32 a93, 0
    v_accvgpr_write_b32 a94, 0
    v_accvgpr_write_b32 a95, 0
    v_accvgpr_write_b32 a96, 0
    v_accvgpr_write_b32 a97, 0
    v_accvgpr_write_b32 a98, 0
    v_accvgpr_write_b32 a99, 0
    v_accvgpr_write_b32 a100, 0
    v_accvgpr_write_b32 a101, 0
    v_accvgpr_write_b32 a102, 0
    v_accvgpr_write_b32 a103, 0
    v_accvgpr_write_b32 a104, 0
    v_accvgpr_write_b32 a105, 0
    v_accvgpr_write_b32 a106, 0
    v_accvgpr_write_b32 a107, 0
    v_accvgpr_write_b32 a108, 0
    v_accvgpr_write_b32 a109, 0
    v_accvgpr_write_b32 a110, 0
    v_accvgpr_write_b32 a111, 0
    v_accvgpr_write_b32 a112, 0
    v_accvgpr_write_b32 a113, 0
    v_accvgpr_write_b32 a114, 0
    v_accvgpr_write_b32 a115, 0
    v_accvgpr_write_b32 a116, 0
    v_accvgpr_write_b32 a117, 0
    v_accvgpr_write_b32 a118, 0
    v_accvgpr_write_b32 a119, 0
    v_accvgpr_write_b32 a120, 0
    v_accvgpr_write_b32 a121, 0
    v_accvgpr_write_b32 a122, 0
    v_accvgpr_write_b32 a123, 0
    v_accvgpr_write_b32 a124, 0
    v_accvgpr_write_b32 a125, 0
    v_accvgpr_write_b32 a126, 0
    v_accvgpr_write_b32 a127, 0
    v_mov_b32 v240, 0
    v_mov_b32 v241, 0
    v_mov_b32 v242, 0
    v_mov_b32 v243, 0
    s_waitcnt vmcnt(0)
    s_barrier
    ds_read_b128 a[128:131], v2 offset:49152
    ds_read_b128 a[132:135], v3 offset:49152
    ds_read_b128 a[136:139], v4 offset:49152
    ds_read_b128 a[140:143], v5 offset:49152
    ds_read_b128 a[144:147], v2 offset:53248
    ds_read_b128 a[148:151], v3 offset:53248
    ds_read_b128 a[152:155], v4 offset:53248
    ds_read_b128 a[156:159], v5 offset:53248
    ds_read_b128 a[160:163], v2 offset:57344
    ds_read_b128 a[164:167], v3 offset:57344
    ds_read_b128 a[168:171], v4 offset:57344
    ds_read_b128 a[172:175], v5 offset:57344
    ds_read_b128 a[176:179], v2 offset:61440
    ds_read_b128 a[180:183], v3 offset:61440
    ds_read_b128 a[184:187], v4 offset:61440
    ds_read_b128 a[188:191], v5 offset:61440
    s_waitcnt lgkmcnt(0)
    s_branch L_at_negm
L_at_codeend:
.section .rodata,"a"
.p2align 6
.amdhsa_kernel recurrent_scan__mha_block_cached__glu_gated_bilinear__prompt_kernel
  .amdhsa_next_free_vgpr 512
  .amdhsa_next_free_sgpr 102
  .amdhsa_accum_offset 256
  .amdhsa_group_segment_fixed_size 0
  .amdhsa_kernarg_size 96
  .amdhsa_user_sgpr_count 2
  .amdhsa_user_sgpr_kernarg_segment_ptr 1
  .amdhsa_system_sgpr_workgroup_id_x 1
.end_amdhsa_kernel
```
